```python
import torch

def _softmax(x, axis=-1):
    return torch.softmax(x, dim=axis)

def _gelu(x):
    return torch.nn.functional.gelu(x, approximate='tanh')

def _silu(x):
    return torch.nn.functional.silu(x)

def _sigmoid(x):
    return torch.sigmoid(x)

def _layernorm(x, axis=-1, eps=1e-05):
    m = x.mean(dim=axis, keepdim=True)
    v = x.var(dim=axis, keepdim=True, unbiased=False)
    return (x - m) / torch.sqrt(v + eps)

def _scatter_add(tgt, idx, src, axis=0):
    return tgt.clone().index_add_(axis, idx, src)

def _segment_sum(src, seg, n):
    out = torch.zeros((n,) + src.shape[1:], dtype=src.dtype)
    return out.index_add_(0, seg, src)

def _pad(x, pw):
    flat = tuple((v for pair in reversed(pw) for v in pair))
    return torch.nn.functional.pad(x, flat)
kernel_name = 'adaLN_cond__memory_aug_recurrent_mem_tr__geglu_ffn__prompt'

def setup_inputs():

    _w = lambda a: (lambda t: t.to(torch.bfloat16) if t.is_floating_point() else t)(torch.as_tensor(a))

    def _A_setup():
        B, S, Dm = (1, 2048, 576)
        H, Dh = (32, 128)
        M, seg = (8, 32)
        seg = min(seg, S)
        S = S // seg * seg
        return {'x': _w((lambda *s: torch.randn(*s, dtype=torch.bfloat16) * 0.05)(B, S, Dm)), 'mem0': _w((lambda *s: torch.randn(*s, dtype=torch.bfloat16) * 0.4)(B, M, Dm)), 'Wq': _w((lambda *s: torch.randn(*s, dtype=torch.bfloat16) * 3.2)(Dm, H, Dh) * Dm ** (-0.5)), 'Wk': _w((lambda *s: torch.randn(*s, dtype=torch.bfloat16) * 3.2)(Dm, H, Dh) * Dm ** (-0.5)), 'Wv': _w((lambda *s: torch.randn(*s, dtype=torch.bfloat16) * 0.4)(Dm, H, Dh) * Dm ** (-0.5)), 'Wo': _w((lambda *s: torch.randn(*s, dtype=torch.bfloat16) * 0.4)(H, Dh, Dm) * (H * Dh) ** (-0.5)), 'seg_len': seg}
    _A_in = _A_setup()

    def _B_setup():
        B, S, D, F = (1, 2048, 576, 4608)
        return {'x': _w((lambda *s: torch.randn(*s, dtype=torch.bfloat16) * 0.05)(B, S, D)), 'w_gate': _w((lambda *s: torch.randn(*s, dtype=torch.bfloat16) * 0.05)(D, F)), 'w_up': _w((lambda *s: torch.randn(*s, dtype=torch.bfloat16) * 0.05)(D, F)), 'w_down': _w((lambda *s: torch.randn(*s, dtype=torch.bfloat16) * 0.05)(F, D))}
    _B_in = _B_setup()
    return {'A_x': _A_in['x'], 'A_mem0': _A_in['mem0'], 'A_Wq': _A_in['Wq'], 'A_Wk': _A_in['Wk'], 'A_Wv': _A_in['Wv'], 'A_Wo': _A_in['Wo'], 'A_seg_len': _A_in['seg_len'], 'B_x': _B_in['x'], 'B_w_gate': _B_in['w_gate'], 'B_w_up': _B_in['w_up'], 'B_w_down': _B_in['w_down'], 'c': _w((lambda *s: torch.randn(*s, dtype=torch.bfloat16) * 0.1)(1, 576) * 8.0), 'w_mod': _w((lambda *s: torch.randn(*s, dtype=torch.bfloat16) * 0.1)(576, 6 * 576) * 576 ** (-0.5) * 8.0)}

def reference(A_x, A_mem0, A_Wq, A_Wk, A_Wv, A_Wo, A_seg_len, B_x, B_w_gate, B_w_up, B_w_down, c, w_mod):

    def _A_ref(x, mem0, Wq, Wk, Wv, Wo, seg_len):
        B, S, Dm = x.shape
        H, Dh = (Wq.shape[1], Wq.shape[2])
        M = mem0.shape[1]
        scale = Dh ** (-0.5)
        n_seg = S // seg_len
        L = M + seg_len
        idx = torch.arange(L)
        mask = (idx[:, None] < M) | (idx[:, None] >= idx[None, :])
        mem = mem0
        outs = []
        for s in range(n_seg):
            xs = x[:, s * seg_len:(s + 1) * seg_len, :].clone()
            h = torch.concatenate([mem, xs], axis=1)
            q = torch.einsum('btd,dhe->bhte', h, Wq)
            k = torch.einsum('btd,dhe->bhte', h, Wk)
            v = torch.einsum('btd,dhe->bhte', h, Wv)
            scores = torch.einsum('bhqe,bhke->bhqk', q, k) * scale
            scores = torch.where(mask[None, None], scores, -1000000000.0)
            p = _softmax(scores, axis=-1)
            o = torch.einsum('bhqk,bhke->bhqe', p, v)
            o = torch.einsum('bhte,hed->btd', o, Wo)
            mem = o[:, :M, :].clone()
            outs.append(o[:, M:, :])
        return torch.concatenate(outs, axis=1)

    def _B_ref(x, w_gate, w_up, w_down):
        return _gelu(x @ w_gate) * (x @ w_up) @ w_down
    x = A_x
    mod = (_silu(c) @ w_mod).reshape(c.shape[0], 6, 1, -1)
    sa, ca, ga, sb, cb, gb = (mod[:, 0].clone(), mod[:, 1].clone(), mod[:, 2].clone(), mod[:, 3].clone(), mod[:, 4].clone(), mod[:, 5].clone())
    h = _layernorm(x, axis=-1) * (1 + ca) + sa
    x = x + ga * _A_ref(h, A_mem0, A_Wq, A_Wk, A_Wv, A_Wo, A_seg_len)
    h = _layernorm(x, axis=-1) * (1 + cb) + sb
    x = x + gb * _B_ref(h, B_w_gate, B_w_up, B_w_down)
    return x
```

```asm
; @launch kernel=zero_kernel grid=(1,1,1) block=(256,1,1) lds=0
; @launch kernel=mega_kernel grid=(256,1,1) block=(256,1,1) lds=163840
.amdgcn_target "amdgcn-amd-amdhsa--gfx950"
.text
.globl zero_kernel
.p2align 8
.type zero_kernel,@function
zero_kernel:
 s_cmp_ge_u32 s2, 1
 s_cbranch_scc1 zero_kernel_end1
 s_load_dwordx2 s[8:9], s[0:1], 120
 s_waitcnt lgkmcnt(0)
 s_add_u32 s12, s8, 264241152
 s_addc_u32 s13, s9, 0
 s_and_b32 s13, s13, 0xffff
 s_mov_b32 s14, 12288
 s_mov_b32 s15, 0x00020000
 v_lshlrev_b32 v1, 6, v0
 v_mov_b32 v4, 0
 v_mov_b32 v5, 0
 v_mov_b32 v6, 0
 v_mov_b32 v7, 0
 buffer_store_dwordx4 v[4:7], v1, s[12:15], 0 offen offset:0
 buffer_store_dwordx4 v[4:7], v1, s[12:15], 0 offen offset:16
 buffer_store_dwordx4 v[4:7], v1, s[12:15], 0 offen offset:32
 buffer_store_dwordx4 v[4:7], v1, s[12:15], 0 offen offset:48
zero_kernel_end1:
    s_endpgm
.globl mega_kernel
.p2align 8
.type mega_kernel,@function
mega_kernel:
 s_cmp_ge_u32 s2, 256
 s_cbranch_scc1 mega_kernel_end1
 s_load_dwordx4 s[4:7], s[0:1], 16
 s_load_dwordx4 s[8:11], s[0:1], 32
 s_load_dwordx2 s[12:13], s[0:1], 120
 s_load_dwordx2 s[90:91], s[0:1], 112
 v_and_b32 v1, 63, v0
 v_lshrrev_b32 v2, 6, v0
 s_nop 0
 v_readfirstlane_b32 s14, v2
 s_waitcnt lgkmcnt(0)
 s_mov_b32 s96, s90
 s_and_b32 s97, s91, 0xffff
 s_mov_b32 s98, 256
 s_mov_b32 s99, 0x00020000
 s_mov_b32 s93, s14
 s_mov_b32 s101, 0
 s_getreg_b32 s40, hwreg(HW_REG_XCC_ID)
 s_and_b32 s40, s40, 15
 s_cmp_lg_u32 s40, 0
 s_cbranch_scc1 mega_kernel_loop2
mega_kernel_rec3:
 s_barrier
 s_cmp_lg_u32 s93, 0
 s_cbranch_scc1 mega_kernel_w4
 s_mov_b64 exec, 1
 v_mov_b32 v2, 1
 buffer_atomic_add v2, off, s[96:99], 0 offset:0 sc0 sc1
 v_mov_b32 v3, 163824
 s_waitcnt vmcnt(0)
 ds_write_b32 v3, v2
 s_waitcnt lgkmcnt(0)
 s_mov_b64 exec, -1
mega_kernel_w4:
 s_barrier
 v_mov_b32 v3, 163824
 ds_read_b32 v2, v3
 s_waitcnt lgkmcnt(0)
 v_readfirstlane_b32 s94, v2
 s_nop 3
 s_cmp_ge_u32 s94, 32
 s_cbranch_scc1 mega_kernel_loop2
 s_load_dwordx4 s[4:7], s[0:1], 16
 s_load_dwordx4 s[8:11], s[0:1], 32
 s_load_dwordx2 s[12:13], s[0:1], 120
 v_and_b32 v1, 63, v0
 s_mov_b32 s14, s93
 s_waitcnt lgkmcnt(0)
 s_add_u32 s16, s12, 117440512
 s_addc_u32 s17, s13, 0
 s_and_b32 s17, s17, 0xffff
 s_mov_b32 s18, 2359296
 s_mov_b32 s19, 0x00020000
 s_add_u32 s20, s12, 119799808
 s_addc_u32 s21, s13, 0
 s_and_b32 s21, s21, 0xffff
 s_mov_b32 s22, 271360
 s_mov_b32 s23, 0x00020000
 s_add_u32 s24, s12, 4194304
 s_addc_u32 s25, s13, 0
 s_and_b32 s25, s25, 0xffff
 s_mov_b32 s26, 50331648
 s_mov_b32 s27, 0x00020000
 s_add_u32 s28, s12, 58720256
 s_addc_u32 s29, s13, 0
 s_and_b32 s29, s29, 0xffff
 s_mov_b32 s30, 8388608
 s_mov_b32 s31, 0x00020000
 v_lshrrev_b32 v3, 4, v1
 v_and_b32 v4, 15, v1
 s_lshl_b32 s15, s94, 8
 v_lshlrev_b32 v5, 13, v3
 v_lshl_add_u32 v5, v4, 4, v5
 v_lshrrev_b32 v6, 2, v4
 v_and_b32 v7, 1, v3
 v_lshl_add_u32 v6, v7, 2, v6
 v_lshrrev_b32 v7, 1, v3
 v_lshl_add_u32 v6, v7, 4, v6
 v_lshlrev_b32 v6, 8, v6
 v_and_b32 v7, 3, v1
 v_lshl_add_u32 v6, v7, 3, v6
 s_mul_i32 s32, s14, 36
 s_mov_b32 s36, s4
 s_and_b32 s37, s5, 0xffff
 s_mov_b32 s38, 4718592
 s_mov_b32 s39, 0x00020000
 s_barrier
 s_mul_i32 s33, s32, 32768
 s_add_u32 s33, s33, s15
 s_lshl_b32 s34, s32, 10
 s_add_u32 s35, s33, 0
 s_add_u32 m0, s34, 0
 s_nop 0
 buffer_load_dwordx4 v5, s[36:39], s35 offen lds
 s_add_u32 s35, s33, 32768
 s_add_u32 m0, s34, 1024
 s_nop 0
 buffer_load_dwordx4 v5, s[36:39], s35 offen lds
 s_add_u32 s35, s33, 65536
 s_add_u32 m0, s34, 2048
 s_nop 0
 buffer_load_dwordx4 v5, s[36:39], s35 offen lds
 s_add_u32 s35, s33, 98304
 s_add_u32 m0, s34, 3072
 s_nop 0
 buffer_load_dwordx4 v5, s[36:39], s35 offen lds
 s_add_u32 s35, s33, 131072
 s_add_u32 m0, s34, 4096
 s_nop 0
 buffer_load_dwordx4 v5, s[36:39], s35 offen lds
 s_add_u32 s35, s33, 163840
 s_add_u32 m0, s34, 5120
 s_nop 0
 buffer_load_dwordx4 v5, s[36:39], s35 offen lds
 s_add_u32 s35, s33, 196608
 s_add_u32 m0, s34, 6144
 s_nop 0
 buffer_load_dwordx4 v5, s[36:39], s35 offen lds
 s_add_u32 s35, s33, 229376
 s_add_u32 m0, s34, 7168
 s_nop 0
 buffer_load_dwordx4 v5, s[36:39], s35 offen lds
 s_add_u32 s35, s33, 262144
 s_add_u32 m0, s34, 8192
 s_nop 0
 buffer_load_dwordx4 v5, s[36:39], s35 offen lds
 s_add_u32 s35, s33, 294912
 s_add_u32 m0, s34, 9216
 s_nop 0
 buffer_load_dwordx4 v5, s[36:39], s35 offen lds
 s_add_u32 s35, s33, 327680
 s_add_u32 m0, s34, 10240
 s_nop 0
 buffer_load_dwordx4 v5, s[36:39], s35 offen lds
 s_add_u32 s35, s33, 360448
 s_add_u32 m0, s34, 11264
 s_nop 0
 buffer_load_dwordx4 v5, s[36:39], s35 offen lds
 s_add_u32 s35, s33, 393216
 s_add_u32 m0, s34, 12288
 s_nop 0
 buffer_load_dwordx4 v5, s[36:39], s35 offen lds
 s_add_u32 s35, s33, 425984
 s_add_u32 m0, s34, 13312
 s_nop 0
 buffer_load_dwordx4 v5, s[36:39], s35 offen lds
 s_add_u32 s35, s33, 458752
 s_add_u32 m0, s34, 14336
 s_nop 0
 buffer_load_dwordx4 v5, s[36:39], s35 offen lds
 s_add_u32 s35, s33, 491520
 s_add_u32 m0, s34, 15360
 s_nop 0
 buffer_load_dwordx4 v5, s[36:39], s35 offen lds
 s_add_u32 s35, s33, 524288
 s_add_u32 m0, s34, 16384
 s_nop 0
 buffer_load_dwordx4 v5, s[36:39], s35 offen lds
 s_add_u32 s35, s33, 557056
 s_add_u32 m0, s34, 17408
 s_nop 0
 buffer_load_dwordx4 v5, s[36:39], s35 offen lds
 s_add_u32 s35, s33, 589824
 s_add_u32 m0, s34, 18432
 s_nop 0
 buffer_load_dwordx4 v5, s[36:39], s35 offen lds
 s_add_u32 s35, s33, 622592
 s_add_u32 m0, s34, 19456
 s_nop 0
 buffer_load_dwordx4 v5, s[36:39], s35 offen lds
 s_add_u32 s35, s33, 655360
 s_add_u32 m0, s34, 20480
 s_nop 0
 buffer_load_dwordx4 v5, s[36:39], s35 offen lds
 s_add_u32 s35, s33, 688128
 s_add_u32 m0, s34, 21504
 s_nop 0
 buffer_load_dwordx4 v5, s[36:39], s35 offen lds
 s_add_u32 s35, s33, 720896
 s_add_u32 m0, s34, 22528
 s_nop 0
 buffer_load_dwordx4 v5, s[36:39], s35 offen lds
 s_add_u32 s35, s33, 753664
 s_add_u32 m0, s34, 23552
 s_nop 0
 buffer_load_dwordx4 v5, s[36:39], s35 offen lds
 s_add_u32 s35, s33, 786432
 s_add_u32 m0, s34, 24576
 s_nop 0
 buffer_load_dwordx4 v5, s[36:39], s35 offen lds
 s_add_u32 s35, s33, 819200
 s_add_u32 m0, s34, 25600
 s_nop 0
 buffer_load_dwordx4 v5, s[36:39], s35 offen lds
 s_add_u32 s35, s33, 851968
 s_add_u32 m0, s34, 26624
 s_nop 0
 buffer_load_dwordx4 v5, s[36:39], s35 offen lds
 s_add_u32 s35, s33, 884736
 s_add_u32 m0, s34, 27648
 s_nop 0
 buffer_load_dwordx4 v5, s[36:39], s35 offen lds
 s_add_u32 s35, s33, 917504
 s_add_u32 m0, s34, 28672
 s_nop 0
 buffer_load_dwordx4 v5, s[36:39], s35 offen lds
 s_add_u32 s35, s33, 950272
 s_add_u32 m0, s34, 29696
 s_nop 0
 buffer_load_dwordx4 v5, s[36:39], s35 offen lds
 s_add_u32 s35, s33, 983040
 s_add_u32 m0, s34, 30720
 s_nop 0
 buffer_load_dwordx4 v5, s[36:39], s35 offen lds
 s_add_u32 s35, s33, 1015808
 s_add_u32 m0, s34, 31744
 s_nop 0
 buffer_load_dwordx4 v5, s[36:39], s35 offen lds
 s_add_u32 s35, s33, 1048576
 s_add_u32 m0, s34, 32768
 s_nop 0
 buffer_load_dwordx4 v5, s[36:39], s35 offen lds
 s_add_u32 s35, s33, 1081344
 s_add_u32 m0, s34, 33792
 s_nop 0
 buffer_load_dwordx4 v5, s[36:39], s35 offen lds
 s_add_u32 s35, s33, 1114112
 s_add_u32 m0, s34, 34816
 s_nop 0
 buffer_load_dwordx4 v5, s[36:39], s35 offen lds
 s_add_u32 s35, s33, 1146880
 s_add_u32 m0, s34, 35840
 s_nop 0
 buffer_load_dwordx4 v5, s[36:39], s35 offen lds
 s_waitcnt vmcnt(0)
 s_barrier
 s_cmp_lg_u32 s14, 0
 s_cbranch_scc1 mega_kernel_sk6
 v_add_u32 v8, 0, v6
 ds_read_b64_tr_b16 v[16:17], v8 offset:0
 ds_read_b64_tr_b16 v[18:19], v8 offset:2048
 ds_read_b64_tr_b16 v[20:21], v8 offset:8192
 ds_read_b64_tr_b16 v[22:23], v8 offset:10240
 ds_read_b64_tr_b16 v[24:25], v8 offset:16384
 ds_read_b64_tr_b16 v[26:27], v8 offset:18432
 ds_read_b64_tr_b16 v[28:29], v8 offset:24576
 ds_read_b64_tr_b16 v[30:31], v8 offset:26624
 ds_read_b64_tr_b16 v[32:33], v8 offset:32768
 ds_read_b64_tr_b16 v[34:35], v8 offset:34816
 ds_read_b64_tr_b16 v[36:37], v8 offset:40960
 ds_read_b64_tr_b16 v[38:39], v8 offset:43008
 s_waitcnt lgkmcnt(0)
 v_accvgpr_write_b32 a0, v16
 v_accvgpr_write_b32 a2, v17
 v_accvgpr_write_b32 a1, v18
 v_accvgpr_write_b32 a3, v19
 v_accvgpr_write_b32 a4, v20
 v_accvgpr_write_b32 a6, v21
 v_accvgpr_write_b32 a5, v22
 v_accvgpr_write_b32 a7, v23
 v_accvgpr_write_b32 a8, v24
 v_accvgpr_write_b32 a10, v25
 v_accvgpr_write_b32 a9, v26
 v_accvgpr_write_b32 a11, v27
 v_accvgpr_write_b32 a12, v28
 v_accvgpr_write_b32 a14, v29
 v_accvgpr_write_b32 a13, v30
 v_accvgpr_write_b32 a15, v31
 v_accvgpr_write_b32 a16, v32
 v_accvgpr_write_b32 a18, v33
 v_accvgpr_write_b32 a17, v34
 v_accvgpr_write_b32 a19, v35
 v_accvgpr_write_b32 a20, v36
 v_accvgpr_write_b32 a22, v37
 v_accvgpr_write_b32 a21, v38
 v_accvgpr_write_b32 a23, v39
 v_add_u32 v8, 49152, v6
 ds_read_b64_tr_b16 v[16:17], v8 offset:0
 ds_read_b64_tr_b16 v[18:19], v8 offset:2048
 ds_read_b64_tr_b16 v[20:21], v8 offset:8192
 ds_read_b64_tr_b16 v[22:23], v8 offset:10240
 ds_read_b64_tr_b16 v[24:25], v8 offset:16384
 ds_read_b64_tr_b16 v[26:27], v8 offset:18432
 ds_read_b64_tr_b16 v[28:29], v8 offset:24576
 ds_read_b64_tr_b16 v[30:31], v8 offset:26624
 ds_read_b64_tr_b16 v[32:33], v8 offset:32768
 ds_read_b64_tr_b16 v[34:35], v8 offset:34816
 ds_read_b64_tr_b16 v[36:37], v8 offset:40960
 ds_read_b64_tr_b16 v[38:39], v8 offset:43008
 s_waitcnt lgkmcnt(0)
 v_accvgpr_write_b32 a24, v16
 v_accvgpr_write_b32 a26, v17
 v_accvgpr_write_b32 a25, v18
 v_accvgpr_write_b32 a27, v19
 v_accvgpr_write_b32 a28, v20
 v_accvgpr_write_b32 a30, v21
 v_accvgpr_write_b32 a29, v22
 v_accvgpr_write_b32 a31, v23
 v_accvgpr_write_b32 a32, v24
 v_accvgpr_write_b32 a34, v25
 v_accvgpr_write_b32 a33, v26
 v_accvgpr_write_b32 a35, v27
 v_accvgpr_write_b32 a36, v28
 v_accvgpr_write_b32 a38, v29
 v_accvgpr_write_b32 a37, v30
 v_accvgpr_write_b32 a39, v31
 v_accvgpr_write_b32 a40, v32
 v_accvgpr_write_b32 a42, v33
 v_accvgpr_write_b32 a41, v34
 v_accvgpr_write_b32 a43, v35
 v_accvgpr_write_b32 a44, v36
 v_accvgpr_write_b32 a46, v37
 v_accvgpr_write_b32 a45, v38
 v_accvgpr_write_b32 a47, v39
 v_add_u32 v8, 98304, v6
 ds_read_b64_tr_b16 v[16:17], v8 offset:0
 ds_read_b64_tr_b16 v[18:19], v8 offset:2048
 ds_read_b64_tr_b16 v[20:21], v8 offset:8192
 ds_read_b64_tr_b16 v[22:23], v8 offset:10240
 ds_read_b64_tr_b16 v[24:25], v8 offset:16384
 ds_read_b64_tr_b16 v[26:27], v8 offset:18432
 ds_read_b64_tr_b16 v[28:29], v8 offset:24576
 ds_read_b64_tr_b16 v[30:31], v8 offset:26624
 ds_read_b64_tr_b16 v[32:33], v8 offset:32768
 ds_read_b64_tr_b16 v[34:35], v8 offset:34816
 ds_read_b64_tr_b16 v[36:37], v8 offset:40960
 ds_read_b64_tr_b16 v[38:39], v8 offset:43008
 s_waitcnt lgkmcnt(0)
 v_accvgpr_write_b32 a48, v16
 v_accvgpr_write_b32 a50, v17
 v_accvgpr_write_b32 a49, v18
 v_accvgpr_write_b32 a51, v19
 v_accvgpr_write_b32 a52, v20
 v_accvgpr_write_b32 a54, v21
 v_accvgpr_write_b32 a53, v22
 v_accvgpr_write_b32 a55, v23
 v_accvgpr_write_b32 a56, v24
 v_accvgpr_write_b32 a58, v25
 v_accvgpr_write_b32 a57, v26
 v_accvgpr_write_b32 a59, v27
 v_accvgpr_write_b32 a60, v28
 v_accvgpr_write_b32 a62, v29
 v_accvgpr_write_b32 a61, v30
 v_accvgpr_write_b32 a63, v31
 v_accvgpr_write_b32 a64, v32
 v_accvgpr_write_b32 a66, v33
 v_accvgpr_write_b32 a65, v34
 v_accvgpr_write_b32 a67, v35
 v_accvgpr_write_b32 a68, v36
 v_accvgpr_write_b32 a70, v37
 v_accvgpr_write_b32 a69, v38
 v_accvgpr_write_b32 a71, v39
 v_add_u32 v8, 0, v6
 ds_read_b64_tr_b16 v[16:17], v8 offset:32
 ds_read_b64_tr_b16 v[18:19], v8 offset:2080
 ds_read_b64_tr_b16 v[20:21], v8 offset:8224
 ds_read_b64_tr_b16 v[22:23], v8 offset:10272
 ds_read_b64_tr_b16 v[24:25], v8 offset:16416
 ds_read_b64_tr_b16 v[26:27], v8 offset:18464
 ds_read_b64_tr_b16 v[28:29], v8 offset:24608
 ds_read_b64_tr_b16 v[30:31], v8 offset:26656
 ds_read_b64_tr_b16 v[32:33], v8 offset:32800
 ds_read_b64_tr_b16 v[34:35], v8 offset:34848
 ds_read_b64_tr_b16 v[36:37], v8 offset:40992
 ds_read_b64_tr_b16 v[38:39], v8 offset:43040
 s_waitcnt lgkmcnt(0)
 v_accvgpr_write_b32 a72, v16
 v_accvgpr_write_b32 a74, v17
 v_accvgpr_write_b32 a73, v18
 v_accvgpr_write_b32 a75, v19
 v_accvgpr_write_b32 a76, v20
 v_accvgpr_write_b32 a78, v21
 v_accvgpr_write_b32 a77, v22
 v_accvgpr_write_b32 a79, v23
 v_accvgpr_write_b32 a80, v24
 v_accvgpr_write_b32 a82, v25
 v_accvgpr_write_b32 a81, v26
 v_accvgpr_write_b32 a83, v27
 v_accvgpr_write_b32 a84, v28
 v_accvgpr_write_b32 a86, v29
 v_accvgpr_write_b32 a85, v30
 v_accvgpr_write_b32 a87, v31
 v_accvgpr_write_b32 a88, v32
 v_accvgpr_write_b32 a90, v33
 v_accvgpr_write_b32 a89, v34
 v_accvgpr_write_b32 a91, v35
 v_accvgpr_write_b32 a92, v36
 v_accvgpr_write_b32 a94, v37
 v_accvgpr_write_b32 a93, v38
 v_accvgpr_write_b32 a95, v39
 v_add_u32 v8, 49152, v6
 ds_read_b64_tr_b16 v[16:17], v8 offset:32
 ds_read_b64_tr_b16 v[18:19], v8 offset:2080
 ds_read_b64_tr_b16 v[20:21], v8 offset:8224
 ds_read_b64_tr_b16 v[22:23], v8 offset:10272
 ds_read_b64_tr_b16 v[24:25], v8 offset:16416
 ds_read_b64_tr_b16 v[26:27], v8 offset:18464
 ds_read_b64_tr_b16 v[28:29], v8 offset:24608
 ds_read_b64_tr_b16 v[30:31], v8 offset:26656
 ds_read_b64_tr_b16 v[32:33], v8 offset:32800
 ds_read_b64_tr_b16 v[34:35], v8 offset:34848
 ds_read_b64_tr_b16 v[36:37], v8 offset:40992
 ds_read_b64_tr_b16 v[38:39], v8 offset:43040
 s_waitcnt lgkmcnt(0)
 v_accvgpr_write_b32 a96, v16
 v_accvgpr_write_b32 a98, v17
 v_accvgpr_write_b32 a97, v18
 v_accvgpr_write_b32 a99, v19
 v_accvgpr_write_b32 a100, v20
 v_accvgpr_write_b32 a102, v21
 v_accvgpr_write_b32 a101, v22
 v_accvgpr_write_b32 a103, v23
 v_accvgpr_write_b32 a104, v24
 v_accvgpr_write_b32 a106, v25
 v_accvgpr_write_b32 a105, v26
 v_accvgpr_write_b32 a107, v27
 v_accvgpr_write_b32 a108, v28
 v_accvgpr_write_b32 a110, v29
 v_accvgpr_write_b32 a109, v30
 v_accvgpr_write_b32 a111, v31
 v_accvgpr_write_b32 a112, v32
 v_accvgpr_write_b32 a114, v33
 v_accvgpr_write_b32 a113, v34
 v_accvgpr_write_b32 a115, v35
 v_accvgpr_write_b32 a116, v36
 v_accvgpr_write_b32 a118, v37
 v_accvgpr_write_b32 a117, v38
 v_accvgpr_write_b32 a119, v39
 v_add_u32 v8, 98304, v6
 ds_read_b64_tr_b16 v[16:17], v8 offset:32
 ds_read_b64_tr_b16 v[18:19], v8 offset:2080
 ds_read_b64_tr_b16 v[20:21], v8 offset:8224
 ds_read_b64_tr_b16 v[22:23], v8 offset:10272
 ds_read_b64_tr_b16 v[24:25], v8 offset:16416
 ds_read_b64_tr_b16 v[26:27], v8 offset:18464
 ds_read_b64_tr_b16 v[28:29], v8 offset:24608
 ds_read_b64_tr_b16 v[30:31], v8 offset:26656
 ds_read_b64_tr_b16 v[32:33], v8 offset:32800
 ds_read_b64_tr_b16 v[34:35], v8 offset:34848
 ds_read_b64_tr_b16 v[36:37], v8 offset:40992
 ds_read_b64_tr_b16 v[38:39], v8 offset:43040
 s_waitcnt lgkmcnt(0)
 v_accvgpr_write_b32 a120, v16
 v_accvgpr_write_b32 a122, v17
 v_accvgpr_write_b32 a121, v18
 v_accvgpr_write_b32 a123, v19
 v_accvgpr_write_b32 a124, v20
 v_accvgpr_write_b32 a126, v21
 v_accvgpr_write_b32 a125, v22
 v_accvgpr_write_b32 a127, v23
 v_accvgpr_write_b32 a128, v24
 v_accvgpr_write_b32 a130, v25
 v_accvgpr_write_b32 a129, v26
 v_accvgpr_write_b32 a131, v27
 v_accvgpr_write_b32 a132, v28
 v_accvgpr_write_b32 a134, v29
 v_accvgpr_write_b32 a133, v30
 v_accvgpr_write_b32 a135, v31
 v_accvgpr_write_b32 a136, v32
 v_accvgpr_write_b32 a138, v33
 v_accvgpr_write_b32 a137, v34
 v_accvgpr_write_b32 a139, v35
 v_accvgpr_write_b32 a140, v36
 v_accvgpr_write_b32 a142, v37
 v_accvgpr_write_b32 a141, v38
 v_accvgpr_write_b32 a143, v39
 v_add_u32 v8, 0, v6
 ds_read_b64_tr_b16 v[16:17], v8 offset:64
 ds_read_b64_tr_b16 v[18:19], v8 offset:2112
 ds_read_b64_tr_b16 v[20:21], v8 offset:8256
 ds_read_b64_tr_b16 v[22:23], v8 offset:10304
 ds_read_b64_tr_b16 v[24:25], v8 offset:16448
 ds_read_b64_tr_b16 v[26:27], v8 offset:18496
 ds_read_b64_tr_b16 v[28:29], v8 offset:24640
 ds_read_b64_tr_b16 v[30:31], v8 offset:26688
 ds_read_b64_tr_b16 v[32:33], v8 offset:32832
 ds_read_b64_tr_b16 v[34:35], v8 offset:34880
 ds_read_b64_tr_b16 v[36:37], v8 offset:41024
 ds_read_b64_tr_b16 v[38:39], v8 offset:43072
 s_waitcnt lgkmcnt(0)
 v_accvgpr_write_b32 a144, v16
 v_accvgpr_write_b32 a146, v17
 v_accvgpr_write_b32 a145, v18
 v_accvgpr_write_b32 a147, v19
 v_accvgpr_write_b32 a148, v20
 v_accvgpr_write_b32 a150, v21
 v_accvgpr_write_b32 a149, v22
 v_accvgpr_write_b32 a151, v23
 v_accvgpr_write_b32 a152, v24
 v_accvgpr_write_b32 a154, v25
 v_accvgpr_write_b32 a153, v26
 v_accvgpr_write_b32 a155, v27
 v_accvgpr_write_b32 a156, v28
 v_accvgpr_write_b32 a158, v29
 v_accvgpr_write_b32 a157, v30
 v_accvgpr_write_b32 a159, v31
 v_accvgpr_write_b32 a160, v32
 v_accvgpr_write_b32 a162, v33
 v_accvgpr_write_b32 a161, v34
 v_accvgpr_write_b32 a163, v35
 v_accvgpr_write_b32 a164, v36
 v_accvgpr_write_b32 a166, v37
 v_accvgpr_write_b32 a165, v38
 v_accvgpr_write_b32 a167, v39
 v_add_u32 v8, 49152, v6
 ds_read_b64_tr_b16 v[16:17], v8 offset:64
 ds_read_b64_tr_b16 v[18:19], v8 offset:2112
 ds_read_b64_tr_b16 v[20:21], v8 offset:8256
 ds_read_b64_tr_b16 v[22:23], v8 offset:10304
 ds_read_b64_tr_b16 v[24:25], v8 offset:16448
 ds_read_b64_tr_b16 v[26:27], v8 offset:18496
 ds_read_b64_tr_b16 v[28:29], v8 offset:24640
 ds_read_b64_tr_b16 v[30:31], v8 offset:26688
 ds_read_b64_tr_b16 v[32:33], v8 offset:32832
 ds_read_b64_tr_b16 v[34:35], v8 offset:34880
 ds_read_b64_tr_b16 v[36:37], v8 offset:41024
 ds_read_b64_tr_b16 v[38:39], v8 offset:43072
 s_waitcnt lgkmcnt(0)
 v_accvgpr_write_b32 a168, v16
 v_accvgpr_write_b32 a170, v17
 v_accvgpr_write_b32 a169, v18
 v_accvgpr_write_b32 a171, v19
 v_accvgpr_write_b32 a172, v20
 v_accvgpr_write_b32 a174, v21
 v_accvgpr_write_b32 a173, v22
 v_accvgpr_write_b32 a175, v23
 v_accvgpr_write_b32 a176, v24
 v_accvgpr_write_b32 a178, v25
 v_accvgpr_write_b32 a177, v26
 v_accvgpr_write_b32 a179, v27
 v_accvgpr_write_b32 a180, v28
 v_accvgpr_write_b32 a182, v29
 v_accvgpr_write_b32 a181, v30
 v_accvgpr_write_b32 a183, v31
 v_accvgpr_write_b32 a184, v32
 v_accvgpr_write_b32 a186, v33
 v_accvgpr_write_b32 a185, v34
 v_accvgpr_write_b32 a187, v35
 v_accvgpr_write_b32 a188, v36
 v_accvgpr_write_b32 a190, v37
 v_accvgpr_write_b32 a189, v38
 v_accvgpr_write_b32 a191, v39
 v_add_u32 v8, 98304, v6
 ds_read_b64_tr_b16 v[16:17], v8 offset:64
 ds_read_b64_tr_b16 v[18:19], v8 offset:2112
 ds_read_b64_tr_b16 v[20:21], v8 offset:8256
 ds_read_b64_tr_b16 v[22:23], v8 offset:10304
 ds_read_b64_tr_b16 v[24:25], v8 offset:16448
 ds_read_b64_tr_b16 v[26:27], v8 offset:18496
 ds_read_b64_tr_b16 v[28:29], v8 offset:24640
 ds_read_b64_tr_b16 v[30:31], v8 offset:26688
 ds_read_b64_tr_b16 v[32:33], v8 offset:32832
 ds_read_b64_tr_b16 v[34:35], v8 offset:34880
 ds_read_b64_tr_b16 v[36:37], v8 offset:41024
 ds_read_b64_tr_b16 v[38:39], v8 offset:43072
 s_waitcnt lgkmcnt(0)
 v_accvgpr_write_b32 a192, v16
 v_accvgpr_write_b32 a194, v17
 v_accvgpr_write_b32 a193, v18
 v_accvgpr_write_b32 a195, v19
 v_accvgpr_write_b32 a196, v20
 v_accvgpr_write_b32 a198, v21
 v_accvgpr_write_b32 a197, v22
 v_accvgpr_write_b32 a199, v23
 v_accvgpr_write_b32 a200, v24
 v_accvgpr_write_b32 a202, v25
 v_accvgpr_write_b32 a201, v26
 v_accvgpr_write_b32 a203, v27
 v_accvgpr_write_b32 a204, v28
 v_accvgpr_write_b32 a206, v29
 v_accvgpr_write_b32 a205, v30
 v_accvgpr_write_b32 a207, v31
 v_accvgpr_write_b32 a208, v32
 v_accvgpr_write_b32 a210, v33
 v_accvgpr_write_b32 a209, v34
 v_accvgpr_write_b32 a211, v35
 v_accvgpr_write_b32 a212, v36
 v_accvgpr_write_b32 a214, v37
 v_accvgpr_write_b32 a213, v38
 v_accvgpr_write_b32 a215, v39
 v_add_u32 v8, 0, v6
 ds_read_b64_tr_b16 v[16:17], v8 offset:96
 ds_read_b64_tr_b16 v[18:19], v8 offset:2144
 ds_read_b64_tr_b16 v[20:21], v8 offset:8288
 ds_read_b64_tr_b16 v[22:23], v8 offset:10336
 ds_read_b64_tr_b16 v[24:25], v8 offset:16480
 ds_read_b64_tr_b16 v[26:27], v8 offset:18528
 ds_read_b64_tr_b16 v[28:29], v8 offset:24672
 ds_read_b64_tr_b16 v[30:31], v8 offset:26720
 ds_read_b64_tr_b16 v[32:33], v8 offset:32864
 ds_read_b64_tr_b16 v[34:35], v8 offset:34912
 ds_read_b64_tr_b16 v[36:37], v8 offset:41056
 ds_read_b64_tr_b16 v[38:39], v8 offset:43104
 s_waitcnt lgkmcnt(0)
 v_accvgpr_write_b32 a216, v16
 v_accvgpr_write_b32 a218, v17
 v_accvgpr_write_b32 a217, v18
 v_accvgpr_write_b32 a219, v19
 v_accvgpr_write_b32 a220, v20
 v_accvgpr_write_b32 a222, v21
 v_accvgpr_write_b32 a221, v22
 v_accvgpr_write_b32 a223, v23
 v_accvgpr_write_b32 a224, v24
 v_accvgpr_write_b32 a226, v25
 v_accvgpr_write_b32 a225, v26
 v_accvgpr_write_b32 a227, v27
 v_accvgpr_write_b32 a228, v28
 v_accvgpr_write_b32 a230, v29
 v_accvgpr_write_b32 a229, v30
 v_accvgpr_write_b32 a231, v31
 v_accvgpr_write_b32 a232, v32
 v_accvgpr_write_b32 a234, v33
 v_accvgpr_write_b32 a233, v34
 v_accvgpr_write_b32 a235, v35
 v_accvgpr_write_b32 a236, v36
 v_accvgpr_write_b32 a238, v37
 v_accvgpr_write_b32 a237, v38
 v_accvgpr_write_b32 a239, v39
 v_add_u32 v8, 49152, v6
 ds_read_b64_tr_b16 v[16:17], v8 offset:96
 ds_read_b64_tr_b16 v[18:19], v8 offset:2144
 ds_read_b64_tr_b16 v[20:21], v8 offset:8288
 ds_read_b64_tr_b16 v[22:23], v8 offset:10336
 ds_read_b64_tr_b16 v[24:25], v8 offset:16480
 ds_read_b64_tr_b16 v[26:27], v8 offset:18528
 ds_read_b64_tr_b16 v[28:29], v8 offset:24672
 ds_read_b64_tr_b16 v[30:31], v8 offset:26720
 ds_read_b64_tr_b16 v[32:33], v8 offset:32864
 ds_read_b64_tr_b16 v[34:35], v8 offset:34912
 ds_read_b64_tr_b16 v[36:37], v8 offset:41056
 ds_read_b64_tr_b16 v[38:39], v8 offset:43104
 s_waitcnt lgkmcnt(0)
 v_accvgpr_write_b32 a240, v16
 v_accvgpr_write_b32 a242, v17
 v_accvgpr_write_b32 a241, v18
 v_accvgpr_write_b32 a243, v19
 v_accvgpr_write_b32 a244, v20
 v_accvgpr_write_b32 a246, v21
 v_accvgpr_write_b32 a245, v22
 v_accvgpr_write_b32 a247, v23
 v_accvgpr_write_b32 a248, v24
 v_accvgpr_write_b32 a250, v25
 v_accvgpr_write_b32 a249, v26
 v_accvgpr_write_b32 a251, v27
 v_accvgpr_write_b32 a252, v28
 v_accvgpr_write_b32 a254, v29
 v_accvgpr_write_b32 a253, v30
 v_accvgpr_write_b32 a255, v31
 v_mov_b32 v80, v32
 v_mov_b32 v82, v33
 v_mov_b32 v81, v34
 v_mov_b32 v83, v35
 v_mov_b32 v84, v36
 v_mov_b32 v86, v37
 v_mov_b32 v85, v38
 v_mov_b32 v87, v39
 v_add_u32 v8, 98304, v6
 ds_read_b64_tr_b16 v[16:17], v8 offset:96
 ds_read_b64_tr_b16 v[18:19], v8 offset:2144
 ds_read_b64_tr_b16 v[20:21], v8 offset:8288
 ds_read_b64_tr_b16 v[22:23], v8 offset:10336
 ds_read_b64_tr_b16 v[24:25], v8 offset:16480
 ds_read_b64_tr_b16 v[26:27], v8 offset:18528
 ds_read_b64_tr_b16 v[28:29], v8 offset:24672
 ds_read_b64_tr_b16 v[30:31], v8 offset:26720
 ds_read_b64_tr_b16 v[32:33], v8 offset:32864
 ds_read_b64_tr_b16 v[34:35], v8 offset:34912
 ds_read_b64_tr_b16 v[36:37], v8 offset:41056
 ds_read_b64_tr_b16 v[38:39], v8 offset:43104
 s_waitcnt lgkmcnt(0)
 v_mov_b32 v88, v16
 v_mov_b32 v90, v17
 v_mov_b32 v89, v18
 v_mov_b32 v91, v19
 v_mov_b32 v92, v20
 v_mov_b32 v94, v21
 v_mov_b32 v93, v22
 v_mov_b32 v95, v23
 v_mov_b32 v96, v24
 v_mov_b32 v98, v25
 v_mov_b32 v97, v26
 v_mov_b32 v99, v27
 v_mov_b32 v100, v28
 v_mov_b32 v102, v29
 v_mov_b32 v101, v30
 v_mov_b32 v103, v31
 v_mov_b32 v104, v32
 v_mov_b32 v106, v33
 v_mov_b32 v105, v34
 v_mov_b32 v107, v35
 v_mov_b32 v108, v36
 v_mov_b32 v110, v37
 v_mov_b32 v109, v38
 v_mov_b32 v111, v39
mega_kernel_sk6:
 s_cmp_lg_u32 s14, 1
 s_cbranch_scc1 mega_kernel_sk7
 v_add_u32 v8, 0, v6
 ds_read_b64_tr_b16 v[16:17], v8 offset:128
 ds_read_b64_tr_b16 v[18:19], v8 offset:2176
 ds_read_b64_tr_b16 v[20:21], v8 offset:8320
 ds_read_b64_tr_b16 v[22:23], v8 offset:10368
 ds_read_b64_tr_b16 v[24:25], v8 offset:16512
 ds_read_b64_tr_b16 v[26:27], v8 offset:18560
 ds_read_b64_tr_b16 v[28:29], v8 offset:24704
 ds_read_b64_tr_b16 v[30:31], v8 offset:26752
 ds_read_b64_tr_b16 v[32:33], v8 offset:32896
 ds_read_b64_tr_b16 v[34:35], v8 offset:34944
 ds_read_b64_tr_b16 v[36:37], v8 offset:41088
 ds_read_b64_tr_b16 v[38:39], v8 offset:43136
 s_waitcnt lgkmcnt(0)
 v_accvgpr_write_b32 a0, v16
 v_accvgpr_write_b32 a2, v17
 v_accvgpr_write_b32 a1, v18
 v_accvgpr_write_b32 a3, v19
 v_accvgpr_write_b32 a4, v20
 v_accvgpr_write_b32 a6, v21
 v_accvgpr_write_b32 a5, v22
 v_accvgpr_write_b32 a7, v23
 v_accvgpr_write_b32 a8, v24
 v_accvgpr_write_b32 a10, v25
 v_accvgpr_write_b32 a9, v26
 v_accvgpr_write_b32 a11, v27
 v_accvgpr_write_b32 a12, v28
 v_accvgpr_write_b32 a14, v29
 v_accvgpr_write_b32 a13, v30
 v_accvgpr_write_b32 a15, v31
 v_accvgpr_write_b32 a16, v32
 v_accvgpr_write_b32 a18, v33
 v_accvgpr_write_b32 a17, v34
 v_accvgpr_write_b32 a19, v35
 v_accvgpr_write_b32 a20, v36
 v_accvgpr_write_b32 a22, v37
 v_accvgpr_write_b32 a21, v38
 v_accvgpr_write_b32 a23, v39
 v_add_u32 v8, 49152, v6
 ds_read_b64_tr_b16 v[16:17], v8 offset:128
 ds_read_b64_tr_b16 v[18:19], v8 offset:2176
 ds_read_b64_tr_b16 v[20:21], v8 offset:8320
 ds_read_b64_tr_b16 v[22:23], v8 offset:10368
 ds_read_b64_tr_b16 v[24:25], v8 offset:16512
 ds_read_b64_tr_b16 v[26:27], v8 offset:18560
 ds_read_b64_tr_b16 v[28:29], v8 offset:24704
 ds_read_b64_tr_b16 v[30:31], v8 offset:26752
 ds_read_b64_tr_b16 v[32:33], v8 offset:32896
 ds_read_b64_tr_b16 v[34:35], v8 offset:34944
 ds_read_b64_tr_b16 v[36:37], v8 offset:41088
 ds_read_b64_tr_b16 v[38:39], v8 offset:43136
 s_waitcnt lgkmcnt(0)
 v_accvgpr_write_b32 a24, v16
 v_accvgpr_write_b32 a26, v17
 v_accvgpr_write_b32 a25, v18
 v_accvgpr_write_b32 a27, v19
 v_accvgpr_write_b32 a28, v20
 v_accvgpr_write_b32 a30, v21
 v_accvgpr_write_b32 a29, v22
 v_accvgpr_write_b32 a31, v23
 v_accvgpr_write_b32 a32, v24
 v_accvgpr_write_b32 a34, v25
 v_accvgpr_write_b32 a33, v26
 v_accvgpr_write_b32 a35, v27
 v_accvgpr_write_b32 a36, v28
 v_accvgpr_write_b32 a38, v29
 v_accvgpr_write_b32 a37, v30
 v_accvgpr_write_b32 a39, v31
 v_accvgpr_write_b32 a40, v32
 v_accvgpr_write_b32 a42, v33
 v_accvgpr_write_b32 a41, v34
 v_accvgpr_write_b32 a43, v35
 v_accvgpr_write_b32 a44, v36
 v_accvgpr_write_b32 a46, v37
 v_accvgpr_write_b32 a45, v38
 v_accvgpr_write_b32 a47, v39
 v_add_u32 v8, 98304, v6
 ds_read_b64_tr_b16 v[16:17], v8 offset:128
 ds_read_b64_tr_b16 v[18:19], v8 offset:2176
 ds_read_b64_tr_b16 v[20:21], v8 offset:8320
 ds_read_b64_tr_b16 v[22:23], v8 offset:10368
 ds_read_b64_tr_b16 v[24:25], v8 offset:16512
 ds_read_b64_tr_b16 v[26:27], v8 offset:18560
 ds_read_b64_tr_b16 v[28:29], v8 offset:24704
 ds_read_b64_tr_b16 v[30:31], v8 offset:26752
 ds_read_b64_tr_b16 v[32:33], v8 offset:32896
 ds_read_b64_tr_b16 v[34:35], v8 offset:34944
 ds_read_b64_tr_b16 v[36:37], v8 offset:41088
 ds_read_b64_tr_b16 v[38:39], v8 offset:43136
 s_waitcnt lgkmcnt(0)
 v_accvgpr_write_b32 a48, v16
 v_accvgpr_write_b32 a50, v17
 v_accvgpr_write_b32 a49, v18
 v_accvgpr_write_b32 a51, v19
 v_accvgpr_write_b32 a52, v20
 v_accvgpr_write_b32 a54, v21
 v_accvgpr_write_b32 a53, v22
 v_accvgpr_write_b32 a55, v23
 v_accvgpr_write_b32 a56, v24
 v_accvgpr_write_b32 a58, v25
 v_accvgpr_write_b32 a57, v26
 v_accvgpr_write_b32 a59, v27
 v_accvgpr_write_b32 a60, v28
 v_accvgpr_write_b32 a62, v29
 v_accvgpr_write_b32 a61, v30
 v_accvgpr_write_b32 a63, v31
 v_accvgpr_write_b32 a64, v32
 v_accvgpr_write_b32 a66, v33
 v_accvgpr_write_b32 a65, v34
 v_accvgpr_write_b32 a67, v35
 v_accvgpr_write_b32 a68, v36
 v_accvgpr_write_b32 a70, v37
 v_accvgpr_write_b32 a69, v38
 v_accvgpr_write_b32 a71, v39
 v_add_u32 v8, 0, v6
 ds_read_b64_tr_b16 v[16:17], v8 offset:160
 ds_read_b64_tr_b16 v[18:19], v8 offset:2208
 ds_read_b64_tr_b16 v[20:21], v8 offset:8352
 ds_read_b64_tr_b16 v[22:23], v8 offset:10400
 ds_read_b64_tr_b16 v[24:25], v8 offset:16544
 ds_read_b64_tr_b16 v[26:27], v8 offset:18592
 ds_read_b64_tr_b16 v[28:29], v8 offset:24736
 ds_read_b64_tr_b16 v[30:31], v8 offset:26784
 ds_read_b64_tr_b16 v[32:33], v8 offset:32928
 ds_read_b64_tr_b16 v[34:35], v8 offset:34976
 ds_read_b64_tr_b16 v[36:37], v8 offset:41120
 ds_read_b64_tr_b16 v[38:39], v8 offset:43168
 s_waitcnt lgkmcnt(0)
 v_accvgpr_write_b32 a72, v16
 v_accvgpr_write_b32 a74, v17
 v_accvgpr_write_b32 a73, v18
 v_accvgpr_write_b32 a75, v19
 v_accvgpr_write_b32 a76, v20
 v_accvgpr_write_b32 a78, v21
 v_accvgpr_write_b32 a77, v22
 v_accvgpr_write_b32 a79, v23
 v_accvgpr_write_b32 a80, v24
 v_accvgpr_write_b32 a82, v25
 v_accvgpr_write_b32 a81, v26
 v_accvgpr_write_b32 a83, v27
 v_accvgpr_write_b32 a84, v28
 v_accvgpr_write_b32 a86, v29
 v_accvgpr_write_b32 a85, v30
 v_accvgpr_write_b32 a87, v31
 v_accvgpr_write_b32 a88, v32
 v_accvgpr_write_b32 a90, v33
 v_accvgpr_write_b32 a89, v34
 v_accvgpr_write_b32 a91, v35
 v_accvgpr_write_b32 a92, v36
 v_accvgpr_write_b32 a94, v37
 v_accvgpr_write_b32 a93, v38
 v_accvgpr_write_b32 a95, v39
 v_add_u32 v8, 49152, v6
 ds_read_b64_tr_b16 v[16:17], v8 offset:160
 ds_read_b64_tr_b16 v[18:19], v8 offset:2208
 ds_read_b64_tr_b16 v[20:21], v8 offset:8352
 ds_read_b64_tr_b16 v[22:23], v8 offset:10400
 ds_read_b64_tr_b16 v[24:25], v8 offset:16544
 ds_read_b64_tr_b16 v[26:27], v8 offset:18592
 ds_read_b64_tr_b16 v[28:29], v8 offset:24736
 ds_read_b64_tr_b16 v[30:31], v8 offset:26784
 ds_read_b64_tr_b16 v[32:33], v8 offset:32928
 ds_read_b64_tr_b16 v[34:35], v8 offset:34976
 ds_read_b64_tr_b16 v[36:37], v8 offset:41120
 ds_read_b64_tr_b16 v[38:39], v8 offset:43168
 s_waitcnt lgkmcnt(0)
 v_accvgpr_write_b32 a96, v16
 v_accvgpr_write_b32 a98, v17
 v_accvgpr_write_b32 a97, v18
 v_accvgpr_write_b32 a99, v19
 v_accvgpr_write_b32 a100, v20
 v_accvgpr_write_b32 a102, v21
 v_accvgpr_write_b32 a101, v22
 v_accvgpr_write_b32 a103, v23
 v_accvgpr_write_b32 a104, v24
 v_accvgpr_write_b32 a106, v25
 v_accvgpr_write_b32 a105, v26
 v_accvgpr_write_b32 a107, v27
 v_accvgpr_write_b32 a108, v28
 v_accvgpr_write_b32 a110, v29
 v_accvgpr_write_b32 a109, v30
 v_accvgpr_write_b32 a111, v31
 v_accvgpr_write_b32 a112, v32
 v_accvgpr_write_b32 a114, v33
 v_accvgpr_write_b32 a113, v34
 v_accvgpr_write_b32 a115, v35
 v_accvgpr_write_b32 a116, v36
 v_accvgpr_write_b32 a118, v37
 v_accvgpr_write_b32 a117, v38
 v_accvgpr_write_b32 a119, v39
 v_add_u32 v8, 98304, v6
 ds_read_b64_tr_b16 v[16:17], v8 offset:160
 ds_read_b64_tr_b16 v[18:19], v8 offset:2208
 ds_read_b64_tr_b16 v[20:21], v8 offset:8352
 ds_read_b64_tr_b16 v[22:23], v8 offset:10400
 ds_read_b64_tr_b16 v[24:25], v8 offset:16544
 ds_read_b64_tr_b16 v[26:27], v8 offset:18592
 ds_read_b64_tr_b16 v[28:29], v8 offset:24736
 ds_read_b64_tr_b16 v[30:31], v8 offset:26784
 ds_read_b64_tr_b16 v[32:33], v8 offset:32928
 ds_read_b64_tr_b16 v[34:35], v8 offset:34976
 ds_read_b64_tr_b16 v[36:37], v8 offset:41120
 ds_read_b64_tr_b16 v[38:39], v8 offset:43168
 s_waitcnt lgkmcnt(0)
 v_accvgpr_write_b32 a120, v16
 v_accvgpr_write_b32 a122, v17
 v_accvgpr_write_b32 a121, v18
 v_accvgpr_write_b32 a123, v19
 v_accvgpr_write_b32 a124, v20
 v_accvgpr_write_b32 a126, v21
 v_accvgpr_write_b32 a125, v22
 v_accvgpr_write_b32 a127, v23
 v_accvgpr_write_b32 a128, v24
 v_accvgpr_write_b32 a130, v25
 v_accvgpr_write_b32 a129, v26
 v_accvgpr_write_b32 a131, v27
 v_accvgpr_write_b32 a132, v28
 v_accvgpr_write_b32 a134, v29
 v_accvgpr_write_b32 a133, v30
 v_accvgpr_write_b32 a135, v31
 v_accvgpr_write_b32 a136, v32
 v_accvgpr_write_b32 a138, v33
 v_accvgpr_write_b32 a137, v34
 v_accvgpr_write_b32 a139, v35
 v_accvgpr_write_b32 a140, v36
 v_accvgpr_write_b32 a142, v37
 v_accvgpr_write_b32 a141, v38
 v_accvgpr_write_b32 a143, v39
 v_add_u32 v8, 0, v6
 ds_read_b64_tr_b16 v[16:17], v8 offset:192
 ds_read_b64_tr_b16 v[18:19], v8 offset:2240
 ds_read_b64_tr_b16 v[20:21], v8 offset:8384
 ds_read_b64_tr_b16 v[22:23], v8 offset:10432
 ds_read_b64_tr_b16 v[24:25], v8 offset:16576
 ds_read_b64_tr_b16 v[26:27], v8 offset:18624
 ds_read_b64_tr_b16 v[28:29], v8 offset:24768
 ds_read_b64_tr_b16 v[30:31], v8 offset:26816
 ds_read_b64_tr_b16 v[32:33], v8 offset:32960
 ds_read_b64_tr_b16 v[34:35], v8 offset:35008
 ds_read_b64_tr_b16 v[36:37], v8 offset:41152
 ds_read_b64_tr_b16 v[38:39], v8 offset:43200
 s_waitcnt lgkmcnt(0)
 v_accvgpr_write_b32 a144, v16
 v_accvgpr_write_b32 a146, v17
 v_accvgpr_write_b32 a145, v18
 v_accvgpr_write_b32 a147, v19
 v_accvgpr_write_b32 a148, v20
 v_accvgpr_write_b32 a150, v21
 v_accvgpr_write_b32 a149, v22
 v_accvgpr_write_b32 a151, v23
 v_accvgpr_write_b32 a152, v24
 v_accvgpr_write_b32 a154, v25
 v_accvgpr_write_b32 a153, v26
 v_accvgpr_write_b32 a155, v27
 v_accvgpr_write_b32 a156, v28
 v_accvgpr_write_b32 a158, v29
 v_accvgpr_write_b32 a157, v30
 v_accvgpr_write_b32 a159, v31
 v_accvgpr_write_b32 a160, v32
 v_accvgpr_write_b32 a162, v33
 v_accvgpr_write_b32 a161, v34
 v_accvgpr_write_b32 a163, v35
 v_accvgpr_write_b32 a164, v36
 v_accvgpr_write_b32 a166, v37
 v_accvgpr_write_b32 a165, v38
 v_accvgpr_write_b32 a167, v39
 v_add_u32 v8, 49152, v6
 ds_read_b64_tr_b16 v[16:17], v8 offset:192
 ds_read_b64_tr_b16 v[18:19], v8 offset:2240
 ds_read_b64_tr_b16 v[20:21], v8 offset:8384
 ds_read_b64_tr_b16 v[22:23], v8 offset:10432
 ds_read_b64_tr_b16 v[24:25], v8 offset:16576
 ds_read_b64_tr_b16 v[26:27], v8 offset:18624
 ds_read_b64_tr_b16 v[28:29], v8 offset:24768
 ds_read_b64_tr_b16 v[30:31], v8 offset:26816
 ds_read_b64_tr_b16 v[32:33], v8 offset:32960
 ds_read_b64_tr_b16 v[34:35], v8 offset:35008
 ds_read_b64_tr_b16 v[36:37], v8 offset:41152
 ds_read_b64_tr_b16 v[38:39], v8 offset:43200
 s_waitcnt lgkmcnt(0)
 v_accvgpr_write_b32 a168, v16
 v_accvgpr_write_b32 a170, v17
 v_accvgpr_write_b32 a169, v18
 v_accvgpr_write_b32 a171, v19
 v_accvgpr_write_b32 a172, v20
 v_accvgpr_write_b32 a174, v21
 v_accvgpr_write_b32 a173, v22
 v_accvgpr_write_b32 a175, v23
 v_accvgpr_write_b32 a176, v24
 v_accvgpr_write_b32 a178, v25
 v_accvgpr_write_b32 a177, v26
 v_accvgpr_write_b32 a179, v27
 v_accvgpr_write_b32 a180, v28
 v_accvgpr_write_b32 a182, v29
 v_accvgpr_write_b32 a181, v30
 v_accvgpr_write_b32 a183, v31
 v_accvgpr_write_b32 a184, v32
 v_accvgpr_write_b32 a186, v33
 v_accvgpr_write_b32 a185, v34
 v_accvgpr_write_b32 a187, v35
 v_accvgpr_write_b32 a188, v36
 v_accvgpr_write_b32 a190, v37
 v_accvgpr_write_b32 a189, v38
 v_accvgpr_write_b32 a191, v39
 v_add_u32 v8, 98304, v6
 ds_read_b64_tr_b16 v[16:17], v8 offset:192
 ds_read_b64_tr_b16 v[18:19], v8 offset:2240
 ds_read_b64_tr_b16 v[20:21], v8 offset:8384
 ds_read_b64_tr_b16 v[22:23], v8 offset:10432
 ds_read_b64_tr_b16 v[24:25], v8 offset:16576
 ds_read_b64_tr_b16 v[26:27], v8 offset:18624
 ds_read_b64_tr_b16 v[28:29], v8 offset:24768
 ds_read_b64_tr_b16 v[30:31], v8 offset:26816
 ds_read_b64_tr_b16 v[32:33], v8 offset:32960
 ds_read_b64_tr_b16 v[34:35], v8 offset:35008
 ds_read_b64_tr_b16 v[36:37], v8 offset:41152
 ds_read_b64_tr_b16 v[38:39], v8 offset:43200
 s_waitcnt lgkmcnt(0)
 v_accvgpr_write_b32 a192, v16
 v_accvgpr_write_b32 a194, v17
 v_accvgpr_write_b32 a193, v18
 v_accvgpr_write_b32 a195, v19
 v_accvgpr_write_b32 a196, v20
 v_accvgpr_write_b32 a198, v21
 v_accvgpr_write_b32 a197, v22
 v_accvgpr_write_b32 a199, v23
 v_accvgpr_write_b32 a200, v24
 v_accvgpr_write_b32 a202, v25
 v_accvgpr_write_b32 a201, v26
 v_accvgpr_write_b32 a203, v27
 v_accvgpr_write_b32 a204, v28
 v_accvgpr_write_b32 a206, v29
 v_accvgpr_write_b32 a205, v30
 v_accvgpr_write_b32 a207, v31
 v_accvgpr_write_b32 a208, v32
 v_accvgpr_write_b32 a210, v33
 v_accvgpr_write_b32 a209, v34
 v_accvgpr_write_b32 a211, v35
 v_accvgpr_write_b32 a212, v36
 v_accvgpr_write_b32 a214, v37
 v_accvgpr_write_b32 a213, v38
 v_accvgpr_write_b32 a215, v39
 v_add_u32 v8, 0, v6
 ds_read_b64_tr_b16 v[16:17], v8 offset:224
 ds_read_b64_tr_b16 v[18:19], v8 offset:2272
 ds_read_b64_tr_b16 v[20:21], v8 offset:8416
 ds_read_b64_tr_b16 v[22:23], v8 offset:10464
 ds_read_b64_tr_b16 v[24:25], v8 offset:16608
 ds_read_b64_tr_b16 v[26:27], v8 offset:18656
 ds_read_b64_tr_b16 v[28:29], v8 offset:24800
 ds_read_b64_tr_b16 v[30:31], v8 offset:26848
 ds_read_b64_tr_b16 v[32:33], v8 offset:32992
 ds_read_b64_tr_b16 v[34:35], v8 offset:35040
 ds_read_b64_tr_b16 v[36:37], v8 offset:41184
 ds_read_b64_tr_b16 v[38:39], v8 offset:43232
 s_waitcnt lgkmcnt(0)
 v_accvgpr_write_b32 a216, v16
 v_accvgpr_write_b32 a218, v17
 v_accvgpr_write_b32 a217, v18
 v_accvgpr_write_b32 a219, v19
 v_accvgpr_write_b32 a220, v20
 v_accvgpr_write_b32 a222, v21
 v_accvgpr_write_b32 a221, v22
 v_accvgpr_write_b32 a223, v23
 v_accvgpr_write_b32 a224, v24
 v_accvgpr_write_b32 a226, v25
 v_accvgpr_write_b32 a225, v26
 v_accvgpr_write_b32 a227, v27
 v_accvgpr_write_b32 a228, v28
 v_accvgpr_write_b32 a230, v29
 v_accvgpr_write_b32 a229, v30
 v_accvgpr_write_b32 a231, v31
 v_accvgpr_write_b32 a232, v32
 v_accvgpr_write_b32 a234, v33
 v_accvgpr_write_b32 a233, v34
 v_accvgpr_write_b32 a235, v35
 v_accvgpr_write_b32 a236, v36
 v_accvgpr_write_b32 a238, v37
 v_accvgpr_write_b32 a237, v38
 v_accvgpr_write_b32 a239, v39
 v_add_u32 v8, 49152, v6
 ds_read_b64_tr_b16 v[16:17], v8 offset:224
 ds_read_b64_tr_b16 v[18:19], v8 offset:2272
 ds_read_b64_tr_b16 v[20:21], v8 offset:8416
 ds_read_b64_tr_b16 v[22:23], v8 offset:10464
 ds_read_b64_tr_b16 v[24:25], v8 offset:16608
 ds_read_b64_tr_b16 v[26:27], v8 offset:18656
 ds_read_b64_tr_b16 v[28:29], v8 offset:24800
 ds_read_b64_tr_b16 v[30:31], v8 offset:26848
 ds_read_b64_tr_b16 v[32:33], v8 offset:32992
 ds_read_b64_tr_b16 v[34:35], v8 offset:35040
 ds_read_b64_tr_b16 v[36:37], v8 offset:41184
 ds_read_b64_tr_b16 v[38:39], v8 offset:43232
 s_waitcnt lgkmcnt(0)
 v_accvgpr_write_b32 a240, v16
 v_accvgpr_write_b32 a242, v17
 v_accvgpr_write_b32 a241, v18
 v_accvgpr_write_b32 a243, v19
 v_accvgpr_write_b32 a244, v20
 v_accvgpr_write_b32 a246, v21
 v_accvgpr_write_b32 a245, v22
 v_accvgpr_write_b32 a247, v23
 v_accvgpr_write_b32 a248, v24
 v_accvgpr_write_b32 a250, v25
 v_accvgpr_write_b32 a249, v26
 v_accvgpr_write_b32 a251, v27
 v_accvgpr_write_b32 a252, v28
 v_accvgpr_write_b32 a254, v29
 v_accvgpr_write_b32 a253, v30
 v_accvgpr_write_b32 a255, v31
 v_mov_b32 v80, v32
 v_mov_b32 v82, v33
 v_mov_b32 v81, v34
 v_mov_b32 v83, v35
 v_mov_b32 v84, v36
 v_mov_b32 v86, v37
 v_mov_b32 v85, v38
 v_mov_b32 v87, v39
 v_add_u32 v8, 98304, v6
 ds_read_b64_tr_b16 v[16:17], v8 offset:224
 ds_read_b64_tr_b16 v[18:19], v8 offset:2272
 ds_read_b64_tr_b16 v[20:21], v8 offset:8416
 ds_read_b64_tr_b16 v[22:23], v8 offset:10464
 ds_read_b64_tr_b16 v[24:25], v8 offset:16608
 ds_read_b64_tr_b16 v[26:27], v8 offset:18656
 ds_read_b64_tr_b16 v[28:29], v8 offset:24800
 ds_read_b64_tr_b16 v[30:31], v8 offset:26848
 ds_read_b64_tr_b16 v[32:33], v8 offset:32992
 ds_read_b64_tr_b16 v[34:35], v8 offset:35040
 ds_read_b64_tr_b16 v[36:37], v8 offset:41184
 ds_read_b64_tr_b16 v[38:39], v8 offset:43232
 s_waitcnt lgkmcnt(0)
 v_mov_b32 v88, v16
 v_mov_b32 v90, v17
 v_mov_b32 v89, v18
 v_mov_b32 v91, v19
 v_mov_b32 v92, v20
 v_mov_b32 v94, v21
 v_mov_b32 v93, v22
 v_mov_b32 v95, v23
 v_mov_b32 v96, v24
 v_mov_b32 v98, v25
 v_mov_b32 v97, v26
 v_mov_b32 v99, v27
 v_mov_b32 v100, v28
 v_mov_b32 v102, v29
 v_mov_b32 v101, v30
 v_mov_b32 v103, v31
 v_mov_b32 v104, v32
 v_mov_b32 v106, v33
 v_mov_b32 v105, v34
 v_mov_b32 v107, v35
 v_mov_b32 v108, v36
 v_mov_b32 v110, v37
 v_mov_b32 v109, v38
 v_mov_b32 v111, v39
mega_kernel_sk7:
 s_mov_b32 s36, s6
 s_and_b32 s37, s7, 0xffff
 s_mov_b32 s38, 4718592
 s_mov_b32 s39, 0x00020000
 s_barrier
 s_mul_i32 s33, s32, 32768
 s_add_u32 s33, s33, s15
 s_lshl_b32 s34, s32, 10
 s_add_u32 s35, s33, 0
 s_add_u32 m0, s34, 0
 s_nop 0
 buffer_load_dwordx4 v5, s[36:39], s35 offen lds
 s_add_u32 s35, s33, 32768
 s_add_u32 m0, s34, 1024
 s_nop 0
 buffer_load_dwordx4 v5, s[36:39], s35 offen lds
 s_add_u32 s35, s33, 65536
 s_add_u32 m0, s34, 2048
 s_nop 0
 buffer_load_dwordx4 v5, s[36:39], s35 offen lds
 s_add_u32 s35, s33, 98304
 s_add_u32 m0, s34, 3072
 s_nop 0
 buffer_load_dwordx4 v5, s[36:39], s35 offen lds
 s_add_u32 s35, s33, 131072
 s_add_u32 m0, s34, 4096
 s_nop 0
 buffer_load_dwordx4 v5, s[36:39], s35 offen lds
 s_add_u32 s35, s33, 163840
 s_add_u32 m0, s34, 5120
 s_nop 0
 buffer_load_dwordx4 v5, s[36:39], s35 offen lds
 s_add_u32 s35, s33, 196608
 s_add_u32 m0, s34, 6144
 s_nop 0
 buffer_load_dwordx4 v5, s[36:39], s35 offen lds
 s_add_u32 s35, s33, 229376
 s_add_u32 m0, s34, 7168
 s_nop 0
 buffer_load_dwordx4 v5, s[36:39], s35 offen lds
 s_add_u32 s35, s33, 262144
 s_add_u32 m0, s34, 8192
 s_nop 0
 buffer_load_dwordx4 v5, s[36:39], s35 offen lds
 s_add_u32 s35, s33, 294912
 s_add_u32 m0, s34, 9216
 s_nop 0
 buffer_load_dwordx4 v5, s[36:39], s35 offen lds
 s_add_u32 s35, s33, 327680
 s_add_u32 m0, s34, 10240
 s_nop 0
 buffer_load_dwordx4 v5, s[36:39], s35 offen lds
 s_add_u32 s35, s33, 360448
 s_add_u32 m0, s34, 11264
 s_nop 0
 buffer_load_dwordx4 v5, s[36:39], s35 offen lds
 s_add_u32 s35, s33, 393216
 s_add_u32 m0, s34, 12288
 s_nop 0
 buffer_load_dwordx4 v5, s[36:39], s35 offen lds
 s_add_u32 s35, s33, 425984
 s_add_u32 m0, s34, 13312
 s_nop 0
 buffer_load_dwordx4 v5, s[36:39], s35 offen lds
 s_add_u32 s35, s33, 458752
 s_add_u32 m0, s34, 14336
 s_nop 0
 buffer_load_dwordx4 v5, s[36:39], s35 offen lds
 s_add_u32 s35, s33, 491520
 s_add_u32 m0, s34, 15360
 s_nop 0
 buffer_load_dwordx4 v5, s[36:39], s35 offen lds
 s_add_u32 s35, s33, 524288
 s_add_u32 m0, s34, 16384
 s_nop 0
 buffer_load_dwordx4 v5, s[36:39], s35 offen lds
 s_add_u32 s35, s33, 557056
 s_add_u32 m0, s34, 17408
 s_nop 0
 buffer_load_dwordx4 v5, s[36:39], s35 offen lds
 s_add_u32 s35, s33, 589824
 s_add_u32 m0, s34, 18432
 s_nop 0
 buffer_load_dwordx4 v5, s[36:39], s35 offen lds
 s_add_u32 s35, s33, 622592
 s_add_u32 m0, s34, 19456
 s_nop 0
 buffer_load_dwordx4 v5, s[36:39], s35 offen lds
 s_add_u32 s35, s33, 655360
 s_add_u32 m0, s34, 20480
 s_nop 0
 buffer_load_dwordx4 v5, s[36:39], s35 offen lds
 s_add_u32 s35, s33, 688128
 s_add_u32 m0, s34, 21504
 s_nop 0
 buffer_load_dwordx4 v5, s[36:39], s35 offen lds
 s_add_u32 s35, s33, 720896
 s_add_u32 m0, s34, 22528
 s_nop 0
 buffer_load_dwordx4 v5, s[36:39], s35 offen lds
 s_add_u32 s35, s33, 753664
 s_add_u32 m0, s34, 23552
 s_nop 0
 buffer_load_dwordx4 v5, s[36:39], s35 offen lds
 s_add_u32 s35, s33, 786432
 s_add_u32 m0, s34, 24576
 s_nop 0
 buffer_load_dwordx4 v5, s[36:39], s35 offen lds
 s_add_u32 s35, s33, 819200
 s_add_u32 m0, s34, 25600
 s_nop 0
 buffer_load_dwordx4 v5, s[36:39], s35 offen lds
 s_add_u32 s35, s33, 851968
 s_add_u32 m0, s34, 26624
 s_nop 0
 buffer_load_dwordx4 v5, s[36:39], s35 offen lds
 s_add_u32 s35, s33, 884736
 s_add_u32 m0, s34, 27648
 s_nop 0
 buffer_load_dwordx4 v5, s[36:39], s35 offen lds
 s_add_u32 s35, s33, 917504
 s_add_u32 m0, s34, 28672
 s_nop 0
 buffer_load_dwordx4 v5, s[36:39], s35 offen lds
 s_add_u32 s35, s33, 950272
 s_add_u32 m0, s34, 29696
 s_nop 0
 buffer_load_dwordx4 v5, s[36:39], s35 offen lds
 s_add_u32 s35, s33, 983040
 s_add_u32 m0, s34, 30720
 s_nop 0
 buffer_load_dwordx4 v5, s[36:39], s35 offen lds
 s_add_u32 s35, s33, 1015808
 s_add_u32 m0, s34, 31744
 s_nop 0
 buffer_load_dwordx4 v5, s[36:39], s35 offen lds
 s_add_u32 s35, s33, 1048576
 s_add_u32 m0, s34, 32768
 s_nop 0
 buffer_load_dwordx4 v5, s[36:39], s35 offen lds
 s_add_u32 s35, s33, 1081344
 s_add_u32 m0, s34, 33792
 s_nop 0
 buffer_load_dwordx4 v5, s[36:39], s35 offen lds
 s_add_u32 s35, s33, 1114112
 s_add_u32 m0, s34, 34816
 s_nop 0
 buffer_load_dwordx4 v5, s[36:39], s35 offen lds
 s_add_u32 s35, s33, 1146880
 s_add_u32 m0, s34, 35840
 s_nop 0
 buffer_load_dwordx4 v5, s[36:39], s35 offen lds
 s_waitcnt vmcnt(0)
 s_barrier
 s_cmp_lg_u32 s14, 2
 s_cbranch_scc1 mega_kernel_sk8
 v_add_u32 v8, 0, v6
 ds_read_b64_tr_b16 v[16:17], v8 offset:0
 ds_read_b64_tr_b16 v[18:19], v8 offset:2048
 ds_read_b64_tr_b16 v[20:21], v8 offset:8192
 ds_read_b64_tr_b16 v[22:23], v8 offset:10240
 ds_read_b64_tr_b16 v[24:25], v8 offset:16384
 ds_read_b64_tr_b16 v[26:27], v8 offset:18432
 ds_read_b64_tr_b16 v[28:29], v8 offset:24576
 ds_read_b64_tr_b16 v[30:31], v8 offset:26624
 ds_read_b64_tr_b16 v[32:33], v8 offset:32768
 ds_read_b64_tr_b16 v[34:35], v8 offset:34816
 ds_read_b64_tr_b16 v[36:37], v8 offset:40960
 ds_read_b64_tr_b16 v[38:39], v8 offset:43008
 s_waitcnt lgkmcnt(0)
 v_accvgpr_write_b32 a0, v16
 v_accvgpr_write_b32 a2, v17
 v_accvgpr_write_b32 a1, v18
 v_accvgpr_write_b32 a3, v19
 v_accvgpr_write_b32 a4, v20
 v_accvgpr_write_b32 a6, v21
 v_accvgpr_write_b32 a5, v22
 v_accvgpr_write_b32 a7, v23
 v_accvgpr_write_b32 a8, v24
 v_accvgpr_write_b32 a10, v25
 v_accvgpr_write_b32 a9, v26
 v_accvgpr_write_b32 a11, v27
 v_accvgpr_write_b32 a12, v28
 v_accvgpr_write_b32 a14, v29
 v_accvgpr_write_b32 a13, v30
 v_accvgpr_write_b32 a15, v31
 v_accvgpr_write_b32 a16, v32
 v_accvgpr_write_b32 a18, v33
 v_accvgpr_write_b32 a17, v34
 v_accvgpr_write_b32 a19, v35
 v_accvgpr_write_b32 a20, v36
 v_accvgpr_write_b32 a22, v37
 v_accvgpr_write_b32 a21, v38
 v_accvgpr_write_b32 a23, v39
 v_add_u32 v8, 49152, v6
 ds_read_b64_tr_b16 v[16:17], v8 offset:0
 ds_read_b64_tr_b16 v[18:19], v8 offset:2048
 ds_read_b64_tr_b16 v[20:21], v8 offset:8192
 ds_read_b64_tr_b16 v[22:23], v8 offset:10240
 ds_read_b64_tr_b16 v[24:25], v8 offset:16384
 ds_read_b64_tr_b16 v[26:27], v8 offset:18432
 ds_read_b64_tr_b16 v[28:29], v8 offset:24576
 ds_read_b64_tr_b16 v[30:31], v8 offset:26624
 ds_read_b64_tr_b16 v[32:33], v8 offset:32768
 ds_read_b64_tr_b16 v[34:35], v8 offset:34816
 ds_read_b64_tr_b16 v[36:37], v8 offset:40960
 ds_read_b64_tr_b16 v[38:39], v8 offset:43008
 s_waitcnt lgkmcnt(0)
 v_accvgpr_write_b32 a24, v16
 v_accvgpr_write_b32 a26, v17
 v_accvgpr_write_b32 a25, v18
 v_accvgpr_write_b32 a27, v19
 v_accvgpr_write_b32 a28, v20
 v_accvgpr_write_b32 a30, v21
 v_accvgpr_write_b32 a29, v22
 v_accvgpr_write_b32 a31, v23
 v_accvgpr_write_b32 a32, v24
 v_accvgpr_write_b32 a34, v25
 v_accvgpr_write_b32 a33, v26
 v_accvgpr_write_b32 a35, v27
 v_accvgpr_write_b32 a36, v28
 v_accvgpr_write_b32 a38, v29
 v_accvgpr_write_b32 a37, v30
 v_accvgpr_write_b32 a39, v31
 v_accvgpr_write_b32 a40, v32
 v_accvgpr_write_b32 a42, v33
 v_accvgpr_write_b32 a41, v34
 v_accvgpr_write_b32 a43, v35
 v_accvgpr_write_b32 a44, v36
 v_accvgpr_write_b32 a46, v37
 v_accvgpr_write_b32 a45, v38
 v_accvgpr_write_b32 a47, v39
 v_add_u32 v8, 98304, v6
 ds_read_b64_tr_b16 v[16:17], v8 offset:0
 ds_read_b64_tr_b16 v[18:19], v8 offset:2048
 ds_read_b64_tr_b16 v[20:21], v8 offset:8192
 ds_read_b64_tr_b16 v[22:23], v8 offset:10240
 ds_read_b64_tr_b16 v[24:25], v8 offset:16384
 ds_read_b64_tr_b16 v[26:27], v8 offset:18432
 ds_read_b64_tr_b16 v[28:29], v8 offset:24576
 ds_read_b64_tr_b16 v[30:31], v8 offset:26624
 ds_read_b64_tr_b16 v[32:33], v8 offset:32768
 ds_read_b64_tr_b16 v[34:35], v8 offset:34816
 ds_read_b64_tr_b16 v[36:37], v8 offset:40960
 ds_read_b64_tr_b16 v[38:39], v8 offset:43008
 s_waitcnt lgkmcnt(0)
 v_accvgpr_write_b32 a48, v16
 v_accvgpr_write_b32 a50, v17
 v_accvgpr_write_b32 a49, v18
 v_accvgpr_write_b32 a51, v19
 v_accvgpr_write_b32 a52, v20
 v_accvgpr_write_b32 a54, v21
 v_accvgpr_write_b32 a53, v22
 v_accvgpr_write_b32 a55, v23
 v_accvgpr_write_b32 a56, v24
 v_accvgpr_write_b32 a58, v25
 v_accvgpr_write_b32 a57, v26
 v_accvgpr_write_b32 a59, v27
 v_accvgpr_write_b32 a60, v28
 v_accvgpr_write_b32 a62, v29
 v_accvgpr_write_b32 a61, v30
 v_accvgpr_write_b32 a63, v31
 v_accvgpr_write_b32 a64, v32
 v_accvgpr_write_b32 a66, v33
 v_accvgpr_write_b32 a65, v34
 v_accvgpr_write_b32 a67, v35
 v_accvgpr_write_b32 a68, v36
 v_accvgpr_write_b32 a70, v37
 v_accvgpr_write_b32 a69, v38
 v_accvgpr_write_b32 a71, v39
 v_add_u32 v8, 0, v6
 ds_read_b64_tr_b16 v[16:17], v8 offset:32
 ds_read_b64_tr_b16 v[18:19], v8 offset:2080
 ds_read_b64_tr_b16 v[20:21], v8 offset:8224
 ds_read_b64_tr_b16 v[22:23], v8 offset:10272
 ds_read_b64_tr_b16 v[24:25], v8 offset:16416
 ds_read_b64_tr_b16 v[26:27], v8 offset:18464
 ds_read_b64_tr_b16 v[28:29], v8 offset:24608
 ds_read_b64_tr_b16 v[30:31], v8 offset:26656
 ds_read_b64_tr_b16 v[32:33], v8 offset:32800
 ds_read_b64_tr_b16 v[34:35], v8 offset:34848
 ds_read_b64_tr_b16 v[36:37], v8 offset:40992
 ds_read_b64_tr_b16 v[38:39], v8 offset:43040
 s_waitcnt lgkmcnt(0)
 v_accvgpr_write_b32 a72, v16
 v_accvgpr_write_b32 a74, v17
 v_accvgpr_write_b32 a73, v18
 v_accvgpr_write_b32 a75, v19
 v_accvgpr_write_b32 a76, v20
 v_accvgpr_write_b32 a78, v21
 v_accvgpr_write_b32 a77, v22
 v_accvgpr_write_b32 a79, v23
 v_accvgpr_write_b32 a80, v24
 v_accvgpr_write_b32 a82, v25
 v_accvgpr_write_b32 a81, v26
 v_accvgpr_write_b32 a83, v27
 v_accvgpr_write_b32 a84, v28
 v_accvgpr_write_b32 a86, v29
 v_accvgpr_write_b32 a85, v30
 v_accvgpr_write_b32 a87, v31
 v_accvgpr_write_b32 a88, v32
 v_accvgpr_write_b32 a90, v33
 v_accvgpr_write_b32 a89, v34
 v_accvgpr_write_b32 a91, v35
 v_accvgpr_write_b32 a92, v36
 v_accvgpr_write_b32 a94, v37
 v_accvgpr_write_b32 a93, v38
 v_accvgpr_write_b32 a95, v39
 v_add_u32 v8, 49152, v6
 ds_read_b64_tr_b16 v[16:17], v8 offset:32
 ds_read_b64_tr_b16 v[18:19], v8 offset:2080
 ds_read_b64_tr_b16 v[20:21], v8 offset:8224
 ds_read_b64_tr_b16 v[22:23], v8 offset:10272
 ds_read_b64_tr_b16 v[24:25], v8 offset:16416
 ds_read_b64_tr_b16 v[26:27], v8 offset:18464
 ds_read_b64_tr_b16 v[28:29], v8 offset:24608
 ds_read_b64_tr_b16 v[30:31], v8 offset:26656
 ds_read_b64_tr_b16 v[32:33], v8 offset:32800
 ds_read_b64_tr_b16 v[34:35], v8 offset:34848
 ds_read_b64_tr_b16 v[36:37], v8 offset:40992
 ds_read_b64_tr_b16 v[38:39], v8 offset:43040
 s_waitcnt lgkmcnt(0)
 v_accvgpr_write_b32 a96, v16
 v_accvgpr_write_b32 a98, v17
 v_accvgpr_write_b32 a97, v18
 v_accvgpr_write_b32 a99, v19
 v_accvgpr_write_b32 a100, v20
 v_accvgpr_write_b32 a102, v21
 v_accvgpr_write_b32 a101, v22
 v_accvgpr_write_b32 a103, v23
 v_accvgpr_write_b32 a104, v24
 v_accvgpr_write_b32 a106, v25
 v_accvgpr_write_b32 a105, v26
 v_accvgpr_write_b32 a107, v27
 v_accvgpr_write_b32 a108, v28
 v_accvgpr_write_b32 a110, v29
 v_accvgpr_write_b32 a109, v30
 v_accvgpr_write_b32 a111, v31
 v_accvgpr_write_b32 a112, v32
 v_accvgpr_write_b32 a114, v33
 v_accvgpr_write_b32 a113, v34
 v_accvgpr_write_b32 a115, v35
 v_accvgpr_write_b32 a116, v36
 v_accvgpr_write_b32 a118, v37
 v_accvgpr_write_b32 a117, v38
 v_accvgpr_write_b32 a119, v39
 v_add_u32 v8, 98304, v6
 ds_read_b64_tr_b16 v[16:17], v8 offset:32
 ds_read_b64_tr_b16 v[18:19], v8 offset:2080
 ds_read_b64_tr_b16 v[20:21], v8 offset:8224
 ds_read_b64_tr_b16 v[22:23], v8 offset:10272
 ds_read_b64_tr_b16 v[24:25], v8 offset:16416
 ds_read_b64_tr_b16 v[26:27], v8 offset:18464
 ds_read_b64_tr_b16 v[28:29], v8 offset:24608
 ds_read_b64_tr_b16 v[30:31], v8 offset:26656
 ds_read_b64_tr_b16 v[32:33], v8 offset:32800
 ds_read_b64_tr_b16 v[34:35], v8 offset:34848
 ds_read_b64_tr_b16 v[36:37], v8 offset:40992
 ds_read_b64_tr_b16 v[38:39], v8 offset:43040
 s_waitcnt lgkmcnt(0)
 v_accvgpr_write_b32 a120, v16
 v_accvgpr_write_b32 a122, v17
 v_accvgpr_write_b32 a121, v18
 v_accvgpr_write_b32 a123, v19
 v_accvgpr_write_b32 a124, v20
 v_accvgpr_write_b32 a126, v21
 v_accvgpr_write_b32 a125, v22
 v_accvgpr_write_b32 a127, v23
 v_accvgpr_write_b32 a128, v24
 v_accvgpr_write_b32 a130, v25
 v_accvgpr_write_b32 a129, v26
 v_accvgpr_write_b32 a131, v27
 v_accvgpr_write_b32 a132, v28
 v_accvgpr_write_b32 a134, v29
 v_accvgpr_write_b32 a133, v30
 v_accvgpr_write_b32 a135, v31
 v_accvgpr_write_b32 a136, v32
 v_accvgpr_write_b32 a138, v33
 v_accvgpr_write_b32 a137, v34
 v_accvgpr_write_b32 a139, v35
 v_accvgpr_write_b32 a140, v36
 v_accvgpr_write_b32 a142, v37
 v_accvgpr_write_b32 a141, v38
 v_accvgpr_write_b32 a143, v39
 v_add_u32 v8, 0, v6
 ds_read_b64_tr_b16 v[16:17], v8 offset:64
 ds_read_b64_tr_b16 v[18:19], v8 offset:2112
 ds_read_b64_tr_b16 v[20:21], v8 offset:8256
 ds_read_b64_tr_b16 v[22:23], v8 offset:10304
 ds_read_b64_tr_b16 v[24:25], v8 offset:16448
 ds_read_b64_tr_b16 v[26:27], v8 offset:18496
 ds_read_b64_tr_b16 v[28:29], v8 offset:24640
 ds_read_b64_tr_b16 v[30:31], v8 offset:26688
 ds_read_b64_tr_b16 v[32:33], v8 offset:32832
 ds_read_b64_tr_b16 v[34:35], v8 offset:34880
 ds_read_b64_tr_b16 v[36:37], v8 offset:41024
 ds_read_b64_tr_b16 v[38:39], v8 offset:43072
 s_waitcnt lgkmcnt(0)
 v_accvgpr_write_b32 a144, v16
 v_accvgpr_write_b32 a146, v17
 v_accvgpr_write_b32 a145, v18
 v_accvgpr_write_b32 a147, v19
 v_accvgpr_write_b32 a148, v20
 v_accvgpr_write_b32 a150, v21
 v_accvgpr_write_b32 a149, v22
 v_accvgpr_write_b32 a151, v23
 v_accvgpr_write_b32 a152, v24
 v_accvgpr_write_b32 a154, v25
 v_accvgpr_write_b32 a153, v26
 v_accvgpr_write_b32 a155, v27
 v_accvgpr_write_b32 a156, v28
 v_accvgpr_write_b32 a158, v29
 v_accvgpr_write_b32 a157, v30
 v_accvgpr_write_b32 a159, v31
 v_accvgpr_write_b32 a160, v32
 v_accvgpr_write_b32 a162, v33
 v_accvgpr_write_b32 a161, v34
 v_accvgpr_write_b32 a163, v35
 v_accvgpr_write_b32 a164, v36
 v_accvgpr_write_b32 a166, v37
 v_accvgpr_write_b32 a165, v38
 v_accvgpr_write_b32 a167, v39
 v_add_u32 v8, 49152, v6
 ds_read_b64_tr_b16 v[16:17], v8 offset:64
 ds_read_b64_tr_b16 v[18:19], v8 offset:2112
 ds_read_b64_tr_b16 v[20:21], v8 offset:8256
 ds_read_b64_tr_b16 v[22:23], v8 offset:10304
 ds_read_b64_tr_b16 v[24:25], v8 offset:16448
 ds_read_b64_tr_b16 v[26:27], v8 offset:18496
 ds_read_b64_tr_b16 v[28:29], v8 offset:24640
 ds_read_b64_tr_b16 v[30:31], v8 offset:26688
 ds_read_b64_tr_b16 v[32:33], v8 offset:32832
 ds_read_b64_tr_b16 v[34:35], v8 offset:34880
 ds_read_b64_tr_b16 v[36:37], v8 offset:41024
 ds_read_b64_tr_b16 v[38:39], v8 offset:43072
 s_waitcnt lgkmcnt(0)
 v_accvgpr_write_b32 a168, v16
 v_accvgpr_write_b32 a170, v17
 v_accvgpr_write_b32 a169, v18
 v_accvgpr_write_b32 a171, v19
 v_accvgpr_write_b32 a172, v20
 v_accvgpr_write_b32 a174, v21
 v_accvgpr_write_b32 a173, v22
 v_accvgpr_write_b32 a175, v23
 v_accvgpr_write_b32 a176, v24
 v_accvgpr_write_b32 a178, v25
 v_accvgpr_write_b32 a177, v26
 v_accvgpr_write_b32 a179, v27
 v_accvgpr_write_b32 a180, v28
 v_accvgpr_write_b32 a182, v29
 v_accvgpr_write_b32 a181, v30
 v_accvgpr_write_b32 a183, v31
 v_accvgpr_write_b32 a184, v32
 v_accvgpr_write_b32 a186, v33
 v_accvgpr_write_b32 a185, v34
 v_accvgpr_write_b32 a187, v35
 v_accvgpr_write_b32 a188, v36
 v_accvgpr_write_b32 a190, v37
 v_accvgpr_write_b32 a189, v38
 v_accvgpr_write_b32 a191, v39
 v_add_u32 v8, 98304, v6
 ds_read_b64_tr_b16 v[16:17], v8 offset:64
 ds_read_b64_tr_b16 v[18:19], v8 offset:2112
 ds_read_b64_tr_b16 v[20:21], v8 offset:8256
 ds_read_b64_tr_b16 v[22:23], v8 offset:10304
 ds_read_b64_tr_b16 v[24:25], v8 offset:16448
 ds_read_b64_tr_b16 v[26:27], v8 offset:18496
 ds_read_b64_tr_b16 v[28:29], v8 offset:24640
 ds_read_b64_tr_b16 v[30:31], v8 offset:26688
 ds_read_b64_tr_b16 v[32:33], v8 offset:32832
 ds_read_b64_tr_b16 v[34:35], v8 offset:34880
 ds_read_b64_tr_b16 v[36:37], v8 offset:41024
 ds_read_b64_tr_b16 v[38:39], v8 offset:43072
 s_waitcnt lgkmcnt(0)
 v_accvgpr_write_b32 a192, v16
 v_accvgpr_write_b32 a194, v17
 v_accvgpr_write_b32 a193, v18
 v_accvgpr_write_b32 a195, v19
 v_accvgpr_write_b32 a196, v20
 v_accvgpr_write_b32 a198, v21
 v_accvgpr_write_b32 a197, v22
 v_accvgpr_write_b32 a199, v23
 v_accvgpr_write_b32 a200, v24
 v_accvgpr_write_b32 a202, v25
 v_accvgpr_write_b32 a201, v26
 v_accvgpr_write_b32 a203, v27
 v_accvgpr_write_b32 a204, v28
 v_accvgpr_write_b32 a206, v29
 v_accvgpr_write_b32 a205, v30
 v_accvgpr_write_b32 a207, v31
 v_accvgpr_write_b32 a208, v32
 v_accvgpr_write_b32 a210, v33
 v_accvgpr_write_b32 a209, v34
 v_accvgpr_write_b32 a211, v35
 v_accvgpr_write_b32 a212, v36
 v_accvgpr_write_b32 a214, v37
 v_accvgpr_write_b32 a213, v38
 v_accvgpr_write_b32 a215, v39
 v_add_u32 v8, 0, v6
 ds_read_b64_tr_b16 v[16:17], v8 offset:96
 ds_read_b64_tr_b16 v[18:19], v8 offset:2144
 ds_read_b64_tr_b16 v[20:21], v8 offset:8288
 ds_read_b64_tr_b16 v[22:23], v8 offset:10336
 ds_read_b64_tr_b16 v[24:25], v8 offset:16480
 ds_read_b64_tr_b16 v[26:27], v8 offset:18528
 ds_read_b64_tr_b16 v[28:29], v8 offset:24672
 ds_read_b64_tr_b16 v[30:31], v8 offset:26720
 ds_read_b64_tr_b16 v[32:33], v8 offset:32864
 ds_read_b64_tr_b16 v[34:35], v8 offset:34912
 ds_read_b64_tr_b16 v[36:37], v8 offset:41056
 ds_read_b64_tr_b16 v[38:39], v8 offset:43104
 s_waitcnt lgkmcnt(0)
 v_accvgpr_write_b32 a216, v16
 v_accvgpr_write_b32 a218, v17
 v_accvgpr_write_b32 a217, v18
 v_accvgpr_write_b32 a219, v19
 v_accvgpr_write_b32 a220, v20
 v_accvgpr_write_b32 a222, v21
 v_accvgpr_write_b32 a221, v22
 v_accvgpr_write_b32 a223, v23
 v_accvgpr_write_b32 a224, v24
 v_accvgpr_write_b32 a226, v25
 v_accvgpr_write_b32 a225, v26
 v_accvgpr_write_b32 a227, v27
 v_accvgpr_write_b32 a228, v28
 v_accvgpr_write_b32 a230, v29
 v_accvgpr_write_b32 a229, v30
 v_accvgpr_write_b32 a231, v31
 v_accvgpr_write_b32 a232, v32
 v_accvgpr_write_b32 a234, v33
 v_accvgpr_write_b32 a233, v34
 v_accvgpr_write_b32 a235, v35
 v_accvgpr_write_b32 a236, v36
 v_accvgpr_write_b32 a238, v37
 v_accvgpr_write_b32 a237, v38
 v_accvgpr_write_b32 a239, v39
 v_add_u32 v8, 49152, v6
 ds_read_b64_tr_b16 v[16:17], v8 offset:96
 ds_read_b64_tr_b16 v[18:19], v8 offset:2144
 ds_read_b64_tr_b16 v[20:21], v8 offset:8288
 ds_read_b64_tr_b16 v[22:23], v8 offset:10336
 ds_read_b64_tr_b16 v[24:25], v8 offset:16480
 ds_read_b64_tr_b16 v[26:27], v8 offset:18528
 ds_read_b64_tr_b16 v[28:29], v8 offset:24672
 ds_read_b64_tr_b16 v[30:31], v8 offset:26720
 ds_read_b64_tr_b16 v[32:33], v8 offset:32864
 ds_read_b64_tr_b16 v[34:35], v8 offset:34912
 ds_read_b64_tr_b16 v[36:37], v8 offset:41056
 ds_read_b64_tr_b16 v[38:39], v8 offset:43104
 s_waitcnt lgkmcnt(0)
 v_accvgpr_write_b32 a240, v16
 v_accvgpr_write_b32 a242, v17
 v_accvgpr_write_b32 a241, v18
 v_accvgpr_write_b32 a243, v19
 v_accvgpr_write_b32 a244, v20
 v_accvgpr_write_b32 a246, v21
 v_accvgpr_write_b32 a245, v22
 v_accvgpr_write_b32 a247, v23
 v_accvgpr_write_b32 a248, v24
 v_accvgpr_write_b32 a250, v25
 v_accvgpr_write_b32 a249, v26
 v_accvgpr_write_b32 a251, v27
 v_accvgpr_write_b32 a252, v28
 v_accvgpr_write_b32 a254, v29
 v_accvgpr_write_b32 a253, v30
 v_accvgpr_write_b32 a255, v31
 v_mov_b32 v80, v32
 v_mov_b32 v82, v33
 v_mov_b32 v81, v34
 v_mov_b32 v83, v35
 v_mov_b32 v84, v36
 v_mov_b32 v86, v37
 v_mov_b32 v85, v38
 v_mov_b32 v87, v39
 v_add_u32 v8, 98304, v6
 ds_read_b64_tr_b16 v[16:17], v8 offset:96
 ds_read_b64_tr_b16 v[18:19], v8 offset:2144
 ds_read_b64_tr_b16 v[20:21], v8 offset:8288
 ds_read_b64_tr_b16 v[22:23], v8 offset:10336
 ds_read_b64_tr_b16 v[24:25], v8 offset:16480
 ds_read_b64_tr_b16 v[26:27], v8 offset:18528
 ds_read_b64_tr_b16 v[28:29], v8 offset:24672
 ds_read_b64_tr_b16 v[30:31], v8 offset:26720
 ds_read_b64_tr_b16 v[32:33], v8 offset:32864
 ds_read_b64_tr_b16 v[34:35], v8 offset:34912
 ds_read_b64_tr_b16 v[36:37], v8 offset:41056
 ds_read_b64_tr_b16 v[38:39], v8 offset:43104
 s_waitcnt lgkmcnt(0)
 v_mov_b32 v88, v16
 v_mov_b32 v90, v17
 v_mov_b32 v89, v18
 v_mov_b32 v91, v19
 v_mov_b32 v92, v20
 v_mov_b32 v94, v21
 v_mov_b32 v93, v22
 v_mov_b32 v95, v23
 v_mov_b32 v96, v24
 v_mov_b32 v98, v25
 v_mov_b32 v97, v26
 v_mov_b32 v99, v27
 v_mov_b32 v100, v28
 v_mov_b32 v102, v29
 v_mov_b32 v101, v30
 v_mov_b32 v103, v31
 v_mov_b32 v104, v32
 v_mov_b32 v106, v33
 v_mov_b32 v105, v34
 v_mov_b32 v107, v35
 v_mov_b32 v108, v36
 v_mov_b32 v110, v37
 v_mov_b32 v109, v38
 v_mov_b32 v111, v39
mega_kernel_sk8:
 s_cmp_lg_u32 s14, 3
 s_cbranch_scc1 mega_kernel_sk9
 v_add_u32 v8, 0, v6
 ds_read_b64_tr_b16 v[16:17], v8 offset:128
 ds_read_b64_tr_b16 v[18:19], v8 offset:2176
 ds_read_b64_tr_b16 v[20:21], v8 offset:8320
 ds_read_b64_tr_b16 v[22:23], v8 offset:10368
 ds_read_b64_tr_b16 v[24:25], v8 offset:16512
 ds_read_b64_tr_b16 v[26:27], v8 offset:18560
 ds_read_b64_tr_b16 v[28:29], v8 offset:24704
 ds_read_b64_tr_b16 v[30:31], v8 offset:26752
 ds_read_b64_tr_b16 v[32:33], v8 offset:32896
 ds_read_b64_tr_b16 v[34:35], v8 offset:34944
 ds_read_b64_tr_b16 v[36:37], v8 offset:41088
 ds_read_b64_tr_b16 v[38:39], v8 offset:43136
 s_waitcnt lgkmcnt(0)
 v_accvgpr_write_b32 a0, v16
 v_accvgpr_write_b32 a2, v17
 v_accvgpr_write_b32 a1, v18
 v_accvgpr_write_b32 a3, v19
 v_accvgpr_write_b32 a4, v20
 v_accvgpr_write_b32 a6, v21
 v_accvgpr_write_b32 a5, v22
 v_accvgpr_write_b32 a7, v23
 v_accvgpr_write_b32 a8, v24
 v_accvgpr_write_b32 a10, v25
 v_accvgpr_write_b32 a9, v26
 v_accvgpr_write_b32 a11, v27
 v_accvgpr_write_b32 a12, v28
 v_accvgpr_write_b32 a14, v29
 v_accvgpr_write_b32 a13, v30
 v_accvgpr_write_b32 a15, v31
 v_accvgpr_write_b32 a16, v32
 v_accvgpr_write_b32 a18, v33
 v_accvgpr_write_b32 a17, v34
 v_accvgpr_write_b32 a19, v35
 v_accvgpr_write_b32 a20, v36
 v_accvgpr_write_b32 a22, v37
 v_accvgpr_write_b32 a21, v38
 v_accvgpr_write_b32 a23, v39
 v_add_u32 v8, 49152, v6
 ds_read_b64_tr_b16 v[16:17], v8 offset:128
 ds_read_b64_tr_b16 v[18:19], v8 offset:2176
 ds_read_b64_tr_b16 v[20:21], v8 offset:8320
 ds_read_b64_tr_b16 v[22:23], v8 offset:10368
 ds_read_b64_tr_b16 v[24:25], v8 offset:16512
 ds_read_b64_tr_b16 v[26:27], v8 offset:18560
 ds_read_b64_tr_b16 v[28:29], v8 offset:24704
 ds_read_b64_tr_b16 v[30:31], v8 offset:26752
 ds_read_b64_tr_b16 v[32:33], v8 offset:32896
 ds_read_b64_tr_b16 v[34:35], v8 offset:34944
 ds_read_b64_tr_b16 v[36:37], v8 offset:41088
 ds_read_b64_tr_b16 v[38:39], v8 offset:43136
 s_waitcnt lgkmcnt(0)
 v_accvgpr_write_b32 a24, v16
 v_accvgpr_write_b32 a26, v17
 v_accvgpr_write_b32 a25, v18
 v_accvgpr_write_b32 a27, v19
 v_accvgpr_write_b32 a28, v20
 v_accvgpr_write_b32 a30, v21
 v_accvgpr_write_b32 a29, v22
 v_accvgpr_write_b32 a31, v23
 v_accvgpr_write_b32 a32, v24
 v_accvgpr_write_b32 a34, v25
 v_accvgpr_write_b32 a33, v26
 v_accvgpr_write_b32 a35, v27
 v_accvgpr_write_b32 a36, v28
 v_accvgpr_write_b32 a38, v29
 v_accvgpr_write_b32 a37, v30
 v_accvgpr_write_b32 a39, v31
 v_accvgpr_write_b32 a40, v32
 v_accvgpr_write_b32 a42, v33
 v_accvgpr_write_b32 a41, v34
 v_accvgpr_write_b32 a43, v35
 v_accvgpr_write_b32 a44, v36
 v_accvgpr_write_b32 a46, v37
 v_accvgpr_write_b32 a45, v38
 v_accvgpr_write_b32 a47, v39
 v_add_u32 v8, 98304, v6
 ds_read_b64_tr_b16 v[16:17], v8 offset:128
 ds_read_b64_tr_b16 v[18:19], v8 offset:2176
 ds_read_b64_tr_b16 v[20:21], v8 offset:8320
 ds_read_b64_tr_b16 v[22:23], v8 offset:10368
 ds_read_b64_tr_b16 v[24:25], v8 offset:16512
 ds_read_b64_tr_b16 v[26:27], v8 offset:18560
 ds_read_b64_tr_b16 v[28:29], v8 offset:24704
 ds_read_b64_tr_b16 v[30:31], v8 offset:26752
 ds_read_b64_tr_b16 v[32:33], v8 offset:32896
 ds_read_b64_tr_b16 v[34:35], v8 offset:34944
 ds_read_b64_tr_b16 v[36:37], v8 offset:41088
 ds_read_b64_tr_b16 v[38:39], v8 offset:43136
 s_waitcnt lgkmcnt(0)
 v_accvgpr_write_b32 a48, v16
 v_accvgpr_write_b32 a50, v17
 v_accvgpr_write_b32 a49, v18
 v_accvgpr_write_b32 a51, v19
 v_accvgpr_write_b32 a52, v20
 v_accvgpr_write_b32 a54, v21
 v_accvgpr_write_b32 a53, v22
 v_accvgpr_write_b32 a55, v23
 v_accvgpr_write_b32 a56, v24
 v_accvgpr_write_b32 a58, v25
 v_accvgpr_write_b32 a57, v26
 v_accvgpr_write_b32 a59, v27
 v_accvgpr_write_b32 a60, v28
 v_accvgpr_write_b32 a62, v29
 v_accvgpr_write_b32 a61, v30
 v_accvgpr_write_b32 a63, v31
 v_accvgpr_write_b32 a64, v32
 v_accvgpr_write_b32 a66, v33
 v_accvgpr_write_b32 a65, v34
 v_accvgpr_write_b32 a67, v35
 v_accvgpr_write_b32 a68, v36
 v_accvgpr_write_b32 a70, v37
 v_accvgpr_write_b32 a69, v38
 v_accvgpr_write_b32 a71, v39
 v_add_u32 v8, 0, v6
 ds_read_b64_tr_b16 v[16:17], v8 offset:160
 ds_read_b64_tr_b16 v[18:19], v8 offset:2208
 ds_read_b64_tr_b16 v[20:21], v8 offset:8352
 ds_read_b64_tr_b16 v[22:23], v8 offset:10400
 ds_read_b64_tr_b16 v[24:25], v8 offset:16544
 ds_read_b64_tr_b16 v[26:27], v8 offset:18592
 ds_read_b64_tr_b16 v[28:29], v8 offset:24736
 ds_read_b64_tr_b16 v[30:31], v8 offset:26784
 ds_read_b64_tr_b16 v[32:33], v8 offset:32928
 ds_read_b64_tr_b16 v[34:35], v8 offset:34976
 ds_read_b64_tr_b16 v[36:37], v8 offset:41120
 ds_read_b64_tr_b16 v[38:39], v8 offset:43168
 s_waitcnt lgkmcnt(0)
 v_accvgpr_write_b32 a72, v16
 v_accvgpr_write_b32 a74, v17
 v_accvgpr_write_b32 a73, v18
 v_accvgpr_write_b32 a75, v19
 v_accvgpr_write_b32 a76, v20
 v_accvgpr_write_b32 a78, v21
 v_accvgpr_write_b32 a77, v22
 v_accvgpr_write_b32 a79, v23
 v_accvgpr_write_b32 a80, v24
 v_accvgpr_write_b32 a82, v25
 v_accvgpr_write_b32 a81, v26
 v_accvgpr_write_b32 a83, v27
 v_accvgpr_write_b32 a84, v28
 v_accvgpr_write_b32 a86, v29
 v_accvgpr_write_b32 a85, v30
 v_accvgpr_write_b32 a87, v31
 v_accvgpr_write_b32 a88, v32
 v_accvgpr_write_b32 a90, v33
 v_accvgpr_write_b32 a89, v34
 v_accvgpr_write_b32 a91, v35
 v_accvgpr_write_b32 a92, v36
 v_accvgpr_write_b32 a94, v37
 v_accvgpr_write_b32 a93, v38
 v_accvgpr_write_b32 a95, v39
 v_add_u32 v8, 49152, v6
 ds_read_b64_tr_b16 v[16:17], v8 offset:160
 ds_read_b64_tr_b16 v[18:19], v8 offset:2208
 ds_read_b64_tr_b16 v[20:21], v8 offset:8352
 ds_read_b64_tr_b16 v[22:23], v8 offset:10400
 ds_read_b64_tr_b16 v[24:25], v8 offset:16544
 ds_read_b64_tr_b16 v[26:27], v8 offset:18592
 ds_read_b64_tr_b16 v[28:29], v8 offset:24736
 ds_read_b64_tr_b16 v[30:31], v8 offset:26784
 ds_read_b64_tr_b16 v[32:33], v8 offset:32928
 ds_read_b64_tr_b16 v[34:35], v8 offset:34976
 ds_read_b64_tr_b16 v[36:37], v8 offset:41120
 ds_read_b64_tr_b16 v[38:39], v8 offset:43168
 s_waitcnt lgkmcnt(0)
 v_accvgpr_write_b32 a96, v16
 v_accvgpr_write_b32 a98, v17
 v_accvgpr_write_b32 a97, v18
 v_accvgpr_write_b32 a99, v19
 v_accvgpr_write_b32 a100, v20
 v_accvgpr_write_b32 a102, v21
 v_accvgpr_write_b32 a101, v22
 v_accvgpr_write_b32 a103, v23
 v_accvgpr_write_b32 a104, v24
 v_accvgpr_write_b32 a106, v25
 v_accvgpr_write_b32 a105, v26
 v_accvgpr_write_b32 a107, v27
 v_accvgpr_write_b32 a108, v28
 v_accvgpr_write_b32 a110, v29
 v_accvgpr_write_b32 a109, v30
 v_accvgpr_write_b32 a111, v31
 v_accvgpr_write_b32 a112, v32
 v_accvgpr_write_b32 a114, v33
 v_accvgpr_write_b32 a113, v34
 v_accvgpr_write_b32 a115, v35
 v_accvgpr_write_b32 a116, v36
 v_accvgpr_write_b32 a118, v37
 v_accvgpr_write_b32 a117, v38
 v_accvgpr_write_b32 a119, v39
 v_add_u32 v8, 98304, v6
 ds_read_b64_tr_b16 v[16:17], v8 offset:160
 ds_read_b64_tr_b16 v[18:19], v8 offset:2208
 ds_read_b64_tr_b16 v[20:21], v8 offset:8352
 ds_read_b64_tr_b16 v[22:23], v8 offset:10400
 ds_read_b64_tr_b16 v[24:25], v8 offset:16544
 ds_read_b64_tr_b16 v[26:27], v8 offset:18592
 ds_read_b64_tr_b16 v[28:29], v8 offset:24736
 ds_read_b64_tr_b16 v[30:31], v8 offset:26784
 ds_read_b64_tr_b16 v[32:33], v8 offset:32928
 ds_read_b64_tr_b16 v[34:35], v8 offset:34976
 ds_read_b64_tr_b16 v[36:37], v8 offset:41120
 ds_read_b64_tr_b16 v[38:39], v8 offset:43168
 s_waitcnt lgkmcnt(0)
 v_accvgpr_write_b32 a120, v16
 v_accvgpr_write_b32 a122, v17
 v_accvgpr_write_b32 a121, v18
 v_accvgpr_write_b32 a123, v19
 v_accvgpr_write_b32 a124, v20
 v_accvgpr_write_b32 a126, v21
 v_accvgpr_write_b32 a125, v22
 v_accvgpr_write_b32 a127, v23
 v_accvgpr_write_b32 a128, v24
 v_accvgpr_write_b32 a130, v25
 v_accvgpr_write_b32 a129, v26
 v_accvgpr_write_b32 a131, v27
 v_accvgpr_write_b32 a132, v28
 v_accvgpr_write_b32 a134, v29
 v_accvgpr_write_b32 a133, v30
 v_accvgpr_write_b32 a135, v31
 v_accvgpr_write_b32 a136, v32
 v_accvgpr_write_b32 a138, v33
 v_accvgpr_write_b32 a137, v34
 v_accvgpr_write_b32 a139, v35
 v_accvgpr_write_b32 a140, v36
 v_accvgpr_write_b32 a142, v37
 v_accvgpr_write_b32 a141, v38
 v_accvgpr_write_b32 a143, v39
 v_add_u32 v8, 0, v6
 ds_read_b64_tr_b16 v[16:17], v8 offset:192
 ds_read_b64_tr_b16 v[18:19], v8 offset:2240
 ds_read_b64_tr_b16 v[20:21], v8 offset:8384
 ds_read_b64_tr_b16 v[22:23], v8 offset:10432
 ds_read_b64_tr_b16 v[24:25], v8 offset:16576
 ds_read_b64_tr_b16 v[26:27], v8 offset:18624
 ds_read_b64_tr_b16 v[28:29], v8 offset:24768
 ds_read_b64_tr_b16 v[30:31], v8 offset:26816
 ds_read_b64_tr_b16 v[32:33], v8 offset:32960
 ds_read_b64_tr_b16 v[34:35], v8 offset:35008
 ds_read_b64_tr_b16 v[36:37], v8 offset:41152
 ds_read_b64_tr_b16 v[38:39], v8 offset:43200
 s_waitcnt lgkmcnt(0)
 v_accvgpr_write_b32 a144, v16
 v_accvgpr_write_b32 a146, v17
 v_accvgpr_write_b32 a145, v18
 v_accvgpr_write_b32 a147, v19
 v_accvgpr_write_b32 a148, v20
 v_accvgpr_write_b32 a150, v21
 v_accvgpr_write_b32 a149, v22
 v_accvgpr_write_b32 a151, v23
 v_accvgpr_write_b32 a152, v24
 v_accvgpr_write_b32 a154, v25
 v_accvgpr_write_b32 a153, v26
 v_accvgpr_write_b32 a155, v27
 v_accvgpr_write_b32 a156, v28
 v_accvgpr_write_b32 a158, v29
 v_accvgpr_write_b32 a157, v30
 v_accvgpr_write_b32 a159, v31
 v_accvgpr_write_b32 a160, v32
 v_accvgpr_write_b32 a162, v33
 v_accvgpr_write_b32 a161, v34
 v_accvgpr_write_b32 a163, v35
 v_accvgpr_write_b32 a164, v36
 v_accvgpr_write_b32 a166, v37
 v_accvgpr_write_b32 a165, v38
 v_accvgpr_write_b32 a167, v39
 v_add_u32 v8, 49152, v6
 ds_read_b64_tr_b16 v[16:17], v8 offset:192
 ds_read_b64_tr_b16 v[18:19], v8 offset:2240
 ds_read_b64_tr_b16 v[20:21], v8 offset:8384
 ds_read_b64_tr_b16 v[22:23], v8 offset:10432
 ds_read_b64_tr_b16 v[24:25], v8 offset:16576
 ds_read_b64_tr_b16 v[26:27], v8 offset:18624
 ds_read_b64_tr_b16 v[28:29], v8 offset:24768
 ds_read_b64_tr_b16 v[30:31], v8 offset:26816
 ds_read_b64_tr_b16 v[32:33], v8 offset:32960
 ds_read_b64_tr_b16 v[34:35], v8 offset:35008
 ds_read_b64_tr_b16 v[36:37], v8 offset:41152
 ds_read_b64_tr_b16 v[38:39], v8 offset:43200
 s_waitcnt lgkmcnt(0)
 v_accvgpr_write_b32 a168, v16
 v_accvgpr_write_b32 a170, v17
 v_accvgpr_write_b32 a169, v18
 v_accvgpr_write_b32 a171, v19
 v_accvgpr_write_b32 a172, v20
 v_accvgpr_write_b32 a174, v21
 v_accvgpr_write_b32 a173, v22
 v_accvgpr_write_b32 a175, v23
 v_accvgpr_write_b32 a176, v24
 v_accvgpr_write_b32 a178, v25
 v_accvgpr_write_b32 a177, v26
 v_accvgpr_write_b32 a179, v27
 v_accvgpr_write_b32 a180, v28
 v_accvgpr_write_b32 a182, v29
 v_accvgpr_write_b32 a181, v30
 v_accvgpr_write_b32 a183, v31
 v_accvgpr_write_b32 a184, v32
 v_accvgpr_write_b32 a186, v33
 v_accvgpr_write_b32 a185, v34
 v_accvgpr_write_b32 a187, v35
 v_accvgpr_write_b32 a188, v36
 v_accvgpr_write_b32 a190, v37
 v_accvgpr_write_b32 a189, v38
 v_accvgpr_write_b32 a191, v39
 v_add_u32 v8, 98304, v6
 ds_read_b64_tr_b16 v[16:17], v8 offset:192
 ds_read_b64_tr_b16 v[18:19], v8 offset:2240
 ds_read_b64_tr_b16 v[20:21], v8 offset:8384
 ds_read_b64_tr_b16 v[22:23], v8 offset:10432
 ds_read_b64_tr_b16 v[24:25], v8 offset:16576
 ds_read_b64_tr_b16 v[26:27], v8 offset:18624
 ds_read_b64_tr_b16 v[28:29], v8 offset:24768
 ds_read_b64_tr_b16 v[30:31], v8 offset:26816
 ds_read_b64_tr_b16 v[32:33], v8 offset:32960
 ds_read_b64_tr_b16 v[34:35], v8 offset:35008
 ds_read_b64_tr_b16 v[36:37], v8 offset:41152
 ds_read_b64_tr_b16 v[38:39], v8 offset:43200
 s_waitcnt lgkmcnt(0)
 v_accvgpr_write_b32 a192, v16
 v_accvgpr_write_b32 a194, v17
 v_accvgpr_write_b32 a193, v18
 v_accvgpr_write_b32 a195, v19
 v_accvgpr_write_b32 a196, v20
 v_accvgpr_write_b32 a198, v21
 v_accvgpr_write_b32 a197, v22
 v_accvgpr_write_b32 a199, v23
 v_accvgpr_write_b32 a200, v24
 v_accvgpr_write_b32 a202, v25
 v_accvgpr_write_b32 a201, v26
 v_accvgpr_write_b32 a203, v27
 v_accvgpr_write_b32 a204, v28
 v_accvgpr_write_b32 a206, v29
 v_accvgpr_write_b32 a205, v30
 v_accvgpr_write_b32 a207, v31
 v_accvgpr_write_b32 a208, v32
 v_accvgpr_write_b32 a210, v33
 v_accvgpr_write_b32 a209, v34
 v_accvgpr_write_b32 a211, v35
 v_accvgpr_write_b32 a212, v36
 v_accvgpr_write_b32 a214, v37
 v_accvgpr_write_b32 a213, v38
 v_accvgpr_write_b32 a215, v39
 v_add_u32 v8, 0, v6
 ds_read_b64_tr_b16 v[16:17], v8 offset:224
 ds_read_b64_tr_b16 v[18:19], v8 offset:2272
 ds_read_b64_tr_b16 v[20:21], v8 offset:8416
 ds_read_b64_tr_b16 v[22:23], v8 offset:10464
 ds_read_b64_tr_b16 v[24:25], v8 offset:16608
 ds_read_b64_tr_b16 v[26:27], v8 offset:18656
 ds_read_b64_tr_b16 v[28:29], v8 offset:24800
 ds_read_b64_tr_b16 v[30:31], v8 offset:26848
 ds_read_b64_tr_b16 v[32:33], v8 offset:32992
 ds_read_b64_tr_b16 v[34:35], v8 offset:35040
 ds_read_b64_tr_b16 v[36:37], v8 offset:41184
 ds_read_b64_tr_b16 v[38:39], v8 offset:43232
 s_waitcnt lgkmcnt(0)
 v_accvgpr_write_b32 a216, v16
 v_accvgpr_write_b32 a218, v17
 v_accvgpr_write_b32 a217, v18
 v_accvgpr_write_b32 a219, v19
 v_accvgpr_write_b32 a220, v20
 v_accvgpr_write_b32 a222, v21
 v_accvgpr_write_b32 a221, v22
 v_accvgpr_write_b32 a223, v23
 v_accvgpr_write_b32 a224, v24
 v_accvgpr_write_b32 a226, v25
 v_accvgpr_write_b32 a225, v26
 v_accvgpr_write_b32 a227, v27
 v_accvgpr_write_b32 a228, v28
 v_accvgpr_write_b32 a230, v29
 v_accvgpr_write_b32 a229, v30
 v_accvgpr_write_b32 a231, v31
 v_accvgpr_write_b32 a232, v32
 v_accvgpr_write_b32 a234, v33
 v_accvgpr_write_b32 a233, v34
 v_accvgpr_write_b32 a235, v35
 v_accvgpr_write_b32 a236, v36
 v_accvgpr_write_b32 a238, v37
 v_accvgpr_write_b32 a237, v38
 v_accvgpr_write_b32 a239, v39
 v_add_u32 v8, 49152, v6
 ds_read_b64_tr_b16 v[16:17], v8 offset:224
 ds_read_b64_tr_b16 v[18:19], v8 offset:2272
 ds_read_b64_tr_b16 v[20:21], v8 offset:8416
 ds_read_b64_tr_b16 v[22:23], v8 offset:10464
 ds_read_b64_tr_b16 v[24:25], v8 offset:16608
 ds_read_b64_tr_b16 v[26:27], v8 offset:18656
 ds_read_b64_tr_b16 v[28:29], v8 offset:24800
 ds_read_b64_tr_b16 v[30:31], v8 offset:26848
 ds_read_b64_tr_b16 v[32:33], v8 offset:32992
 ds_read_b64_tr_b16 v[34:35], v8 offset:35040
 ds_read_b64_tr_b16 v[36:37], v8 offset:41184
 ds_read_b64_tr_b16 v[38:39], v8 offset:43232
 s_waitcnt lgkmcnt(0)
 v_accvgpr_write_b32 a240, v16
 v_accvgpr_write_b32 a242, v17
 v_accvgpr_write_b32 a241, v18
 v_accvgpr_write_b32 a243, v19
 v_accvgpr_write_b32 a244, v20
 v_accvgpr_write_b32 a246, v21
 v_accvgpr_write_b32 a245, v22
 v_accvgpr_write_b32 a247, v23
 v_accvgpr_write_b32 a248, v24
 v_accvgpr_write_b32 a250, v25
 v_accvgpr_write_b32 a249, v26
 v_accvgpr_write_b32 a251, v27
 v_accvgpr_write_b32 a252, v28
 v_accvgpr_write_b32 a254, v29
 v_accvgpr_write_b32 a253, v30
 v_accvgpr_write_b32 a255, v31
 v_mov_b32 v80, v32
 v_mov_b32 v82, v33
 v_mov_b32 v81, v34
 v_mov_b32 v83, v35
 v_mov_b32 v84, v36
 v_mov_b32 v86, v37
 v_mov_b32 v85, v38
 v_mov_b32 v87, v39
 v_add_u32 v8, 98304, v6
 ds_read_b64_tr_b16 v[16:17], v8 offset:224
 ds_read_b64_tr_b16 v[18:19], v8 offset:2272
 ds_read_b64_tr_b16 v[20:21], v8 offset:8416
 ds_read_b64_tr_b16 v[22:23], v8 offset:10464
 ds_read_b64_tr_b16 v[24:25], v8 offset:16608
 ds_read_b64_tr_b16 v[26:27], v8 offset:18656
 ds_read_b64_tr_b16 v[28:29], v8 offset:24800
 ds_read_b64_tr_b16 v[30:31], v8 offset:26848
 ds_read_b64_tr_b16 v[32:33], v8 offset:32992
 ds_read_b64_tr_b16 v[34:35], v8 offset:35040
 ds_read_b64_tr_b16 v[36:37], v8 offset:41184
 ds_read_b64_tr_b16 v[38:39], v8 offset:43232
 s_waitcnt lgkmcnt(0)
 v_mov_b32 v88, v16
 v_mov_b32 v90, v17
 v_mov_b32 v89, v18
 v_mov_b32 v91, v19
 v_mov_b32 v92, v20
 v_mov_b32 v94, v21
 v_mov_b32 v93, v22
 v_mov_b32 v95, v23
 v_mov_b32 v96, v24
 v_mov_b32 v98, v25
 v_mov_b32 v97, v26
 v_mov_b32 v99, v27
 v_mov_b32 v100, v28
 v_mov_b32 v102, v29
 v_mov_b32 v101, v30
 v_mov_b32 v103, v31
 v_mov_b32 v104, v32
 v_mov_b32 v106, v33
 v_mov_b32 v105, v34
 v_mov_b32 v107, v35
 v_mov_b32 v108, v36
 v_mov_b32 v110, v37
 v_mov_b32 v109, v38
 v_mov_b32 v111, v39
mega_kernel_sk9:
 s_mov_b32 s36, s8
 s_and_b32 s37, s9, 0xffff
 s_mov_b32 s38, 4718592
 s_mov_b32 s39, 0x00020000
 s_barrier
 s_mul_i32 s33, s32, 32768
 s_add_u32 s33, s33, s15
 s_lshl_b32 s34, s32, 10
 s_add_u32 s35, s33, 0
 s_add_u32 m0, s34, 0
 s_nop 0
 buffer_load_dwordx4 v5, s[36:39], s35 offen lds
 s_add_u32 s35, s33, 32768
 s_add_u32 m0, s34, 1024
 s_nop 0
 buffer_load_dwordx4 v5, s[36:39], s35 offen lds
 s_add_u32 s35, s33, 65536
 s_add_u32 m0, s34, 2048
 s_nop 0
 buffer_load_dwordx4 v5, s[36:39], s35 offen lds
 s_add_u32 s35, s33, 98304
 s_add_u32 m0, s34, 3072
 s_nop 0
 buffer_load_dwordx4 v5, s[36:39], s35 offen lds
 s_add_u32 s35, s33, 131072
 s_add_u32 m0, s34, 4096
 s_nop 0
 buffer_load_dwordx4 v5, s[36:39], s35 offen lds
 s_add_u32 s35, s33, 163840
 s_add_u32 m0, s34, 5120
 s_nop 0
 buffer_load_dwordx4 v5, s[36:39], s35 offen lds
 s_add_u32 s35, s33, 196608
 s_add_u32 m0, s34, 6144
 s_nop 0
 buffer_load_dwordx4 v5, s[36:39], s35 offen lds
 s_add_u32 s35, s33, 229376
 s_add_u32 m0, s34, 7168
 s_nop 0
 buffer_load_dwordx4 v5, s[36:39], s35 offen lds
 s_add_u32 s35, s33, 262144
 s_add_u32 m0, s34, 8192
 s_nop 0
 buffer_load_dwordx4 v5, s[36:39], s35 offen lds
 s_add_u32 s35, s33, 294912
 s_add_u32 m0, s34, 9216
 s_nop 0
 buffer_load_dwordx4 v5, s[36:39], s35 offen lds
 s_add_u32 s35, s33, 327680
 s_add_u32 m0, s34, 10240
 s_nop 0
 buffer_load_dwordx4 v5, s[36:39], s35 offen lds
 s_add_u32 s35, s33, 360448
 s_add_u32 m0, s34, 11264
 s_nop 0
 buffer_load_dwordx4 v5, s[36:39], s35 offen lds
 s_add_u32 s35, s33, 393216
 s_add_u32 m0, s34, 12288
 s_nop 0
 buffer_load_dwordx4 v5, s[36:39], s35 offen lds
 s_add_u32 s35, s33, 425984
 s_add_u32 m0, s34, 13312
 s_nop 0
 buffer_load_dwordx4 v5, s[36:39], s35 offen lds
 s_add_u32 s35, s33, 458752
 s_add_u32 m0, s34, 14336
 s_nop 0
 buffer_load_dwordx4 v5, s[36:39], s35 offen lds
 s_add_u32 s35, s33, 491520
 s_add_u32 m0, s34, 15360
 s_nop 0
 buffer_load_dwordx4 v5, s[36:39], s35 offen lds
 s_add_u32 s35, s33, 524288
 s_add_u32 m0, s34, 16384
 s_nop 0
 buffer_load_dwordx4 v5, s[36:39], s35 offen lds
 s_add_u32 s35, s33, 557056
 s_add_u32 m0, s34, 17408
 s_nop 0
 buffer_load_dwordx4 v5, s[36:39], s35 offen lds
 s_add_u32 s35, s33, 589824
 s_add_u32 m0, s34, 18432
 s_nop 0
 buffer_load_dwordx4 v5, s[36:39], s35 offen lds
 s_add_u32 s35, s33, 622592
 s_add_u32 m0, s34, 19456
 s_nop 0
 buffer_load_dwordx4 v5, s[36:39], s35 offen lds
 s_add_u32 s35, s33, 655360
 s_add_u32 m0, s34, 20480
 s_nop 0
 buffer_load_dwordx4 v5, s[36:39], s35 offen lds
 s_add_u32 s35, s33, 688128
 s_add_u32 m0, s34, 21504
 s_nop 0
 buffer_load_dwordx4 v5, s[36:39], s35 offen lds
 s_add_u32 s35, s33, 720896
 s_add_u32 m0, s34, 22528
 s_nop 0
 buffer_load_dwordx4 v5, s[36:39], s35 offen lds
 s_add_u32 s35, s33, 753664
 s_add_u32 m0, s34, 23552
 s_nop 0
 buffer_load_dwordx4 v5, s[36:39], s35 offen lds
 s_add_u32 s35, s33, 786432
 s_add_u32 m0, s34, 24576
 s_nop 0
 buffer_load_dwordx4 v5, s[36:39], s35 offen lds
 s_add_u32 s35, s33, 819200
 s_add_u32 m0, s34, 25600
 s_nop 0
 buffer_load_dwordx4 v5, s[36:39], s35 offen lds
 s_add_u32 s35, s33, 851968
 s_add_u32 m0, s34, 26624
 s_nop 0
 buffer_load_dwordx4 v5, s[36:39], s35 offen lds
 s_add_u32 s35, s33, 884736
 s_add_u32 m0, s34, 27648
 s_nop 0
 buffer_load_dwordx4 v5, s[36:39], s35 offen lds
 s_add_u32 s35, s33, 917504
 s_add_u32 m0, s34, 28672
 s_nop 0
 buffer_load_dwordx4 v5, s[36:39], s35 offen lds
 s_add_u32 s35, s33, 950272
 s_add_u32 m0, s34, 29696
 s_nop 0
 buffer_load_dwordx4 v5, s[36:39], s35 offen lds
 s_add_u32 s35, s33, 983040
 s_add_u32 m0, s34, 30720
 s_nop 0
 buffer_load_dwordx4 v5, s[36:39], s35 offen lds
 s_add_u32 s35, s33, 1015808
 s_add_u32 m0, s34, 31744
 s_nop 0
 buffer_load_dwordx4 v5, s[36:39], s35 offen lds
 s_add_u32 s35, s33, 1048576
 s_add_u32 m0, s34, 32768
 s_nop 0
 buffer_load_dwordx4 v5, s[36:39], s35 offen lds
 s_add_u32 s35, s33, 1081344
 s_add_u32 m0, s34, 33792
 s_nop 0
 buffer_load_dwordx4 v5, s[36:39], s35 offen lds
 s_add_u32 s35, s33, 1114112
 s_add_u32 m0, s34, 34816
 s_nop 0
 buffer_load_dwordx4 v5, s[36:39], s35 offen lds
 s_add_u32 s35, s33, 1146880
 s_add_u32 m0, s34, 35840
 s_nop 0
 buffer_load_dwordx4 v5, s[36:39], s35 offen lds
 s_waitcnt vmcnt(0)
 s_barrier
 s_cmp_lg_u32 s14, 0
 s_cbranch_scc1 mega_kernel_sk10
 v_add_u32 v8, 0, v6
 ds_read_b64_tr_b16 v[16:17], v8 offset:0
 ds_read_b64_tr_b16 v[18:19], v8 offset:2048
 ds_read_b64_tr_b16 v[20:21], v8 offset:8192
 ds_read_b64_tr_b16 v[22:23], v8 offset:10240
 ds_read_b64_tr_b16 v[24:25], v8 offset:16384
 ds_read_b64_tr_b16 v[26:27], v8 offset:18432
 ds_read_b64_tr_b16 v[28:29], v8 offset:24576
 ds_read_b64_tr_b16 v[30:31], v8 offset:26624
 ds_read_b64_tr_b16 v[32:33], v8 offset:32768
 ds_read_b64_tr_b16 v[34:35], v8 offset:34816
 ds_read_b64_tr_b16 v[36:37], v8 offset:40960
 ds_read_b64_tr_b16 v[38:39], v8 offset:43008
 s_waitcnt lgkmcnt(0)
 v_mov_b32 v112, v16
 v_mov_b32 v114, v17
 v_mov_b32 v113, v18
 v_mov_b32 v115, v19
 v_mov_b32 v116, v20
 v_mov_b32 v118, v21
 v_mov_b32 v117, v22
 v_mov_b32 v119, v23
 v_mov_b32 v120, v24
 v_mov_b32 v122, v25
 v_mov_b32 v121, v26
 v_mov_b32 v123, v27
 v_mov_b32 v124, v28
 v_mov_b32 v126, v29
 v_mov_b32 v125, v30
 v_mov_b32 v127, v31
 v_mov_b32 v128, v32
 v_mov_b32 v130, v33
 v_mov_b32 v129, v34
 v_mov_b32 v131, v35
 v_mov_b32 v132, v36
 v_mov_b32 v134, v37
 v_mov_b32 v133, v38
 v_mov_b32 v135, v39
 v_add_u32 v8, 49152, v6
 ds_read_b64_tr_b16 v[16:17], v8 offset:0
 ds_read_b64_tr_b16 v[18:19], v8 offset:2048
 ds_read_b64_tr_b16 v[20:21], v8 offset:8192
 ds_read_b64_tr_b16 v[22:23], v8 offset:10240
 ds_read_b64_tr_b16 v[24:25], v8 offset:16384
 ds_read_b64_tr_b16 v[26:27], v8 offset:18432
 ds_read_b64_tr_b16 v[28:29], v8 offset:24576
 ds_read_b64_tr_b16 v[30:31], v8 offset:26624
 ds_read_b64_tr_b16 v[32:33], v8 offset:32768
 ds_read_b64_tr_b16 v[34:35], v8 offset:34816
 ds_read_b64_tr_b16 v[36:37], v8 offset:40960
 ds_read_b64_tr_b16 v[38:39], v8 offset:43008
 s_waitcnt lgkmcnt(0)
 v_mov_b32 v136, v16
 v_mov_b32 v138, v17
 v_mov_b32 v137, v18
 v_mov_b32 v139, v19
 v_mov_b32 v140, v20
 v_mov_b32 v142, v21
 v_mov_b32 v141, v22
 v_mov_b32 v143, v23
 v_mov_b32 v144, v24
 v_mov_b32 v146, v25
 v_mov_b32 v145, v26
 v_mov_b32 v147, v27
 v_mov_b32 v148, v28
 v_mov_b32 v150, v29
 v_mov_b32 v149, v30
 v_mov_b32 v151, v31
 v_mov_b32 v152, v32
 v_mov_b32 v154, v33
 v_mov_b32 v153, v34
 v_mov_b32 v155, v35
 v_mov_b32 v156, v36
 v_mov_b32 v158, v37
 v_mov_b32 v157, v38
 v_mov_b32 v159, v39
 v_add_u32 v8, 98304, v6
 ds_read_b64_tr_b16 v[16:17], v8 offset:0
 ds_read_b64_tr_b16 v[18:19], v8 offset:2048
 ds_read_b64_tr_b16 v[20:21], v8 offset:8192
 ds_read_b64_tr_b16 v[22:23], v8 offset:10240
 ds_read_b64_tr_b16 v[24:25], v8 offset:16384
 ds_read_b64_tr_b16 v[26:27], v8 offset:18432
 ds_read_b64_tr_b16 v[28:29], v8 offset:24576
 ds_read_b64_tr_b16 v[30:31], v8 offset:26624
 ds_read_b64_tr_b16 v[32:33], v8 offset:32768
 ds_read_b64_tr_b16 v[34:35], v8 offset:34816
 ds_read_b64_tr_b16 v[36:37], v8 offset:40960
 ds_read_b64_tr_b16 v[38:39], v8 offset:43008
 s_waitcnt lgkmcnt(0)
 v_mov_b32 v160, v16
 v_mov_b32 v162, v17
 v_mov_b32 v161, v18
 v_mov_b32 v163, v19
 v_mov_b32 v164, v20
 v_mov_b32 v166, v21
 v_mov_b32 v165, v22
 v_mov_b32 v167, v23
 v_mov_b32 v168, v24
 v_mov_b32 v170, v25
 v_mov_b32 v169, v26
 v_mov_b32 v171, v27
 v_mov_b32 v172, v28
 v_mov_b32 v174, v29
 v_mov_b32 v173, v30
 v_mov_b32 v175, v31
 v_mov_b32 v176, v32
 v_mov_b32 v178, v33
 v_mov_b32 v177, v34
 v_mov_b32 v179, v35
 v_mov_b32 v180, v36
 v_mov_b32 v182, v37
 v_mov_b32 v181, v38
 v_mov_b32 v183, v39
 v_add_u32 v8, 0, v6
 ds_read_b64_tr_b16 v[16:17], v8 offset:32
 ds_read_b64_tr_b16 v[18:19], v8 offset:2080
 ds_read_b64_tr_b16 v[20:21], v8 offset:8224
 ds_read_b64_tr_b16 v[22:23], v8 offset:10272
 ds_read_b64_tr_b16 v[24:25], v8 offset:16416
 ds_read_b64_tr_b16 v[26:27], v8 offset:18464
 ds_read_b64_tr_b16 v[28:29], v8 offset:24608
 ds_read_b64_tr_b16 v[30:31], v8 offset:26656
 ds_read_b64_tr_b16 v[32:33], v8 offset:32800
 ds_read_b64_tr_b16 v[34:35], v8 offset:34848
 ds_read_b64_tr_b16 v[36:37], v8 offset:40992
 ds_read_b64_tr_b16 v[38:39], v8 offset:43040
 s_waitcnt lgkmcnt(0)
 v_mov_b32 v184, v16
 v_mov_b32 v186, v17
 v_mov_b32 v185, v18
 v_mov_b32 v187, v19
 v_mov_b32 v188, v20
 v_mov_b32 v190, v21
 v_mov_b32 v189, v22
 v_mov_b32 v191, v23
 v_mov_b32 v192, v24
 v_mov_b32 v194, v25
 v_mov_b32 v193, v26
 v_mov_b32 v195, v27
 v_mov_b32 v196, v28
 v_mov_b32 v198, v29
 v_mov_b32 v197, v30
 v_mov_b32 v199, v31
 v_mov_b32 v200, v32
 v_mov_b32 v202, v33
 v_mov_b32 v201, v34
 v_mov_b32 v203, v35
 v_mov_b32 v204, v36
 v_mov_b32 v206, v37
 v_mov_b32 v205, v38
 v_mov_b32 v207, v39
 v_add_u32 v8, 49152, v6
 ds_read_b64_tr_b16 v[16:17], v8 offset:32
 ds_read_b64_tr_b16 v[18:19], v8 offset:2080
 ds_read_b64_tr_b16 v[20:21], v8 offset:8224
 ds_read_b64_tr_b16 v[22:23], v8 offset:10272
 ds_read_b64_tr_b16 v[24:25], v8 offset:16416
 ds_read_b64_tr_b16 v[26:27], v8 offset:18464
 ds_read_b64_tr_b16 v[28:29], v8 offset:24608
 ds_read_b64_tr_b16 v[30:31], v8 offset:26656
 ds_read_b64_tr_b16 v[32:33], v8 offset:32800
 ds_read_b64_tr_b16 v[34:35], v8 offset:34848
 ds_read_b64_tr_b16 v[36:37], v8 offset:40992
 ds_read_b64_tr_b16 v[38:39], v8 offset:43040
 s_waitcnt lgkmcnt(0)
 v_mov_b32 v208, v16
 v_mov_b32 v210, v17
 v_mov_b32 v209, v18
 v_mov_b32 v211, v19
 v_mov_b32 v212, v20
 v_mov_b32 v214, v21
 v_mov_b32 v213, v22
 v_mov_b32 v215, v23
 v_mov_b32 v216, v24
 v_mov_b32 v218, v25
 v_mov_b32 v217, v26
 v_mov_b32 v219, v27
 v_mov_b32 v220, v28
 v_mov_b32 v222, v29
 v_mov_b32 v221, v30
 v_mov_b32 v223, v31
 v_mov_b32 v224, v32
 v_mov_b32 v226, v33
 v_mov_b32 v225, v34
 v_mov_b32 v227, v35
 v_mov_b32 v228, v36
 v_mov_b32 v230, v37
 v_mov_b32 v229, v38
 v_mov_b32 v231, v39
 v_add_u32 v8, 98304, v6
 ds_read_b64_tr_b16 v[16:17], v8 offset:32
 ds_read_b64_tr_b16 v[18:19], v8 offset:2080
 ds_read_b64_tr_b16 v[20:21], v8 offset:8224
 ds_read_b64_tr_b16 v[22:23], v8 offset:10272
 ds_read_b64_tr_b16 v[24:25], v8 offset:16416
 ds_read_b64_tr_b16 v[26:27], v8 offset:18464
 ds_read_b64_tr_b16 v[28:29], v8 offset:24608
 ds_read_b64_tr_b16 v[30:31], v8 offset:26656
 ds_read_b64_tr_b16 v[32:33], v8 offset:32800
 ds_read_b64_tr_b16 v[34:35], v8 offset:34848
 ds_read_b64_tr_b16 v[36:37], v8 offset:40992
 ds_read_b64_tr_b16 v[38:39], v8 offset:43040
 s_waitcnt lgkmcnt(0)
 v_mov_b32 v232, v16
 v_mov_b32 v234, v17
 v_mov_b32 v233, v18
 v_mov_b32 v235, v19
 v_mov_b32 v236, v20
 v_mov_b32 v238, v21
 v_mov_b32 v237, v22
 v_mov_b32 v239, v23
 v_mov_b32 v240, v24
 v_mov_b32 v242, v25
 v_mov_b32 v241, v26
 v_mov_b32 v243, v27
 v_mov_b32 v244, v28
 v_mov_b32 v246, v29
 v_mov_b32 v245, v30
 v_mov_b32 v247, v31
 v_mov_b32 v248, v32
 v_mov_b32 v250, v33
 v_mov_b32 v249, v34
 v_mov_b32 v251, v35
 v_mov_b32 v252, v36
 v_mov_b32 v254, v37
 v_mov_b32 v253, v38
 v_mov_b32 v255, v39
mega_kernel_sk10:
 s_cmp_lg_u32 s14, 1
 s_cbranch_scc1 mega_kernel_sk11
 v_add_u32 v8, 0, v6
 ds_read_b64_tr_b16 v[16:17], v8 offset:64
 ds_read_b64_tr_b16 v[18:19], v8 offset:2112
 ds_read_b64_tr_b16 v[20:21], v8 offset:8256
 ds_read_b64_tr_b16 v[22:23], v8 offset:10304
 ds_read_b64_tr_b16 v[24:25], v8 offset:16448
 ds_read_b64_tr_b16 v[26:27], v8 offset:18496
 ds_read_b64_tr_b16 v[28:29], v8 offset:24640
 ds_read_b64_tr_b16 v[30:31], v8 offset:26688
 ds_read_b64_tr_b16 v[32:33], v8 offset:32832
 ds_read_b64_tr_b16 v[34:35], v8 offset:34880
 ds_read_b64_tr_b16 v[36:37], v8 offset:41024
 ds_read_b64_tr_b16 v[38:39], v8 offset:43072
 s_waitcnt lgkmcnt(0)
 v_mov_b32 v112, v16
 v_mov_b32 v114, v17
 v_mov_b32 v113, v18
 v_mov_b32 v115, v19
 v_mov_b32 v116, v20
 v_mov_b32 v118, v21
 v_mov_b32 v117, v22
 v_mov_b32 v119, v23
 v_mov_b32 v120, v24
 v_mov_b32 v122, v25
 v_mov_b32 v121, v26
 v_mov_b32 v123, v27
 v_mov_b32 v124, v28
 v_mov_b32 v126, v29
 v_mov_b32 v125, v30
 v_mov_b32 v127, v31
 v_mov_b32 v128, v32
 v_mov_b32 v130, v33
 v_mov_b32 v129, v34
 v_mov_b32 v131, v35
 v_mov_b32 v132, v36
 v_mov_b32 v134, v37
 v_mov_b32 v133, v38
 v_mov_b32 v135, v39
 v_add_u32 v8, 49152, v6
 ds_read_b64_tr_b16 v[16:17], v8 offset:64
 ds_read_b64_tr_b16 v[18:19], v8 offset:2112
 ds_read_b64_tr_b16 v[20:21], v8 offset:8256
 ds_read_b64_tr_b16 v[22:23], v8 offset:10304
 ds_read_b64_tr_b16 v[24:25], v8 offset:16448
 ds_read_b64_tr_b16 v[26:27], v8 offset:18496
 ds_read_b64_tr_b16 v[28:29], v8 offset:24640
 ds_read_b64_tr_b16 v[30:31], v8 offset:26688
 ds_read_b64_tr_b16 v[32:33], v8 offset:32832
 ds_read_b64_tr_b16 v[34:35], v8 offset:34880
 ds_read_b64_tr_b16 v[36:37], v8 offset:41024
 ds_read_b64_tr_b16 v[38:39], v8 offset:43072
 s_waitcnt lgkmcnt(0)
 v_mov_b32 v136, v16
 v_mov_b32 v138, v17
 v_mov_b32 v137, v18
 v_mov_b32 v139, v19
 v_mov_b32 v140, v20
 v_mov_b32 v142, v21
 v_mov_b32 v141, v22
 v_mov_b32 v143, v23
 v_mov_b32 v144, v24
 v_mov_b32 v146, v25
 v_mov_b32 v145, v26
 v_mov_b32 v147, v27
 v_mov_b32 v148, v28
 v_mov_b32 v150, v29
 v_mov_b32 v149, v30
 v_mov_b32 v151, v31
 v_mov_b32 v152, v32
 v_mov_b32 v154, v33
 v_mov_b32 v153, v34
 v_mov_b32 v155, v35
 v_mov_b32 v156, v36
 v_mov_b32 v158, v37
 v_mov_b32 v157, v38
 v_mov_b32 v159, v39
 v_add_u32 v8, 98304, v6
 ds_read_b64_tr_b16 v[16:17], v8 offset:64
 ds_read_b64_tr_b16 v[18:19], v8 offset:2112
 ds_read_b64_tr_b16 v[20:21], v8 offset:8256
 ds_read_b64_tr_b16 v[22:23], v8 offset:10304
 ds_read_b64_tr_b16 v[24:25], v8 offset:16448
 ds_read_b64_tr_b16 v[26:27], v8 offset:18496
 ds_read_b64_tr_b16 v[28:29], v8 offset:24640
 ds_read_b64_tr_b16 v[30:31], v8 offset:26688
 ds_read_b64_tr_b16 v[32:33], v8 offset:32832
 ds_read_b64_tr_b16 v[34:35], v8 offset:34880
 ds_read_b64_tr_b16 v[36:37], v8 offset:41024
 ds_read_b64_tr_b16 v[38:39], v8 offset:43072
 s_waitcnt lgkmcnt(0)
 v_mov_b32 v160, v16
 v_mov_b32 v162, v17
 v_mov_b32 v161, v18
 v_mov_b32 v163, v19
 v_mov_b32 v164, v20
 v_mov_b32 v166, v21
 v_mov_b32 v165, v22
 v_mov_b32 v167, v23
 v_mov_b32 v168, v24
 v_mov_b32 v170, v25
 v_mov_b32 v169, v26
 v_mov_b32 v171, v27
 v_mov_b32 v172, v28
 v_mov_b32 v174, v29
 v_mov_b32 v173, v30
 v_mov_b32 v175, v31
 v_mov_b32 v176, v32
 v_mov_b32 v178, v33
 v_mov_b32 v177, v34
 v_mov_b32 v179, v35
 v_mov_b32 v180, v36
 v_mov_b32 v182, v37
 v_mov_b32 v181, v38
 v_mov_b32 v183, v39
 v_add_u32 v8, 0, v6
 ds_read_b64_tr_b16 v[16:17], v8 offset:96
 ds_read_b64_tr_b16 v[18:19], v8 offset:2144
 ds_read_b64_tr_b16 v[20:21], v8 offset:8288
 ds_read_b64_tr_b16 v[22:23], v8 offset:10336
 ds_read_b64_tr_b16 v[24:25], v8 offset:16480
 ds_read_b64_tr_b16 v[26:27], v8 offset:18528
 ds_read_b64_tr_b16 v[28:29], v8 offset:24672
 ds_read_b64_tr_b16 v[30:31], v8 offset:26720
 ds_read_b64_tr_b16 v[32:33], v8 offset:32864
 ds_read_b64_tr_b16 v[34:35], v8 offset:34912
 ds_read_b64_tr_b16 v[36:37], v8 offset:41056
 ds_read_b64_tr_b16 v[38:39], v8 offset:43104
 s_waitcnt lgkmcnt(0)
 v_mov_b32 v184, v16
 v_mov_b32 v186, v17
 v_mov_b32 v185, v18
 v_mov_b32 v187, v19
 v_mov_b32 v188, v20
 v_mov_b32 v190, v21
 v_mov_b32 v189, v22
 v_mov_b32 v191, v23
 v_mov_b32 v192, v24
 v_mov_b32 v194, v25
 v_mov_b32 v193, v26
 v_mov_b32 v195, v27
 v_mov_b32 v196, v28
 v_mov_b32 v198, v29
 v_mov_b32 v197, v30
 v_mov_b32 v199, v31
 v_mov_b32 v200, v32
 v_mov_b32 v202, v33
 v_mov_b32 v201, v34
 v_mov_b32 v203, v35
 v_mov_b32 v204, v36
 v_mov_b32 v206, v37
 v_mov_b32 v205, v38
 v_mov_b32 v207, v39
 v_add_u32 v8, 49152, v6
 ds_read_b64_tr_b16 v[16:17], v8 offset:96
 ds_read_b64_tr_b16 v[18:19], v8 offset:2144
 ds_read_b64_tr_b16 v[20:21], v8 offset:8288
 ds_read_b64_tr_b16 v[22:23], v8 offset:10336
 ds_read_b64_tr_b16 v[24:25], v8 offset:16480
 ds_read_b64_tr_b16 v[26:27], v8 offset:18528
 ds_read_b64_tr_b16 v[28:29], v8 offset:24672
 ds_read_b64_tr_b16 v[30:31], v8 offset:26720
 ds_read_b64_tr_b16 v[32:33], v8 offset:32864
 ds_read_b64_tr_b16 v[34:35], v8 offset:34912
 ds_read_b64_tr_b16 v[36:37], v8 offset:41056
 ds_read_b64_tr_b16 v[38:39], v8 offset:43104
 s_waitcnt lgkmcnt(0)
 v_mov_b32 v208, v16
 v_mov_b32 v210, v17
 v_mov_b32 v209, v18
 v_mov_b32 v211, v19
 v_mov_b32 v212, v20
 v_mov_b32 v214, v21
 v_mov_b32 v213, v22
 v_mov_b32 v215, v23
 v_mov_b32 v216, v24
 v_mov_b32 v218, v25
 v_mov_b32 v217, v26
 v_mov_b32 v219, v27
 v_mov_b32 v220, v28
 v_mov_b32 v222, v29
 v_mov_b32 v221, v30
 v_mov_b32 v223, v31
 v_mov_b32 v224, v32
 v_mov_b32 v226, v33
 v_mov_b32 v225, v34
 v_mov_b32 v227, v35
 v_mov_b32 v228, v36
 v_mov_b32 v230, v37
 v_mov_b32 v229, v38
 v_mov_b32 v231, v39
 v_add_u32 v8, 98304, v6
 ds_read_b64_tr_b16 v[16:17], v8 offset:96
 ds_read_b64_tr_b16 v[18:19], v8 offset:2144
 ds_read_b64_tr_b16 v[20:21], v8 offset:8288
 ds_read_b64_tr_b16 v[22:23], v8 offset:10336
 ds_read_b64_tr_b16 v[24:25], v8 offset:16480
 ds_read_b64_tr_b16 v[26:27], v8 offset:18528
 ds_read_b64_tr_b16 v[28:29], v8 offset:24672
 ds_read_b64_tr_b16 v[30:31], v8 offset:26720
 ds_read_b64_tr_b16 v[32:33], v8 offset:32864
 ds_read_b64_tr_b16 v[34:35], v8 offset:34912
 ds_read_b64_tr_b16 v[36:37], v8 offset:41056
 ds_read_b64_tr_b16 v[38:39], v8 offset:43104
 s_waitcnt lgkmcnt(0)
 v_mov_b32 v232, v16
 v_mov_b32 v234, v17
 v_mov_b32 v233, v18
 v_mov_b32 v235, v19
 v_mov_b32 v236, v20
 v_mov_b32 v238, v21
 v_mov_b32 v237, v22
 v_mov_b32 v239, v23
 v_mov_b32 v240, v24
 v_mov_b32 v242, v25
 v_mov_b32 v241, v26
 v_mov_b32 v243, v27
 v_mov_b32 v244, v28
 v_mov_b32 v246, v29
 v_mov_b32 v245, v30
 v_mov_b32 v247, v31
 v_mov_b32 v248, v32
 v_mov_b32 v250, v33
 v_mov_b32 v249, v34
 v_mov_b32 v251, v35
 v_mov_b32 v252, v36
 v_mov_b32 v254, v37
 v_mov_b32 v253, v38
 v_mov_b32 v255, v39
mega_kernel_sk11:
 s_cmp_lg_u32 s14, 2
 s_cbranch_scc1 mega_kernel_sk12
 v_add_u32 v8, 0, v6
 ds_read_b64_tr_b16 v[16:17], v8 offset:128
 ds_read_b64_tr_b16 v[18:19], v8 offset:2176
 ds_read_b64_tr_b16 v[20:21], v8 offset:8320
 ds_read_b64_tr_b16 v[22:23], v8 offset:10368
 ds_read_b64_tr_b16 v[24:25], v8 offset:16512
 ds_read_b64_tr_b16 v[26:27], v8 offset:18560
 ds_read_b64_tr_b16 v[28:29], v8 offset:24704
 ds_read_b64_tr_b16 v[30:31], v8 offset:26752
 ds_read_b64_tr_b16 v[32:33], v8 offset:32896
 ds_read_b64_tr_b16 v[34:35], v8 offset:34944
 ds_read_b64_tr_b16 v[36:37], v8 offset:41088
 ds_read_b64_tr_b16 v[38:39], v8 offset:43136
 s_waitcnt lgkmcnt(0)
 v_mov_b32 v112, v16
 v_mov_b32 v114, v17
 v_mov_b32 v113, v18
 v_mov_b32 v115, v19
 v_mov_b32 v116, v20
 v_mov_b32 v118, v21
 v_mov_b32 v117, v22
 v_mov_b32 v119, v23
 v_mov_b32 v120, v24
 v_mov_b32 v122, v25
 v_mov_b32 v121, v26
 v_mov_b32 v123, v27
 v_mov_b32 v124, v28
 v_mov_b32 v126, v29
 v_mov_b32 v125, v30
 v_mov_b32 v127, v31
 v_mov_b32 v128, v32
 v_mov_b32 v130, v33
 v_mov_b32 v129, v34
 v_mov_b32 v131, v35
 v_mov_b32 v132, v36
 v_mov_b32 v134, v37
 v_mov_b32 v133, v38
 v_mov_b32 v135, v39
 v_add_u32 v8, 49152, v6
 ds_read_b64_tr_b16 v[16:17], v8 offset:128
 ds_read_b64_tr_b16 v[18:19], v8 offset:2176
 ds_read_b64_tr_b16 v[20:21], v8 offset:8320
 ds_read_b64_tr_b16 v[22:23], v8 offset:10368
 ds_read_b64_tr_b16 v[24:25], v8 offset:16512
 ds_read_b64_tr_b16 v[26:27], v8 offset:18560
 ds_read_b64_tr_b16 v[28:29], v8 offset:24704
 ds_read_b64_tr_b16 v[30:31], v8 offset:26752
 ds_read_b64_tr_b16 v[32:33], v8 offset:32896
 ds_read_b64_tr_b16 v[34:35], v8 offset:34944
 ds_read_b64_tr_b16 v[36:37], v8 offset:41088
 ds_read_b64_tr_b16 v[38:39], v8 offset:43136
 s_waitcnt lgkmcnt(0)
 v_mov_b32 v136, v16
 v_mov_b32 v138, v17
 v_mov_b32 v137, v18
 v_mov_b32 v139, v19
 v_mov_b32 v140, v20
 v_mov_b32 v142, v21
 v_mov_b32 v141, v22
 v_mov_b32 v143, v23
 v_mov_b32 v144, v24
 v_mov_b32 v146, v25
 v_mov_b32 v145, v26
 v_mov_b32 v147, v27
 v_mov_b32 v148, v28
 v_mov_b32 v150, v29
 v_mov_b32 v149, v30
 v_mov_b32 v151, v31
 v_mov_b32 v152, v32
 v_mov_b32 v154, v33
 v_mov_b32 v153, v34
 v_mov_b32 v155, v35
 v_mov_b32 v156, v36
 v_mov_b32 v158, v37
 v_mov_b32 v157, v38
 v_mov_b32 v159, v39
 v_add_u32 v8, 98304, v6
 ds_read_b64_tr_b16 v[16:17], v8 offset:128
 ds_read_b64_tr_b16 v[18:19], v8 offset:2176
 ds_read_b64_tr_b16 v[20:21], v8 offset:8320
 ds_read_b64_tr_b16 v[22:23], v8 offset:10368
 ds_read_b64_tr_b16 v[24:25], v8 offset:16512
 ds_read_b64_tr_b16 v[26:27], v8 offset:18560
 ds_read_b64_tr_b16 v[28:29], v8 offset:24704
 ds_read_b64_tr_b16 v[30:31], v8 offset:26752
 ds_read_b64_tr_b16 v[32:33], v8 offset:32896
 ds_read_b64_tr_b16 v[34:35], v8 offset:34944
 ds_read_b64_tr_b16 v[36:37], v8 offset:41088
 ds_read_b64_tr_b16 v[38:39], v8 offset:43136
 s_waitcnt lgkmcnt(0)
 v_mov_b32 v160, v16
 v_mov_b32 v162, v17
 v_mov_b32 v161, v18
 v_mov_b32 v163, v19
 v_mov_b32 v164, v20
 v_mov_b32 v166, v21
 v_mov_b32 v165, v22
 v_mov_b32 v167, v23
 v_mov_b32 v168, v24
 v_mov_b32 v170, v25
 v_mov_b32 v169, v26
 v_mov_b32 v171, v27
 v_mov_b32 v172, v28
 v_mov_b32 v174, v29
 v_mov_b32 v173, v30
 v_mov_b32 v175, v31
 v_mov_b32 v176, v32
 v_mov_b32 v178, v33
 v_mov_b32 v177, v34
 v_mov_b32 v179, v35
 v_mov_b32 v180, v36
 v_mov_b32 v182, v37
 v_mov_b32 v181, v38
 v_mov_b32 v183, v39
 v_add_u32 v8, 0, v6
 ds_read_b64_tr_b16 v[16:17], v8 offset:160
 ds_read_b64_tr_b16 v[18:19], v8 offset:2208
 ds_read_b64_tr_b16 v[20:21], v8 offset:8352
 ds_read_b64_tr_b16 v[22:23], v8 offset:10400
 ds_read_b64_tr_b16 v[24:25], v8 offset:16544
 ds_read_b64_tr_b16 v[26:27], v8 offset:18592
 ds_read_b64_tr_b16 v[28:29], v8 offset:24736
 ds_read_b64_tr_b16 v[30:31], v8 offset:26784
 ds_read_b64_tr_b16 v[32:33], v8 offset:32928
 ds_read_b64_tr_b16 v[34:35], v8 offset:34976
 ds_read_b64_tr_b16 v[36:37], v8 offset:41120
 ds_read_b64_tr_b16 v[38:39], v8 offset:43168
 s_waitcnt lgkmcnt(0)
 v_mov_b32 v184, v16
 v_mov_b32 v186, v17
 v_mov_b32 v185, v18
 v_mov_b32 v187, v19
 v_mov_b32 v188, v20
 v_mov_b32 v190, v21
 v_mov_b32 v189, v22
 v_mov_b32 v191, v23
 v_mov_b32 v192, v24
 v_mov_b32 v194, v25
 v_mov_b32 v193, v26
 v_mov_b32 v195, v27
 v_mov_b32 v196, v28
 v_mov_b32 v198, v29
 v_mov_b32 v197, v30
 v_mov_b32 v199, v31
 v_mov_b32 v200, v32
 v_mov_b32 v202, v33
 v_mov_b32 v201, v34
 v_mov_b32 v203, v35
 v_mov_b32 v204, v36
 v_mov_b32 v206, v37
 v_mov_b32 v205, v38
 v_mov_b32 v207, v39
 v_add_u32 v8, 49152, v6
 ds_read_b64_tr_b16 v[16:17], v8 offset:160
 ds_read_b64_tr_b16 v[18:19], v8 offset:2208
 ds_read_b64_tr_b16 v[20:21], v8 offset:8352
 ds_read_b64_tr_b16 v[22:23], v8 offset:10400
 ds_read_b64_tr_b16 v[24:25], v8 offset:16544
 ds_read_b64_tr_b16 v[26:27], v8 offset:18592
 ds_read_b64_tr_b16 v[28:29], v8 offset:24736
 ds_read_b64_tr_b16 v[30:31], v8 offset:26784
 ds_read_b64_tr_b16 v[32:33], v8 offset:32928
 ds_read_b64_tr_b16 v[34:35], v8 offset:34976
 ds_read_b64_tr_b16 v[36:37], v8 offset:41120
 ds_read_b64_tr_b16 v[38:39], v8 offset:43168
 s_waitcnt lgkmcnt(0)
 v_mov_b32 v208, v16
 v_mov_b32 v210, v17
 v_mov_b32 v209, v18
 v_mov_b32 v211, v19
 v_mov_b32 v212, v20
 v_mov_b32 v214, v21
 v_mov_b32 v213, v22
 v_mov_b32 v215, v23
 v_mov_b32 v216, v24
 v_mov_b32 v218, v25
 v_mov_b32 v217, v26
 v_mov_b32 v219, v27
 v_mov_b32 v220, v28
 v_mov_b32 v222, v29
 v_mov_b32 v221, v30
 v_mov_b32 v223, v31
 v_mov_b32 v224, v32
 v_mov_b32 v226, v33
 v_mov_b32 v225, v34
 v_mov_b32 v227, v35
 v_mov_b32 v228, v36
 v_mov_b32 v230, v37
 v_mov_b32 v229, v38
 v_mov_b32 v231, v39
 v_add_u32 v8, 98304, v6
 ds_read_b64_tr_b16 v[16:17], v8 offset:160
 ds_read_b64_tr_b16 v[18:19], v8 offset:2208
 ds_read_b64_tr_b16 v[20:21], v8 offset:8352
 ds_read_b64_tr_b16 v[22:23], v8 offset:10400
 ds_read_b64_tr_b16 v[24:25], v8 offset:16544
 ds_read_b64_tr_b16 v[26:27], v8 offset:18592
 ds_read_b64_tr_b16 v[28:29], v8 offset:24736
 ds_read_b64_tr_b16 v[30:31], v8 offset:26784
 ds_read_b64_tr_b16 v[32:33], v8 offset:32928
 ds_read_b64_tr_b16 v[34:35], v8 offset:34976
 ds_read_b64_tr_b16 v[36:37], v8 offset:41120
 ds_read_b64_tr_b16 v[38:39], v8 offset:43168
 s_waitcnt lgkmcnt(0)
 v_mov_b32 v232, v16
 v_mov_b32 v234, v17
 v_mov_b32 v233, v18
 v_mov_b32 v235, v19
 v_mov_b32 v236, v20
 v_mov_b32 v238, v21
 v_mov_b32 v237, v22
 v_mov_b32 v239, v23
 v_mov_b32 v240, v24
 v_mov_b32 v242, v25
 v_mov_b32 v241, v26
 v_mov_b32 v243, v27
 v_mov_b32 v244, v28
 v_mov_b32 v246, v29
 v_mov_b32 v245, v30
 v_mov_b32 v247, v31
 v_mov_b32 v248, v32
 v_mov_b32 v250, v33
 v_mov_b32 v249, v34
 v_mov_b32 v251, v35
 v_mov_b32 v252, v36
 v_mov_b32 v254, v37
 v_mov_b32 v253, v38
 v_mov_b32 v255, v39
mega_kernel_sk12:
 s_cmp_lg_u32 s14, 3
 s_cbranch_scc1 mega_kernel_sk13
 v_add_u32 v8, 0, v6
 ds_read_b64_tr_b16 v[16:17], v8 offset:192
 ds_read_b64_tr_b16 v[18:19], v8 offset:2240
 ds_read_b64_tr_b16 v[20:21], v8 offset:8384
 ds_read_b64_tr_b16 v[22:23], v8 offset:10432
 ds_read_b64_tr_b16 v[24:25], v8 offset:16576
 ds_read_b64_tr_b16 v[26:27], v8 offset:18624
 ds_read_b64_tr_b16 v[28:29], v8 offset:24768
 ds_read_b64_tr_b16 v[30:31], v8 offset:26816
 ds_read_b64_tr_b16 v[32:33], v8 offset:32960
 ds_read_b64_tr_b16 v[34:35], v8 offset:35008
 ds_read_b64_tr_b16 v[36:37], v8 offset:41152
 ds_read_b64_tr_b16 v[38:39], v8 offset:43200
 s_waitcnt lgkmcnt(0)
 v_mov_b32 v112, v16
 v_mov_b32 v114, v17
 v_mov_b32 v113, v18
 v_mov_b32 v115, v19
 v_mov_b32 v116, v20
 v_mov_b32 v118, v21
 v_mov_b32 v117, v22
 v_mov_b32 v119, v23
 v_mov_b32 v120, v24
 v_mov_b32 v122, v25
 v_mov_b32 v121, v26
 v_mov_b32 v123, v27
 v_mov_b32 v124, v28
 v_mov_b32 v126, v29
 v_mov_b32 v125, v30
 v_mov_b32 v127, v31
 v_mov_b32 v128, v32
 v_mov_b32 v130, v33
 v_mov_b32 v129, v34
 v_mov_b32 v131, v35
 v_mov_b32 v132, v36
 v_mov_b32 v134, v37
 v_mov_b32 v133, v38
 v_mov_b32 v135, v39
 v_add_u32 v8, 49152, v6
 ds_read_b64_tr_b16 v[16:17], v8 offset:192
 ds_read_b64_tr_b16 v[18:19], v8 offset:2240
 ds_read_b64_tr_b16 v[20:21], v8 offset:8384
 ds_read_b64_tr_b16 v[22:23], v8 offset:10432
 ds_read_b64_tr_b16 v[24:25], v8 offset:16576
 ds_read_b64_tr_b16 v[26:27], v8 offset:18624
 ds_read_b64_tr_b16 v[28:29], v8 offset:24768
 ds_read_b64_tr_b16 v[30:31], v8 offset:26816
 ds_read_b64_tr_b16 v[32:33], v8 offset:32960
 ds_read_b64_tr_b16 v[34:35], v8 offset:35008
 ds_read_b64_tr_b16 v[36:37], v8 offset:41152
 ds_read_b64_tr_b16 v[38:39], v8 offset:43200
 s_waitcnt lgkmcnt(0)
 v_mov_b32 v136, v16
 v_mov_b32 v138, v17
 v_mov_b32 v137, v18
 v_mov_b32 v139, v19
 v_mov_b32 v140, v20
 v_mov_b32 v142, v21
 v_mov_b32 v141, v22
 v_mov_b32 v143, v23
 v_mov_b32 v144, v24
 v_mov_b32 v146, v25
 v_mov_b32 v145, v26
 v_mov_b32 v147, v27
 v_mov_b32 v148, v28
 v_mov_b32 v150, v29
 v_mov_b32 v149, v30
 v_mov_b32 v151, v31
 v_mov_b32 v152, v32
 v_mov_b32 v154, v33
 v_mov_b32 v153, v34
 v_mov_b32 v155, v35
 v_mov_b32 v156, v36
 v_mov_b32 v158, v37
 v_mov_b32 v157, v38
 v_mov_b32 v159, v39
 v_add_u32 v8, 98304, v6
 ds_read_b64_tr_b16 v[16:17], v8 offset:192
 ds_read_b64_tr_b16 v[18:19], v8 offset:2240
 ds_read_b64_tr_b16 v[20:21], v8 offset:8384
 ds_read_b64_tr_b16 v[22:23], v8 offset:10432
 ds_read_b64_tr_b16 v[24:25], v8 offset:16576
 ds_read_b64_tr_b16 v[26:27], v8 offset:18624
 ds_read_b64_tr_b16 v[28:29], v8 offset:24768
 ds_read_b64_tr_b16 v[30:31], v8 offset:26816
 ds_read_b64_tr_b16 v[32:33], v8 offset:32960
 ds_read_b64_tr_b16 v[34:35], v8 offset:35008
 ds_read_b64_tr_b16 v[36:37], v8 offset:41152
 ds_read_b64_tr_b16 v[38:39], v8 offset:43200
 s_waitcnt lgkmcnt(0)
 v_mov_b32 v160, v16
 v_mov_b32 v162, v17
 v_mov_b32 v161, v18
 v_mov_b32 v163, v19
 v_mov_b32 v164, v20
 v_mov_b32 v166, v21
 v_mov_b32 v165, v22
 v_mov_b32 v167, v23
 v_mov_b32 v168, v24
 v_mov_b32 v170, v25
 v_mov_b32 v169, v26
 v_mov_b32 v171, v27
 v_mov_b32 v172, v28
 v_mov_b32 v174, v29
 v_mov_b32 v173, v30
 v_mov_b32 v175, v31
 v_mov_b32 v176, v32
 v_mov_b32 v178, v33
 v_mov_b32 v177, v34
 v_mov_b32 v179, v35
 v_mov_b32 v180, v36
 v_mov_b32 v182, v37
 v_mov_b32 v181, v38
 v_mov_b32 v183, v39
 v_add_u32 v8, 0, v6
 ds_read_b64_tr_b16 v[16:17], v8 offset:224
 ds_read_b64_tr_b16 v[18:19], v8 offset:2272
 ds_read_b64_tr_b16 v[20:21], v8 offset:8416
 ds_read_b64_tr_b16 v[22:23], v8 offset:10464
 ds_read_b64_tr_b16 v[24:25], v8 offset:16608
 ds_read_b64_tr_b16 v[26:27], v8 offset:18656
 ds_read_b64_tr_b16 v[28:29], v8 offset:24800
 ds_read_b64_tr_b16 v[30:31], v8 offset:26848
 ds_read_b64_tr_b16 v[32:33], v8 offset:32992
 ds_read_b64_tr_b16 v[34:35], v8 offset:35040
 ds_read_b64_tr_b16 v[36:37], v8 offset:41184
 ds_read_b64_tr_b16 v[38:39], v8 offset:43232
 s_waitcnt lgkmcnt(0)
 v_mov_b32 v184, v16
 v_mov_b32 v186, v17
 v_mov_b32 v185, v18
 v_mov_b32 v187, v19
 v_mov_b32 v188, v20
 v_mov_b32 v190, v21
 v_mov_b32 v189, v22
 v_mov_b32 v191, v23
 v_mov_b32 v192, v24
 v_mov_b32 v194, v25
 v_mov_b32 v193, v26
 v_mov_b32 v195, v27
 v_mov_b32 v196, v28
 v_mov_b32 v198, v29
 v_mov_b32 v197, v30
 v_mov_b32 v199, v31
 v_mov_b32 v200, v32
 v_mov_b32 v202, v33
 v_mov_b32 v201, v34
 v_mov_b32 v203, v35
 v_mov_b32 v204, v36
 v_mov_b32 v206, v37
 v_mov_b32 v205, v38
 v_mov_b32 v207, v39
 v_add_u32 v8, 49152, v6
 ds_read_b64_tr_b16 v[16:17], v8 offset:224
 ds_read_b64_tr_b16 v[18:19], v8 offset:2272
 ds_read_b64_tr_b16 v[20:21], v8 offset:8416
 ds_read_b64_tr_b16 v[22:23], v8 offset:10464
 ds_read_b64_tr_b16 v[24:25], v8 offset:16608
 ds_read_b64_tr_b16 v[26:27], v8 offset:18656
 ds_read_b64_tr_b16 v[28:29], v8 offset:24800
 ds_read_b64_tr_b16 v[30:31], v8 offset:26848
 ds_read_b64_tr_b16 v[32:33], v8 offset:32992
 ds_read_b64_tr_b16 v[34:35], v8 offset:35040
 ds_read_b64_tr_b16 v[36:37], v8 offset:41184
 ds_read_b64_tr_b16 v[38:39], v8 offset:43232
 s_waitcnt lgkmcnt(0)
 v_mov_b32 v208, v16
 v_mov_b32 v210, v17
 v_mov_b32 v209, v18
 v_mov_b32 v211, v19
 v_mov_b32 v212, v20
 v_mov_b32 v214, v21
 v_mov_b32 v213, v22
 v_mov_b32 v215, v23
 v_mov_b32 v216, v24
 v_mov_b32 v218, v25
 v_mov_b32 v217, v26
 v_mov_b32 v219, v27
 v_mov_b32 v220, v28
 v_mov_b32 v222, v29
 v_mov_b32 v221, v30
 v_mov_b32 v223, v31
 v_mov_b32 v224, v32
 v_mov_b32 v226, v33
 v_mov_b32 v225, v34
 v_mov_b32 v227, v35
 v_mov_b32 v228, v36
 v_mov_b32 v230, v37
 v_mov_b32 v229, v38
 v_mov_b32 v231, v39
 v_add_u32 v8, 98304, v6
 ds_read_b64_tr_b16 v[16:17], v8 offset:224
 ds_read_b64_tr_b16 v[18:19], v8 offset:2272
 ds_read_b64_tr_b16 v[20:21], v8 offset:8416
 ds_read_b64_tr_b16 v[22:23], v8 offset:10464
 ds_read_b64_tr_b16 v[24:25], v8 offset:16608
 ds_read_b64_tr_b16 v[26:27], v8 offset:18656
 ds_read_b64_tr_b16 v[28:29], v8 offset:24800
 ds_read_b64_tr_b16 v[30:31], v8 offset:26848
 ds_read_b64_tr_b16 v[32:33], v8 offset:32992
 ds_read_b64_tr_b16 v[34:35], v8 offset:35040
 ds_read_b64_tr_b16 v[36:37], v8 offset:41184
 ds_read_b64_tr_b16 v[38:39], v8 offset:43232
 s_waitcnt lgkmcnt(0)
 v_mov_b32 v232, v16
 v_mov_b32 v234, v17
 v_mov_b32 v233, v18
 v_mov_b32 v235, v19
 v_mov_b32 v236, v20
 v_mov_b32 v238, v21
 v_mov_b32 v237, v22
 v_mov_b32 v239, v23
 v_mov_b32 v240, v24
 v_mov_b32 v242, v25
 v_mov_b32 v241, v26
 v_mov_b32 v243, v27
 v_mov_b32 v244, v28
 v_mov_b32 v246, v29
 v_mov_b32 v245, v30
 v_mov_b32 v247, v31
 v_mov_b32 v248, v32
 v_mov_b32 v250, v33
 v_mov_b32 v249, v34
 v_mov_b32 v251, v35
 v_mov_b32 v252, v36
 v_mov_b32 v254, v37
 v_mov_b32 v253, v38
 v_mov_b32 v255, v39
mega_kernel_sk13:
 s_mov_b32 s36, s10
 s_and_b32 s37, s11, 0xffff
 s_mov_b32 s38, 4718592
 s_mov_b32 s39, 0x00020000
 s_mul_i32 s33, s94, 147456
 v_lshlrev_b32 v5, 4, v1
 v_lshrrev_b32 v6, 2, v4
 v_lshl_add_u32 v6, v3, 2, v6
 v_mul_u32_u24 v6, 1152, v6
 v_lshl_add_u32 v6, v7, 3, v6
 s_mul_i32 s34, s14, 288
 s_add_u32 s34, s34, 131072
 v_add_u32 v6, s34, v6
 s_lshl_b32 s34, s14, 15
 v_lshl_add_u32 v8, v1, 4, s34
 s_barrier
 s_add_u32 s35, s14, 0
 s_lshl_b32 s35, s35, 10
 s_add_u32 m0, s35, 131072
 s_add_u32 s35, s35, 0
 s_add_u32 s35, s35, s33
 buffer_load_dwordx4 v5, s[36:39], s35 offen lds
 s_add_u32 s35, s14, 4
 s_lshl_b32 s35, s35, 10
 s_add_u32 m0, s35, 131072
 s_add_u32 s35, s35, 0
 s_add_u32 s35, s35, s33
 buffer_load_dwordx4 v5, s[36:39], s35 offen lds
 s_add_u32 s35, s14, 8
 s_lshl_b32 s35, s35, 10
 s_add_u32 m0, s35, 131072
 s_add_u32 s35, s35, 0
 s_add_u32 s35, s35, s33
 buffer_load_dwordx4 v5, s[36:39], s35 offen lds
 s_add_u32 s35, s14, 12
 s_lshl_b32 s35, s35, 10
 s_add_u32 m0, s35, 131072
 s_add_u32 s35, s35, 0
 s_add_u32 s35, s35, s33
 buffer_load_dwordx4 v5, s[36:39], s35 offen lds
 s_cmp_ge_u32 s14, 2
 s_cbranch_scc1 mega_kernel_sk14
 s_add_u32 s35, s14, 16
 s_lshl_b32 s35, s35, 10
 s_add_u32 m0, s35, 131072
 s_add_u32 s35, s35, 0
 s_add_u32 s35, s35, s33
 buffer_load_dwordx4 v5, s[36:39], s35 offen lds
mega_kernel_sk14:
 s_waitcnt vmcnt(0)
 s_barrier
 ds_read_b64_tr_b16 v[16:17], v6 offset:0
 ds_read_b64_tr_b16 v[18:19], v6 offset:32
 ds_read_b64_tr_b16 v[20:21], v6 offset:64
 ds_read_b64_tr_b16 v[22:23], v6 offset:96
 ds_read_b64_tr_b16 v[24:25], v6 offset:128
 ds_read_b64_tr_b16 v[26:27], v6 offset:160
 ds_read_b64_tr_b16 v[28:29], v6 offset:192
 ds_read_b64_tr_b16 v[30:31], v6 offset:224
 ds_read_b64_tr_b16 v[32:33], v6 offset:256
 s_waitcnt lgkmcnt(0)
 ds_write_b64 v8, v[16:17] offset:0
 ds_write_b64 v8, v[18:19] offset:4096
 ds_write_b64 v8, v[20:21] offset:8192
 ds_write_b64 v8, v[22:23] offset:12288
 ds_write_b64 v8, v[24:25] offset:16384
 ds_write_b64 v8, v[26:27] offset:20480
 ds_write_b64 v8, v[28:29] offset:24576
 ds_write_b64 v8, v[30:31] offset:28672
 v_mov_b32 v64, v32
 v_mov_b32 v65, v33
 s_waitcnt lgkmcnt(0)
 s_barrier
 s_add_u32 s35, s14, 0
 s_lshl_b32 s35, s35, 10
 s_add_u32 m0, s35, 131072
 s_add_u32 s35, s35, 18432
 s_add_u32 s35, s35, s33
 buffer_load_dwordx4 v5, s[36:39], s35 offen lds
 s_add_u32 s35, s14, 4
 s_lshl_b32 s35, s35, 10
 s_add_u32 m0, s35, 131072
 s_add_u32 s35, s35, 18432
 s_add_u32 s35, s35, s33
 buffer_load_dwordx4 v5, s[36:39], s35 offen lds
 s_add_u32 s35, s14, 8
 s_lshl_b32 s35, s35, 10
 s_add_u32 m0, s35, 131072
 s_add_u32 s35, s35, 18432
 s_add_u32 s35, s35, s33
 buffer_load_dwordx4 v5, s[36:39], s35 offen lds
 s_add_u32 s35, s14, 12
 s_lshl_b32 s35, s35, 10
 s_add_u32 m0, s35, 131072
 s_add_u32 s35, s35, 18432
 s_add_u32 s35, s35, s33
 buffer_load_dwordx4 v5, s[36:39], s35 offen lds
 s_cmp_ge_u32 s14, 2
 s_cbranch_scc1 mega_kernel_sk15
 s_add_u32 s35, s14, 16
 s_lshl_b32 s35, s35, 10
 s_add_u32 m0, s35, 131072
 s_add_u32 s35, s35, 18432
 s_add_u32 s35, s35, s33
 buffer_load_dwordx4 v5, s[36:39], s35 offen lds
mega_kernel_sk15:
 s_waitcnt vmcnt(0)
 s_barrier
 ds_read_b64_tr_b16 v[16:17], v6 offset:0
 ds_read_b64_tr_b16 v[18:19], v6 offset:32
 ds_read_b64_tr_b16 v[20:21], v6 offset:64
 ds_read_b64_tr_b16 v[22:23], v6 offset:96
 ds_read_b64_tr_b16 v[24:25], v6 offset:128
 ds_read_b64_tr_b16 v[26:27], v6 offset:160
 ds_read_b64_tr_b16 v[28:29], v6 offset:192
 ds_read_b64_tr_b16 v[30:31], v6 offset:224
 ds_read_b64_tr_b16 v[32:33], v6 offset:256
 s_waitcnt lgkmcnt(0)
 ds_write_b64 v8, v[16:17] offset:8
 ds_write_b64 v8, v[18:19] offset:4104
 ds_write_b64 v8, v[20:21] offset:8200
 ds_write_b64 v8, v[22:23] offset:12296
 ds_write_b64 v8, v[24:25] offset:16392
 ds_write_b64 v8, v[26:27] offset:20488
 ds_write_b64 v8, v[28:29] offset:24584
 ds_write_b64 v8, v[30:31] offset:28680
 v_mov_b32 v66, v32
 v_mov_b32 v67, v33
 s_waitcnt lgkmcnt(0)
 s_barrier
 s_add_u32 s35, s14, 0
 s_lshl_b32 s35, s35, 10
 s_add_u32 m0, s35, 131072
 s_add_u32 s35, s35, 36864
 s_add_u32 s35, s35, s33
 buffer_load_dwordx4 v5, s[36:39], s35 offen lds
 s_add_u32 s35, s14, 4
 s_lshl_b32 s35, s35, 10
 s_add_u32 m0, s35, 131072
 s_add_u32 s35, s35, 36864
 s_add_u32 s35, s35, s33
 buffer_load_dwordx4 v5, s[36:39], s35 offen lds
 s_add_u32 s35, s14, 8
 s_lshl_b32 s35, s35, 10
 s_add_u32 m0, s35, 131072
 s_add_u32 s35, s35, 36864
 s_add_u32 s35, s35, s33
 buffer_load_dwordx4 v5, s[36:39], s35 offen lds
 s_add_u32 s35, s14, 12
 s_lshl_b32 s35, s35, 10
 s_add_u32 m0, s35, 131072
 s_add_u32 s35, s35, 36864
 s_add_u32 s35, s35, s33
 buffer_load_dwordx4 v5, s[36:39], s35 offen lds
 s_cmp_ge_u32 s14, 2
 s_cbranch_scc1 mega_kernel_sk16
 s_add_u32 s35, s14, 16
 s_lshl_b32 s35, s35, 10
 s_add_u32 m0, s35, 131072
 s_add_u32 s35, s35, 36864
 s_add_u32 s35, s35, s33
 buffer_load_dwordx4 v5, s[36:39], s35 offen lds
mega_kernel_sk16:
 s_waitcnt vmcnt(0)
 s_barrier
 ds_read_b64_tr_b16 v[16:17], v6 offset:0
 ds_read_b64_tr_b16 v[18:19], v6 offset:32
 ds_read_b64_tr_b16 v[20:21], v6 offset:64
 ds_read_b64_tr_b16 v[22:23], v6 offset:96
 ds_read_b64_tr_b16 v[24:25], v6 offset:128
 ds_read_b64_tr_b16 v[26:27], v6 offset:160
 ds_read_b64_tr_b16 v[28:29], v6 offset:192
 ds_read_b64_tr_b16 v[30:31], v6 offset:224
 ds_read_b64_tr_b16 v[32:33], v6 offset:256
 s_waitcnt lgkmcnt(0)
 ds_write_b64 v8, v[16:17] offset:1024
 ds_write_b64 v8, v[18:19] offset:5120
 ds_write_b64 v8, v[20:21] offset:9216
 ds_write_b64 v8, v[22:23] offset:13312
 ds_write_b64 v8, v[24:25] offset:17408
 ds_write_b64 v8, v[26:27] offset:21504
 ds_write_b64 v8, v[28:29] offset:25600
 ds_write_b64 v8, v[30:31] offset:29696
 v_mov_b32 v68, v32
 v_mov_b32 v69, v33
 s_waitcnt lgkmcnt(0)
 s_barrier
 s_add_u32 s35, s14, 0
 s_lshl_b32 s35, s35, 10
 s_add_u32 m0, s35, 131072
 s_add_u32 s35, s35, 55296
 s_add_u32 s35, s35, s33
 buffer_load_dwordx4 v5, s[36:39], s35 offen lds
 s_add_u32 s35, s14, 4
 s_lshl_b32 s35, s35, 10
 s_add_u32 m0, s35, 131072
 s_add_u32 s35, s35, 55296
 s_add_u32 s35, s35, s33
 buffer_load_dwordx4 v5, s[36:39], s35 offen lds
 s_add_u32 s35, s14, 8
 s_lshl_b32 s35, s35, 10
 s_add_u32 m0, s35, 131072
 s_add_u32 s35, s35, 55296
 s_add_u32 s35, s35, s33
 buffer_load_dwordx4 v5, s[36:39], s35 offen lds
 s_add_u32 s35, s14, 12
 s_lshl_b32 s35, s35, 10
 s_add_u32 m0, s35, 131072
 s_add_u32 s35, s35, 55296
 s_add_u32 s35, s35, s33
 buffer_load_dwordx4 v5, s[36:39], s35 offen lds
 s_cmp_ge_u32 s14, 2
 s_cbranch_scc1 mega_kernel_sk17
 s_add_u32 s35, s14, 16
 s_lshl_b32 s35, s35, 10
 s_add_u32 m0, s35, 131072
 s_add_u32 s35, s35, 55296
 s_add_u32 s35, s35, s33
 buffer_load_dwordx4 v5, s[36:39], s35 offen lds
mega_kernel_sk17:
 s_waitcnt vmcnt(0)
 s_barrier
 ds_read_b64_tr_b16 v[16:17], v6 offset:0
 ds_read_b64_tr_b16 v[18:19], v6 offset:32
 ds_read_b64_tr_b16 v[20:21], v6 offset:64
 ds_read_b64_tr_b16 v[22:23], v6 offset:96
 ds_read_b64_tr_b16 v[24:25], v6 offset:128
 ds_read_b64_tr_b16 v[26:27], v6 offset:160
 ds_read_b64_tr_b16 v[28:29], v6 offset:192
 ds_read_b64_tr_b16 v[30:31], v6 offset:224
 ds_read_b64_tr_b16 v[32:33], v6 offset:256
 s_waitcnt lgkmcnt(0)
 ds_write_b64 v8, v[16:17] offset:1032
 ds_write_b64 v8, v[18:19] offset:5128
 ds_write_b64 v8, v[20:21] offset:9224
 ds_write_b64 v8, v[22:23] offset:13320
 ds_write_b64 v8, v[24:25] offset:17416
 ds_write_b64 v8, v[26:27] offset:21512
 ds_write_b64 v8, v[28:29] offset:25608
 ds_write_b64 v8, v[30:31] offset:29704
 v_mov_b32 v70, v32
 v_mov_b32 v71, v33
 s_waitcnt lgkmcnt(0)
 s_barrier
 s_add_u32 s35, s14, 0
 s_lshl_b32 s35, s35, 10
 s_add_u32 m0, s35, 131072
 s_add_u32 s35, s35, 73728
 s_add_u32 s35, s35, s33
 buffer_load_dwordx4 v5, s[36:39], s35 offen lds
 s_add_u32 s35, s14, 4
 s_lshl_b32 s35, s35, 10
 s_add_u32 m0, s35, 131072
 s_add_u32 s35, s35, 73728
 s_add_u32 s35, s35, s33
 buffer_load_dwordx4 v5, s[36:39], s35 offen lds
 s_add_u32 s35, s14, 8
 s_lshl_b32 s35, s35, 10
 s_add_u32 m0, s35, 131072
 s_add_u32 s35, s35, 73728
 s_add_u32 s35, s35, s33
 buffer_load_dwordx4 v5, s[36:39], s35 offen lds
 s_add_u32 s35, s14, 12
 s_lshl_b32 s35, s35, 10
 s_add_u32 m0, s35, 131072
 s_add_u32 s35, s35, 73728
 s_add_u32 s35, s35, s33
 buffer_load_dwordx4 v5, s[36:39], s35 offen lds
 s_cmp_ge_u32 s14, 2
 s_cbranch_scc1 mega_kernel_sk18
 s_add_u32 s35, s14, 16
 s_lshl_b32 s35, s35, 10
 s_add_u32 m0, s35, 131072
 s_add_u32 s35, s35, 73728
 s_add_u32 s35, s35, s33
 buffer_load_dwordx4 v5, s[36:39], s35 offen lds
mega_kernel_sk18:
 s_waitcnt vmcnt(0)
 s_barrier
 ds_read_b64_tr_b16 v[16:17], v6 offset:0
 ds_read_b64_tr_b16 v[18:19], v6 offset:32
 ds_read_b64_tr_b16 v[20:21], v6 offset:64
 ds_read_b64_tr_b16 v[22:23], v6 offset:96
 ds_read_b64_tr_b16 v[24:25], v6 offset:128
 ds_read_b64_tr_b16 v[26:27], v6 offset:160
 ds_read_b64_tr_b16 v[28:29], v6 offset:192
 ds_read_b64_tr_b16 v[30:31], v6 offset:224
 ds_read_b64_tr_b16 v[32:33], v6 offset:256
 s_waitcnt lgkmcnt(0)
 ds_write_b64 v8, v[16:17] offset:2048
 ds_write_b64 v8, v[18:19] offset:6144
 ds_write_b64 v8, v[20:21] offset:10240
 ds_write_b64 v8, v[22:23] offset:14336
 ds_write_b64 v8, v[24:25] offset:18432
 ds_write_b64 v8, v[26:27] offset:22528
 ds_write_b64 v8, v[28:29] offset:26624
 ds_write_b64 v8, v[30:31] offset:30720
 v_mov_b32 v72, v32
 v_mov_b32 v73, v33
 s_waitcnt lgkmcnt(0)
 s_barrier
 s_add_u32 s35, s14, 0
 s_lshl_b32 s35, s35, 10
 s_add_u32 m0, s35, 131072
 s_add_u32 s35, s35, 92160
 s_add_u32 s35, s35, s33
 buffer_load_dwordx4 v5, s[36:39], s35 offen lds
 s_add_u32 s35, s14, 4
 s_lshl_b32 s35, s35, 10
 s_add_u32 m0, s35, 131072
 s_add_u32 s35, s35, 92160
 s_add_u32 s35, s35, s33
 buffer_load_dwordx4 v5, s[36:39], s35 offen lds
 s_add_u32 s35, s14, 8
 s_lshl_b32 s35, s35, 10
 s_add_u32 m0, s35, 131072
 s_add_u32 s35, s35, 92160
 s_add_u32 s35, s35, s33
 buffer_load_dwordx4 v5, s[36:39], s35 offen lds
 s_add_u32 s35, s14, 12
 s_lshl_b32 s35, s35, 10
 s_add_u32 m0, s35, 131072
 s_add_u32 s35, s35, 92160
 s_add_u32 s35, s35, s33
 buffer_load_dwordx4 v5, s[36:39], s35 offen lds
 s_cmp_ge_u32 s14, 2
 s_cbranch_scc1 mega_kernel_sk19
 s_add_u32 s35, s14, 16
 s_lshl_b32 s35, s35, 10
 s_add_u32 m0, s35, 131072
 s_add_u32 s35, s35, 92160
 s_add_u32 s35, s35, s33
 buffer_load_dwordx4 v5, s[36:39], s35 offen lds
mega_kernel_sk19:
 s_waitcnt vmcnt(0)
 s_barrier
 ds_read_b64_tr_b16 v[16:17], v6 offset:0
 ds_read_b64_tr_b16 v[18:19], v6 offset:32
 ds_read_b64_tr_b16 v[20:21], v6 offset:64
 ds_read_b64_tr_b16 v[22:23], v6 offset:96
 ds_read_b64_tr_b16 v[24:25], v6 offset:128
 ds_read_b64_tr_b16 v[26:27], v6 offset:160
 ds_read_b64_tr_b16 v[28:29], v6 offset:192
 ds_read_b64_tr_b16 v[30:31], v6 offset:224
 ds_read_b64_tr_b16 v[32:33], v6 offset:256
 s_waitcnt lgkmcnt(0)
 ds_write_b64 v8, v[16:17] offset:2056
 ds_write_b64 v8, v[18:19] offset:6152
 ds_write_b64 v8, v[20:21] offset:10248
 ds_write_b64 v8, v[22:23] offset:14344
 ds_write_b64 v8, v[24:25] offset:18440
 ds_write_b64 v8, v[26:27] offset:22536
 ds_write_b64 v8, v[28:29] offset:26632
 ds_write_b64 v8, v[30:31] offset:30728
 v_mov_b32 v74, v32
 v_mov_b32 v75, v33
 s_waitcnt lgkmcnt(0)
 s_barrier
 s_add_u32 s35, s14, 0
 s_lshl_b32 s35, s35, 10
 s_add_u32 m0, s35, 131072
 s_add_u32 s35, s35, 110592
 s_add_u32 s35, s35, s33
 buffer_load_dwordx4 v5, s[36:39], s35 offen lds
 s_add_u32 s35, s14, 4
 s_lshl_b32 s35, s35, 10
 s_add_u32 m0, s35, 131072
 s_add_u32 s35, s35, 110592
 s_add_u32 s35, s35, s33
 buffer_load_dwordx4 v5, s[36:39], s35 offen lds
 s_add_u32 s35, s14, 8
 s_lshl_b32 s35, s35, 10
 s_add_u32 m0, s35, 131072
 s_add_u32 s35, s35, 110592
 s_add_u32 s35, s35, s33
 buffer_load_dwordx4 v5, s[36:39], s35 offen lds
 s_add_u32 s35, s14, 12
 s_lshl_b32 s35, s35, 10
 s_add_u32 m0, s35, 131072
 s_add_u32 s35, s35, 110592
 s_add_u32 s35, s35, s33
 buffer_load_dwordx4 v5, s[36:39], s35 offen lds
 s_cmp_ge_u32 s14, 2
 s_cbranch_scc1 mega_kernel_sk20
 s_add_u32 s35, s14, 16
 s_lshl_b32 s35, s35, 10
 s_add_u32 m0, s35, 131072
 s_add_u32 s35, s35, 110592
 s_add_u32 s35, s35, s33
 buffer_load_dwordx4 v5, s[36:39], s35 offen lds
mega_kernel_sk20:
 s_waitcnt vmcnt(0)
 s_barrier
 ds_read_b64_tr_b16 v[16:17], v6 offset:0
 ds_read_b64_tr_b16 v[18:19], v6 offset:32
 ds_read_b64_tr_b16 v[20:21], v6 offset:64
 ds_read_b64_tr_b16 v[22:23], v6 offset:96
 ds_read_b64_tr_b16 v[24:25], v6 offset:128
 ds_read_b64_tr_b16 v[26:27], v6 offset:160
 ds_read_b64_tr_b16 v[28:29], v6 offset:192
 ds_read_b64_tr_b16 v[30:31], v6 offset:224
 ds_read_b64_tr_b16 v[32:33], v6 offset:256
 s_waitcnt lgkmcnt(0)
 ds_write_b64 v8, v[16:17] offset:3072
 ds_write_b64 v8, v[18:19] offset:7168
 ds_write_b64 v8, v[20:21] offset:11264
 ds_write_b64 v8, v[22:23] offset:15360
 ds_write_b64 v8, v[24:25] offset:19456
 ds_write_b64 v8, v[26:27] offset:23552
 ds_write_b64 v8, v[28:29] offset:27648
 ds_write_b64 v8, v[30:31] offset:31744
 v_mov_b32 v76, v32
 v_mov_b32 v77, v33
 s_waitcnt lgkmcnt(0)
 s_barrier
 s_add_u32 s35, s14, 0
 s_lshl_b32 s35, s35, 10
 s_add_u32 m0, s35, 131072
 s_add_u32 s35, s35, 129024
 s_add_u32 s35, s35, s33
 buffer_load_dwordx4 v5, s[36:39], s35 offen lds
 s_add_u32 s35, s14, 4
 s_lshl_b32 s35, s35, 10
 s_add_u32 m0, s35, 131072
 s_add_u32 s35, s35, 129024
 s_add_u32 s35, s35, s33
 buffer_load_dwordx4 v5, s[36:39], s35 offen lds
 s_add_u32 s35, s14, 8
 s_lshl_b32 s35, s35, 10
 s_add_u32 m0, s35, 131072
 s_add_u32 s35, s35, 129024
 s_add_u32 s35, s35, s33
 buffer_load_dwordx4 v5, s[36:39], s35 offen lds
 s_add_u32 s35, s14, 12
 s_lshl_b32 s35, s35, 10
 s_add_u32 m0, s35, 131072
 s_add_u32 s35, s35, 129024
 s_add_u32 s35, s35, s33
 buffer_load_dwordx4 v5, s[36:39], s35 offen lds
 s_cmp_ge_u32 s14, 2
 s_cbranch_scc1 mega_kernel_sk21
 s_add_u32 s35, s14, 16
 s_lshl_b32 s35, s35, 10
 s_add_u32 m0, s35, 131072
 s_add_u32 s35, s35, 129024
 s_add_u32 s35, s35, s33
 buffer_load_dwordx4 v5, s[36:39], s35 offen lds
mega_kernel_sk21:
 s_waitcnt vmcnt(0)
 s_barrier
 ds_read_b64_tr_b16 v[16:17], v6 offset:0
 ds_read_b64_tr_b16 v[18:19], v6 offset:32
 ds_read_b64_tr_b16 v[20:21], v6 offset:64
 ds_read_b64_tr_b16 v[22:23], v6 offset:96
 ds_read_b64_tr_b16 v[24:25], v6 offset:128
 ds_read_b64_tr_b16 v[26:27], v6 offset:160
 ds_read_b64_tr_b16 v[28:29], v6 offset:192
 ds_read_b64_tr_b16 v[30:31], v6 offset:224
 ds_read_b64_tr_b16 v[32:33], v6 offset:256
 s_waitcnt lgkmcnt(0)
 ds_write_b64 v8, v[16:17] offset:3080
 ds_write_b64 v8, v[18:19] offset:7176
 ds_write_b64 v8, v[20:21] offset:11272
 ds_write_b64 v8, v[22:23] offset:15368
 ds_write_b64 v8, v[24:25] offset:19464
 ds_write_b64 v8, v[26:27] offset:23560
 ds_write_b64 v8, v[28:29] offset:27656
 ds_write_b64 v8, v[30:31] offset:31752
 v_mov_b32 v78, v32
 v_mov_b32 v79, v33
 s_waitcnt lgkmcnt(0)
 s_barrier
 v_and_b32 v9, 7, v1
 v_lshlrev_b32 v2, 4, v1
 v_add_u32 v2, 147456, v2
 v_mul_u32_u24 v5, 1568, v3
 v_lshl_add_u32 v5, v4, 1, v5
 s_lshl_b32 s34, s14, 7
 s_add_u32 s34, s34, 156800
 v_add_u32 v0, s34, v5
 s_lshl_b32 s34, s14, 6
 s_add_u32 s34, s34, 157312
 v_add_u32 v5, s34, v5
 v_mul_u32_u24 v6, 784, v9
 v_lshl_add_u32 v6, v3, 4, v6
 v_add_u32 v6, 156800, v6
 v_xor_b32 v7, v3, v4
 v_lshlrev_b32 v7, 4, v7
 v_lshl_add_u32 v7, v4, 8, v7
 v_add_u32 v7, 131072, v7
 v_lshrrev_b32 v10, 2, v4
 v_lshl_add_u32 v10, v3, 2, v10
 v_and_b32 v11, 7, v10
 v_lshlrev_b32 v8, 8, v10
 v_lshl_add_u32 v8, v11, 5, v8
 v_and_b32 v12, 3, v1
 v_lshl_add_u32 v8, v12, 3, v8
 v_add_u32 v8, 139264, v8
 v_mul_u32_u24 v9, 784, v11
 v_lshl_add_u32 v9, v12, 3, v9
 v_add_u32 v9, 157312, v9
 s_lshl_b32 s34, s14, 15
 v_lshl_add_u32 v10, v1, 4, s34
 v_lshlrev_b32 v11, 6, v4
 v_lshl_add_u32 v11, v3, 4, v11
 s_mul_i32 s34, s14, 4608
 v_add_u32 v11, s34, v11
 v_and_b32 v12, 1, v1
 v_mul_u32_u24 v12, 0xaaaa, v12
 v_add_u32 v12, 0x4444, v12
 v_lshlrev_b32 v13, 4, v1
 s_mul_i32 s55, s14, 3072
 s_add_u32 s34, s55, 147456
 v_add_u32 v14, s34, v13
 v_cmp_gt_u32 s[40:41], 8, v4
 v_cmp_lt_u32 s[42:43], 31, v1
 v_mov_b32 v20, v3
 s_movk_i32 s35, 24576
 v_mul_lo_u32 v21, v20, s35
 v_xor_b32 v22, v20, v4
 v_lshl_add_u32 v1, v22, 4, v21
 v_lshrrev_b32 v22, 1, v4
 v_and_b32 v23, 7, v20
 v_xor_b32 v22, v22, v23
 v_lshlrev_b32 v22, 1, v22
 v_and_b32 v23, 1, v4
 v_or_b32 v22, v22, v23
 v_lshl_add_u32 v3, v22, 4, v21
 s_mov_b32 s44, 0x3db504f3
 s_mov_b32 s45, 0x3fb8aa3b
 s_mov_b32 s46, 0
 s_lshl_b32 s54, s14, 10
 s_movk_i32 s56, 784
 s_add_u32 s60, s12, 264241152
 s_addc_u32 s61, s13, 0
 s_and_b32 s61, s61, 0xffff
 s_mov_b32 s62, 12288
 s_mov_b32 s63, 0x00020000
 s_getreg_b32 s34, hwreg(HW_REG_XCC_ID)
 s_and_b32 s34, s34, 15
 s_add_u32 s34, s34, 1
 s_lshl_b32 s35, s94, 2
 s_add_u32 s35, s35, 10240
 v_mov_b32 v16, s34
 s_mov_b64 exec, 1
 buffer_store_dword v16, off, s[60:63], s35 sc1
 s_mov_b64 exec, -1
 v_lshrrev_b32 v17, 4, v13
 v_and_b32 v17, 31, v17
 v_lshlrev_b32 v17, 2, v17
 v_add_u32 v17, 10240, v17
 s_mov_b32 s35, 0
mega_kernel_hs22:
 buffer_load_dword v18, v17, s[60:63], 0 offen sc1
 s_waitcnt vmcnt(0)
 v_cmp_eq_u32 vcc, 0, v18
 s_cbranch_vccz mega_kernel_hd23
 s_sleep 4
 s_add_u32 s35, s35, 1
 s_cmp_lt_u32 s35, 4000000
 s_cbranch_scc1 mega_kernel_hs22
mega_kernel_hd23:
 v_cmp_ne_u32 vcc, s34, v18
 s_cmp_eq_u64 vcc, 0
 s_cselect_b32 s59, 1, 0
 s_mov_b32 s35, 0
 s_mov_b32 s34, 8256
mega_kernel_fw24:
 buffer_load_dword v16, off, s[60:63], s34 sc1
 s_waitcnt vmcnt(0)
 v_readfirstlane_b32 s58, v16
 s_nop 3
 s_cmp_ge_u32 s58, 5
 s_cbranch_scc1 mega_kernel_fd25
 s_sleep 8
 s_add_u32 s35, s35, 1
 s_cmp_lt_u32 s35, 2000000
 s_cbranch_scc1 mega_kernel_fw24
mega_kernel_fd25:
 s_mov_b32 s35, 0
 s_mov_b32 s34, 9216
mega_kernel_fw26:
 buffer_load_dword v16, off, s[60:63], s34 sc1
 s_waitcnt vmcnt(0)
 v_readfirstlane_b32 s58, v16
 s_nop 3
 s_cmp_ge_u32 s58, 16
 s_cbranch_scc1 mega_kernel_fd27
 s_sleep 8
 s_add_u32 s35, s35, 1
 s_cmp_lt_u32 s35, 2000000
 s_cbranch_scc1 mega_kernel_fw26
mega_kernel_fd27:
 s_and_b32 s34, s46, 3
 s_cmp_lg_u32 s34, 0
 s_cbranch_scc1 mega_kernel_kvs28
 s_cmp_ge_u32 s46, 64
 s_cbranch_scc1 mega_kernel_kvs28
 s_lshl_b32 s34, s46, 4
 s_mov_b32 s35, 0
mega_kernel_kvp29:
 buffer_load_dword v16, off, s[60:63], s34 sc1
 s_waitcnt vmcnt(0)
 v_readfirstlane_b32 s58, v16
 s_nop 3
 s_cmp_ge_u32 s58, 32
 s_cbranch_scc1 mega_kernel_kvs28
 s_sleep 8
 s_add_u32 s35, s35, 1
 s_cmp_lt_u32 s35, 2000000
 s_cbranch_scc1 mega_kernel_kvp29
mega_kernel_kvs28:
 s_cmp_lg_u32 s14, 3
 s_cbranch_scc1 mega_kernel_kd30
 s_mul_i32 s47, s46, 786432
 s_add_u32 s47, s47, s15
 s_add_u32 s47, s47, 8192
 v_xor_b32 v60, 0, v1
 v_xor_b32 v61, 0, v3
 s_add_u32 s35, s47, 0
 s_mov_b32 m0, 131072
 s_nop 0
 buffer_load_dwordx4 v60, s[24:27], s35 offen lds
 s_add_u32 s35, s35, 8192
 s_mov_b32 m0, 139264
 s_nop 0
 buffer_load_dwordx4 v61, s[24:27], s35 offen lds
 s_add_u32 s35, s47, 393216
 s_mov_b32 m0, 135168
 s_nop 0
 buffer_load_dwordx4 v60, s[24:27], s35 offen lds
 s_add_u32 s35, s35, 8192
 s_mov_b32 m0, 143360
 s_nop 0
 buffer_load_dwordx4 v61, s[24:27], s35 offen lds
 v_xor_b32 v60, 64, v1
 v_xor_b32 v61, 128, v3
 s_add_u32 s35, s47, 98304
 s_mov_b32 m0, 132096
 s_nop 0
 buffer_load_dwordx4 v60, s[24:27], s35 offen lds
 s_add_u32 s35, s35, 8192
 s_mov_b32 m0, 140288
 s_nop 0
 buffer_load_dwordx4 v61, s[24:27], s35 offen lds
 s_add_u32 s35, s47, 491520
 s_mov_b32 m0, 136192
 s_nop 0
 buffer_load_dwordx4 v60, s[24:27], s35 offen lds
 s_add_u32 s35, s35, 8192
 s_mov_b32 m0, 144384
 s_nop 0
 buffer_load_dwordx4 v61, s[24:27], s35 offen lds
 v_xor_b32 v60, 128, v1
 v_xor_b32 v61, 0, v3
 s_add_u32 s35, s47, 196608
 s_mov_b32 m0, 133120
 s_nop 0
 buffer_load_dwordx4 v60, s[24:27], s35 offen lds
 s_add_u32 s35, s35, 8192
 s_mov_b32 m0, 141312
 s_nop 0
 buffer_load_dwordx4 v61, s[24:27], s35 offen lds
 s_add_u32 s35, s47, 589824
 s_mov_b32 m0, 137216
 s_nop 0
 buffer_load_dwordx4 v60, s[24:27], s35 offen lds
 s_add_u32 s35, s35, 8192
 s_mov_b32 m0, 145408
 s_nop 0
 buffer_load_dwordx4 v61, s[24:27], s35 offen lds
 v_xor_b32 v60, 192, v1
 v_xor_b32 v61, 128, v3
 s_add_u32 s35, s47, 294912
 s_mov_b32 m0, 134144
 s_nop 0
 buffer_load_dwordx4 v60, s[24:27], s35 offen lds
 s_add_u32 s35, s35, 8192
 s_mov_b32 m0, 142336
 s_nop 0
 buffer_load_dwordx4 v61, s[24:27], s35 offen lds
 s_add_u32 s35, s47, 688128
 s_mov_b32 m0, 138240
 s_nop 0
 buffer_load_dwordx4 v60, s[24:27], s35 offen lds
 s_add_u32 s35, s35, 8192
 s_mov_b32 m0, 146432
 s_nop 0
 buffer_load_dwordx4 v61, s[24:27], s35 offen lds
mega_kernel_kd30:
mega_kernel_step31:
 s_add_u32 s53, s46, 1
 s_and_b32 s34, s53, 3
 s_cmp_lg_u32 s34, 0
 s_cbranch_scc1 mega_kernel_kvs35
 s_cmp_ge_u32 s53, 64
 s_cbranch_scc1 mega_kernel_kvs35
 s_lshl_b32 s34, s53, 4
 s_mov_b32 s35, 0
mega_kernel_kvp36:
 buffer_load_dword v16, off, s[60:63], s34 sc1
 s_waitcnt vmcnt(0)
 v_readfirstlane_b32 s58, v16
 s_nop 3
 s_cmp_ge_u32 s58, 32
 s_cbranch_scc1 mega_kernel_kvs35
 s_sleep 8
 s_add_u32 s35, s35, 1
 s_cmp_lt_u32 s35, 2000000
 s_cbranch_scc1 mega_kernel_kvp36
mega_kernel_kvs35:
 s_cmp_eq_u32 s14, 3
 s_cbranch_scc1 mega_kernel_pd33
 s_and_b32 s47, s46, 3
 s_mul_i32 s47, s47, 9216
 s_cmp_eq_u32 s46, 0
 s_cselect_b32 s47, 262144, s47
 s_add_u32 s47, s47, s55
 s_mov_b32 s49, 0
 s_sleep 3
 s_waitcnt vmcnt(0)
 s_add_u32 m0, s55, 147456
 s_add_u32 s48, s47, 0
 buffer_load_dwordx4 v13, s[20:23], s48 offen sc1 lds
 s_add_u32 m0, s55, 148480
 s_add_u32 s48, s47, 1024
 buffer_load_dwordx4 v13, s[20:23], s48 offen sc1 lds
 s_add_u32 m0, s55, 149504
 s_add_u32 s48, s47, 2048
 buffer_load_dwordx4 v13, s[20:23], s48 offen sc1 lds
 s_sleep 3
mega_kernel_poll32:
 s_add_u32 m0, s55, 147456
 s_add_u32 s48, s47, 0
 buffer_load_dwordx4 v13, s[20:23], s48 offen sc1 lds
 s_add_u32 m0, s55, 148480
 s_add_u32 s48, s47, 1024
 buffer_load_dwordx4 v13, s[20:23], s48 offen sc1 lds
 s_add_u32 m0, s55, 149504
 s_add_u32 s48, s47, 2048
 buffer_load_dwordx4 v13, s[20:23], s48 offen sc1 lds
 s_waitcnt vmcnt(3)
 ds_read_b128 v[16:19], v14 offset:0
 ds_read_b128 v[20:23], v14 offset:1024
 ds_read_b128 v[24:27], v14 offset:2048
 s_waitcnt lgkmcnt(0)
 v_max3_u32 v28, v16, v17, v18
 v_max3_u32 v29, v19, v20, v21
 v_max3_u32 v30, v22, v23, v24
 v_max3_u32 v31, v25, v26, v27
 v_max3_u32 v28, v28, v29, v30
 v_max_u32 v28, v28, v31
 v_cmp_eq_u32 vcc, -1, v28
 s_cbranch_vccz mega_kernel_pd33
 s_add_u32 s49, s49, 1
 s_cmp_lt_u32 s49, 300000
 s_cbranch_scc1 mega_kernel_poll32
mega_kernel_pd33:
 s_barrier
 ds_read_b128 v[32:35], v2 offset:0
 ds_read_b128 v[36:39], v2 offset:1024
 ds_read_b128 v[40:43], v2 offset:2048
 v_mov_b32 v16, 0
 v_mov_b32 v17, 0
 v_mov_b32 v18, 0
 v_mov_b32 v19, 0
 v_mov_b32 v20, 0
 v_mov_b32 v21, 0
 v_mov_b32 v22, 0
 v_mov_b32 v23, 0
 v_mov_b32 v24, 0
 v_mov_b32 v25, 0
 v_mov_b32 v26, 0
 v_mov_b32 v27, 0
 v_mov_b32 v28, 0
 v_mov_b32 v29, 0
 v_mov_b32 v30, 0
 v_mov_b32 v31, 0
 s_waitcnt lgkmcnt(2)
 v_smfmac_f32_16x16x64_bf16 v[16:19], v[32:35], a[0:7], v12
 v_smfmac_f32_16x16x64_bf16 v[20:23], v[32:35], a[72:79], v12
 v_smfmac_f32_16x16x64_bf16 v[24:27], v[32:35], a[144:151], v12
 v_smfmac_f32_16x16x64_bf16 v[28:31], v[32:35], a[216:223], v12
 ds_read_b128 v[32:35], v2 offset:3072
 s_waitcnt lgkmcnt(2)
 v_smfmac_f32_16x16x64_bf16 v[16:19], v[36:39], a[8:15], v12
 v_smfmac_f32_16x16x64_bf16 v[20:23], v[36:39], a[80:87], v12
 v_smfmac_f32_16x16x64_bf16 v[24:27], v[36:39], a[152:159], v12
 v_smfmac_f32_16x16x64_bf16 v[28:31], v[36:39], a[224:231], v12
 ds_read_b128 v[36:39], v2 offset:4096
 s_waitcnt lgkmcnt(2)
 v_smfmac_f32_16x16x64_bf16 v[16:19], v[40:43], a[16:23], v12
 v_smfmac_f32_16x16x64_bf16 v[20:23], v[40:43], a[88:95], v12
 v_smfmac_f32_16x16x64_bf16 v[24:27], v[40:43], a[160:167], v12
 v_smfmac_f32_16x16x64_bf16 v[28:31], v[40:43], a[232:239], v12
 ds_read_b128 v[40:43], v2 offset:5120
 s_waitcnt lgkmcnt(2)
 v_smfmac_f32_16x16x64_bf16 v[16:19], v[32:35], a[24:31], v12
 v_smfmac_f32_16x16x64_bf16 v[20:23], v[32:35], a[96:103], v12
 v_smfmac_f32_16x16x64_bf16 v[24:27], v[32:35], a[168:175], v12
 v_smfmac_f32_16x16x64_bf16 v[28:31], v[32:35], a[240:247], v12
 ds_read_b128 v[32:35], v2 offset:6144
 s_waitcnt lgkmcnt(2)
 v_smfmac_f32_16x16x64_bf16 v[16:19], v[36:39], a[32:39], v12
 v_smfmac_f32_16x16x64_bf16 v[20:23], v[36:39], a[104:111], v12
 v_smfmac_f32_16x16x64_bf16 v[24:27], v[36:39], a[176:183], v12
 v_smfmac_f32_16x16x64_bf16 v[28:31], v[36:39], a[248:255], v12
 ds_read_b128 v[36:39], v2 offset:7168
 s_waitcnt lgkmcnt(2)
 v_smfmac_f32_16x16x64_bf16 v[16:19], v[40:43], a[40:47], v12
 v_smfmac_f32_16x16x64_bf16 v[20:23], v[40:43], a[112:119], v12
 v_smfmac_f32_16x16x64_bf16 v[24:27], v[40:43], a[184:191], v12
 v_smfmac_f32_16x16x64_bf16 v[28:31], v[40:43], v[80:87], v12
 ds_read_b128 v[40:43], v2 offset:8192
 s_waitcnt lgkmcnt(2)
 v_smfmac_f32_16x16x64_bf16 v[16:19], v[32:35], a[48:55], v12
 v_smfmac_f32_16x16x64_bf16 v[20:23], v[32:35], a[120:127], v12
 v_smfmac_f32_16x16x64_bf16 v[24:27], v[32:35], a[192:199], v12
 v_smfmac_f32_16x16x64_bf16 v[28:31], v[32:35], v[88:95], v12
 s_waitcnt lgkmcnt(1)
 v_smfmac_f32_16x16x64_bf16 v[16:19], v[36:39], a[56:63], v12
 v_smfmac_f32_16x16x64_bf16 v[20:23], v[36:39], a[128:135], v12
 v_smfmac_f32_16x16x64_bf16 v[24:27], v[36:39], a[200:207], v12
 v_smfmac_f32_16x16x64_bf16 v[28:31], v[36:39], v[96:103], v12
 s_waitcnt lgkmcnt(0)
 v_smfmac_f32_16x16x64_bf16 v[16:19], v[40:43], a[64:71], v12
 v_smfmac_f32_16x16x64_bf16 v[20:23], v[40:43], a[136:143], v12
 v_smfmac_f32_16x16x64_bf16 v[24:27], v[40:43], a[208:215], v12
 v_smfmac_f32_16x16x64_bf16 v[28:31], v[40:43], v[104:111], v12
 s_nop 7
 v_add_f32 v44, v16, v17
 v_add_f32 v45, v18, v19
 v_cvt_pk_bf16_f32 v46, v44, v45
 ds_write_b16 v0, v46 offset:0
 ds_write_b16_d16_hi v0, v46 offset:784
 v_add_f32 v44, v20, v21
 v_add_f32 v45, v22, v23
 v_cvt_pk_bf16_f32 v47, v44, v45
 ds_write_b16 v0, v47 offset:32
 ds_write_b16_d16_hi v0, v47 offset:816
 v_add_f32 v44, v24, v25
 v_add_f32 v45, v26, v27
 v_cvt_pk_bf16_f32 v48, v44, v45
 ds_write_b16 v0, v48 offset:64
 ds_write_b16_d16_hi v0, v48 offset:848
 v_add_f32 v44, v28, v29
 v_add_f32 v45, v30, v31
 v_cvt_pk_bf16_f32 v49, v44, v45
 ds_write_b16 v0, v49 offset:96
 ds_write_b16_d16_hi v0, v49 offset:880
 s_waitcnt vmcnt(0) lgkmcnt(0)
 s_barrier
 s_cmp_eq_u32 s46, 0
 s_cbranch_scc1 mega_kernel_k037
 s_sub_u32 s53, s46, 1
 s_cmp_lg_u32 s14, 0
 s_cbranch_scc1 mega_kernel_ks38
 s_lshr_b32 s34, s53, 2
 s_add_u32 s34, s34, 32
 s_lshl_b32 s34, s34, 6
 s_mov_b64 exec, 1
 v_mov_b32 v16, 1
 buffer_atomic_add v16, off, s[60:63], s34 sc1
 s_mov_b64 exec, -1
mega_kernel_ks38:
mega_kernel_k037:
 s_cmp_eq_u32 s46, 63
 s_cbranch_scc1 mega_kernel_vonly39
 ds_read_b128 v[16:19], v6 offset:0
 ds_read_b128 v[20:23], v6 offset:256
 v_xor_b32 v60, 0, v7
 ds_read_b128 v[24:27], v60
 ds_read_b128 v[28:31], v60 offset:4096
 ds_read_b128 v[32:35], v6 offset:64
 ds_read_b128 v[36:39], v6 offset:320
 v_xor_b32 v60, 64, v7
 ds_read_b128 v[40:43], v60
 ds_read_b128 v[44:47], v60 offset:4096
 v_mov_b32 v48, 0
 v_mov_b32 v49, 0
 v_mov_b32 v50, 0
 v_mov_b32 v51, 0
 v_mov_b32 v52, 0
 v_mov_b32 v53, 0
 v_mov_b32 v54, 0
 v_mov_b32 v55, 0
 v_mov_b32 v56, 0
 v_mov_b32 v57, 0
 v_mov_b32 v58, 0
 v_mov_b32 v59, 0
 s_waitcnt lgkmcnt(4)
 v_mfma_f32_16x16x32_bf16 v[48:51], v[20:23], v[16:19], v[48:51]
 v_mfma_f32_16x16x32_bf16 v[52:55], v[24:27], v[16:19], v[52:55]
 v_mfma_f32_16x16x32_bf16 v[56:59], v[28:31], v[16:19], v[56:59]
 ds_read_b128 v[16:19], v6 offset:128
 ds_read_b128 v[20:23], v6 offset:384
 v_xor_b32 v60, 128, v7
 ds_read_b128 v[24:27], v60
 ds_read_b128 v[28:31], v60 offset:4096
 s_waitcnt lgkmcnt(4)
 v_mfma_f32_16x16x32_bf16 v[48:51], v[36:39], v[32:35], v[48:51]
 v_mfma_f32_16x16x32_bf16 v[52:55], v[40:43], v[32:35], v[52:55]
 v_mfma_f32_16x16x32_bf16 v[56:59], v[44:47], v[32:35], v[56:59]
 ds_read_b128 v[32:35], v6 offset:192
 ds_read_b128 v[36:39], v6 offset:448
 v_xor_b32 v60, 192, v7
 ds_read_b128 v[40:43], v60
 ds_read_b128 v[44:47], v60 offset:4096
 s_waitcnt lgkmcnt(4)
 v_mfma_f32_16x16x32_bf16 v[48:51], v[20:23], v[16:19], v[48:51]
 v_mfma_f32_16x16x32_bf16 v[52:55], v[24:27], v[16:19], v[52:55]
 v_mfma_f32_16x16x32_bf16 v[56:59], v[28:31], v[16:19], v[56:59]
 s_waitcnt lgkmcnt(0)
 v_mfma_f32_16x16x32_bf16 v[48:51], v[36:39], v[32:35], v[48:51]
 v_mfma_f32_16x16x32_bf16 v[52:55], v[40:43], v[32:35], v[52:55]
 v_mfma_f32_16x16x32_bf16 v[56:59], v[44:47], v[32:35], v[56:59]
 s_lshl_b32 s52, s14, 6
 s_add_u32 s53, s52, 0
 v_xor_b32 v60, s53, v8
 ds_read_b64_tr_b16 v[16:17], v60
 ds_read_b64_tr_b16 v[18:19], v60 offset:4096
 s_add_u32 s53, s52, 32
 v_xor_b32 v60, s53, v8
 ds_read_b64_tr_b16 v[24:25], v60
 ds_read_b64_tr_b16 v[26:27], v60 offset:4096
 ds_read_b128 v[40:43], v2 offset:0
 ds_read_b128 v[44:47], v2 offset:1024
 v_mov_b32 v32, 0
 v_mov_b32 v33, 0
 v_mov_b32 v34, 0
 v_mov_b32 v35, 0
 v_mov_b32 v36, 0
 v_mov_b32 v37, 0
 v_mov_b32 v38, 0
 v_mov_b32 v39, 0
 v_cvt_pk_bf16_f32 v60, v48, v49
 v_cvt_pk_bf16_f32 v61, v50, v51
 v_cvt_pk_bf16_f32 v62, v52, v53
 v_cvt_pk_bf16_f32 v63, v54, v55
 v_cvt_pk_bf16_f32 v4, v56, v57
 v_cvt_pk_bf16_f32 v15, v58, v59
 v_lshlrev_b32 v48, 16, v60
 s_waitcnt lgkmcnt(1)
 v_smfmac_f32_16x16x64_bf16 v[32:35], v[40:43], v[112:119], v12
 v_and_b32 v49, 0xffff0000, v60
 v_lshlrev_b32 v50, 16, v61
 v_and_b32 v51, 0xffff0000, v61
 v_lshlrev_b32 v52, 16, v62
 v_and_b32 v53, 0xffff0000, v62
 v_lshlrev_b32 v54, 16, v63
 v_smfmac_f32_16x16x64_bf16 v[36:39], v[40:43], v[184:191], v12
 ds_read_b128 v[40:43], v2 offset:2048
 v_and_b32 v55, 0xffff0000, v63
 v_lshlrev_b32 v56, 16, v4
 v_and_b32 v57, 0xffff0000, v4
 v_lshlrev_b32 v58, 16, v15
 v_and_b32 v59, 0xffff0000, v15
 v_mul_f32 v48, s44, v48
 s_waitcnt lgkmcnt(1)
 v_smfmac_f32_16x16x64_bf16 v[32:35], v[44:47], v[120:127], v12
 v_mul_f32 v49, s44, v49
 v_mul_f32 v50, s44, v50
 v_mul_f32 v51, s44, v51
 v_mul_f32 v52, s44, v52
 v_mul_f32 v53, s44, v53
 v_mul_f32 v54, s44, v54
 v_smfmac_f32_16x16x64_bf16 v[36:39], v[44:47], v[192:199], v12
 ds_read_b128 v[44:47], v2 offset:3072
 v_mul_f32 v55, s44, v55
 v_mul_f32 v56, s44, v56
 v_mul_f32 v57, s44, v57
 v_mul_f32 v58, s44, v58
 v_mul_f32 v59, s44, v59
 v_cvt_pk_bf16_f32 v60, v48, v49
 s_waitcnt lgkmcnt(1)
 v_smfmac_f32_16x16x64_bf16 v[32:35], v[40:43], v[128:135], v12
 v_cvt_pk_bf16_f32 v61, v50, v51
 v_cvt_pk_bf16_f32 v62, v52, v53
 v_cvt_pk_bf16_f32 v63, v54, v55
 v_cvt_pk_bf16_f32 v4, v56, v57
 v_cvt_pk_bf16_f32 v15, v58, v59
 v_lshlrev_b32 v48, 16, v60
 v_smfmac_f32_16x16x64_bf16 v[36:39], v[40:43], v[200:207], v12
 ds_read_b128 v[40:43], v2 offset:4096
 v_and_b32 v49, 0xffff0000, v60
 v_lshlrev_b32 v50, 16, v61
 v_and_b32 v51, 0xffff0000, v61
 v_lshlrev_b32 v52, 16, v62
 v_and_b32 v53, 0xffff0000, v62
 v_lshlrev_b32 v54, 16, v63
 v_and_b32 v55, 0xffff0000, v63
 s_waitcnt lgkmcnt(1)
 v_smfmac_f32_16x16x64_bf16 v[32:35], v[44:47], v[136:143], v12
 v_lshlrev_b32 v56, 16, v4
 v_and_b32 v57, 0xffff0000, v4
 v_lshlrev_b32 v58, 16, v15
 v_and_b32 v59, 0xffff0000, v15
 v_mov_b32 v4, 0xff800000
 v_cndmask_b32 v48, v48, v4, s[42:43]
 v_smfmac_f32_16x16x64_bf16 v[36:39], v[44:47], v[208:215], v12
 ds_read_b128 v[44:47], v2 offset:5120
 v_cndmask_b32 v49, v49, v4, s[42:43]
 v_cndmask_b32 v50, v50, v4, s[42:43]
 v_cndmask_b32 v51, v51, v4, s[42:43]
 v_max3_f32 v60, v48, v49, v50
 v_max3_f32 v61, v51, v52, v53
 v_max3_f32 v62, v54, v55, v56
 s_waitcnt lgkmcnt(1)
 v_smfmac_f32_16x16x64_bf16 v[32:35], v[40:43], v[144:151], v12
 v_max3_f32 v63, v57, v58, v59
 v_max3_f32 v60, v60, v61, v62
 v_max_f32 v60, v60, v63
 v_mov_b32 v61, v60
 s_nop 1
 v_permlane32_swap_b32 v60, v61
 v_max_f32 v60, v60, v61
 v_mov_b32 v61, v60
 s_nop 1
 v_permlane16_swap_b32 v60, v61
 v_smfmac_f32_16x16x64_bf16 v[36:39], v[40:43], v[216:223], v12
 ds_read_b128 v[40:43], v2 offset:6144
 v_max_f32 v60, v60, v61
 v_mul_f32 v60, s45, v60
 v_fma_f32 v48, v48, s45, -v60
 v_fma_f32 v49, v49, s45, -v60
 v_fma_f32 v50, v50, s45, -v60
 v_fma_f32 v51, v51, s45, -v60
 s_waitcnt lgkmcnt(1)
 v_smfmac_f32_16x16x64_bf16 v[32:35], v[44:47], v[152:159], v12
 v_fma_f32 v52, v52, s45, -v60
 v_fma_f32 v53, v53, s45, -v60
 v_fma_f32 v54, v54, s45, -v60
 v_fma_f32 v55, v55, s45, -v60
 v_fma_f32 v56, v56, s45, -v60
 v_fma_f32 v57, v57, s45, -v60
 v_smfmac_f32_16x16x64_bf16 v[36:39], v[44:47], v[224:231], v12
 ds_read_b128 v[44:47], v2 offset:7168
 v_fma_f32 v58, v58, s45, -v60
 v_fma_f32 v59, v59, s45, -v60
 v_exp_f32 v48, v48
 v_exp_f32 v49, v49
 v_exp_f32 v50, v50
 v_exp_f32 v51, v51
 v_exp_f32 v52, v52
 s_waitcnt lgkmcnt(1)
 v_smfmac_f32_16x16x64_bf16 v[32:35], v[40:43], v[160:167], v12
 v_exp_f32 v53, v53
 v_exp_f32 v54, v54
 v_exp_f32 v55, v55
 v_exp_f32 v56, v56
 v_exp_f32 v57, v57
 v_exp_f32 v58, v58
 v_smfmac_f32_16x16x64_bf16 v[36:39], v[40:43], v[232:239], v12
 ds_read_b128 v[40:43], v2 offset:8192
 v_exp_f32 v59, v59
 s_nop 0
 v_add_f32 v60, v48, v49
 v_add_f32 v61, v50, v51
 v_add_f32 v62, v52, v53
 v_add_f32 v63, v54, v55
 s_waitcnt lgkmcnt(1)
 v_smfmac_f32_16x16x64_bf16 v[32:35], v[44:47], v[168:175], v12
 v_add_f32 v4, v56, v57
 v_add_f32 v15, v58, v59
 v_add_f32 v60, v60, v61
 v_add_f32 v62, v62, v63
 v_add_f32 v4, v4, v15
 v_add_f32 v60, v60, v62
 v_smfmac_f32_16x16x64_bf16 v[36:39], v[44:47], v[240:247], v12
 v_add_f32 v60, v60, v4
 v_mov_b32 v61, v60
 s_nop 1
 v_permlane32_swap_b32 v60, v61
 v_add_f32 v60, v60, v61
 v_mov_b32 v61, v60
 s_nop 1
 v_permlane16_swap_b32 v60, v61
 v_add_f32 v60, v60, v61
 v_rcp_f32 v61, v60
 s_nop 0
 s_waitcnt lgkmcnt(0)
 v_smfmac_f32_16x16x64_bf16 v[32:35], v[40:43], v[176:183], v12
 v_mul_f32 v48, v48, v61
 v_mul_f32 v49, v49, v61
 v_mul_f32 v50, v50, v61
 v_mul_f32 v51, v51, v61
 v_mul_f32 v52, v52, v61
 v_mul_f32 v53, v53, v61
 v_smfmac_f32_16x16x64_bf16 v[36:39], v[40:43], v[248:255], v12
 v_mul_f32 v54, v54, v61
 v_mul_f32 v55, v55, v61
 v_mul_f32 v56, v56, v61
 v_mul_f32 v57, v57, v61
 v_mul_f32 v58, v58, v61
 v_mul_f32 v59, v59, v61
 v_cvt_pk_bf16_f32 v22, v48, v49
 v_cvt_pk_bf16_f32 v23, v50, v51
 v_cvt_pk_bf16_f32 v60, v52, v53
 v_cvt_pk_bf16_f32 v61, v54, v55
 v_cvt_pk_bf16_f32 v62, v56, v57
 v_cvt_pk_bf16_f32 v63, v58, v59
 s_branch mega_kernel_vj40
mega_kernel_vonly39:
 ds_read_b128 v[40:43], v2 offset:0
 ds_read_b128 v[44:47], v2 offset:1024
 v_mov_b32 v32, 0
 v_mov_b32 v33, 0
 v_mov_b32 v34, 0
 v_mov_b32 v35, 0
 v_mov_b32 v36, 0
 v_mov_b32 v37, 0
 v_mov_b32 v38, 0
 v_mov_b32 v39, 0
 s_waitcnt lgkmcnt(1)
 v_smfmac_f32_16x16x64_bf16 v[32:35], v[40:43], v[112:119], v12
 v_smfmac_f32_16x16x64_bf16 v[36:39], v[40:43], v[184:191], v12
 ds_read_b128 v[40:43], v2 offset:2048
 s_waitcnt lgkmcnt(1)
 v_smfmac_f32_16x16x64_bf16 v[32:35], v[44:47], v[120:127], v12
 v_smfmac_f32_16x16x64_bf16 v[36:39], v[44:47], v[192:199], v12
 ds_read_b128 v[44:47], v2 offset:3072
 s_waitcnt lgkmcnt(1)
 v_smfmac_f32_16x16x64_bf16 v[32:35], v[40:43], v[128:135], v12
 v_smfmac_f32_16x16x64_bf16 v[36:39], v[40:43], v[200:207], v12
 ds_read_b128 v[40:43], v2 offset:4096
 s_waitcnt lgkmcnt(1)
 v_smfmac_f32_16x16x64_bf16 v[32:35], v[44:47], v[136:143], v12
 v_smfmac_f32_16x16x64_bf16 v[36:39], v[44:47], v[208:215], v12
 ds_read_b128 v[44:47], v2 offset:5120
 s_waitcnt lgkmcnt(1)
 v_smfmac_f32_16x16x64_bf16 v[32:35], v[40:43], v[144:151], v12
 v_smfmac_f32_16x16x64_bf16 v[36:39], v[40:43], v[216:223], v12
 ds_read_b128 v[40:43], v2 offset:6144
 s_waitcnt lgkmcnt(1)
 v_smfmac_f32_16x16x64_bf16 v[32:35], v[44:47], v[152:159], v12
 v_smfmac_f32_16x16x64_bf16 v[36:39], v[44:47], v[224:231], v12
 ds_read_b128 v[44:47], v2 offset:7168
 s_waitcnt lgkmcnt(1)
 v_smfmac_f32_16x16x64_bf16 v[32:35], v[40:43], v[160:167], v12
 v_smfmac_f32_16x16x64_bf16 v[36:39], v[40:43], v[232:239], v12
 ds_read_b128 v[40:43], v2 offset:8192
 s_waitcnt lgkmcnt(1)
 v_smfmac_f32_16x16x64_bf16 v[32:35], v[44:47], v[168:175], v12
 v_smfmac_f32_16x16x64_bf16 v[36:39], v[44:47], v[240:247], v12
 s_waitcnt lgkmcnt(0)
 v_smfmac_f32_16x16x64_bf16 v[32:35], v[40:43], v[176:183], v12
 v_smfmac_f32_16x16x64_bf16 v[36:39], v[40:43], v[248:255], v12
mega_kernel_vj40:
 s_nop 7
 v_add_f32 v40, v32, v33
 v_add_f32 v41, v34, v35
 v_cvt_pk_bf16_f32 v42, v40, v41
 ds_write_b16 v5, v42 offset:0
 ds_write_b16_d16_hi v5, v42 offset:784
 v_add_f32 v40, v36, v37
 v_add_f32 v41, v38, v39
 v_cvt_pk_bf16_f32 v43, v40, v41
 ds_write_b16 v5, v43 offset:32
 ds_write_b16_d16_hi v5, v43 offset:816
 s_cmp_eq_u32 s46, 63
 s_cbranch_scc1 mega_kernel_fin34
 v_mov_b32 v32, 0
 v_mov_b32 v33, 0
 v_mov_b32 v34, 0
 v_mov_b32 v35, 0
 v_mov_b32 v36, 0
 v_mov_b32 v37, 0
 v_mov_b32 v38, 0
 v_mov_b32 v39, 0
 s_waitcnt lgkmcnt(0)
 s_barrier
 s_add_u32 s53, s52, 0
 v_add_u32 v4, s53, v9
 ds_read_b64_tr_b16 v[20:21], v4
 s_add_u32 s53, s52, 32
 v_add_u32 v4, s53, v9
 ds_read_b64_tr_b16 v[28:29], v4
 v_mfma_f32_16x16x32_bf16 v[32:35], v[16:19], v[60:63], v[32:35]
 v_mfma_f32_16x16x32_bf16 v[36:39], v[24:27], v[60:63], v[36:39]
 v_add_u32 v44, s52, v6
 s_waitcnt lgkmcnt(0)
 s_nop 4
 v_mfma_f32_16x16x16_bf16 v[32:35], v[20:21], v[22:23], v[32:35]
 v_mfma_f32_16x16x16_bf16 v[36:39], v[28:29], v[22:23], v[36:39]
 ds_read_b128 v[48:51], v10 offset:0
 ds_read_b128 v[52:55], v10 offset:1024
 ds_read_b128 v[56:59], v10 offset:2048
 ds_read_b128 v[60:63], v10 offset:3072
 s_nop 3
 v_cvt_pk_bf16_f32 v40, v32, v33
 v_cvt_pk_bf16_f32 v41, v34, v35
 v_cvt_pk_bf16_f32 v42, v36, v37
 v_cvt_pk_bf16_f32 v43, v38, v39
 s_mov_b64 exec, s[40:41]
 ds_write_b128 v44, v[40:43]
 s_mov_b64 exec, -1
 v_mov_b32 v32, 0
 v_mov_b32 v33, 0
 v_mov_b32 v34, 0
 v_mov_b32 v35, 0
 v_mov_b32 v36, 0
 v_mov_b32 v37, 0
 v_mov_b32 v38, 0
 v_mov_b32 v39, 0
 s_waitcnt lgkmcnt(0)
 s_barrier
 v_lshrrev_b32 v4, 8, v13
 s_and_b32 s34, s14, 1
 s_lshl_b32 s34, s34, 2
 v_add_u32 v4, s34, v4
 v_and_b32 v15, 0xf0, v13
 v_mad_u32_u24 v44, v4, s56, v15
 s_lshr_b32 s34, s14, 1
 s_lshl_b32 s35, s34, 8
 s_add_u32 s35, s35, 157056
 v_add_u32 v44, s35, v44
 v_lshl_add_u32 v4, v4, 14, v15
 s_lshl_b32 s34, s34, 13
 s_mul_i32 s58, s46, 131072
 s_add_u32 s58, s58, s34
 s_add_u32 s58, s58, s15
 ds_read_b128 v[44:47], v44
 ds_read_b128 v[16:19], v6 offset:0
 ds_read_b128 v[20:23], v6 offset:64
 ds_read_b128 v[24:27], v6 offset:128
 ds_read_b128 v[28:31], v6 offset:192
 s_and_b32 s47, s46, 3
 s_lshl_b32 s47, s47, 5
 s_add_u32 s47, s47, s94
 s_mul_i32 s47, s47, 18432
 v_mov_b32 v40, 0
 v_mov_b32 v41, 0
 v_mov_b32 v42, 0
 v_mov_b32 v43, 0
 s_waitcnt lgkmcnt(0)
 v_mfma_f32_16x16x32_bf16 v[32:35], v[64:67], v[16:19], v[32:35]
 v_mfma_f32_16x16x32_bf16 v[32:35], v[68:71], v[20:23], v[32:35]
 v_mfma_f32_16x16x32_bf16 v[32:35], v[72:75], v[24:27], v[32:35]
 v_mfma_f32_16x16x32_bf16 v[32:35], v[76:79], v[28:31], v[32:35]
 buffer_store_dwordx4 v[44:47], v4, s[28:31], s58 offen sc1
 s_waitcnt lgkmcnt(3)
 v_mfma_f32_16x16x32_bf16 v[36:39], v[48:51], v[16:19], v[36:39]
 ds_read_b128 v[48:51], v10 offset:4096
 s_waitcnt lgkmcnt(3)
 v_mfma_f32_16x16x32_bf16 v[36:39], v[52:55], v[20:23], v[36:39]
 ds_read_b128 v[52:55], v10 offset:5120
 s_waitcnt lgkmcnt(3)
 v_mfma_f32_16x16x32_bf16 v[36:39], v[56:59], v[24:27], v[36:39]
 ds_read_b128 v[56:59], v10 offset:6144
 s_waitcnt lgkmcnt(3)
 v_mfma_f32_16x16x32_bf16 v[36:39], v[60:63], v[28:31], v[36:39]
 ds_read_b128 v[60:63], v10 offset:7168
 s_mov_b64 exec, s[40:41]
 s_add_u32 s50, s47, 4096
 s_cmp_eq_u32 s59, 1
 s_cbranch_scc1 mega_kernel_da41
 buffer_store_dwordx4 v[32:35], v11, s[16:19], s50 offen sc1
 s_branch mega_kernel_db42
mega_kernel_da41:
 buffer_store_dwordx4 v[32:35], v11, s[16:19], s50 offen
mega_kernel_db42:
 s_mov_b64 exec, -1
 s_waitcnt lgkmcnt(3)
 v_mfma_f32_16x16x32_bf16 v[40:43], v[48:51], v[16:19], v[40:43]
 ds_read_b128 v[48:51], v10 offset:8192
 s_waitcnt lgkmcnt(3)
 v_mfma_f32_16x16x32_bf16 v[40:43], v[52:55], v[20:23], v[40:43]
 ds_read_b128 v[52:55], v10 offset:9216
 s_waitcnt lgkmcnt(3)
 v_mfma_f32_16x16x32_bf16 v[40:43], v[56:59], v[24:27], v[40:43]
 ds_read_b128 v[56:59], v10 offset:10240
 s_waitcnt lgkmcnt(3)
 v_mfma_f32_16x16x32_bf16 v[40:43], v[60:63], v[28:31], v[40:43]
 ds_read_b128 v[60:63], v10 offset:11264
 s_mov_b64 exec, s[40:41]
 s_cmp_eq_u32 s59, 1
 s_cbranch_scc1 mega_kernel_da43
 buffer_store_dwordx4 v[36:39], v11, s[16:19], s47 offen offset:0 sc1
 s_branch mega_kernel_db44
mega_kernel_da43:
 buffer_store_dwordx4 v[36:39], v11, s[16:19], s47 offen offset:0
mega_kernel_db44:
 s_mov_b64 exec, -1
 v_mov_b32 v32, 0
 v_mov_b32 v33, 0
 v_mov_b32 v34, 0
 v_mov_b32 v35, 0
 s_nop 1
 s_waitcnt lgkmcnt(3)
 v_mfma_f32_16x16x32_bf16 v[32:35], v[48:51], v[16:19], v[32:35]
 ds_read_b128 v[48:51], v10 offset:12288
 s_waitcnt lgkmcnt(3)
 v_mfma_f32_16x16x32_bf16 v[32:35], v[52:55], v[20:23], v[32:35]
 ds_read_b128 v[52:55], v10 offset:13312
 s_waitcnt lgkmcnt(3)
 v_mfma_f32_16x16x32_bf16 v[32:35], v[56:59], v[24:27], v[32:35]
 ds_read_b128 v[56:59], v10 offset:14336
 s_waitcnt lgkmcnt(3)
 v_mfma_f32_16x16x32_bf16 v[32:35], v[60:63], v[28:31], v[32:35]
 ds_read_b128 v[60:63], v10 offset:15360
 s_mov_b64 exec, s[40:41]
 s_cmp_eq_u32 s59, 1
 s_cbranch_scc1 mega_kernel_da45
 buffer_store_dwordx4 v[40:43], v11, s[16:19], s47 offen offset:512 sc1
 s_branch mega_kernel_db46
mega_kernel_da45:
 buffer_store_dwordx4 v[40:43], v11, s[16:19], s47 offen offset:512
mega_kernel_db46:
 s_mov_b64 exec, -1
 v_mov_b32 v36, 0
 v_mov_b32 v37, 0
 v_mov_b32 v38, 0
 v_mov_b32 v39, 0
 s_nop 1
 s_waitcnt lgkmcnt(3)
 v_mfma_f32_16x16x32_bf16 v[36:39], v[48:51], v[16:19], v[36:39]
 ds_read_b128 v[48:51], v10 offset:16384
 s_waitcnt lgkmcnt(3)
 v_mfma_f32_16x16x32_bf16 v[36:39], v[52:55], v[20:23], v[36:39]
 ds_read_b128 v[52:55], v10 offset:17408
 s_waitcnt lgkmcnt(3)
 v_mfma_f32_16x16x32_bf16 v[36:39], v[56:59], v[24:27], v[36:39]
 ds_read_b128 v[56:59], v10 offset:18432
 s_waitcnt lgkmcnt(3)
 v_mfma_f32_16x16x32_bf16 v[36:39], v[60:63], v[28:31], v[36:39]
 ds_read_b128 v[60:63], v10 offset:19456
 s_mov_b64 exec, s[40:41]
 s_cmp_eq_u32 s59, 1
 s_cbranch_scc1 mega_kernel_da47
 buffer_store_dwordx4 v[32:35], v11, s[16:19], s47 offen offset:1024 sc1
 s_branch mega_kernel_db48
mega_kernel_da47:
 buffer_store_dwordx4 v[32:35], v11, s[16:19], s47 offen offset:1024
mega_kernel_db48:
 s_mov_b64 exec, -1
 v_mov_b32 v40, 0
 v_mov_b32 v41, 0
 v_mov_b32 v42, 0
 v_mov_b32 v43, 0
 s_nop 1
 s_waitcnt lgkmcnt(3)
 v_mfma_f32_16x16x32_bf16 v[40:43], v[48:51], v[16:19], v[40:43]
 ds_read_b128 v[48:51], v10 offset:20480
 s_waitcnt lgkmcnt(3)
 v_mfma_f32_16x16x32_bf16 v[40:43], v[52:55], v[20:23], v[40:43]
 ds_read_b128 v[52:55], v10 offset:21504
 s_waitcnt lgkmcnt(3)
 v_mfma_f32_16x16x32_bf16 v[40:43], v[56:59], v[24:27], v[40:43]
 ds_read_b128 v[56:59], v10 offset:22528
 s_waitcnt lgkmcnt(3)
 v_mfma_f32_16x16x32_bf16 v[40:43], v[60:63], v[28:31], v[40:43]
 ds_read_b128 v[60:63], v10 offset:23552
 s_mov_b64 exec, s[40:41]
 s_cmp_eq_u32 s59, 1
 s_cbranch_scc1 mega_kernel_da49
 buffer_store_dwordx4 v[36:39], v11, s[16:19], s47 offen offset:1536 sc1
 s_branch mega_kernel_db50
mega_kernel_da49:
 buffer_store_dwordx4 v[36:39], v11, s[16:19], s47 offen offset:1536
mega_kernel_db50:
 s_mov_b64 exec, -1
 v_mov_b32 v32, 0
 v_mov_b32 v33, 0
 v_mov_b32 v34, 0
 v_mov_b32 v35, 0
 s_nop 1
 s_waitcnt lgkmcnt(3)
 v_mfma_f32_16x16x32_bf16 v[32:35], v[48:51], v[16:19], v[32:35]
 ds_read_b128 v[48:51], v10 offset:24576
 s_waitcnt lgkmcnt(3)
 v_mfma_f32_16x16x32_bf16 v[32:35], v[52:55], v[20:23], v[32:35]
 ds_read_b128 v[52:55], v10 offset:25600
 s_waitcnt lgkmcnt(3)
 v_mfma_f32_16x16x32_bf16 v[32:35], v[56:59], v[24:27], v[32:35]
 ds_read_b128 v[56:59], v10 offset:26624
 s_waitcnt lgkmcnt(3)
 v_mfma_f32_16x16x32_bf16 v[32:35], v[60:63], v[28:31], v[32:35]
 ds_read_b128 v[60:63], v10 offset:27648
 s_mov_b64 exec, s[40:41]
 s_cmp_eq_u32 s59, 1
 s_cbranch_scc1 mega_kernel_da51
 buffer_store_dwordx4 v[40:43], v11, s[16:19], s47 offen offset:2048 sc1
 s_branch mega_kernel_db52
mega_kernel_da51:
 buffer_store_dwordx4 v[40:43], v11, s[16:19], s47 offen offset:2048
mega_kernel_db52:
 s_mov_b64 exec, -1
 v_mov_b32 v36, 0
 v_mov_b32 v37, 0
 v_mov_b32 v38, 0
 v_mov_b32 v39, 0
 s_nop 1
 s_waitcnt lgkmcnt(3)
 v_mfma_f32_16x16x32_bf16 v[36:39], v[48:51], v[16:19], v[36:39]
 ds_read_b128 v[48:51], v10 offset:28672
 s_waitcnt lgkmcnt(3)
 v_mfma_f32_16x16x32_bf16 v[36:39], v[52:55], v[20:23], v[36:39]
 ds_read_b128 v[52:55], v10 offset:29696
 s_waitcnt lgkmcnt(3)
 v_mfma_f32_16x16x32_bf16 v[36:39], v[56:59], v[24:27], v[36:39]
 ds_read_b128 v[56:59], v10 offset:30720
 s_waitcnt lgkmcnt(3)
 v_mfma_f32_16x16x32_bf16 v[36:39], v[60:63], v[28:31], v[36:39]
 ds_read_b128 v[60:63], v10 offset:31744
 s_mov_b64 exec, s[40:41]
 s_cmp_eq_u32 s59, 1
 s_cbranch_scc1 mega_kernel_da53
 buffer_store_dwordx4 v[32:35], v11, s[16:19], s47 offen offset:2560 sc1
 s_branch mega_kernel_db54
mega_kernel_da53:
 buffer_store_dwordx4 v[32:35], v11, s[16:19], s47 offen offset:2560
mega_kernel_db54:
 s_mov_b64 exec, -1
 v_mov_b32 v40, 0
 v_mov_b32 v41, 0
 v_mov_b32 v42, 0
 v_mov_b32 v43, 0
 s_nop 1
 s_waitcnt lgkmcnt(3)
 v_mfma_f32_16x16x32_bf16 v[40:43], v[48:51], v[16:19], v[40:43]
 s_waitcnt lgkmcnt(2)
 v_mfma_f32_16x16x32_bf16 v[40:43], v[52:55], v[20:23], v[40:43]
 s_waitcnt lgkmcnt(1)
 v_mfma_f32_16x16x32_bf16 v[40:43], v[56:59], v[24:27], v[40:43]
 s_waitcnt lgkmcnt(0)
 v_mfma_f32_16x16x32_bf16 v[40:43], v[60:63], v[28:31], v[40:43]
 s_mov_b64 exec, s[40:41]
 s_cmp_eq_u32 s59, 1
 s_cbranch_scc1 mega_kernel_da55
 buffer_store_dwordx4 v[36:39], v11, s[16:19], s47 offen offset:3072 sc1
 s_branch mega_kernel_db56
mega_kernel_da55:
 buffer_store_dwordx4 v[36:39], v11, s[16:19], s47 offen offset:3072
mega_kernel_db56:
 s_mov_b64 exec, -1
 s_nop 7
 s_mov_b64 exec, s[40:41]
 s_cmp_eq_u32 s59, 1
 s_cbranch_scc1 mega_kernel_da57
 buffer_store_dwordx4 v[40:43], v11, s[16:19], s47 offen offset:3584 sc1
 s_branch mega_kernel_db58
mega_kernel_da57:
 buffer_store_dwordx4 v[40:43], v11, s[16:19], s47 offen offset:3584
mega_kernel_db58:
 s_mov_b64 exec, -1
 v_lshrrev_b32 v60, 7, v13
 v_lshrrev_b32 v61, 4, v13
 v_and_b32 v61, 7, v61
 v_mul_u32_u24 v62, 18432, v60
 v_lshl_add_u32 v62, v61, 4, v62
 s_and_b32 s47, s46, 3
 s_mul_i32 s47, s47, 589824
 s_lshl_b32 s48, s14, 7
 s_add_u32 s47, s47, s48
 s_add_u32 s51, s94, 32
 s_cmp_lt_u32 s94, 4
 s_cselect_b32 s51, s51, s94
 s_lshl_b32 s48, s94, 9
 s_add_u32 s48, s48, s47
 s_lshl_b32 s50, s51, 9
 s_add_u32 s50, s50, s47
 s_mov_b32 s49, 0
 s_mov_b32 s90, s48
 s_mov_b32 s91, s50
 v_mov_b32 v32, 0
 v_mov_b32 v33, 0
 v_mov_b32 v34, 0
 v_mov_b32 v35, 0
 v_mov_b32 v36, 0
 v_mov_b32 v37, 0
 v_mov_b32 v38, 0
 v_mov_b32 v39, 0
 v_mov_b32 v40, 0
 v_mov_b32 v41, 0
 v_mov_b32 v42, 0
 v_mov_b32 v43, 0
 v_mov_b32 v44, 0
 v_mov_b32 v45, 0
 v_mov_b32 v46, 0
 v_mov_b32 v47, 0
mega_kernel_rp59:
 s_add_u32 s52, s48, 0
 buffer_load_dwordx4 v[16:19], v62, s[16:19], s52 offen sc1
 s_add_u32 s52, s48, 147456
 buffer_load_dwordx4 v[20:23], v62, s[16:19], s52 offen sc1
 s_add_u32 s52, s48, 294912
 buffer_load_dwordx4 v[24:27], v62, s[16:19], s52 offen sc1
 s_add_u32 s52, s48, 442368
 buffer_load_dwordx4 v[28:31], v62, s[16:19], s52 offen sc1
 s_cmp_ge_u32 s94, 4
 s_cbranch_scc1 mega_kernel_one61
 s_add_u32 s52, s50, 0
 buffer_load_dwordx4 v[32:35], v62, s[16:19], s52 offen sc1
 s_add_u32 s52, s50, 147456
 buffer_load_dwordx4 v[36:39], v62, s[16:19], s52 offen sc1
 s_add_u32 s52, s50, 294912
 buffer_load_dwordx4 v[40:43], v62, s[16:19], s52 offen sc1
 s_add_u32 s52, s50, 442368
 buffer_load_dwordx4 v[44:47], v62, s[16:19], s52 offen sc1
mega_kernel_one61:
 s_waitcnt vmcnt(0)
 v_add_f32 v48, v16, v20
 v_add_f32 v24, v24, v28
 v_add_f32 v49, v17, v21
 v_add_f32 v25, v25, v29
 v_add_f32 v50, v18, v22
 v_add_f32 v26, v26, v30
 v_add_f32 v51, v19, v23
 v_add_f32 v27, v27, v31
 v_add_f32 v48, v48, v24
 v_add_f32 v49, v49, v25
 v_add_f32 v50, v50, v26
 v_add_f32 v51, v51, v27
 v_add_f32 v52, v32, v36
 v_add_f32 v40, v40, v44
 v_add_f32 v53, v33, v37
 v_add_f32 v41, v41, v45
 v_add_f32 v54, v34, v38
 v_add_f32 v42, v42, v46
 v_add_f32 v55, v35, v39
 v_add_f32 v43, v43, v47
 v_add_f32 v52, v52, v40
 v_add_f32 v53, v53, v41
 v_add_f32 v54, v54, v42
 v_add_f32 v55, v55, v43
 v_add_f32 v56, v48, v49
 v_add_f32 v57, v50, v51
 v_add_f32 v58, v52, v53
 v_add_f32 v59, v54, v55
 v_add_f32 v56, v56, v57
 v_add_f32 v58, v58, v59
 v_cmp_u_f32 vcc, v56, v58
 s_cbranch_vccz mega_kernel_rd60
 s_add_u32 s49, s49, 1
 s_cmp_lt_u32 s49, 300000
 s_cbranch_scc1 mega_kernel_rp59
mega_kernel_rd60:
 v_mov_b32 v16, v48
 v_mov_b32 v17, v49
 v_mov_b32 v18, v50
 v_mov_b32 v19, v51
 v_mov_b32 v20, v52
 v_mov_b32 v21, v53
 v_mov_b32 v22, v54
 v_mov_b32 v23, v55
 s_nop 0
 v_permlane32_swap_b32 v48, v16
 v_permlane32_swap_b32 v49, v17
 v_permlane32_swap_b32 v50, v18
 v_permlane32_swap_b32 v51, v19
 v_permlane32_swap_b32 v52, v20
 v_permlane32_swap_b32 v53, v21
 v_permlane32_swap_b32 v54, v22
 v_permlane32_swap_b32 v55, v23
 v_add_f32 v48, v48, v16
 v_add_f32 v49, v49, v17
 v_add_f32 v50, v50, v18
 v_add_f32 v51, v51, v19
 v_add_f32 v52, v52, v20
 v_add_f32 v53, v53, v21
 v_add_f32 v54, v54, v22
 v_add_f32 v55, v55, v23
 v_mov_b32 v16, v48
 v_mov_b32 v17, v49
 v_mov_b32 v18, v50
 v_mov_b32 v19, v51
 v_mov_b32 v20, v52
 v_mov_b32 v21, v53
 v_mov_b32 v22, v54
 v_mov_b32 v23, v55
 s_nop 0
 v_permlane16_swap_b32 v48, v16
 v_permlane16_swap_b32 v49, v17
 v_permlane16_swap_b32 v50, v18
 v_permlane16_swap_b32 v51, v19
 v_permlane16_swap_b32 v52, v20
 v_permlane16_swap_b32 v53, v21
 v_permlane16_swap_b32 v54, v22
 v_permlane16_swap_b32 v55, v23
 v_add_f32 v48, v48, v16
 v_add_f32 v49, v49, v17
 v_add_f32 v50, v50, v18
 v_add_f32 v51, v51, v19
 v_add_f32 v52, v52, v20
 v_add_f32 v53, v53, v21
 v_add_f32 v54, v54, v22
 v_add_f32 v55, v55, v23
 s_nop 1
 v_add_f32_dpp v48, v48, v48 row_ror:8 row_mask:0xf bank_mask:0xf
 v_add_f32_dpp v49, v49, v49 row_ror:8 row_mask:0xf bank_mask:0xf
 v_add_f32_dpp v50, v50, v50 row_ror:8 row_mask:0xf bank_mask:0xf
 v_add_f32_dpp v51, v51, v51 row_ror:8 row_mask:0xf bank_mask:0xf
 v_add_f32_dpp v52, v52, v52 row_ror:8 row_mask:0xf bank_mask:0xf
 v_add_f32_dpp v53, v53, v53 row_ror:8 row_mask:0xf bank_mask:0xf
 v_add_f32_dpp v54, v54, v54 row_ror:8 row_mask:0xf bank_mask:0xf
 v_add_f32_dpp v55, v55, v55 row_ror:8 row_mask:0xf bank_mask:0xf
 v_cvt_pk_bf16_f32 v16, v48, v49
 v_cvt_pk_bf16_f32 v17, v50, v51
 v_cvt_pk_bf16_f32 v18, v52, v53
 v_cvt_pk_bf16_f32 v19, v54, v55
 v_min_u32 v16, 0xfffffffe, v16
 v_min_u32 v17, 0xfffffffe, v17
 v_min_u32 v18, 0xfffffffe, v18
 v_min_u32 v19, 0xfffffffe, v19
 v_lshlrev_b32 v61, 3, v61
 s_add_u32 s48, s46, 1
 s_and_b32 s48, s48, 3
 s_mul_i32 s48, s48, 9216
 s_lshl_b32 s52, s14, 6
 s_add_u32 s48, s48, s52
 s_lshl_b32 s50, s51, 8
 s_add_u32 s50, s50, s48
 s_lshl_b32 s52, s94, 8
 s_add_u32 s48, s48, s52
 v_mov_b32 v20, -1
 v_mov_b32 v21, -1
 v_mov_b32 v22, -1
 v_mov_b32 v23, -1
 s_mov_b64 exec, 0xff
 s_cmp_eq_u32 s59, 1
 s_cbranch_scc1 mega_kernel_da62
 buffer_store_dwordx2 v[16:17], v61, s[20:23], s48 offen sc1
 s_branch mega_kernel_db63
mega_kernel_da62:
 buffer_store_dwordx2 v[16:17], v61, s[20:23], s48 offen
mega_kernel_db63:
 s_cmp_ge_u32 s94, 4
 s_cbranch_scc1 mega_kernel_nb64
 s_cmp_eq_u32 s59, 1
 s_cbranch_scc1 mega_kernel_da65
 buffer_store_dwordx2 v[18:19], v61, s[20:23], s50 offen sc1
 s_branch mega_kernel_db66
mega_kernel_da65:
 buffer_store_dwordx2 v[18:19], v61, s[20:23], s50 offen
mega_kernel_db66:
mega_kernel_nb64:
 s_and_b32 s34, s46, 3
 s_add_u32 s35, s46, 1
 s_and_b32 s35, s35, 3
 s_sub_u32 s34, s34, s35
 s_mul_i32 s34, s34, 9216
 s_add_u32 s48, s48, s34
 s_add_u32 s50, s50, s34
 s_cmp_eq_u32 s46, 0
 s_cbranch_scc1 mega_kernel_z67
 s_cmp_eq_u32 s59, 1
 s_cbranch_scc1 mega_kernel_da68
 buffer_store_dwordx2 v[20:21], v61, s[20:23], s48 offen sc1
 s_branch mega_kernel_db69
mega_kernel_da68:
 buffer_store_dwordx2 v[20:21], v61, s[20:23], s48 offen
mega_kernel_db69:
 s_cmp_eq_u32 s59, 1
 s_cbranch_scc1 mega_kernel_da70
 buffer_store_dwordx2 v[20:21], v61, s[20:23], s50 offen sc1
 s_branch mega_kernel_db71
mega_kernel_da70:
 buffer_store_dwordx2 v[20:21], v61, s[20:23], s50 offen
mega_kernel_db71:
mega_kernel_z67:
 s_mov_b64 exec, -1
 s_add_u32 s52, s90, 0
 s_cmp_eq_u32 s59, 1
 s_cbranch_scc1 mega_kernel_da73
 buffer_store_dwordx4 v[20:23], v62, s[16:19], s52 offen sc1
 s_branch mega_kernel_db74
mega_kernel_da73:
 buffer_store_dwordx4 v[20:23], v62, s[16:19], s52 offen
mega_kernel_db74:
 s_add_u32 s52, s90, 147456
 s_cmp_eq_u32 s59, 1
 s_cbranch_scc1 mega_kernel_da75
 buffer_store_dwordx4 v[20:23], v62, s[16:19], s52 offen sc1
 s_branch mega_kernel_db76
mega_kernel_da75:
 buffer_store_dwordx4 v[20:23], v62, s[16:19], s52 offen
mega_kernel_db76:
 s_add_u32 s52, s90, 294912
 s_cmp_eq_u32 s59, 1
 s_cbranch_scc1 mega_kernel_da77
 buffer_store_dwordx4 v[20:23], v62, s[16:19], s52 offen sc1
 s_branch mega_kernel_db78
mega_kernel_da77:
 buffer_store_dwordx4 v[20:23], v62, s[16:19], s52 offen
mega_kernel_db78:
 s_add_u32 s52, s90, 442368
 s_cmp_eq_u32 s59, 1
 s_cbranch_scc1 mega_kernel_da79
 buffer_store_dwordx4 v[20:23], v62, s[16:19], s52 offen sc1
 s_branch mega_kernel_db80
mega_kernel_da79:
 buffer_store_dwordx4 v[20:23], v62, s[16:19], s52 offen
mega_kernel_db80:
 s_cmp_ge_u32 s94, 4
 s_cbranch_scc1 mega_kernel_pb72
 s_add_u32 s52, s91, 0
 s_cmp_eq_u32 s59, 1
 s_cbranch_scc1 mega_kernel_da81
 buffer_store_dwordx4 v[20:23], v62, s[16:19], s52 offen sc1
 s_branch mega_kernel_db82
mega_kernel_da81:
 buffer_store_dwordx4 v[20:23], v62, s[16:19], s52 offen
mega_kernel_db82:
 s_add_u32 s52, s91, 147456
 s_cmp_eq_u32 s59, 1
 s_cbranch_scc1 mega_kernel_da83
 buffer_store_dwordx4 v[20:23], v62, s[16:19], s52 offen sc1
 s_branch mega_kernel_db84
mega_kernel_da83:
 buffer_store_dwordx4 v[20:23], v62, s[16:19], s52 offen
mega_kernel_db84:
 s_add_u32 s52, s91, 294912
 s_cmp_eq_u32 s59, 1
 s_cbranch_scc1 mega_kernel_da85
 buffer_store_dwordx4 v[20:23], v62, s[16:19], s52 offen sc1
 s_branch mega_kernel_db86
mega_kernel_da85:
 buffer_store_dwordx4 v[20:23], v62, s[16:19], s52 offen
mega_kernel_db86:
 s_add_u32 s52, s91, 442368
 s_cmp_eq_u32 s59, 1
 s_cbranch_scc1 mega_kernel_da87
 buffer_store_dwordx4 v[20:23], v62, s[16:19], s52 offen sc1
 s_branch mega_kernel_db88
mega_kernel_da87:
 buffer_store_dwordx4 v[20:23], v62, s[16:19], s52 offen
mega_kernel_db88:
mega_kernel_pb72:
 s_add_u32 s53, s46, 1
 s_cmp_lg_u32 s14, 3
 s_cbranch_scc1 mega_kernel_kd89
 s_mul_i32 s47, s53, 786432
 s_add_u32 s47, s47, s15
 s_add_u32 s47, s47, 8192
 v_xor_b32 v60, 0, v1
 v_xor_b32 v61, 0, v3
 s_add_u32 s35, s47, 0
 s_mov_b32 m0, 131072
 s_nop 0
 buffer_load_dwordx4 v60, s[24:27], s35 offen lds
 s_add_u32 s35, s35, 8192
 s_mov_b32 m0, 139264
 s_nop 0
 buffer_load_dwordx4 v61, s[24:27], s35 offen lds
 s_add_u32 s35, s47, 393216
 s_mov_b32 m0, 135168
 s_nop 0
 buffer_load_dwordx4 v60, s[24:27], s35 offen lds
 s_add_u32 s35, s35, 8192
 s_mov_b32 m0, 143360
 s_nop 0
 buffer_load_dwordx4 v61, s[24:27], s35 offen lds
 v_xor_b32 v60, 64, v1
 v_xor_b32 v61, 128, v3
 s_add_u32 s35, s47, 98304
 s_mov_b32 m0, 132096
 s_nop 0
 buffer_load_dwordx4 v60, s[24:27], s35 offen lds
 s_add_u32 s35, s35, 8192
 s_mov_b32 m0, 140288
 s_nop 0
 buffer_load_dwordx4 v61, s[24:27], s35 offen lds
 s_add_u32 s35, s47, 491520
 s_mov_b32 m0, 136192
 s_nop 0
 buffer_load_dwordx4 v60, s[24:27], s35 offen lds
 s_add_u32 s35, s35, 8192
 s_mov_b32 m0, 144384
 s_nop 0
 buffer_load_dwordx4 v61, s[24:27], s35 offen lds
 v_xor_b32 v60, 128, v1
 v_xor_b32 v61, 0, v3
 s_add_u32 s35, s47, 196608
 s_mov_b32 m0, 133120
 s_nop 0
 buffer_load_dwordx4 v60, s[24:27], s35 offen lds
 s_add_u32 s35, s35, 8192
 s_mov_b32 m0, 141312
 s_nop 0
 buffer_load_dwordx4 v61, s[24:27], s35 offen lds
 s_add_u32 s35, s47, 589824
 s_mov_b32 m0, 137216
 s_nop 0
 buffer_load_dwordx4 v60, s[24:27], s35 offen lds
 s_add_u32 s35, s35, 8192
 s_mov_b32 m0, 145408
 s_nop 0
 buffer_load_dwordx4 v61, s[24:27], s35 offen lds
 v_xor_b32 v60, 192, v1
 v_xor_b32 v61, 128, v3
 s_add_u32 s35, s47, 294912
 s_mov_b32 m0, 134144
 s_nop 0
 buffer_load_dwordx4 v60, s[24:27], s35 offen lds
 s_add_u32 s35, s35, 8192
 s_mov_b32 m0, 142336
 s_nop 0
 buffer_load_dwordx4 v61, s[24:27], s35 offen lds
 s_add_u32 s35, s47, 688128
 s_mov_b32 m0, 138240
 s_nop 0
 buffer_load_dwordx4 v60, s[24:27], s35 offen lds
 s_add_u32 s35, s35, 8192
 s_mov_b32 m0, 146432
 s_nop 0
 buffer_load_dwordx4 v61, s[24:27], s35 offen lds
mega_kernel_kd89:
 s_add_u32 s46, s46, 1
 s_branch mega_kernel_step31
mega_kernel_fin34:
 s_waitcnt lgkmcnt(0)
 s_barrier
 v_lshrrev_b32 v4, 8, v13
 s_and_b32 s34, s14, 1
 s_lshl_b32 s34, s34, 2
 v_add_u32 v4, s34, v4
 v_and_b32 v15, 0xf0, v13
 v_mad_u32_u24 v44, v4, s56, v15
 s_lshr_b32 s34, s14, 1
 s_lshl_b32 s35, s34, 8
 s_add_u32 s35, s35, 157056
 v_add_u32 v44, s35, v44
 v_lshl_add_u32 v4, v4, 14, v15
 s_lshl_b32 s34, s34, 13
 s_mul_i32 s58, s46, 131072
 s_add_u32 s58, s58, s34
 s_add_u32 s58, s58, s15
 ds_read_b128 v[44:47], v44
 s_waitcnt lgkmcnt(0)
 buffer_store_dwordx4 v[44:47], v4, s[28:31], s58 offen sc1
 s_waitcnt vmcnt(0)
 s_barrier
 s_cmp_lg_u32 s14, 0
 s_cbranch_scc1 mega_kernel_ks90
 s_lshr_b32 s34, s46, 2
 s_add_u32 s34, s34, 32
 s_lshl_b32 s34, s34, 6
 s_mov_b64 exec, 1
 v_mov_b32 v16, 1
 buffer_atomic_add v16, off, s[60:63], s34 sc1
 s_mov_b64 exec, -1
mega_kernel_ks90:
 s_branch mega_kernel_end1
mega_kernel_bqkv92:
 s_load_dwordx2 s[8:9], s[0:1], 120
 s_load_dwordx4 s[4:7], s[0:1], 16
 s_load_dwordx2 s[10:11], s[0:1], 32
 s_mov_b32 s43, 89478486
 s_mul_hi_u32 s45, s2, s43
 s_mul_i32 s44, s45, 48
 s_sub_u32 s44, s2, s44
 s_mov_b32 s46, 0
 s_waitcnt lgkmcnt(0)
 s_add_u32 s12, s8, 1048576
 s_addc_u32 s13, s9, 0
 s_and_b32 s13, s13, 0xffff
 s_mov_b32 s14, 2359296
 s_mov_b32 s15, 0x00020000
 s_lshr_b32 s47, s44, 4
 s_cmp_eq_u32 s47, 1
 s_cselect_b32 s4, s6, s4
 s_cselect_b32 s5, s7, s5
 s_cmp_eq_u32 s47, 2
 s_cselect_b32 s4, s10, s4
 s_cselect_b32 s5, s11, s5
 s_mov_b32 s16, s4
 s_and_b32 s17, s5, 0xffff
 s_mov_b32 s18, 4718592
 s_mov_b32 s19, 0x00020000
 s_mov_b32 s20, s4
 s_and_b32 s21, s5, 0xffff
 s_mov_b32 s22, 4718592
 s_mov_b32 s23, 0x00020000
 s_add_u32 s24, s8, 4194304
 s_addc_u32 s25, s9, 0
 s_and_b32 s25, s25, 0xffff
 s_mov_b32 s26, 50331648
 s_mov_b32 s27, 0x00020000
 s_and_b32 s48, s44, 15
 s_lshl_b32 s48, s48, 9
 s_add_u32 s49, s48, 256
 s_lshl_b32 s50, s44, 9
 s_mul_i32 s51, s46, 1152
 s_mul_i32 s52, s46, 4718592
 s_mul_i32 s53, s45, 147456
 s_add_u32 s53, s53, s51
 s_add_u32 s48, s48, s52
 s_add_u32 s49, s49, s52
 v_and_b32 v1, 63, v0
 v_lshrrev_b32 v2, 6, v0
 s_nop 0
 v_readfirstlane_b32 s54, v2
 v_lshrrev_b32 v3, 4, v1
 v_and_b32 v4, 15, v1
 v_lshrrev_b32 v5, 3, v1
 s_movk_i32 s55, 1152
 v_mul_lo_u32 v5, v5, s55
 v_and_b32 v6, 7, v1
 v_add_u32 v7, 0, v3
 v_and_b32 v7, 7, v7
 v_xor_b32 v7, v7, v6
 v_lshl_add_u32 v8, v7, 4, v5
 v_add_u32 v7, 4, v3
 v_and_b32 v7, 7, v7
 v_xor_b32 v7, v7, v6
 v_lshl_add_u32 v9, v7, 4, v5
 s_mul_i32 s56, s54, 36864
 s_add_u32 s53, s53, s56
 s_mov_b32 s57, 8192
 v_mul_lo_u32 v5, v3, s57
 v_lshrrev_b32 v6, 1, v4
 v_or_b32 v7, 0, v3
 v_xor_b32 v7, v7, v6
 v_lshlrev_b32 v7, 1, v7
 v_and_b32 v12, 1, v1
 v_or_b32 v7, v7, v12
 v_lshl_add_u32 v10, v7, 4, v5
 v_or_b32 v7, 4, v3
 v_xor_b32 v7, v7, v6
 v_lshlrev_b32 v7, 1, v7
 v_and_b32 v12, 1, v1
 v_or_b32 v7, v7, v12
 v_lshl_add_u32 v11, v7, 4, v5
 s_lshr_b32 s58, s54, 1
 s_and_b32 s59, s54, 1
 s_cmp_eq_u32 s58, 1
 s_cselect_b32 s28, s20, s16
 s_cselect_b32 s29, s21, s17
 s_mov_b32 s30, s18
 s_mov_b32 s31, s19
 s_cselect_b32 s60, s49, s48
 s_mul_i32 s61, s59, 262144
 s_add_u32 s60, s60, s61
 s_lshl_b32 s61, s58, 14
 s_lshl_b32 s62, s59, 13
 s_add_u32 s61, s61, s62
 s_add_u32 s61, s61, 16384
 s_lshl_b32 s62, s54, 12
 v_lshrrev_b32 v5, 1, v4
 s_lshr_b32 s58, s54, 1
 s_mul_i32 s58, s58, 8192
 v_lshl_add_u32 v6, v4, 7, s58
 v_add_u32 v7, 0, v3
 v_xor_b32 v7, v7, v5
 v_lshl_add_u32 v7, v7, 4, v6
 v_add_u32 v16, 0, v7
 v_add_u32 v18, 49152, v7
 v_add_u32 v20, 98304, v7
 v_add_u32 v7, 4, v3
 v_xor_b32 v7, v7, v5
 v_lshl_add_u32 v7, v7, 4, v6
 v_add_u32 v17, 0, v7
 v_add_u32 v19, 49152, v7
 v_add_u32 v21, 98304, v7
 v_lshrrev_b32 v5, 2, v4
 v_lshl_add_u32 v6, v3, 3, v5
 v_lshlrev_b32 v6, 8, v6
 v_and_b32 v7, 3, v1
 v_lshl_add_u32 v6, v7, 3, v6
 v_and_b32 v7, 1, v3
 v_lshl_or_b32 v5, v7, 2, v5
 s_and_b32 s58, s54, 1
 s_lshl_b32 s58, s58, 14
 s_add_u32 s58, s58, 16384
 v_add_u32 v6, s58, v6
 v_xor_b32 v7, 0, v5
 v_lshl_add_u32 v7, v7, 5, v6
 v_add_u32 v32, 0, v7
 v_add_u32 v40, 49152, v7
 v_add_u32 v48, 98304, v7
 v_xor_b32 v7, 1, v5
 v_lshl_add_u32 v7, v7, 5, v6
 v_add_u32 v33, 0, v7
 v_add_u32 v41, 49152, v7
 v_add_u32 v49, 98304, v7
 v_xor_b32 v7, 2, v5
 v_lshl_add_u32 v7, v7, 5, v6
 v_add_u32 v34, 0, v7
 v_add_u32 v42, 49152, v7
 v_add_u32 v50, 98304, v7
 v_xor_b32 v7, 3, v5
 v_lshl_add_u32 v7, v7, 5, v6
 v_add_u32 v35, 0, v7
 v_add_u32 v43, 49152, v7
 v_add_u32 v51, 98304, v7
 v_xor_b32 v7, 4, v5
 v_lshl_add_u32 v7, v7, 5, v6
 v_add_u32 v36, 0, v7
 v_add_u32 v44, 49152, v7
 v_add_u32 v52, 98304, v7
 v_xor_b32 v7, 5, v5
 v_lshl_add_u32 v7, v7, 5, v6
 v_add_u32 v37, 0, v7
 v_add_u32 v45, 49152, v7
 v_add_u32 v53, 98304, v7
 v_xor_b32 v7, 6, v5
 v_lshl_add_u32 v7, v7, 5, v6
 v_add_u32 v38, 0, v7
 v_add_u32 v46, 49152, v7
 v_add_u32 v54, 98304, v7
 v_xor_b32 v7, 7, v5
 v_lshl_add_u32 v7, v7, 5, v6
 v_add_u32 v39, 0, v7
 v_add_u32 v47, 49152, v7
 v_add_u32 v55, 98304, v7
 v_accvgpr_write_b32 a0, 0
 v_accvgpr_write_b32 a1, 0
 v_accvgpr_write_b32 a2, 0
 v_accvgpr_write_b32 a3, 0
 v_accvgpr_write_b32 a4, 0
 v_accvgpr_write_b32 a5, 0
 v_accvgpr_write_b32 a6, 0
 v_accvgpr_write_b32 a7, 0
 v_accvgpr_write_b32 a8, 0
 v_accvgpr_write_b32 a9, 0
 v_accvgpr_write_b32 a10, 0
 v_accvgpr_write_b32 a11, 0
 v_accvgpr_write_b32 a12, 0
 v_accvgpr_write_b32 a13, 0
 v_accvgpr_write_b32 a14, 0
 v_accvgpr_write_b32 a15, 0
 v_accvgpr_write_b32 a16, 0
 v_accvgpr_write_b32 a17, 0
 v_accvgpr_write_b32 a18, 0
 v_accvgpr_write_b32 a19, 0
 v_accvgpr_write_b32 a20, 0
 v_accvgpr_write_b32 a21, 0
 v_accvgpr_write_b32 a22, 0
 v_accvgpr_write_b32 a23, 0
 v_accvgpr_write_b32 a24, 0
 v_accvgpr_write_b32 a25, 0
 v_accvgpr_write_b32 a26, 0
 v_accvgpr_write_b32 a27, 0
 v_accvgpr_write_b32 a28, 0
 v_accvgpr_write_b32 a29, 0
 v_accvgpr_write_b32 a30, 0
 v_accvgpr_write_b32 a31, 0
 v_accvgpr_write_b32 a32, 0
 v_accvgpr_write_b32 a33, 0
 v_accvgpr_write_b32 a34, 0
 v_accvgpr_write_b32 a35, 0
 v_accvgpr_write_b32 a36, 0
 v_accvgpr_write_b32 a37, 0
 v_accvgpr_write_b32 a38, 0
 v_accvgpr_write_b32 a39, 0
 v_accvgpr_write_b32 a40, 0
 v_accvgpr_write_b32 a41, 0
 v_accvgpr_write_b32 a42, 0
 v_accvgpr_write_b32 a43, 0
 v_accvgpr_write_b32 a44, 0
 v_accvgpr_write_b32 a45, 0
 v_accvgpr_write_b32 a46, 0
 v_accvgpr_write_b32 a47, 0
 v_accvgpr_write_b32 a48, 0
 v_accvgpr_write_b32 a49, 0
 v_accvgpr_write_b32 a50, 0
 v_accvgpr_write_b32 a51, 0
 v_accvgpr_write_b32 a52, 0
 v_accvgpr_write_b32 a53, 0
 v_accvgpr_write_b32 a54, 0
 v_accvgpr_write_b32 a55, 0
 v_accvgpr_write_b32 a56, 0
 v_accvgpr_write_b32 a57, 0
 v_accvgpr_write_b32 a58, 0
 v_accvgpr_write_b32 a59, 0
 v_accvgpr_write_b32 a60, 0
 v_accvgpr_write_b32 a61, 0
 v_accvgpr_write_b32 a62, 0
 v_accvgpr_write_b32 a63, 0
 v_accvgpr_write_b32 a64, 0
 v_accvgpr_write_b32 a65, 0
 v_accvgpr_write_b32 a66, 0
 v_accvgpr_write_b32 a67, 0
 v_accvgpr_write_b32 a68, 0
 v_accvgpr_write_b32 a69, 0
 v_accvgpr_write_b32 a70, 0
 v_accvgpr_write_b32 a71, 0
 v_accvgpr_write_b32 a72, 0
 v_accvgpr_write_b32 a73, 0
 v_accvgpr_write_b32 a74, 0
 v_accvgpr_write_b32 a75, 0
 v_accvgpr_write_b32 a76, 0
 v_accvgpr_write_b32 a77, 0
 v_accvgpr_write_b32 a78, 0
 v_accvgpr_write_b32 a79, 0
 v_accvgpr_write_b32 a80, 0
 v_accvgpr_write_b32 a81, 0
 v_accvgpr_write_b32 a82, 0
 v_accvgpr_write_b32 a83, 0
 v_accvgpr_write_b32 a84, 0
 v_accvgpr_write_b32 a85, 0
 v_accvgpr_write_b32 a86, 0
 v_accvgpr_write_b32 a87, 0
 v_accvgpr_write_b32 a88, 0
 v_accvgpr_write_b32 a89, 0
 v_accvgpr_write_b32 a90, 0
 v_accvgpr_write_b32 a91, 0
 v_accvgpr_write_b32 a92, 0
 v_accvgpr_write_b32 a93, 0
 v_accvgpr_write_b32 a94, 0
 v_accvgpr_write_b32 a95, 0
 v_accvgpr_write_b32 a96, 0
 v_accvgpr_write_b32 a97, 0
 v_accvgpr_write_b32 a98, 0
 v_accvgpr_write_b32 a99, 0
 v_accvgpr_write_b32 a100, 0
 v_accvgpr_write_b32 a101, 0
 v_accvgpr_write_b32 a102, 0
 v_accvgpr_write_b32 a103, 0
 v_accvgpr_write_b32 a104, 0
 v_accvgpr_write_b32 a105, 0
 v_accvgpr_write_b32 a106, 0
 v_accvgpr_write_b32 a107, 0
 v_accvgpr_write_b32 a108, 0
 v_accvgpr_write_b32 a109, 0
 v_accvgpr_write_b32 a110, 0
 v_accvgpr_write_b32 a111, 0
 v_accvgpr_write_b32 a112, 0
 v_accvgpr_write_b32 a113, 0
 v_accvgpr_write_b32 a114, 0
 v_accvgpr_write_b32 a115, 0
 v_accvgpr_write_b32 a116, 0
 v_accvgpr_write_b32 a117, 0
 v_accvgpr_write_b32 a118, 0
 v_accvgpr_write_b32 a119, 0
 v_accvgpr_write_b32 a120, 0
 v_accvgpr_write_b32 a121, 0
 v_accvgpr_write_b32 a122, 0
 v_accvgpr_write_b32 a123, 0
 v_accvgpr_write_b32 a124, 0
 v_accvgpr_write_b32 a125, 0
 v_accvgpr_write_b32 a126, 0
 v_accvgpr_write_b32 a127, 0
 s_add_u32 s63, s53, 0
 s_add_u32 m0, s62, 0
 s_nop 0
 buffer_load_dwordx4 v8, s[12:15], s63 offen lds
 s_add_u32 s63, s53, 9216
 s_add_u32 m0, s62, 1024
 s_nop 0
 buffer_load_dwordx4 v9, s[12:15], s63 offen lds
 s_add_u32 s63, s53, 18432
 s_add_u32 m0, s62, 2048
 s_nop 0
 buffer_load_dwordx4 v8, s[12:15], s63 offen lds
 s_add_u32 s63, s53, 27648
 s_add_u32 m0, s62, 3072
 s_nop 0
 buffer_load_dwordx4 v9, s[12:15], s63 offen lds
 s_add_u32 s63, s60, 0
 s_add_u32 m0, s61, 0
 s_nop 0
 buffer_load_dwordx4 v10, s[28:31], s63 offen lds
 s_add_u32 s63, s60, 32768
 s_add_u32 m0, s61, 1024
 s_nop 0
 buffer_load_dwordx4 v10, s[28:31], s63 offen lds
 s_add_u32 s63, s60, 65536
 s_add_u32 m0, s61, 2048
 s_nop 0
 buffer_load_dwordx4 v11, s[28:31], s63 offen lds
 s_add_u32 s63, s60, 98304
 s_add_u32 m0, s61, 3072
 s_nop 0
 buffer_load_dwordx4 v11, s[28:31], s63 offen lds
 s_add_u32 s63, s60, 131072
 s_add_u32 m0, s61, 4096
 s_nop 0
 buffer_load_dwordx4 v10, s[28:31], s63 offen lds
 s_add_u32 s63, s60, 163840
 s_add_u32 m0, s61, 5120
 s_nop 0
 buffer_load_dwordx4 v10, s[28:31], s63 offen lds
 s_add_u32 s63, s60, 196608
 s_add_u32 m0, s61, 6144
 s_nop 0
 buffer_load_dwordx4 v11, s[28:31], s63 offen lds
 s_add_u32 s63, s60, 229376
 s_add_u32 m0, s61, 7168
 s_nop 0
 buffer_load_dwordx4 v11, s[28:31], s63 offen lds
 s_add_u32 s63, s53, 128
 s_add_u32 m0, s62, 49152
 s_nop 0
 buffer_load_dwordx4 v8, s[12:15], s63 offen lds
 s_add_u32 s63, s53, 9344
 s_add_u32 m0, s62, 50176
 s_nop 0
 buffer_load_dwordx4 v9, s[12:15], s63 offen lds
 s_add_u32 s63, s53, 18560
 s_add_u32 m0, s62, 51200
 s_nop 0
 buffer_load_dwordx4 v8, s[12:15], s63 offen lds
 s_add_u32 s63, s53, 27776
 s_add_u32 m0, s62, 52224
 s_nop 0
 buffer_load_dwordx4 v9, s[12:15], s63 offen lds
 s_add_u32 s63, s60, 524288
 s_add_u32 m0, s61, 49152
 s_nop 0
 buffer_load_dwordx4 v10, s[28:31], s63 offen lds
 s_add_u32 s63, s60, 557056
 s_add_u32 m0, s61, 50176
 s_nop 0
 buffer_load_dwordx4 v10, s[28:31], s63 offen lds
 s_add_u32 s63, s60, 589824
 s_add_u32 m0, s61, 51200
 s_nop 0
 buffer_load_dwordx4 v11, s[28:31], s63 offen lds
 s_add_u32 s63, s60, 622592
 s_add_u32 m0, s61, 52224
 s_nop 0
 buffer_load_dwordx4 v11, s[28:31], s63 offen lds
 s_add_u32 s63, s60, 655360
 s_add_u32 m0, s61, 53248
 s_nop 0
 buffer_load_dwordx4 v10, s[28:31], s63 offen lds
 s_add_u32 s63, s60, 688128
 s_add_u32 m0, s61, 54272
 s_nop 0
 buffer_load_dwordx4 v10, s[28:31], s63 offen lds
 s_add_u32 s63, s60, 720896
 s_add_u32 m0, s61, 55296
 s_nop 0
 buffer_load_dwordx4 v11, s[28:31], s63 offen lds
 s_add_u32 s63, s60, 753664
 s_add_u32 m0, s61, 56320
 s_nop 0
 buffer_load_dwordx4 v11, s[28:31], s63 offen lds
 s_add_u32 s63, s53, 256
 s_add_u32 m0, s62, 98304
 s_nop 0
 buffer_load_dwordx4 v8, s[12:15], s63 offen lds
 s_add_u32 s63, s53, 9472
 s_add_u32 m0, s62, 99328
 s_nop 0
 buffer_load_dwordx4 v9, s[12:15], s63 offen lds
 s_add_u32 s63, s53, 18688
 s_add_u32 m0, s62, 100352
 s_nop 0
 buffer_load_dwordx4 v8, s[12:15], s63 offen lds
 s_add_u32 s63, s53, 27904
 s_add_u32 m0, s62, 101376
 s_nop 0
 buffer_load_dwordx4 v9, s[12:15], s63 offen lds
 s_add_u32 s63, s60, 1048576
 s_add_u32 m0, s61, 98304
 s_nop 0
 buffer_load_dwordx4 v10, s[28:31], s63 offen lds
 s_add_u32 s63, s60, 1081344
 s_add_u32 m0, s61, 99328
 s_nop 0
 buffer_load_dwordx4 v10, s[28:31], s63 offen lds
 s_add_u32 s63, s60, 1114112
 s_add_u32 m0, s61, 100352
 s_nop 0
 buffer_load_dwordx4 v11, s[28:31], s63 offen lds
 s_add_u32 s63, s60, 1146880
 s_add_u32 m0, s61, 101376
 s_nop 0
 buffer_load_dwordx4 v11, s[28:31], s63 offen lds
 s_add_u32 s63, s60, 1179648
 s_add_u32 m0, s61, 102400
 s_nop 0
 buffer_load_dwordx4 v10, s[28:31], s63 offen lds
 s_add_u32 s63, s60, 1212416
 s_add_u32 m0, s61, 103424
 s_nop 0
 buffer_load_dwordx4 v10, s[28:31], s63 offen lds
 s_add_u32 s63, s60, 1245184
 s_add_u32 m0, s61, 104448
 s_nop 0
 buffer_load_dwordx4 v11, s[28:31], s63 offen lds
 s_add_u32 s63, s60, 1277952
 s_add_u32 m0, s61, 105472
 s_nop 0
 buffer_load_dwordx4 v11, s[28:31], s63 offen lds
 s_waitcnt vmcnt(24)
 s_barrier
 ds_read_b128 v[64:67], v16 offset:0
 ds_read_b128 v[68:71], v16 offset:2048
 ds_read_b128 v[72:75], v16 offset:4096
 ds_read_b128 v[76:79], v16 offset:6144
 ds_read_b64_tr_b16 v[80:81], v32 offset:0
 ds_read_b64_tr_b16 v[82:83], v32 offset:1024
 ds_read_b64_tr_b16 v[84:85], v33 offset:0
 ds_read_b64_tr_b16 v[86:87], v33 offset:1024
 ds_read_b64_tr_b16 v[88:89], v34 offset:0
 ds_read_b64_tr_b16 v[90:91], v34 offset:1024
 ds_read_b64_tr_b16 v[92:93], v35 offset:0
 ds_read_b64_tr_b16 v[94:95], v35 offset:1024
 ds_read_b64_tr_b16 v[96:97], v36 offset:0
 ds_read_b64_tr_b16 v[98:99], v36 offset:1024
 ds_read_b64_tr_b16 v[100:101], v37 offset:0
 ds_read_b64_tr_b16 v[102:103], v37 offset:1024
 ds_read_b64_tr_b16 v[104:105], v38 offset:0
 ds_read_b64_tr_b16 v[106:107], v38 offset:1024
 ds_read_b64_tr_b16 v[108:109], v39 offset:0
 ds_read_b64_tr_b16 v[110:111], v39 offset:1024
 s_waitcnt lgkmcnt(0)
 v_mfma_f32_16x16x32_bf16 a[0:3], v[80:83], v[64:67], a[0:3]
 v_mfma_f32_16x16x32_bf16 a[4:7], v[80:83], v[68:71], a[4:7]
 ds_read_b128 v[112:115], v17 offset:0
 v_mfma_f32_16x16x32_bf16 a[8:11], v[80:83], v[72:75], a[8:11]
 v_mfma_f32_16x16x32_bf16 a[12:15], v[80:83], v[76:79], a[12:15]
 ds_read_b128 v[116:119], v17 offset:2048
 v_mfma_f32_16x16x32_bf16 a[16:19], v[84:87], v[64:67], a[16:19]
 ds_read_b128 v[120:123], v17 offset:4096
 v_mfma_f32_16x16x32_bf16 a[20:23], v[84:87], v[68:71], a[20:23]
 v_mfma_f32_16x16x32_bf16 a[24:27], v[84:87], v[72:75], a[24:27]
 ds_read_b128 v[124:127], v17 offset:6144
 v_mfma_f32_16x16x32_bf16 a[28:31], v[84:87], v[76:79], a[28:31]
 ds_read_b64_tr_b16 v[128:129], v32 offset:8192
 v_mfma_f32_16x16x32_bf16 a[32:35], v[88:91], v[64:67], a[32:35]
 v_mfma_f32_16x16x32_bf16 a[36:39], v[88:91], v[68:71], a[36:39]
 ds_read_b64_tr_b16 v[130:131], v32 offset:9216
 v_mfma_f32_16x16x32_bf16 a[40:43], v[88:91], v[72:75], a[40:43]
 v_mfma_f32_16x16x32_bf16 a[44:47], v[88:91], v[76:79], a[44:47]
 ds_read_b64_tr_b16 v[132:133], v33 offset:8192
 v_mfma_f32_16x16x32_bf16 a[48:51], v[92:95], v[64:67], a[48:51]
 ds_read_b64_tr_b16 v[134:135], v33 offset:9216
 v_mfma_f32_16x16x32_bf16 a[52:55], v[92:95], v[68:71], a[52:55]
 v_mfma_f32_16x16x32_bf16 a[56:59], v[92:95], v[72:75], a[56:59]
 ds_read_b64_tr_b16 v[136:137], v34 offset:8192
 v_mfma_f32_16x16x32_bf16 a[60:63], v[92:95], v[76:79], a[60:63]
 ds_read_b64_tr_b16 v[138:139], v34 offset:9216
 v_mfma_f32_16x16x32_bf16 a[64:67], v[96:99], v[64:67], a[64:67]
 v_mfma_f32_16x16x32_bf16 a[68:71], v[96:99], v[68:71], a[68:71]
 ds_read_b64_tr_b16 v[140:141], v35 offset:8192
 v_mfma_f32_16x16x32_bf16 a[72:75], v[96:99], v[72:75], a[72:75]
 v_mfma_f32_16x16x32_bf16 a[76:79], v[96:99], v[76:79], a[76:79]
 ds_read_b64_tr_b16 v[142:143], v35 offset:9216
 v_mfma_f32_16x16x32_bf16 a[80:83], v[100:103], v[64:67], a[80:83]
 ds_read_b64_tr_b16 v[144:145], v36 offset:8192
 v_mfma_f32_16x16x32_bf16 a[84:87], v[100:103], v[68:71], a[84:87]
 v_mfma_f32_16x16x32_bf16 a[88:91], v[100:103], v[72:75], a[88:91]
 ds_read_b64_tr_b16 v[146:147], v36 offset:9216
 v_mfma_f32_16x16x32_bf16 a[92:95], v[100:103], v[76:79], a[92:95]
 ds_read_b64_tr_b16 v[148:149], v37 offset:8192
 v_mfma_f32_16x16x32_bf16 a[96:99], v[104:107], v[64:67], a[96:99]
 v_mfma_f32_16x16x32_bf16 a[100:103], v[104:107], v[68:71], a[100:103]
 ds_read_b64_tr_b16 v[150:151], v37 offset:9216
 v_mfma_f32_16x16x32_bf16 a[104:107], v[104:107], v[72:75], a[104:107]
 v_mfma_f32_16x16x32_bf16 a[108:111], v[104:107], v[76:79], a[108:111]
 ds_read_b64_tr_b16 v[152:153], v38 offset:8192
 v_mfma_f32_16x16x32_bf16 a[112:115], v[108:111], v[64:67], a[112:115]
 ds_read_b64_tr_b16 v[154:155], v38 offset:9216
 v_mfma_f32_16x16x32_bf16 a[116:119], v[108:111], v[68:71], a[116:119]
 v_mfma_f32_16x16x32_bf16 a[120:123], v[108:111], v[72:75], a[120:123]
 ds_read_b64_tr_b16 v[156:157], v39 offset:8192
 v_mfma_f32_16x16x32_bf16 a[124:127], v[108:111], v[76:79], a[124:127]
 ds_read_b64_tr_b16 v[158:159], v39 offset:9216
 s_waitcnt lgkmcnt(0)
 s_waitcnt vmcnt(12)
 s_barrier
 v_mfma_f32_16x16x32_bf16 a[0:3], v[128:131], v[112:115], a[0:3]
 s_add_u32 s63, s53, 384
 s_add_u32 m0, s62, 0
 s_nop 0
 buffer_load_dwordx4 v8, s[12:15], s63 offen lds
 v_mfma_f32_16x16x32_bf16 a[4:7], v[128:131], v[116:119], a[4:7]
 s_add_u32 s63, s53, 9600
 s_add_u32 m0, s62, 1024
 s_nop 0
 buffer_load_dwordx4 v9, s[12:15], s63 offen lds
 v_mfma_f32_16x16x32_bf16 a[8:11], v[128:131], v[120:123], a[8:11]
 s_add_u32 s63, s53, 18816
 s_add_u32 m0, s62, 2048
 s_nop 0
 buffer_load_dwordx4 v8, s[12:15], s63 offen lds
 v_mfma_f32_16x16x32_bf16 a[12:15], v[128:131], v[124:127], a[12:15]
 s_add_u32 s63, s53, 28032
 s_add_u32 m0, s62, 3072
 s_nop 0
 buffer_load_dwordx4 v9, s[12:15], s63 offen lds
 v_mfma_f32_16x16x32_bf16 a[16:19], v[132:135], v[112:115], a[16:19]
 s_add_u32 s63, s60, 1572864
 s_add_u32 m0, s61, 0
 s_nop 0
 buffer_load_dwordx4 v10, s[28:31], s63 offen lds
 v_mfma_f32_16x16x32_bf16 a[20:23], v[132:135], v[116:119], a[20:23]
 s_add_u32 s63, s60, 1605632
 s_add_u32 m0, s61, 1024
 s_nop 0
 buffer_load_dwordx4 v10, s[28:31], s63 offen lds
 v_mfma_f32_16x16x32_bf16 a[24:27], v[132:135], v[120:123], a[24:27]
 s_add_u32 s63, s60, 1638400
 s_add_u32 m0, s61, 2048
 s_nop 0
 buffer_load_dwordx4 v11, s[28:31], s63 offen lds
 v_mfma_f32_16x16x32_bf16 a[28:31], v[132:135], v[124:127], a[28:31]
 s_add_u32 s63, s60, 1671168
 s_add_u32 m0, s61, 3072
 s_nop 0
 buffer_load_dwordx4 v11, s[28:31], s63 offen lds
 v_mfma_f32_16x16x32_bf16 a[32:35], v[136:139], v[112:115], a[32:35]
 s_add_u32 s63, s60, 1703936
 s_add_u32 m0, s61, 4096
 s_nop 0
 buffer_load_dwordx4 v10, s[28:31], s63 offen lds
 v_mfma_f32_16x16x32_bf16 a[36:39], v[136:139], v[116:119], a[36:39]
 s_add_u32 s63, s60, 1736704
 s_add_u32 m0, s61, 5120
 s_nop 0
 buffer_load_dwordx4 v10, s[28:31], s63 offen lds
 v_mfma_f32_16x16x32_bf16 a[40:43], v[136:139], v[120:123], a[40:43]
 s_add_u32 s63, s60, 1769472
 s_add_u32 m0, s61, 6144
 s_nop 0
 buffer_load_dwordx4 v11, s[28:31], s63 offen lds
 v_mfma_f32_16x16x32_bf16 a[44:47], v[136:139], v[124:127], a[44:47]
 s_add_u32 s63, s60, 1802240
 s_add_u32 m0, s61, 7168
 s_nop 0
 buffer_load_dwordx4 v11, s[28:31], s63 offen lds
 v_mfma_f32_16x16x32_bf16 a[48:51], v[140:143], v[112:115], a[48:51]
 ds_read_b128 v[64:67], v18 offset:0
 v_mfma_f32_16x16x32_bf16 a[52:55], v[140:143], v[116:119], a[52:55]
 ds_read_b128 v[68:71], v18 offset:2048
 v_mfma_f32_16x16x32_bf16 a[56:59], v[140:143], v[120:123], a[56:59]
 ds_read_b128 v[72:75], v18 offset:4096
 v_mfma_f32_16x16x32_bf16 a[60:63], v[140:143], v[124:127], a[60:63]
 ds_read_b128 v[76:79], v18 offset:6144
 v_mfma_f32_16x16x32_bf16 a[64:67], v[144:147], v[112:115], a[64:67]
 ds_read_b64_tr_b16 v[80:81], v40 offset:0
 v_mfma_f32_16x16x32_bf16 a[68:71], v[144:147], v[116:119], a[68:71]
 ds_read_b64_tr_b16 v[82:83], v40 offset:1024
 v_mfma_f32_16x16x32_bf16 a[72:75], v[144:147], v[120:123], a[72:75]
 ds_read_b64_tr_b16 v[84:85], v41 offset:0
 v_mfma_f32_16x16x32_bf16 a[76:79], v[144:147], v[124:127], a[76:79]
 ds_read_b64_tr_b16 v[86:87], v41 offset:1024
 v_mfma_f32_16x16x32_bf16 a[80:83], v[148:151], v[112:115], a[80:83]
 ds_read_b64_tr_b16 v[88:89], v42 offset:0
 v_mfma_f32_16x16x32_bf16 a[84:87], v[148:151], v[116:119], a[84:87]
 ds_read_b64_tr_b16 v[90:91], v42 offset:1024
 v_mfma_f32_16x16x32_bf16 a[88:91], v[148:151], v[120:123], a[88:91]
 ds_read_b64_tr_b16 v[92:93], v43 offset:0
 v_mfma_f32_16x16x32_bf16 a[92:95], v[148:151], v[124:127], a[92:95]
 ds_read_b64_tr_b16 v[94:95], v43 offset:1024
 v_mfma_f32_16x16x32_bf16 a[96:99], v[152:155], v[112:115], a[96:99]
 ds_read_b64_tr_b16 v[96:97], v44 offset:0
 v_mfma_f32_16x16x32_bf16 a[100:103], v[152:155], v[116:119], a[100:103]
 ds_read_b64_tr_b16 v[98:99], v44 offset:1024
 v_mfma_f32_16x16x32_bf16 a[104:107], v[152:155], v[120:123], a[104:107]
 ds_read_b64_tr_b16 v[100:101], v45 offset:0
 v_mfma_f32_16x16x32_bf16 a[108:111], v[152:155], v[124:127], a[108:111]
 ds_read_b64_tr_b16 v[102:103], v45 offset:1024
 v_mfma_f32_16x16x32_bf16 a[112:115], v[156:159], v[112:115], a[112:115]
 ds_read_b64_tr_b16 v[104:105], v46 offset:0
 v_mfma_f32_16x16x32_bf16 a[116:119], v[156:159], v[116:119], a[116:119]
 ds_read_b64_tr_b16 v[106:107], v46 offset:1024
 v_mfma_f32_16x16x32_bf16 a[120:123], v[156:159], v[120:123], a[120:123]
 ds_read_b64_tr_b16 v[108:109], v47 offset:0
 v_mfma_f32_16x16x32_bf16 a[124:127], v[156:159], v[124:127], a[124:127]
 ds_read_b64_tr_b16 v[110:111], v47 offset:1024
 s_waitcnt lgkmcnt(0)
 v_mfma_f32_16x16x32_bf16 a[0:3], v[80:83], v[64:67], a[0:3]
 v_mfma_f32_16x16x32_bf16 a[4:7], v[80:83], v[68:71], a[4:7]
 ds_read_b128 v[112:115], v19 offset:0
 v_mfma_f32_16x16x32_bf16 a[8:11], v[80:83], v[72:75], a[8:11]
 v_mfma_f32_16x16x32_bf16 a[12:15], v[80:83], v[76:79], a[12:15]
 ds_read_b128 v[116:119], v19 offset:2048
 v_mfma_f32_16x16x32_bf16 a[16:19], v[84:87], v[64:67], a[16:19]
 ds_read_b128 v[120:123], v19 offset:4096
 v_mfma_f32_16x16x32_bf16 a[20:23], v[84:87], v[68:71], a[20:23]
 v_mfma_f32_16x16x32_bf16 a[24:27], v[84:87], v[72:75], a[24:27]
 ds_read_b128 v[124:127], v19 offset:6144
 v_mfma_f32_16x16x32_bf16 a[28:31], v[84:87], v[76:79], a[28:31]
 ds_read_b64_tr_b16 v[128:129], v40 offset:8192
 v_mfma_f32_16x16x32_bf16 a[32:35], v[88:91], v[64:67], a[32:35]
 v_mfma_f32_16x16x32_bf16 a[36:39], v[88:91], v[68:71], a[36:39]
 ds_read_b64_tr_b16 v[130:131], v40 offset:9216
 v_mfma_f32_16x16x32_bf16 a[40:43], v[88:91], v[72:75], a[40:43]
 v_mfma_f32_16x16x32_bf16 a[44:47], v[88:91], v[76:79], a[44:47]
 ds_read_b64_tr_b16 v[132:133], v41 offset:8192
 v_mfma_f32_16x16x32_bf16 a[48:51], v[92:95], v[64:67], a[48:51]
 ds_read_b64_tr_b16 v[134:135], v41 offset:9216
 v_mfma_f32_16x16x32_bf16 a[52:55], v[92:95], v[68:71], a[52:55]
 v_mfma_f32_16x16x32_bf16 a[56:59], v[92:95], v[72:75], a[56:59]
 ds_read_b64_tr_b16 v[136:137], v42 offset:8192
 v_mfma_f32_16x16x32_bf16 a[60:63], v[92:95], v[76:79], a[60:63]
 ds_read_b64_tr_b16 v[138:139], v42 offset:9216
 v_mfma_f32_16x16x32_bf16 a[64:67], v[96:99], v[64:67], a[64:67]
 v_mfma_f32_16x16x32_bf16 a[68:71], v[96:99], v[68:71], a[68:71]
 ds_read_b64_tr_b16 v[140:141], v43 offset:8192
 v_mfma_f32_16x16x32_bf16 a[72:75], v[96:99], v[72:75], a[72:75]
 v_mfma_f32_16x16x32_bf16 a[76:79], v[96:99], v[76:79], a[76:79]
 ds_read_b64_tr_b16 v[142:143], v43 offset:9216
 v_mfma_f32_16x16x32_bf16 a[80:83], v[100:103], v[64:67], a[80:83]
 ds_read_b64_tr_b16 v[144:145], v44 offset:8192
 v_mfma_f32_16x16x32_bf16 a[84:87], v[100:103], v[68:71], a[84:87]
 v_mfma_f32_16x16x32_bf16 a[88:91], v[100:103], v[72:75], a[88:91]
 ds_read_b64_tr_b16 v[146:147], v44 offset:9216
 v_mfma_f32_16x16x32_bf16 a[92:95], v[100:103], v[76:79], a[92:95]
 ds_read_b64_tr_b16 v[148:149], v45 offset:8192
 v_mfma_f32_16x16x32_bf16 a[96:99], v[104:107], v[64:67], a[96:99]
 v_mfma_f32_16x16x32_bf16 a[100:103], v[104:107], v[68:71], a[100:103]
 ds_read_b64_tr_b16 v[150:151], v45 offset:9216
 v_mfma_f32_16x16x32_bf16 a[104:107], v[104:107], v[72:75], a[104:107]
 v_mfma_f32_16x16x32_bf16 a[108:111], v[104:107], v[76:79], a[108:111]
 ds_read_b64_tr_b16 v[152:153], v46 offset:8192
 v_mfma_f32_16x16x32_bf16 a[112:115], v[108:111], v[64:67], a[112:115]
 ds_read_b64_tr_b16 v[154:155], v46 offset:9216
 v_mfma_f32_16x16x32_bf16 a[116:119], v[108:111], v[68:71], a[116:119]
 v_mfma_f32_16x16x32_bf16 a[120:123], v[108:111], v[72:75], a[120:123]
 ds_read_b64_tr_b16 v[156:157], v47 offset:8192
 v_mfma_f32_16x16x32_bf16 a[124:127], v[108:111], v[76:79], a[124:127]
 ds_read_b64_tr_b16 v[158:159], v47 offset:9216
 s_waitcnt lgkmcnt(0)
 s_waitcnt vmcnt(12)
 s_barrier
 v_mfma_f32_16x16x32_bf16 a[0:3], v[128:131], v[112:115], a[0:3]
 s_add_u32 s63, s53, 512
 s_add_u32 m0, s62, 49152
 s_nop 0
 buffer_load_dwordx4 v8, s[12:15], s63 offen lds
 v_mfma_f32_16x16x32_bf16 a[4:7], v[128:131], v[116:119], a[4:7]
 s_add_u32 s63, s53, 9728
 s_add_u32 m0, s62, 50176
 s_nop 0
 buffer_load_dwordx4 v9, s[12:15], s63 offen lds
 v_mfma_f32_16x16x32_bf16 a[8:11], v[128:131], v[120:123], a[8:11]
 s_add_u32 s63, s53, 18944
 s_add_u32 m0, s62, 51200
 s_nop 0
 buffer_load_dwordx4 v8, s[12:15], s63 offen lds
 v_mfma_f32_16x16x32_bf16 a[12:15], v[128:131], v[124:127], a[12:15]
 s_add_u32 s63, s53, 28160
 s_add_u32 m0, s62, 52224
 s_nop 0
 buffer_load_dwordx4 v9, s[12:15], s63 offen lds
 v_mfma_f32_16x16x32_bf16 a[16:19], v[132:135], v[112:115], a[16:19]
 s_add_u32 s63, s60, 2097152
 s_add_u32 m0, s61, 49152
 s_nop 0
 buffer_load_dwordx4 v10, s[28:31], s63 offen lds
 v_mfma_f32_16x16x32_bf16 a[20:23], v[132:135], v[116:119], a[20:23]
 s_add_u32 s63, s60, 2129920
 s_add_u32 m0, s61, 50176
 s_nop 0
 buffer_load_dwordx4 v10, s[28:31], s63 offen lds
 v_mfma_f32_16x16x32_bf16 a[24:27], v[132:135], v[120:123], a[24:27]
 s_add_u32 s63, s60, 2162688
 s_add_u32 m0, s61, 51200
 s_nop 0
 buffer_load_dwordx4 v11, s[28:31], s63 offen lds
 v_mfma_f32_16x16x32_bf16 a[28:31], v[132:135], v[124:127], a[28:31]
 s_add_u32 s63, s60, 2195456
 s_add_u32 m0, s61, 52224
 s_nop 0
 buffer_load_dwordx4 v11, s[28:31], s63 offen lds
 v_mfma_f32_16x16x32_bf16 a[32:35], v[136:139], v[112:115], a[32:35]
 s_add_u32 s63, s60, 2228224
 s_add_u32 m0, s61, 53248
 s_nop 0
 buffer_load_dwordx4 v10, s[28:31], s63 offen lds
 v_mfma_f32_16x16x32_bf16 a[36:39], v[136:139], v[116:119], a[36:39]
 s_add_u32 s63, s60, 2260992
 s_add_u32 m0, s61, 54272
 s_nop 0
 buffer_load_dwordx4 v10, s[28:31], s63 offen lds
 v_mfma_f32_16x16x32_bf16 a[40:43], v[136:139], v[120:123], a[40:43]
 s_add_u32 s63, s60, 2293760
 s_add_u32 m0, s61, 55296
 s_nop 0
 buffer_load_dwordx4 v11, s[28:31], s63 offen lds
 v_mfma_f32_16x16x32_bf16 a[44:47], v[136:139], v[124:127], a[44:47]
 s_add_u32 s63, s60, 2326528
 s_add_u32 m0, s61, 56320
 s_nop 0
 buffer_load_dwordx4 v11, s[28:31], s63 offen lds
 v_mfma_f32_16x16x32_bf16 a[48:51], v[140:143], v[112:115], a[48:51]
 ds_read_b128 v[64:67], v20 offset:0
 v_mfma_f32_16x16x32_bf16 a[52:55], v[140:143], v[116:119], a[52:55]
 ds_read_b128 v[68:71], v20 offset:2048
 v_mfma_f32_16x16x32_bf16 a[56:59], v[140:143], v[120:123], a[56:59]
 ds_read_b128 v[72:75], v20 offset:4096
 v_mfma_f32_16x16x32_bf16 a[60:63], v[140:143], v[124:127], a[60:63]
 ds_read_b128 v[76:79], v20 offset:6144
 v_mfma_f32_16x16x32_bf16 a[64:67], v[144:147], v[112:115], a[64:67]
 ds_read_b64_tr_b16 v[80:81], v48 offset:0
 v_mfma_f32_16x16x32_bf16 a[68:71], v[144:147], v[116:119], a[68:71]
 ds_read_b64_tr_b16 v[82:83], v48 offset:1024
 v_mfma_f32_16x16x32_bf16 a[72:75], v[144:147], v[120:123], a[72:75]
 ds_read_b64_tr_b16 v[84:85], v49 offset:0
 v_mfma_f32_16x16x32_bf16 a[76:79], v[144:147], v[124:127], a[76:79]
 ds_read_b64_tr_b16 v[86:87], v49 offset:1024
 v_mfma_f32_16x16x32_bf16 a[80:83], v[148:151], v[112:115], a[80:83]
 ds_read_b64_tr_b16 v[88:89], v50 offset:0
 v_mfma_f32_16x16x32_bf16 a[84:87], v[148:151], v[116:119], a[84:87]
 ds_read_b64_tr_b16 v[90:91], v50 offset:1024
 v_mfma_f32_16x16x32_bf16 a[88:91], v[148:151], v[120:123], a[88:91]
 ds_read_b64_tr_b16 v[92:93], v51 offset:0
 v_mfma_f32_16x16x32_bf16 a[92:95], v[148:151], v[124:127], a[92:95]
 ds_read_b64_tr_b16 v[94:95], v51 offset:1024
 v_mfma_f32_16x16x32_bf16 a[96:99], v[152:155], v[112:115], a[96:99]
 ds_read_b64_tr_b16 v[96:97], v52 offset:0
 v_mfma_f32_16x16x32_bf16 a[100:103], v[152:155], v[116:119], a[100:103]
 ds_read_b64_tr_b16 v[98:99], v52 offset:1024
 v_mfma_f32_16x16x32_bf16 a[104:107], v[152:155], v[120:123], a[104:107]
 ds_read_b64_tr_b16 v[100:101], v53 offset:0
 v_mfma_f32_16x16x32_bf16 a[108:111], v[152:155], v[124:127], a[108:111]
 ds_read_b64_tr_b16 v[102:103], v53 offset:1024
 v_mfma_f32_16x16x32_bf16 a[112:115], v[156:159], v[112:115], a[112:115]
 ds_read_b64_tr_b16 v[104:105], v54 offset:0
 v_mfma_f32_16x16x32_bf16 a[116:119], v[156:159], v[116:119], a[116:119]
 ds_read_b64_tr_b16 v[106:107], v54 offset:1024
 v_mfma_f32_16x16x32_bf16 a[120:123], v[156:159], v[120:123], a[120:123]
 ds_read_b64_tr_b16 v[108:109], v55 offset:0
 v_mfma_f32_16x16x32_bf16 a[124:127], v[156:159], v[124:127], a[124:127]
 ds_read_b64_tr_b16 v[110:111], v55 offset:1024
 s_waitcnt lgkmcnt(0)
 v_mfma_f32_16x16x32_bf16 a[0:3], v[80:83], v[64:67], a[0:3]
 v_mfma_f32_16x16x32_bf16 a[4:7], v[80:83], v[68:71], a[4:7]
 ds_read_b128 v[112:115], v21 offset:0
 v_mfma_f32_16x16x32_bf16 a[8:11], v[80:83], v[72:75], a[8:11]
 v_mfma_f32_16x16x32_bf16 a[12:15], v[80:83], v[76:79], a[12:15]
 ds_read_b128 v[116:119], v21 offset:2048
 v_mfma_f32_16x16x32_bf16 a[16:19], v[84:87], v[64:67], a[16:19]
 ds_read_b128 v[120:123], v21 offset:4096
 v_mfma_f32_16x16x32_bf16 a[20:23], v[84:87], v[68:71], a[20:23]
 v_mfma_f32_16x16x32_bf16 a[24:27], v[84:87], v[72:75], a[24:27]
 ds_read_b128 v[124:127], v21 offset:6144
 v_mfma_f32_16x16x32_bf16 a[28:31], v[84:87], v[76:79], a[28:31]
 ds_read_b64_tr_b16 v[128:129], v48 offset:8192
 v_mfma_f32_16x16x32_bf16 a[32:35], v[88:91], v[64:67], a[32:35]
 v_mfma_f32_16x16x32_bf16 a[36:39], v[88:91], v[68:71], a[36:39]
 ds_read_b64_tr_b16 v[130:131], v48 offset:9216
 v_mfma_f32_16x16x32_bf16 a[40:43], v[88:91], v[72:75], a[40:43]
 v_mfma_f32_16x16x32_bf16 a[44:47], v[88:91], v[76:79], a[44:47]
 ds_read_b64_tr_b16 v[132:133], v49 offset:8192
 v_mfma_f32_16x16x32_bf16 a[48:51], v[92:95], v[64:67], a[48:51]
 ds_read_b64_tr_b16 v[134:135], v49 offset:9216
 v_mfma_f32_16x16x32_bf16 a[52:55], v[92:95], v[68:71], a[52:55]
 v_mfma_f32_16x16x32_bf16 a[56:59], v[92:95], v[72:75], a[56:59]
 ds_read_b64_tr_b16 v[136:137], v50 offset:8192
 v_mfma_f32_16x16x32_bf16 a[60:63], v[92:95], v[76:79], a[60:63]
 ds_read_b64_tr_b16 v[138:139], v50 offset:9216
 v_mfma_f32_16x16x32_bf16 a[64:67], v[96:99], v[64:67], a[64:67]
 v_mfma_f32_16x16x32_bf16 a[68:71], v[96:99], v[68:71], a[68:71]
 ds_read_b64_tr_b16 v[140:141], v51 offset:8192
 v_mfma_f32_16x16x32_bf16 a[72:75], v[96:99], v[72:75], a[72:75]
 v_mfma_f32_16x16x32_bf16 a[76:79], v[96:99], v[76:79], a[76:79]
 ds_read_b64_tr_b16 v[142:143], v51 offset:9216
 v_mfma_f32_16x16x32_bf16 a[80:83], v[100:103], v[64:67], a[80:83]
 ds_read_b64_tr_b16 v[144:145], v52 offset:8192
 v_mfma_f32_16x16x32_bf16 a[84:87], v[100:103], v[68:71], a[84:87]
 v_mfma_f32_16x16x32_bf16 a[88:91], v[100:103], v[72:75], a[88:91]
 ds_read_b64_tr_b16 v[146:147], v52 offset:9216
 v_mfma_f32_16x16x32_bf16 a[92:95], v[100:103], v[76:79], a[92:95]
 ds_read_b64_tr_b16 v[148:149], v53 offset:8192
 v_mfma_f32_16x16x32_bf16 a[96:99], v[104:107], v[64:67], a[96:99]
 v_mfma_f32_16x16x32_bf16 a[100:103], v[104:107], v[68:71], a[100:103]
 ds_read_b64_tr_b16 v[150:151], v53 offset:9216
 v_mfma_f32_16x16x32_bf16 a[104:107], v[104:107], v[72:75], a[104:107]
 v_mfma_f32_16x16x32_bf16 a[108:111], v[104:107], v[76:79], a[108:111]
 ds_read_b64_tr_b16 v[152:153], v54 offset:8192
 v_mfma_f32_16x16x32_bf16 a[112:115], v[108:111], v[64:67], a[112:115]
 ds_read_b64_tr_b16 v[154:155], v54 offset:9216
 v_mfma_f32_16x16x32_bf16 a[116:119], v[108:111], v[68:71], a[116:119]
 v_mfma_f32_16x16x32_bf16 a[120:123], v[108:111], v[72:75], a[120:123]
 ds_read_b64_tr_b16 v[156:157], v55 offset:8192
 v_mfma_f32_16x16x32_bf16 a[124:127], v[108:111], v[76:79], a[124:127]
 ds_read_b64_tr_b16 v[158:159], v55 offset:9216
 s_waitcnt lgkmcnt(0)
 s_waitcnt vmcnt(12)
 s_barrier
 v_mfma_f32_16x16x32_bf16 a[0:3], v[128:131], v[112:115], a[0:3]
 s_add_u32 s63, s53, 640
 s_add_u32 m0, s62, 98304
 s_nop 0
 buffer_load_dwordx4 v8, s[12:15], s63 offen lds
 v_mfma_f32_16x16x32_bf16 a[4:7], v[128:131], v[116:119], a[4:7]
 s_add_u32 s63, s53, 9856
 s_add_u32 m0, s62, 99328
 s_nop 0
 buffer_load_dwordx4 v9, s[12:15], s63 offen lds
 v_mfma_f32_16x16x32_bf16 a[8:11], v[128:131], v[120:123], a[8:11]
 s_add_u32 s63, s53, 19072
 s_add_u32 m0, s62, 100352
 s_nop 0
 buffer_load_dwordx4 v8, s[12:15], s63 offen lds
 v_mfma_f32_16x16x32_bf16 a[12:15], v[128:131], v[124:127], a[12:15]
 s_add_u32 s63, s53, 28288
 s_add_u32 m0, s62, 101376
 s_nop 0
 buffer_load_dwordx4 v9, s[12:15], s63 offen lds
 v_mfma_f32_16x16x32_bf16 a[16:19], v[132:135], v[112:115], a[16:19]
 s_add_u32 s63, s60, 2621440
 s_add_u32 m0, s61, 98304
 s_nop 0
 buffer_load_dwordx4 v10, s[28:31], s63 offen lds
 v_mfma_f32_16x16x32_bf16 a[20:23], v[132:135], v[116:119], a[20:23]
 s_add_u32 s63, s60, 2654208
 s_add_u32 m0, s61, 99328
 s_nop 0
 buffer_load_dwordx4 v10, s[28:31], s63 offen lds
 v_mfma_f32_16x16x32_bf16 a[24:27], v[132:135], v[120:123], a[24:27]
 s_add_u32 s63, s60, 2686976
 s_add_u32 m0, s61, 100352
 s_nop 0
 buffer_load_dwordx4 v11, s[28:31], s63 offen lds
 v_mfma_f32_16x16x32_bf16 a[28:31], v[132:135], v[124:127], a[28:31]
 s_add_u32 s63, s60, 2719744
 s_add_u32 m0, s61, 101376
 s_nop 0
 buffer_load_dwordx4 v11, s[28:31], s63 offen lds
 v_mfma_f32_16x16x32_bf16 a[32:35], v[136:139], v[112:115], a[32:35]
 s_add_u32 s63, s60, 2752512
 s_add_u32 m0, s61, 102400
 s_nop 0
 buffer_load_dwordx4 v10, s[28:31], s63 offen lds
 v_mfma_f32_16x16x32_bf16 a[36:39], v[136:139], v[116:119], a[36:39]
 s_add_u32 s63, s60, 2785280
 s_add_u32 m0, s61, 103424
 s_nop 0
 buffer_load_dwordx4 v10, s[28:31], s63 offen lds
 v_mfma_f32_16x16x32_bf16 a[40:43], v[136:139], v[120:123], a[40:43]
 s_add_u32 s63, s60, 2818048
 s_add_u32 m0, s61, 104448
 s_nop 0
 buffer_load_dwordx4 v11, s[28:31], s63 offen lds
 v_mfma_f32_16x16x32_bf16 a[44:47], v[136:139], v[124:127], a[44:47]
 s_add_u32 s63, s60, 2850816
 s_add_u32 m0, s61, 105472
 s_nop 0
 buffer_load_dwordx4 v11, s[28:31], s63 offen lds
 v_mfma_f32_16x16x32_bf16 a[48:51], v[140:143], v[112:115], a[48:51]
 ds_read_b128 v[64:67], v16 offset:0
 v_mfma_f32_16x16x32_bf16 a[52:55], v[140:143], v[116:119], a[52:55]
 ds_read_b128 v[68:71], v16 offset:2048
 v_mfma_f32_16x16x32_bf16 a[56:59], v[140:143], v[120:123], a[56:59]
 ds_read_b128 v[72:75], v16 offset:4096
 v_mfma_f32_16x16x32_bf16 a[60:63], v[140:143], v[124:127], a[60:63]
 ds_read_b128 v[76:79], v16 offset:6144
 v_mfma_f32_16x16x32_bf16 a[64:67], v[144:147], v[112:115], a[64:67]
 ds_read_b64_tr_b16 v[80:81], v32 offset:0
 v_mfma_f32_16x16x32_bf16 a[68:71], v[144:147], v[116:119], a[68:71]
 ds_read_b64_tr_b16 v[82:83], v32 offset:1024
 v_mfma_f32_16x16x32_bf16 a[72:75], v[144:147], v[120:123], a[72:75]
 ds_read_b64_tr_b16 v[84:85], v33 offset:0
 v_mfma_f32_16x16x32_bf16 a[76:79], v[144:147], v[124:127], a[76:79]
 ds_read_b64_tr_b16 v[86:87], v33 offset:1024
 v_mfma_f32_16x16x32_bf16 a[80:83], v[148:151], v[112:115], a[80:83]
 ds_read_b64_tr_b16 v[88:89], v34 offset:0
 v_mfma_f32_16x16x32_bf16 a[84:87], v[148:151], v[116:119], a[84:87]
 ds_read_b64_tr_b16 v[90:91], v34 offset:1024
 v_mfma_f32_16x16x32_bf16 a[88:91], v[148:151], v[120:123], a[88:91]
 ds_read_b64_tr_b16 v[92:93], v35 offset:0
 v_mfma_f32_16x16x32_bf16 a[92:95], v[148:151], v[124:127], a[92:95]
 ds_read_b64_tr_b16 v[94:95], v35 offset:1024
 v_mfma_f32_16x16x32_bf16 a[96:99], v[152:155], v[112:115], a[96:99]
 ds_read_b64_tr_b16 v[96:97], v36 offset:0
 v_mfma_f32_16x16x32_bf16 a[100:103], v[152:155], v[116:119], a[100:103]
 ds_read_b64_tr_b16 v[98:99], v36 offset:1024
 v_mfma_f32_16x16x32_bf16 a[104:107], v[152:155], v[120:123], a[104:107]
 ds_read_b64_tr_b16 v[100:101], v37 offset:0
 v_mfma_f32_16x16x32_bf16 a[108:111], v[152:155], v[124:127], a[108:111]
 ds_read_b64_tr_b16 v[102:103], v37 offset:1024
 v_mfma_f32_16x16x32_bf16 a[112:115], v[156:159], v[112:115], a[112:115]
 ds_read_b64_tr_b16 v[104:105], v38 offset:0
 v_mfma_f32_16x16x32_bf16 a[116:119], v[156:159], v[116:119], a[116:119]
 ds_read_b64_tr_b16 v[106:107], v38 offset:1024
 v_mfma_f32_16x16x32_bf16 a[120:123], v[156:159], v[120:123], a[120:123]
 ds_read_b64_tr_b16 v[108:109], v39 offset:0
 v_mfma_f32_16x16x32_bf16 a[124:127], v[156:159], v[124:127], a[124:127]
 ds_read_b64_tr_b16 v[110:111], v39 offset:1024
 s_waitcnt lgkmcnt(0)
 v_mfma_f32_16x16x32_bf16 a[0:3], v[80:83], v[64:67], a[0:3]
 v_mfma_f32_16x16x32_bf16 a[4:7], v[80:83], v[68:71], a[4:7]
 ds_read_b128 v[112:115], v17 offset:0
 v_mfma_f32_16x16x32_bf16 a[8:11], v[80:83], v[72:75], a[8:11]
 v_mfma_f32_16x16x32_bf16 a[12:15], v[80:83], v[76:79], a[12:15]
 ds_read_b128 v[116:119], v17 offset:2048
 v_mfma_f32_16x16x32_bf16 a[16:19], v[84:87], v[64:67], a[16:19]
 ds_read_b128 v[120:123], v17 offset:4096
 v_mfma_f32_16x16x32_bf16 a[20:23], v[84:87], v[68:71], a[20:23]
 v_mfma_f32_16x16x32_bf16 a[24:27], v[84:87], v[72:75], a[24:27]
 ds_read_b128 v[124:127], v17 offset:6144
 v_mfma_f32_16x16x32_bf16 a[28:31], v[84:87], v[76:79], a[28:31]
 ds_read_b64_tr_b16 v[128:129], v32 offset:8192
 v_mfma_f32_16x16x32_bf16 a[32:35], v[88:91], v[64:67], a[32:35]
 v_mfma_f32_16x16x32_bf16 a[36:39], v[88:91], v[68:71], a[36:39]
 ds_read_b64_tr_b16 v[130:131], v32 offset:9216
 v_mfma_f32_16x16x32_bf16 a[40:43], v[88:91], v[72:75], a[40:43]
 v_mfma_f32_16x16x32_bf16 a[44:47], v[88:91], v[76:79], a[44:47]
 ds_read_b64_tr_b16 v[132:133], v33 offset:8192
 v_mfma_f32_16x16x32_bf16 a[48:51], v[92:95], v[64:67], a[48:51]
 ds_read_b64_tr_b16 v[134:135], v33 offset:9216
 v_mfma_f32_16x16x32_bf16 a[52:55], v[92:95], v[68:71], a[52:55]
 v_mfma_f32_16x16x32_bf16 a[56:59], v[92:95], v[72:75], a[56:59]
 ds_read_b64_tr_b16 v[136:137], v34 offset:8192
 v_mfma_f32_16x16x32_bf16 a[60:63], v[92:95], v[76:79], a[60:63]
 ds_read_b64_tr_b16 v[138:139], v34 offset:9216
 v_mfma_f32_16x16x32_bf16 a[64:67], v[96:99], v[64:67], a[64:67]
 v_mfma_f32_16x16x32_bf16 a[68:71], v[96:99], v[68:71], a[68:71]
 ds_read_b64_tr_b16 v[140:141], v35 offset:8192
 v_mfma_f32_16x16x32_bf16 a[72:75], v[96:99], v[72:75], a[72:75]
 v_mfma_f32_16x16x32_bf16 a[76:79], v[96:99], v[76:79], a[76:79]
 ds_read_b64_tr_b16 v[142:143], v35 offset:9216
 v_mfma_f32_16x16x32_bf16 a[80:83], v[100:103], v[64:67], a[80:83]
 ds_read_b64_tr_b16 v[144:145], v36 offset:8192
 v_mfma_f32_16x16x32_bf16 a[84:87], v[100:103], v[68:71], a[84:87]
 v_mfma_f32_16x16x32_bf16 a[88:91], v[100:103], v[72:75], a[88:91]
 ds_read_b64_tr_b16 v[146:147], v36 offset:9216
 v_mfma_f32_16x16x32_bf16 a[92:95], v[100:103], v[76:79], a[92:95]
 ds_read_b64_tr_b16 v[148:149], v37 offset:8192
 v_mfma_f32_16x16x32_bf16 a[96:99], v[104:107], v[64:67], a[96:99]
 v_mfma_f32_16x16x32_bf16 a[100:103], v[104:107], v[68:71], a[100:103]
 ds_read_b64_tr_b16 v[150:151], v37 offset:9216
 v_mfma_f32_16x16x32_bf16 a[104:107], v[104:107], v[72:75], a[104:107]
 v_mfma_f32_16x16x32_bf16 a[108:111], v[104:107], v[76:79], a[108:111]
 ds_read_b64_tr_b16 v[152:153], v38 offset:8192
 v_mfma_f32_16x16x32_bf16 a[112:115], v[108:111], v[64:67], a[112:115]
 ds_read_b64_tr_b16 v[154:155], v38 offset:9216
 v_mfma_f32_16x16x32_bf16 a[116:119], v[108:111], v[68:71], a[116:119]
 v_mfma_f32_16x16x32_bf16 a[120:123], v[108:111], v[72:75], a[120:123]
 ds_read_b64_tr_b16 v[156:157], v39 offset:8192
 v_mfma_f32_16x16x32_bf16 a[124:127], v[108:111], v[76:79], a[124:127]
 ds_read_b64_tr_b16 v[158:159], v39 offset:9216
 s_waitcnt lgkmcnt(0)
 s_waitcnt vmcnt(12)
 s_barrier
 v_mfma_f32_16x16x32_bf16 a[0:3], v[128:131], v[112:115], a[0:3]
 s_add_u32 s63, s53, 768
 s_add_u32 m0, s62, 0
 s_nop 0
 buffer_load_dwordx4 v8, s[12:15], s63 offen lds
 v_mfma_f32_16x16x32_bf16 a[4:7], v[128:131], v[116:119], a[4:7]
 s_add_u32 s63, s53, 9984
 s_add_u32 m0, s62, 1024
 s_nop 0
 buffer_load_dwordx4 v9, s[12:15], s63 offen lds
 v_mfma_f32_16x16x32_bf16 a[8:11], v[128:131], v[120:123], a[8:11]
 s_add_u32 s63, s53, 19200
 s_add_u32 m0, s62, 2048
 s_nop 0
 buffer_load_dwordx4 v8, s[12:15], s63 offen lds
 v_mfma_f32_16x16x32_bf16 a[12:15], v[128:131], v[124:127], a[12:15]
 s_add_u32 s63, s53, 28416
 s_add_u32 m0, s62, 3072
 s_nop 0
 buffer_load_dwordx4 v9, s[12:15], s63 offen lds
 v_mfma_f32_16x16x32_bf16 a[16:19], v[132:135], v[112:115], a[16:19]
 s_add_u32 s63, s60, 3145728
 s_add_u32 m0, s61, 0
 s_nop 0
 buffer_load_dwordx4 v10, s[28:31], s63 offen lds
 v_mfma_f32_16x16x32_bf16 a[20:23], v[132:135], v[116:119], a[20:23]
 s_add_u32 s63, s60, 3178496
 s_add_u32 m0, s61, 1024
 s_nop 0
 buffer_load_dwordx4 v10, s[28:31], s63 offen lds
 v_mfma_f32_16x16x32_bf16 a[24:27], v[132:135], v[120:123], a[24:27]
 s_add_u32 s63, s60, 3211264
 s_add_u32 m0, s61, 2048
 s_nop 0
 buffer_load_dwordx4 v11, s[28:31], s63 offen lds
 v_mfma_f32_16x16x32_bf16 a[28:31], v[132:135], v[124:127], a[28:31]
 s_add_u32 s63, s60, 3244032
 s_add_u32 m0, s61, 3072
 s_nop 0
 buffer_load_dwordx4 v11, s[28:31], s63 offen lds
 v_mfma_f32_16x16x32_bf16 a[32:35], v[136:139], v[112:115], a[32:35]
 s_add_u32 s63, s60, 3276800
 s_add_u32 m0, s61, 4096
 s_nop 0
 buffer_load_dwordx4 v10, s[28:31], s63 offen lds
 v_mfma_f32_16x16x32_bf16 a[36:39], v[136:139], v[116:119], a[36:39]
 s_add_u32 s63, s60, 3309568
 s_add_u32 m0, s61, 5120
 s_nop 0
 buffer_load_dwordx4 v10, s[28:31], s63 offen lds
 v_mfma_f32_16x16x32_bf16 a[40:43], v[136:139], v[120:123], a[40:43]
 s_add_u32 s63, s60, 3342336
 s_add_u32 m0, s61, 6144
 s_nop 0
 buffer_load_dwordx4 v11, s[28:31], s63 offen lds
 v_mfma_f32_16x16x32_bf16 a[44:47], v[136:139], v[124:127], a[44:47]
 s_add_u32 s63, s60, 3375104
 s_add_u32 m0, s61, 7168
 s_nop 0
 buffer_load_dwordx4 v11, s[28:31], s63 offen lds
 v_mfma_f32_16x16x32_bf16 a[48:51], v[140:143], v[112:115], a[48:51]
 ds_read_b128 v[64:67], v18 offset:0
 v_mfma_f32_16x16x32_bf16 a[52:55], v[140:143], v[116:119], a[52:55]
 ds_read_b128 v[68:71], v18 offset:2048
 v_mfma_f32_16x16x32_bf16 a[56:59], v[140:143], v[120:123], a[56:59]
 ds_read_b128 v[72:75], v18 offset:4096
 v_mfma_f32_16x16x32_bf16 a[60:63], v[140:143], v[124:127], a[60:63]
 ds_read_b128 v[76:79], v18 offset:6144
 v_mfma_f32_16x16x32_bf16 a[64:67], v[144:147], v[112:115], a[64:67]
 ds_read_b64_tr_b16 v[80:81], v40 offset:0
 v_mfma_f32_16x16x32_bf16 a[68:71], v[144:147], v[116:119], a[68:71]
 ds_read_b64_tr_b16 v[82:83], v40 offset:1024
 v_mfma_f32_16x16x32_bf16 a[72:75], v[144:147], v[120:123], a[72:75]
 ds_read_b64_tr_b16 v[84:85], v41 offset:0
 v_mfma_f32_16x16x32_bf16 a[76:79], v[144:147], v[124:127], a[76:79]
 ds_read_b64_tr_b16 v[86:87], v41 offset:1024
 v_mfma_f32_16x16x32_bf16 a[80:83], v[148:151], v[112:115], a[80:83]
 ds_read_b64_tr_b16 v[88:89], v42 offset:0
 v_mfma_f32_16x16x32_bf16 a[84:87], v[148:151], v[116:119], a[84:87]
 ds_read_b64_tr_b16 v[90:91], v42 offset:1024
 v_mfma_f32_16x16x32_bf16 a[88:91], v[148:151], v[120:123], a[88:91]
 ds_read_b64_tr_b16 v[92:93], v43 offset:0
 v_mfma_f32_16x16x32_bf16 a[92:95], v[148:151], v[124:127], a[92:95]
 ds_read_b64_tr_b16 v[94:95], v43 offset:1024
 v_mfma_f32_16x16x32_bf16 a[96:99], v[152:155], v[112:115], a[96:99]
 ds_read_b64_tr_b16 v[96:97], v44 offset:0
 v_mfma_f32_16x16x32_bf16 a[100:103], v[152:155], v[116:119], a[100:103]
 ds_read_b64_tr_b16 v[98:99], v44 offset:1024
 v_mfma_f32_16x16x32_bf16 a[104:107], v[152:155], v[120:123], a[104:107]
 ds_read_b64_tr_b16 v[100:101], v45 offset:0
 v_mfma_f32_16x16x32_bf16 a[108:111], v[152:155], v[124:127], a[108:111]
 ds_read_b64_tr_b16 v[102:103], v45 offset:1024
 v_mfma_f32_16x16x32_bf16 a[112:115], v[156:159], v[112:115], a[112:115]
 ds_read_b64_tr_b16 v[104:105], v46 offset:0
 v_mfma_f32_16x16x32_bf16 a[116:119], v[156:159], v[116:119], a[116:119]
 ds_read_b64_tr_b16 v[106:107], v46 offset:1024
 v_mfma_f32_16x16x32_bf16 a[120:123], v[156:159], v[120:123], a[120:123]
 ds_read_b64_tr_b16 v[108:109], v47 offset:0
 v_mfma_f32_16x16x32_bf16 a[124:127], v[156:159], v[124:127], a[124:127]
 ds_read_b64_tr_b16 v[110:111], v47 offset:1024
 s_waitcnt lgkmcnt(0)
 v_mfma_f32_16x16x32_bf16 a[0:3], v[80:83], v[64:67], a[0:3]
 v_mfma_f32_16x16x32_bf16 a[4:7], v[80:83], v[68:71], a[4:7]
 ds_read_b128 v[112:115], v19 offset:0
 v_mfma_f32_16x16x32_bf16 a[8:11], v[80:83], v[72:75], a[8:11]
 v_mfma_f32_16x16x32_bf16 a[12:15], v[80:83], v[76:79], a[12:15]
 ds_read_b128 v[116:119], v19 offset:2048
 v_mfma_f32_16x16x32_bf16 a[16:19], v[84:87], v[64:67], a[16:19]
 ds_read_b128 v[120:123], v19 offset:4096
 v_mfma_f32_16x16x32_bf16 a[20:23], v[84:87], v[68:71], a[20:23]
 v_mfma_f32_16x16x32_bf16 a[24:27], v[84:87], v[72:75], a[24:27]
 ds_read_b128 v[124:127], v19 offset:6144
 v_mfma_f32_16x16x32_bf16 a[28:31], v[84:87], v[76:79], a[28:31]
 ds_read_b64_tr_b16 v[128:129], v40 offset:8192
 v_mfma_f32_16x16x32_bf16 a[32:35], v[88:91], v[64:67], a[32:35]
 v_mfma_f32_16x16x32_bf16 a[36:39], v[88:91], v[68:71], a[36:39]
 ds_read_b64_tr_b16 v[130:131], v40 offset:9216
 v_mfma_f32_16x16x32_bf16 a[40:43], v[88:91], v[72:75], a[40:43]
 v_mfma_f32_16x16x32_bf16 a[44:47], v[88:91], v[76:79], a[44:47]
 ds_read_b64_tr_b16 v[132:133], v41 offset:8192
 v_mfma_f32_16x16x32_bf16 a[48:51], v[92:95], v[64:67], a[48:51]
 ds_read_b64_tr_b16 v[134:135], v41 offset:9216
 v_mfma_f32_16x16x32_bf16 a[52:55], v[92:95], v[68:71], a[52:55]
 v_mfma_f32_16x16x32_bf16 a[56:59], v[92:95], v[72:75], a[56:59]
 ds_read_b64_tr_b16 v[136:137], v42 offset:8192
 v_mfma_f32_16x16x32_bf16 a[60:63], v[92:95], v[76:79], a[60:63]
 ds_read_b64_tr_b16 v[138:139], v42 offset:9216
 v_mfma_f32_16x16x32_bf16 a[64:67], v[96:99], v[64:67], a[64:67]
 v_mfma_f32_16x16x32_bf16 a[68:71], v[96:99], v[68:71], a[68:71]
 ds_read_b64_tr_b16 v[140:141], v43 offset:8192
 v_mfma_f32_16x16x32_bf16 a[72:75], v[96:99], v[72:75], a[72:75]
 v_mfma_f32_16x16x32_bf16 a[76:79], v[96:99], v[76:79], a[76:79]
 ds_read_b64_tr_b16 v[142:143], v43 offset:9216
 v_mfma_f32_16x16x32_bf16 a[80:83], v[100:103], v[64:67], a[80:83]
 ds_read_b64_tr_b16 v[144:145], v44 offset:8192
 v_mfma_f32_16x16x32_bf16 a[84:87], v[100:103], v[68:71], a[84:87]
 v_mfma_f32_16x16x32_bf16 a[88:91], v[100:103], v[72:75], a[88:91]
 ds_read_b64_tr_b16 v[146:147], v44 offset:9216
 v_mfma_f32_16x16x32_bf16 a[92:95], v[100:103], v[76:79], a[92:95]
 ds_read_b64_tr_b16 v[148:149], v45 offset:8192
 v_mfma_f32_16x16x32_bf16 a[96:99], v[104:107], v[64:67], a[96:99]
 v_mfma_f32_16x16x32_bf16 a[100:103], v[104:107], v[68:71], a[100:103]
 ds_read_b64_tr_b16 v[150:151], v45 offset:9216
 v_mfma_f32_16x16x32_bf16 a[104:107], v[104:107], v[72:75], a[104:107]
 v_mfma_f32_16x16x32_bf16 a[108:111], v[104:107], v[76:79], a[108:111]
 ds_read_b64_tr_b16 v[152:153], v46 offset:8192
 v_mfma_f32_16x16x32_bf16 a[112:115], v[108:111], v[64:67], a[112:115]
 ds_read_b64_tr_b16 v[154:155], v46 offset:9216
 v_mfma_f32_16x16x32_bf16 a[116:119], v[108:111], v[68:71], a[116:119]
 v_mfma_f32_16x16x32_bf16 a[120:123], v[108:111], v[72:75], a[120:123]
 ds_read_b64_tr_b16 v[156:157], v47 offset:8192
 v_mfma_f32_16x16x32_bf16 a[124:127], v[108:111], v[76:79], a[124:127]
 ds_read_b64_tr_b16 v[158:159], v47 offset:9216
 s_waitcnt lgkmcnt(0)
 s_waitcnt vmcnt(12)
 s_barrier
 v_mfma_f32_16x16x32_bf16 a[0:3], v[128:131], v[112:115], a[0:3]
 s_add_u32 s63, s53, 896
 s_add_u32 m0, s62, 49152
 s_nop 0
 buffer_load_dwordx4 v8, s[12:15], s63 offen lds
 v_mfma_f32_16x16x32_bf16 a[4:7], v[128:131], v[116:119], a[4:7]
 s_add_u32 s63, s53, 10112
 s_add_u32 m0, s62, 50176
 s_nop 0
 buffer_load_dwordx4 v9, s[12:15], s63 offen lds
 v_mfma_f32_16x16x32_bf16 a[8:11], v[128:131], v[120:123], a[8:11]
 s_add_u32 s63, s53, 19328
 s_add_u32 m0, s62, 51200
 s_nop 0
 buffer_load_dwordx4 v8, s[12:15], s63 offen lds
 v_mfma_f32_16x16x32_bf16 a[12:15], v[128:131], v[124:127], a[12:15]
 s_add_u32 s63, s53, 28544
 s_add_u32 m0, s62, 52224
 s_nop 0
 buffer_load_dwordx4 v9, s[12:15], s63 offen lds
 v_mfma_f32_16x16x32_bf16 a[16:19], v[132:135], v[112:115], a[16:19]
 s_add_u32 s63, s60, 3670016
 s_add_u32 m0, s61, 49152
 s_nop 0
 buffer_load_dwordx4 v10, s[28:31], s63 offen lds
 v_mfma_f32_16x16x32_bf16 a[20:23], v[132:135], v[116:119], a[20:23]
 s_add_u32 s63, s60, 3702784
 s_add_u32 m0, s61, 50176
 s_nop 0
 buffer_load_dwordx4 v10, s[28:31], s63 offen lds
 v_mfma_f32_16x16x32_bf16 a[24:27], v[132:135], v[120:123], a[24:27]
 s_add_u32 s63, s60, 3735552
 s_add_u32 m0, s61, 51200
 s_nop 0
 buffer_load_dwordx4 v11, s[28:31], s63 offen lds
 v_mfma_f32_16x16x32_bf16 a[28:31], v[132:135], v[124:127], a[28:31]
 s_add_u32 s63, s60, 3768320
 s_add_u32 m0, s61, 52224
 s_nop 0
 buffer_load_dwordx4 v11, s[28:31], s63 offen lds
 v_mfma_f32_16x16x32_bf16 a[32:35], v[136:139], v[112:115], a[32:35]
 s_add_u32 s63, s60, 3801088
 s_add_u32 m0, s61, 53248
 s_nop 0
 buffer_load_dwordx4 v10, s[28:31], s63 offen lds
 v_mfma_f32_16x16x32_bf16 a[36:39], v[136:139], v[116:119], a[36:39]
 s_add_u32 s63, s60, 3833856
 s_add_u32 m0, s61, 54272
 s_nop 0
 buffer_load_dwordx4 v10, s[28:31], s63 offen lds
 v_mfma_f32_16x16x32_bf16 a[40:43], v[136:139], v[120:123], a[40:43]
 s_add_u32 s63, s60, 3866624
 s_add_u32 m0, s61, 55296
 s_nop 0
 buffer_load_dwordx4 v11, s[28:31], s63 offen lds
 v_mfma_f32_16x16x32_bf16 a[44:47], v[136:139], v[124:127], a[44:47]
 s_add_u32 s63, s60, 3899392
 s_add_u32 m0, s61, 56320
 s_nop 0
 buffer_load_dwordx4 v11, s[28:31], s63 offen lds
 v_mfma_f32_16x16x32_bf16 a[48:51], v[140:143], v[112:115], a[48:51]
 ds_read_b128 v[64:67], v20 offset:0
 v_mfma_f32_16x16x32_bf16 a[52:55], v[140:143], v[116:119], a[52:55]
 ds_read_b128 v[68:71], v20 offset:2048
 v_mfma_f32_16x16x32_bf16 a[56:59], v[140:143], v[120:123], a[56:59]
 ds_read_b128 v[72:75], v20 offset:4096
 v_mfma_f32_16x16x32_bf16 a[60:63], v[140:143], v[124:127], a[60:63]
 ds_read_b128 v[76:79], v20 offset:6144
 v_mfma_f32_16x16x32_bf16 a[64:67], v[144:147], v[112:115], a[64:67]
 ds_read_b64_tr_b16 v[80:81], v48 offset:0
 v_mfma_f32_16x16x32_bf16 a[68:71], v[144:147], v[116:119], a[68:71]
 ds_read_b64_tr_b16 v[82:83], v48 offset:1024
 v_mfma_f32_16x16x32_bf16 a[72:75], v[144:147], v[120:123], a[72:75]
 ds_read_b64_tr_b16 v[84:85], v49 offset:0
 v_mfma_f32_16x16x32_bf16 a[76:79], v[144:147], v[124:127], a[76:79]
 ds_read_b64_tr_b16 v[86:87], v49 offset:1024
 v_mfma_f32_16x16x32_bf16 a[80:83], v[148:151], v[112:115], a[80:83]
 ds_read_b64_tr_b16 v[88:89], v50 offset:0
 v_mfma_f32_16x16x32_bf16 a[84:87], v[148:151], v[116:119], a[84:87]
 ds_read_b64_tr_b16 v[90:91], v50 offset:1024
 v_mfma_f32_16x16x32_bf16 a[88:91], v[148:151], v[120:123], a[88:91]
 ds_read_b64_tr_b16 v[92:93], v51 offset:0
 v_mfma_f32_16x16x32_bf16 a[92:95], v[148:151], v[124:127], a[92:95]
 ds_read_b64_tr_b16 v[94:95], v51 offset:1024
 v_mfma_f32_16x16x32_bf16 a[96:99], v[152:155], v[112:115], a[96:99]
 ds_read_b64_tr_b16 v[96:97], v52 offset:0
 v_mfma_f32_16x16x32_bf16 a[100:103], v[152:155], v[116:119], a[100:103]
 ds_read_b64_tr_b16 v[98:99], v52 offset:1024
 v_mfma_f32_16x16x32_bf16 a[104:107], v[152:155], v[120:123], a[104:107]
 ds_read_b64_tr_b16 v[100:101], v53 offset:0
 v_mfma_f32_16x16x32_bf16 a[108:111], v[152:155], v[124:127], a[108:111]
 ds_read_b64_tr_b16 v[102:103], v53 offset:1024
 v_mfma_f32_16x16x32_bf16 a[112:115], v[156:159], v[112:115], a[112:115]
 ds_read_b64_tr_b16 v[104:105], v54 offset:0
 v_mfma_f32_16x16x32_bf16 a[116:119], v[156:159], v[116:119], a[116:119]
 ds_read_b64_tr_b16 v[106:107], v54 offset:1024
 v_mfma_f32_16x16x32_bf16 a[120:123], v[156:159], v[120:123], a[120:123]
 ds_read_b64_tr_b16 v[108:109], v55 offset:0
 v_mfma_f32_16x16x32_bf16 a[124:127], v[156:159], v[124:127], a[124:127]
 ds_read_b64_tr_b16 v[110:111], v55 offset:1024
 s_waitcnt lgkmcnt(0)
 v_mfma_f32_16x16x32_bf16 a[0:3], v[80:83], v[64:67], a[0:3]
 v_mfma_f32_16x16x32_bf16 a[4:7], v[80:83], v[68:71], a[4:7]
 ds_read_b128 v[112:115], v21 offset:0
 v_mfma_f32_16x16x32_bf16 a[8:11], v[80:83], v[72:75], a[8:11]
 v_mfma_f32_16x16x32_bf16 a[12:15], v[80:83], v[76:79], a[12:15]
 ds_read_b128 v[116:119], v21 offset:2048
 v_mfma_f32_16x16x32_bf16 a[16:19], v[84:87], v[64:67], a[16:19]
 ds_read_b128 v[120:123], v21 offset:4096
 v_mfma_f32_16x16x32_bf16 a[20:23], v[84:87], v[68:71], a[20:23]
 v_mfma_f32_16x16x32_bf16 a[24:27], v[84:87], v[72:75], a[24:27]
 ds_read_b128 v[124:127], v21 offset:6144
 v_mfma_f32_16x16x32_bf16 a[28:31], v[84:87], v[76:79], a[28:31]
 ds_read_b64_tr_b16 v[128:129], v48 offset:8192
 v_mfma_f32_16x16x32_bf16 a[32:35], v[88:91], v[64:67], a[32:35]
 v_mfma_f32_16x16x32_bf16 a[36:39], v[88:91], v[68:71], a[36:39]
 ds_read_b64_tr_b16 v[130:131], v48 offset:9216
 v_mfma_f32_16x16x32_bf16 a[40:43], v[88:91], v[72:75], a[40:43]
 v_mfma_f32_16x16x32_bf16 a[44:47], v[88:91], v[76:79], a[44:47]
 ds_read_b64_tr_b16 v[132:133], v49 offset:8192
 v_mfma_f32_16x16x32_bf16 a[48:51], v[92:95], v[64:67], a[48:51]
 ds_read_b64_tr_b16 v[134:135], v49 offset:9216
 v_mfma_f32_16x16x32_bf16 a[52:55], v[92:95], v[68:71], a[52:55]
 v_mfma_f32_16x16x32_bf16 a[56:59], v[92:95], v[72:75], a[56:59]
 ds_read_b64_tr_b16 v[136:137], v50 offset:8192
 v_mfma_f32_16x16x32_bf16 a[60:63], v[92:95], v[76:79], a[60:63]
 ds_read_b64_tr_b16 v[138:139], v50 offset:9216
 v_mfma_f32_16x16x32_bf16 a[64:67], v[96:99], v[64:67], a[64:67]
 v_mfma_f32_16x16x32_bf16 a[68:71], v[96:99], v[68:71], a[68:71]
 ds_read_b64_tr_b16 v[140:141], v51 offset:8192
 v_mfma_f32_16x16x32_bf16 a[72:75], v[96:99], v[72:75], a[72:75]
 v_mfma_f32_16x16x32_bf16 a[76:79], v[96:99], v[76:79], a[76:79]
 ds_read_b64_tr_b16 v[142:143], v51 offset:9216
 v_mfma_f32_16x16x32_bf16 a[80:83], v[100:103], v[64:67], a[80:83]
 ds_read_b64_tr_b16 v[144:145], v52 offset:8192
 v_mfma_f32_16x16x32_bf16 a[84:87], v[100:103], v[68:71], a[84:87]
 v_mfma_f32_16x16x32_bf16 a[88:91], v[100:103], v[72:75], a[88:91]
 ds_read_b64_tr_b16 v[146:147], v52 offset:9216
 v_mfma_f32_16x16x32_bf16 a[92:95], v[100:103], v[76:79], a[92:95]
 ds_read_b64_tr_b16 v[148:149], v53 offset:8192
 v_mfma_f32_16x16x32_bf16 a[96:99], v[104:107], v[64:67], a[96:99]
 v_mfma_f32_16x16x32_bf16 a[100:103], v[104:107], v[68:71], a[100:103]
 ds_read_b64_tr_b16 v[150:151], v53 offset:9216
 v_mfma_f32_16x16x32_bf16 a[104:107], v[104:107], v[72:75], a[104:107]
 v_mfma_f32_16x16x32_bf16 a[108:111], v[104:107], v[76:79], a[108:111]
 ds_read_b64_tr_b16 v[152:153], v54 offset:8192
 v_mfma_f32_16x16x32_bf16 a[112:115], v[108:111], v[64:67], a[112:115]
 ds_read_b64_tr_b16 v[154:155], v54 offset:9216
 v_mfma_f32_16x16x32_bf16 a[116:119], v[108:111], v[68:71], a[116:119]
 v_mfma_f32_16x16x32_bf16 a[120:123], v[108:111], v[72:75], a[120:123]
 ds_read_b64_tr_b16 v[156:157], v55 offset:8192
 v_mfma_f32_16x16x32_bf16 a[124:127], v[108:111], v[76:79], a[124:127]
 ds_read_b64_tr_b16 v[158:159], v55 offset:9216
 s_waitcnt lgkmcnt(0)
 s_waitcnt vmcnt(12)
 s_barrier
 v_mfma_f32_16x16x32_bf16 a[0:3], v[128:131], v[112:115], a[0:3]
 s_add_u32 s63, s53, 1024
 s_add_u32 m0, s62, 98304
 s_nop 0
 buffer_load_dwordx4 v8, s[12:15], s63 offen lds
 v_mfma_f32_16x16x32_bf16 a[4:7], v[128:131], v[116:119], a[4:7]
 s_add_u32 s63, s53, 10240
 s_add_u32 m0, s62, 99328
 s_nop 0
 buffer_load_dwordx4 v9, s[12:15], s63 offen lds
 v_mfma_f32_16x16x32_bf16 a[8:11], v[128:131], v[120:123], a[8:11]
 s_add_u32 s63, s53, 19456
 s_add_u32 m0, s62, 100352
 s_nop 0
 buffer_load_dwordx4 v8, s[12:15], s63 offen lds
 v_mfma_f32_16x16x32_bf16 a[12:15], v[128:131], v[124:127], a[12:15]
 s_add_u32 s63, s53, 28672
 s_add_u32 m0, s62, 101376
 s_nop 0
 buffer_load_dwordx4 v9, s[12:15], s63 offen lds
 v_mfma_f32_16x16x32_bf16 a[16:19], v[132:135], v[112:115], a[16:19]
 s_add_u32 s63, s60, 4194304
 s_add_u32 m0, s61, 98304
 s_nop 0
 buffer_load_dwordx4 v10, s[28:31], s63 offen lds
 v_mfma_f32_16x16x32_bf16 a[20:23], v[132:135], v[116:119], a[20:23]
 s_add_u32 s63, s60, 4227072
 s_add_u32 m0, s61, 99328
 s_nop 0
 buffer_load_dwordx4 v10, s[28:31], s63 offen lds
 v_mfma_f32_16x16x32_bf16 a[24:27], v[132:135], v[120:123], a[24:27]
 s_add_u32 s63, s60, 4259840
 s_add_u32 m0, s61, 100352
 s_nop 0
 buffer_load_dwordx4 v11, s[28:31], s63 offen lds
 v_mfma_f32_16x16x32_bf16 a[28:31], v[132:135], v[124:127], a[28:31]
 s_add_u32 s63, s60, 4292608
 s_add_u32 m0, s61, 101376
 s_nop 0
 buffer_load_dwordx4 v11, s[28:31], s63 offen lds
 v_mfma_f32_16x16x32_bf16 a[32:35], v[136:139], v[112:115], a[32:35]
 s_add_u32 s63, s60, 4325376
 s_add_u32 m0, s61, 102400
 s_nop 0
 buffer_load_dwordx4 v10, s[28:31], s63 offen lds
 v_mfma_f32_16x16x32_bf16 a[36:39], v[136:139], v[116:119], a[36:39]
 s_add_u32 s63, s60, 4358144
 s_add_u32 m0, s61, 103424
 s_nop 0
 buffer_load_dwordx4 v10, s[28:31], s63 offen lds
 v_mfma_f32_16x16x32_bf16 a[40:43], v[136:139], v[120:123], a[40:43]
 s_add_u32 s63, s60, 4390912
 s_add_u32 m0, s61, 104448
 s_nop 0
 buffer_load_dwordx4 v11, s[28:31], s63 offen lds
 v_mfma_f32_16x16x32_bf16 a[44:47], v[136:139], v[124:127], a[44:47]
 s_add_u32 s63, s60, 4423680
 s_add_u32 m0, s61, 105472
 s_nop 0
 buffer_load_dwordx4 v11, s[28:31], s63 offen lds
 v_mfma_f32_16x16x32_bf16 a[48:51], v[140:143], v[112:115], a[48:51]
 ds_read_b128 v[64:67], v16 offset:0
 v_mfma_f32_16x16x32_bf16 a[52:55], v[140:143], v[116:119], a[52:55]
 ds_read_b128 v[68:71], v16 offset:2048
 v_mfma_f32_16x16x32_bf16 a[56:59], v[140:143], v[120:123], a[56:59]
 ds_read_b128 v[72:75], v16 offset:4096
 v_mfma_f32_16x16x32_bf16 a[60:63], v[140:143], v[124:127], a[60:63]
 ds_read_b128 v[76:79], v16 offset:6144
 v_mfma_f32_16x16x32_bf16 a[64:67], v[144:147], v[112:115], a[64:67]
 ds_read_b64_tr_b16 v[80:81], v32 offset:0
 v_mfma_f32_16x16x32_bf16 a[68:71], v[144:147], v[116:119], a[68:71]
 ds_read_b64_tr_b16 v[82:83], v32 offset:1024
 v_mfma_f32_16x16x32_bf16 a[72:75], v[144:147], v[120:123], a[72:75]
 ds_read_b64_tr_b16 v[84:85], v33 offset:0
 v_mfma_f32_16x16x32_bf16 a[76:79], v[144:147], v[124:127], a[76:79]
 ds_read_b64_tr_b16 v[86:87], v33 offset:1024
 v_mfma_f32_16x16x32_bf16 a[80:83], v[148:151], v[112:115], a[80:83]
 ds_read_b64_tr_b16 v[88:89], v34 offset:0
 v_mfma_f32_16x16x32_bf16 a[84:87], v[148:151], v[116:119], a[84:87]
 ds_read_b64_tr_b16 v[90:91], v34 offset:1024
 v_mfma_f32_16x16x32_bf16 a[88:91], v[148:151], v[120:123], a[88:91]
 ds_read_b64_tr_b16 v[92:93], v35 offset:0
 v_mfma_f32_16x16x32_bf16 a[92:95], v[148:151], v[124:127], a[92:95]
 ds_read_b64_tr_b16 v[94:95], v35 offset:1024
 v_mfma_f32_16x16x32_bf16 a[96:99], v[152:155], v[112:115], a[96:99]
 ds_read_b64_tr_b16 v[96:97], v36 offset:0
 v_mfma_f32_16x16x32_bf16 a[100:103], v[152:155], v[116:119], a[100:103]
 ds_read_b64_tr_b16 v[98:99], v36 offset:1024
 v_mfma_f32_16x16x32_bf16 a[104:107], v[152:155], v[120:123], a[104:107]
 ds_read_b64_tr_b16 v[100:101], v37 offset:0
 v_mfma_f32_16x16x32_bf16 a[108:111], v[152:155], v[124:127], a[108:111]
 ds_read_b64_tr_b16 v[102:103], v37 offset:1024
 v_mfma_f32_16x16x32_bf16 a[112:115], v[156:159], v[112:115], a[112:115]
 ds_read_b64_tr_b16 v[104:105], v38 offset:0
 v_mfma_f32_16x16x32_bf16 a[116:119], v[156:159], v[116:119], a[116:119]
 ds_read_b64_tr_b16 v[106:107], v38 offset:1024
 v_mfma_f32_16x16x32_bf16 a[120:123], v[156:159], v[120:123], a[120:123]
 ds_read_b64_tr_b16 v[108:109], v39 offset:0
 v_mfma_f32_16x16x32_bf16 a[124:127], v[156:159], v[124:127], a[124:127]
 ds_read_b64_tr_b16 v[110:111], v39 offset:1024
 s_waitcnt lgkmcnt(0)
 v_mfma_f32_16x16x32_bf16 a[0:3], v[80:83], v[64:67], a[0:3]
 v_mfma_f32_16x16x32_bf16 a[4:7], v[80:83], v[68:71], a[4:7]
 ds_read_b128 v[112:115], v17 offset:0
 v_mfma_f32_16x16x32_bf16 a[8:11], v[80:83], v[72:75], a[8:11]
 v_mfma_f32_16x16x32_bf16 a[12:15], v[80:83], v[76:79], a[12:15]
 ds_read_b128 v[116:119], v17 offset:2048
 v_mfma_f32_16x16x32_bf16 a[16:19], v[84:87], v[64:67], a[16:19]
 ds_read_b128 v[120:123], v17 offset:4096
 v_mfma_f32_16x16x32_bf16 a[20:23], v[84:87], v[68:71], a[20:23]
 v_mfma_f32_16x16x32_bf16 a[24:27], v[84:87], v[72:75], a[24:27]
 ds_read_b128 v[124:127], v17 offset:6144
 v_mfma_f32_16x16x32_bf16 a[28:31], v[84:87], v[76:79], a[28:31]
 ds_read_b64_tr_b16 v[128:129], v32 offset:8192
 v_mfma_f32_16x16x32_bf16 a[32:35], v[88:91], v[64:67], a[32:35]
 v_mfma_f32_16x16x32_bf16 a[36:39], v[88:91], v[68:71], a[36:39]
 ds_read_b64_tr_b16 v[130:131], v32 offset:9216
 v_mfma_f32_16x16x32_bf16 a[40:43], v[88:91], v[72:75], a[40:43]
 v_mfma_f32_16x16x32_bf16 a[44:47], v[88:91], v[76:79], a[44:47]
 ds_read_b64_tr_b16 v[132:133], v33 offset:8192
 v_mfma_f32_16x16x32_bf16 a[48:51], v[92:95], v[64:67], a[48:51]
 ds_read_b64_tr_b16 v[134:135], v33 offset:9216
 v_mfma_f32_16x16x32_bf16 a[52:55], v[92:95], v[68:71], a[52:55]
 v_mfma_f32_16x16x32_bf16 a[56:59], v[92:95], v[72:75], a[56:59]
 ds_read_b64_tr_b16 v[136:137], v34 offset:8192
 v_mfma_f32_16x16x32_bf16 a[60:63], v[92:95], v[76:79], a[60:63]
 ds_read_b64_tr_b16 v[138:139], v34 offset:9216
 v_mfma_f32_16x16x32_bf16 a[64:67], v[96:99], v[64:67], a[64:67]
 v_mfma_f32_16x16x32_bf16 a[68:71], v[96:99], v[68:71], a[68:71]
 ds_read_b64_tr_b16 v[140:141], v35 offset:8192
 v_mfma_f32_16x16x32_bf16 a[72:75], v[96:99], v[72:75], a[72:75]
 v_mfma_f32_16x16x32_bf16 a[76:79], v[96:99], v[76:79], a[76:79]
 ds_read_b64_tr_b16 v[142:143], v35 offset:9216
 v_mfma_f32_16x16x32_bf16 a[80:83], v[100:103], v[64:67], a[80:83]
 ds_read_b64_tr_b16 v[144:145], v36 offset:8192
 v_mfma_f32_16x16x32_bf16 a[84:87], v[100:103], v[68:71], a[84:87]
 v_mfma_f32_16x16x32_bf16 a[88:91], v[100:103], v[72:75], a[88:91]
 ds_read_b64_tr_b16 v[146:147], v36 offset:9216
 v_mfma_f32_16x16x32_bf16 a[92:95], v[100:103], v[76:79], a[92:95]
 ds_read_b64_tr_b16 v[148:149], v37 offset:8192
 v_mfma_f32_16x16x32_bf16 a[96:99], v[104:107], v[64:67], a[96:99]
 v_mfma_f32_16x16x32_bf16 a[100:103], v[104:107], v[68:71], a[100:103]
 ds_read_b64_tr_b16 v[150:151], v37 offset:9216
 v_mfma_f32_16x16x32_bf16 a[104:107], v[104:107], v[72:75], a[104:107]
 v_mfma_f32_16x16x32_bf16 a[108:111], v[104:107], v[76:79], a[108:111]
 ds_read_b64_tr_b16 v[152:153], v38 offset:8192
 v_mfma_f32_16x16x32_bf16 a[112:115], v[108:111], v[64:67], a[112:115]
 ds_read_b64_tr_b16 v[154:155], v38 offset:9216
 v_mfma_f32_16x16x32_bf16 a[116:119], v[108:111], v[68:71], a[116:119]
 v_mfma_f32_16x16x32_bf16 a[120:123], v[108:111], v[72:75], a[120:123]
 ds_read_b64_tr_b16 v[156:157], v39 offset:8192
 v_mfma_f32_16x16x32_bf16 a[124:127], v[108:111], v[76:79], a[124:127]
 ds_read_b64_tr_b16 v[158:159], v39 offset:9216
 s_waitcnt lgkmcnt(0)
 s_waitcnt vmcnt(12)
 s_barrier
 v_mfma_f32_16x16x32_bf16 a[0:3], v[128:131], v[112:115], a[0:3]
 v_mfma_f32_16x16x32_bf16 a[4:7], v[128:131], v[116:119], a[4:7]
 ds_read_b128 v[64:67], v18 offset:0
 v_mfma_f32_16x16x32_bf16 a[8:11], v[128:131], v[120:123], a[8:11]
 v_mfma_f32_16x16x32_bf16 a[12:15], v[128:131], v[124:127], a[12:15]
 ds_read_b128 v[68:71], v18 offset:2048
 v_mfma_f32_16x16x32_bf16 a[16:19], v[132:135], v[112:115], a[16:19]
 ds_read_b128 v[72:75], v18 offset:4096
 v_mfma_f32_16x16x32_bf16 a[20:23], v[132:135], v[116:119], a[20:23]
 v_mfma_f32_16x16x32_bf16 a[24:27], v[132:135], v[120:123], a[24:27]
 ds_read_b128 v[76:79], v18 offset:6144
 v_mfma_f32_16x16x32_bf16 a[28:31], v[132:135], v[124:127], a[28:31]
 ds_read_b64_tr_b16 v[80:81], v40 offset:0
 v_mfma_f32_16x16x32_bf16 a[32:35], v[136:139], v[112:115], a[32:35]
 v_mfma_f32_16x16x32_bf16 a[36:39], v[136:139], v[116:119], a[36:39]
 ds_read_b64_tr_b16 v[82:83], v40 offset:1024
 v_mfma_f32_16x16x32_bf16 a[40:43], v[136:139], v[120:123], a[40:43]
 v_mfma_f32_16x16x32_bf16 a[44:47], v[136:139], v[124:127], a[44:47]
 ds_read_b64_tr_b16 v[84:85], v41 offset:0
 v_mfma_f32_16x16x32_bf16 a[48:51], v[140:143], v[112:115], a[48:51]
 ds_read_b64_tr_b16 v[86:87], v41 offset:1024
 v_mfma_f32_16x16x32_bf16 a[52:55], v[140:143], v[116:119], a[52:55]
 v_mfma_f32_16x16x32_bf16 a[56:59], v[140:143], v[120:123], a[56:59]
 ds_read_b64_tr_b16 v[88:89], v42 offset:0
 v_mfma_f32_16x16x32_bf16 a[60:63], v[140:143], v[124:127], a[60:63]
 ds_read_b64_tr_b16 v[90:91], v42 offset:1024
 v_mfma_f32_16x16x32_bf16 a[64:67], v[144:147], v[112:115], a[64:67]
 v_mfma_f32_16x16x32_bf16 a[68:71], v[144:147], v[116:119], a[68:71]
 ds_read_b64_tr_b16 v[92:93], v43 offset:0
 v_mfma_f32_16x16x32_bf16 a[72:75], v[144:147], v[120:123], a[72:75]
 v_mfma_f32_16x16x32_bf16 a[76:79], v[144:147], v[124:127], a[76:79]
 ds_read_b64_tr_b16 v[94:95], v43 offset:1024
 v_mfma_f32_16x16x32_bf16 a[80:83], v[148:151], v[112:115], a[80:83]
 ds_read_b64_tr_b16 v[96:97], v44 offset:0
 v_mfma_f32_16x16x32_bf16 a[84:87], v[148:151], v[116:119], a[84:87]
 v_mfma_f32_16x16x32_bf16 a[88:91], v[148:151], v[120:123], a[88:91]
 ds_read_b64_tr_b16 v[98:99], v44 offset:1024
 v_mfma_f32_16x16x32_bf16 a[92:95], v[148:151], v[124:127], a[92:95]
 ds_read_b64_tr_b16 v[100:101], v45 offset:0
 v_mfma_f32_16x16x32_bf16 a[96:99], v[152:155], v[112:115], a[96:99]
 v_mfma_f32_16x16x32_bf16 a[100:103], v[152:155], v[116:119], a[100:103]
 ds_read_b64_tr_b16 v[102:103], v45 offset:1024
 v_mfma_f32_16x16x32_bf16 a[104:107], v[152:155], v[120:123], a[104:107]
 v_mfma_f32_16x16x32_bf16 a[108:111], v[152:155], v[124:127], a[108:111]
 ds_read_b64_tr_b16 v[104:105], v46 offset:0
 v_mfma_f32_16x16x32_bf16 a[112:115], v[156:159], v[112:115], a[112:115]
 ds_read_b64_tr_b16 v[106:107], v46 offset:1024
 v_mfma_f32_16x16x32_bf16 a[116:119], v[156:159], v[116:119], a[116:119]
 v_mfma_f32_16x16x32_bf16 a[120:123], v[156:159], v[120:123], a[120:123]
 ds_read_b64_tr_b16 v[108:109], v47 offset:0
 v_mfma_f32_16x16x32_bf16 a[124:127], v[156:159], v[124:127], a[124:127]
 ds_read_b64_tr_b16 v[110:111], v47 offset:1024
 s_waitcnt lgkmcnt(0)
 v_mfma_f32_16x16x32_bf16 a[0:3], v[80:83], v[64:67], a[0:3]
 v_mfma_f32_16x16x32_bf16 a[4:7], v[80:83], v[68:71], a[4:7]
 ds_read_b128 v[112:115], v19 offset:0
 v_mfma_f32_16x16x32_bf16 a[8:11], v[80:83], v[72:75], a[8:11]
 v_mfma_f32_16x16x32_bf16 a[12:15], v[80:83], v[76:79], a[12:15]
 ds_read_b128 v[116:119], v19 offset:2048
 v_mfma_f32_16x16x32_bf16 a[16:19], v[84:87], v[64:67], a[16:19]
 ds_read_b128 v[120:123], v19 offset:4096
 v_mfma_f32_16x16x32_bf16 a[20:23], v[84:87], v[68:71], a[20:23]
 v_mfma_f32_16x16x32_bf16 a[24:27], v[84:87], v[72:75], a[24:27]
 ds_read_b128 v[124:127], v19 offset:6144
 v_mfma_f32_16x16x32_bf16 a[28:31], v[84:87], v[76:79], a[28:31]
 ds_read_b64_tr_b16 v[128:129], v40 offset:8192
 v_mfma_f32_16x16x32_bf16 a[32:35], v[88:91], v[64:67], a[32:35]
 v_mfma_f32_16x16x32_bf16 a[36:39], v[88:91], v[68:71], a[36:39]
 ds_read_b64_tr_b16 v[130:131], v40 offset:9216
 v_mfma_f32_16x16x32_bf16 a[40:43], v[88:91], v[72:75], a[40:43]
 v_mfma_f32_16x16x32_bf16 a[44:47], v[88:91], v[76:79], a[44:47]
 ds_read_b64_tr_b16 v[132:133], v41 offset:8192
 v_mfma_f32_16x16x32_bf16 a[48:51], v[92:95], v[64:67], a[48:51]
 ds_read_b64_tr_b16 v[134:135], v41 offset:9216
 v_mfma_f32_16x16x32_bf16 a[52:55], v[92:95], v[68:71], a[52:55]
 v_mfma_f32_16x16x32_bf16 a[56:59], v[92:95], v[72:75], a[56:59]
 ds_read_b64_tr_b16 v[136:137], v42 offset:8192
 v_mfma_f32_16x16x32_bf16 a[60:63], v[92:95], v[76:79], a[60:63]
 ds_read_b64_tr_b16 v[138:139], v42 offset:9216
 v_mfma_f32_16x16x32_bf16 a[64:67], v[96:99], v[64:67], a[64:67]
 v_mfma_f32_16x16x32_bf16 a[68:71], v[96:99], v[68:71], a[68:71]
 ds_read_b64_tr_b16 v[140:141], v43 offset:8192
 v_mfma_f32_16x16x32_bf16 a[72:75], v[96:99], v[72:75], a[72:75]
 v_mfma_f32_16x16x32_bf16 a[76:79], v[96:99], v[76:79], a[76:79]
 ds_read_b64_tr_b16 v[142:143], v43 offset:9216
 v_mfma_f32_16x16x32_bf16 a[80:83], v[100:103], v[64:67], a[80:83]
 ds_read_b64_tr_b16 v[144:145], v44 offset:8192
 v_mfma_f32_16x16x32_bf16 a[84:87], v[100:103], v[68:71], a[84:87]
 v_mfma_f32_16x16x32_bf16 a[88:91], v[100:103], v[72:75], a[88:91]
 ds_read_b64_tr_b16 v[146:147], v44 offset:9216
 v_mfma_f32_16x16x32_bf16 a[92:95], v[100:103], v[76:79], a[92:95]
 ds_read_b64_tr_b16 v[148:149], v45 offset:8192
 v_mfma_f32_16x16x32_bf16 a[96:99], v[104:107], v[64:67], a[96:99]
 v_mfma_f32_16x16x32_bf16 a[100:103], v[104:107], v[68:71], a[100:103]
 ds_read_b64_tr_b16 v[150:151], v45 offset:9216
 v_mfma_f32_16x16x32_bf16 a[104:107], v[104:107], v[72:75], a[104:107]
 v_mfma_f32_16x16x32_bf16 a[108:111], v[104:107], v[76:79], a[108:111]
 ds_read_b64_tr_b16 v[152:153], v46 offset:8192
 v_mfma_f32_16x16x32_bf16 a[112:115], v[108:111], v[64:67], a[112:115]
 ds_read_b64_tr_b16 v[154:155], v46 offset:9216
 v_mfma_f32_16x16x32_bf16 a[116:119], v[108:111], v[68:71], a[116:119]
 v_mfma_f32_16x16x32_bf16 a[120:123], v[108:111], v[72:75], a[120:123]
 ds_read_b64_tr_b16 v[156:157], v47 offset:8192
 v_mfma_f32_16x16x32_bf16 a[124:127], v[108:111], v[76:79], a[124:127]
 ds_read_b64_tr_b16 v[158:159], v47 offset:9216
 s_waitcnt lgkmcnt(0)
 s_waitcnt vmcnt(0)
 s_barrier
 v_mfma_f32_16x16x32_bf16 a[0:3], v[128:131], v[112:115], a[0:3]
 v_mfma_f32_16x16x32_bf16 a[4:7], v[128:131], v[116:119], a[4:7]
 ds_read_b128 v[64:67], v20 offset:0
 v_mfma_f32_16x16x32_bf16 a[8:11], v[128:131], v[120:123], a[8:11]
 v_mfma_f32_16x16x32_bf16 a[12:15], v[128:131], v[124:127], a[12:15]
 ds_read_b128 v[68:71], v20 offset:2048
 v_mfma_f32_16x16x32_bf16 a[16:19], v[132:135], v[112:115], a[16:19]
 ds_read_b128 v[72:75], v20 offset:4096
 v_mfma_f32_16x16x32_bf16 a[20:23], v[132:135], v[116:119], a[20:23]
 v_mfma_f32_16x16x32_bf16 a[24:27], v[132:135], v[120:123], a[24:27]
 ds_read_b128 v[76:79], v20 offset:6144
 v_mfma_f32_16x16x32_bf16 a[28:31], v[132:135], v[124:127], a[28:31]
 ds_read_b64_tr_b16 v[80:81], v48 offset:0
 v_mfma_f32_16x16x32_bf16 a[32:35], v[136:139], v[112:115], a[32:35]
 v_mfma_f32_16x16x32_bf16 a[36:39], v[136:139], v[116:119], a[36:39]
 ds_read_b64_tr_b16 v[82:83], v48 offset:1024
 v_mfma_f32_16x16x32_bf16 a[40:43], v[136:139], v[120:123], a[40:43]
 v_mfma_f32_16x16x32_bf16 a[44:47], v[136:139], v[124:127], a[44:47]
 ds_read_b64_tr_b16 v[84:85], v49 offset:0
 v_mfma_f32_16x16x32_bf16 a[48:51], v[140:143], v[112:115], a[48:51]
 ds_read_b64_tr_b16 v[86:87], v49 offset:1024
 v_mfma_f32_16x16x32_bf16 a[52:55], v[140:143], v[116:119], a[52:55]
 v_mfma_f32_16x16x32_bf16 a[56:59], v[140:143], v[120:123], a[56:59]
 ds_read_b64_tr_b16 v[88:89], v50 offset:0
 v_mfma_f32_16x16x32_bf16 a[60:63], v[140:143], v[124:127], a[60:63]
 ds_read_b64_tr_b16 v[90:91], v50 offset:1024
 v_mfma_f32_16x16x32_bf16 a[64:67], v[144:147], v[112:115], a[64:67]
 v_mfma_f32_16x16x32_bf16 a[68:71], v[144:147], v[116:119], a[68:71]
 ds_read_b64_tr_b16 v[92:93], v51 offset:0
 v_mfma_f32_16x16x32_bf16 a[72:75], v[144:147], v[120:123], a[72:75]
 v_mfma_f32_16x16x32_bf16 a[76:79], v[144:147], v[124:127], a[76:79]
 ds_read_b64_tr_b16 v[94:95], v51 offset:1024
 v_mfma_f32_16x16x32_bf16 a[80:83], v[148:151], v[112:115], a[80:83]
 ds_read_b64_tr_b16 v[96:97], v52 offset:0
 v_mfma_f32_16x16x32_bf16 a[84:87], v[148:151], v[116:119], a[84:87]
 v_mfma_f32_16x16x32_bf16 a[88:91], v[148:151], v[120:123], a[88:91]
 ds_read_b64_tr_b16 v[98:99], v52 offset:1024
 v_mfma_f32_16x16x32_bf16 a[92:95], v[148:151], v[124:127], a[92:95]
 ds_read_b64_tr_b16 v[100:101], v53 offset:0
 v_mfma_f32_16x16x32_bf16 a[96:99], v[152:155], v[112:115], a[96:99]
 v_mfma_f32_16x16x32_bf16 a[100:103], v[152:155], v[116:119], a[100:103]
 ds_read_b64_tr_b16 v[102:103], v53 offset:1024
 v_mfma_f32_16x16x32_bf16 a[104:107], v[152:155], v[120:123], a[104:107]
 v_mfma_f32_16x16x32_bf16 a[108:111], v[152:155], v[124:127], a[108:111]
 ds_read_b64_tr_b16 v[104:105], v54 offset:0
 v_mfma_f32_16x16x32_bf16 a[112:115], v[156:159], v[112:115], a[112:115]
 ds_read_b64_tr_b16 v[106:107], v54 offset:1024
 v_mfma_f32_16x16x32_bf16 a[116:119], v[156:159], v[116:119], a[116:119]
 v_mfma_f32_16x16x32_bf16 a[120:123], v[156:159], v[120:123], a[120:123]
 ds_read_b64_tr_b16 v[108:109], v55 offset:0
 v_mfma_f32_16x16x32_bf16 a[124:127], v[156:159], v[124:127], a[124:127]
 ds_read_b64_tr_b16 v[110:111], v55 offset:1024
 s_waitcnt lgkmcnt(0)
 v_mfma_f32_16x16x32_bf16 a[0:3], v[80:83], v[64:67], a[0:3]
 v_mfma_f32_16x16x32_bf16 a[4:7], v[80:83], v[68:71], a[4:7]
 ds_read_b128 v[112:115], v21 offset:0
 v_mfma_f32_16x16x32_bf16 a[8:11], v[80:83], v[72:75], a[8:11]
 v_mfma_f32_16x16x32_bf16 a[12:15], v[80:83], v[76:79], a[12:15]
 ds_read_b128 v[116:119], v21 offset:2048
 v_mfma_f32_16x16x32_bf16 a[16:19], v[84:87], v[64:67], a[16:19]
 ds_read_b128 v[120:123], v21 offset:4096
 v_mfma_f32_16x16x32_bf16 a[20:23], v[84:87], v[68:71], a[20:23]
 v_mfma_f32_16x16x32_bf16 a[24:27], v[84:87], v[72:75], a[24:27]
 ds_read_b128 v[124:127], v21 offset:6144
 v_mfma_f32_16x16x32_bf16 a[28:31], v[84:87], v[76:79], a[28:31]
 ds_read_b64_tr_b16 v[128:129], v48 offset:8192
 v_mfma_f32_16x16x32_bf16 a[32:35], v[88:91], v[64:67], a[32:35]
 v_mfma_f32_16x16x32_bf16 a[36:39], v[88:91], v[68:71], a[36:39]
 ds_read_b64_tr_b16 v[130:131], v48 offset:9216
 v_mfma_f32_16x16x32_bf16 a[40:43], v[88:91], v[72:75], a[40:43]
 v_mfma_f32_16x16x32_bf16 a[44:47], v[88:91], v[76:79], a[44:47]
 ds_read_b64_tr_b16 v[132:133], v49 offset:8192
 v_mfma_f32_16x16x32_bf16 a[48:51], v[92:95], v[64:67], a[48:51]
 ds_read_b64_tr_b16 v[134:135], v49 offset:9216
 v_mfma_f32_16x16x32_bf16 a[52:55], v[92:95], v[68:71], a[52:55]
 v_mfma_f32_16x16x32_bf16 a[56:59], v[92:95], v[72:75], a[56:59]
 ds_read_b64_tr_b16 v[136:137], v50 offset:8192
 v_mfma_f32_16x16x32_bf16 a[60:63], v[92:95], v[76:79], a[60:63]
 ds_read_b64_tr_b16 v[138:139], v50 offset:9216
 v_mfma_f32_16x16x32_bf16 a[64:67], v[96:99], v[64:67], a[64:67]
 v_mfma_f32_16x16x32_bf16 a[68:71], v[96:99], v[68:71], a[68:71]
 ds_read_b64_tr_b16 v[140:141], v51 offset:8192
 v_mfma_f32_16x16x32_bf16 a[72:75], v[96:99], v[72:75], a[72:75]
 v_mfma_f32_16x16x32_bf16 a[76:79], v[96:99], v[76:79], a[76:79]
 ds_read_b64_tr_b16 v[142:143], v51 offset:9216
 v_mfma_f32_16x16x32_bf16 a[80:83], v[100:103], v[64:67], a[80:83]
 ds_read_b64_tr_b16 v[144:145], v52 offset:8192
 v_mfma_f32_16x16x32_bf16 a[84:87], v[100:103], v[68:71], a[84:87]
 v_mfma_f32_16x16x32_bf16 a[88:91], v[100:103], v[72:75], a[88:91]
 ds_read_b64_tr_b16 v[146:147], v52 offset:9216
 v_mfma_f32_16x16x32_bf16 a[92:95], v[100:103], v[76:79], a[92:95]
 ds_read_b64_tr_b16 v[148:149], v53 offset:8192
 v_mfma_f32_16x16x32_bf16 a[96:99], v[104:107], v[64:67], a[96:99]
 v_mfma_f32_16x16x32_bf16 a[100:103], v[104:107], v[68:71], a[100:103]
 ds_read_b64_tr_b16 v[150:151], v53 offset:9216
 v_mfma_f32_16x16x32_bf16 a[104:107], v[104:107], v[72:75], a[104:107]
 v_mfma_f32_16x16x32_bf16 a[108:111], v[104:107], v[76:79], a[108:111]
 ds_read_b64_tr_b16 v[152:153], v54 offset:8192
 v_mfma_f32_16x16x32_bf16 a[112:115], v[108:111], v[64:67], a[112:115]
 ds_read_b64_tr_b16 v[154:155], v54 offset:9216
 v_mfma_f32_16x16x32_bf16 a[116:119], v[108:111], v[68:71], a[116:119]
 v_mfma_f32_16x16x32_bf16 a[120:123], v[108:111], v[72:75], a[120:123]
 ds_read_b64_tr_b16 v[156:157], v55 offset:8192
 v_mfma_f32_16x16x32_bf16 a[124:127], v[108:111], v[76:79], a[124:127]
 ds_read_b64_tr_b16 v[158:159], v55 offset:9216
 s_waitcnt lgkmcnt(0)
 v_mfma_f32_16x16x32_bf16 a[0:3], v[128:131], v[112:115], a[0:3]
 v_mfma_f32_16x16x32_bf16 a[4:7], v[128:131], v[116:119], a[4:7]
 v_mfma_f32_16x16x32_bf16 a[8:11], v[128:131], v[120:123], a[8:11]
 v_mfma_f32_16x16x32_bf16 a[12:15], v[128:131], v[124:127], a[12:15]
 v_mfma_f32_16x16x32_bf16 a[16:19], v[132:135], v[112:115], a[16:19]
 v_mfma_f32_16x16x32_bf16 a[20:23], v[132:135], v[116:119], a[20:23]
 v_mfma_f32_16x16x32_bf16 a[24:27], v[132:135], v[120:123], a[24:27]
 v_mfma_f32_16x16x32_bf16 a[28:31], v[132:135], v[124:127], a[28:31]
 v_mfma_f32_16x16x32_bf16 a[32:35], v[136:139], v[112:115], a[32:35]
 v_mfma_f32_16x16x32_bf16 a[36:39], v[136:139], v[116:119], a[36:39]
 v_mfma_f32_16x16x32_bf16 a[40:43], v[136:139], v[120:123], a[40:43]
 v_mfma_f32_16x16x32_bf16 a[44:47], v[136:139], v[124:127], a[44:47]
 v_mfma_f32_16x16x32_bf16 a[48:51], v[140:143], v[112:115], a[48:51]
 v_mfma_f32_16x16x32_bf16 a[52:55], v[140:143], v[116:119], a[52:55]
 v_mfma_f32_16x16x32_bf16 a[56:59], v[140:143], v[120:123], a[56:59]
 v_mfma_f32_16x16x32_bf16 a[60:63], v[140:143], v[124:127], a[60:63]
 v_mfma_f32_16x16x32_bf16 a[64:67], v[144:147], v[112:115], a[64:67]
 v_mfma_f32_16x16x32_bf16 a[68:71], v[144:147], v[116:119], a[68:71]
 v_mfma_f32_16x16x32_bf16 a[72:75], v[144:147], v[120:123], a[72:75]
 v_mfma_f32_16x16x32_bf16 a[76:79], v[144:147], v[124:127], a[76:79]
 v_mfma_f32_16x16x32_bf16 a[80:83], v[148:151], v[112:115], a[80:83]
 v_mfma_f32_16x16x32_bf16 a[84:87], v[148:151], v[116:119], a[84:87]
 v_mfma_f32_16x16x32_bf16 a[88:91], v[148:151], v[120:123], a[88:91]
 v_mfma_f32_16x16x32_bf16 a[92:95], v[148:151], v[124:127], a[92:95]
 v_mfma_f32_16x16x32_bf16 a[96:99], v[152:155], v[112:115], a[96:99]
 v_mfma_f32_16x16x32_bf16 a[100:103], v[152:155], v[116:119], a[100:103]
 v_mfma_f32_16x16x32_bf16 a[104:107], v[152:155], v[120:123], a[104:107]
 v_mfma_f32_16x16x32_bf16 a[108:111], v[152:155], v[124:127], a[108:111]
 v_mfma_f32_16x16x32_bf16 a[112:115], v[156:159], v[112:115], a[112:115]
 v_mfma_f32_16x16x32_bf16 a[116:119], v[156:159], v[116:119], a[116:119]
 v_mfma_f32_16x16x32_bf16 a[120:123], v[156:159], v[120:123], a[120:123]
 v_mfma_f32_16x16x32_bf16 a[124:127], v[156:159], v[124:127], a[124:127]
 s_nop 7
 s_nop 7
 s_lshr_b32 s58, s54, 1
 s_lshl_b32 s58, s58, 6
 s_lshl_b32 s59, s45, 7
 s_add_u32 s58, s58, s59
 v_add_u32 v5, s58, v4
 s_movk_i32 s59, 24576
 v_mul_lo_u32 v5, v5, s59
 v_lshl_add_u32 v5, v3, 3, v5
 s_and_b32 s58, s54, 1
 s_lshl_b32 s58, s58, 8
 s_add_u32 s50, s50, s58
 s_add_u32 s58, s50, 0
 v_accvgpr_read_b32 v64, a0
 v_accvgpr_read_b32 v65, a1
 v_accvgpr_read_b32 v66, a2
 v_accvgpr_read_b32 v67, a3
 v_cvt_pk_bf16_f32 v68, v64, v65
 v_cvt_pk_bf16_f32 v69, v66, v67
 buffer_store_dwordx2 v[68:69], v5, s[24:27], s58 offen offset:0 sc1
 v_accvgpr_read_b32 v96, a16
 v_accvgpr_read_b32 v97, a17
 v_accvgpr_read_b32 v98, a18
 v_accvgpr_read_b32 v99, a19
 v_cvt_pk_bf16_f32 v100, v96, v97
 v_cvt_pk_bf16_f32 v101, v98, v99
 buffer_store_dwordx2 v[100:101], v5, s[24:27], s58 offen offset:32 sc1
 v_accvgpr_read_b32 v64, a32
 v_accvgpr_read_b32 v65, a33
 v_accvgpr_read_b32 v66, a34
 v_accvgpr_read_b32 v67, a35
 v_cvt_pk_bf16_f32 v68, v64, v65
 v_cvt_pk_bf16_f32 v69, v66, v67
 buffer_store_dwordx2 v[68:69], v5, s[24:27], s58 offen offset:64 sc1
 v_accvgpr_read_b32 v96, a48
 v_accvgpr_read_b32 v97, a49
 v_accvgpr_read_b32 v98, a50
 v_accvgpr_read_b32 v99, a51
 v_cvt_pk_bf16_f32 v100, v96, v97
 v_cvt_pk_bf16_f32 v101, v98, v99
 buffer_store_dwordx2 v[100:101], v5, s[24:27], s58 offen offset:96 sc1
 v_accvgpr_read_b32 v64, a64
 v_accvgpr_read_b32 v65, a65
 v_accvgpr_read_b32 v66, a66
 v_accvgpr_read_b32 v67, a67
 v_cvt_pk_bf16_f32 v68, v64, v65
 v_cvt_pk_bf16_f32 v69, v66, v67
 buffer_store_dwordx2 v[68:69], v5, s[24:27], s58 offen offset:128 sc1
 v_accvgpr_read_b32 v96, a80
 v_accvgpr_read_b32 v97, a81
 v_accvgpr_read_b32 v98, a82
 v_accvgpr_read_b32 v99, a83
 v_cvt_pk_bf16_f32 v100, v96, v97
 v_cvt_pk_bf16_f32 v101, v98, v99
 buffer_store_dwordx2 v[100:101], v5, s[24:27], s58 offen offset:160 sc1
 v_accvgpr_read_b32 v64, a96
 v_accvgpr_read_b32 v65, a97
 v_accvgpr_read_b32 v66, a98
 v_accvgpr_read_b32 v67, a99
 v_cvt_pk_bf16_f32 v68, v64, v65
 v_cvt_pk_bf16_f32 v69, v66, v67
 buffer_store_dwordx2 v[68:69], v5, s[24:27], s58 offen offset:192 sc1
 v_accvgpr_read_b32 v96, a112
 v_accvgpr_read_b32 v97, a113
 v_accvgpr_read_b32 v98, a114
 v_accvgpr_read_b32 v99, a115
 v_cvt_pk_bf16_f32 v100, v96, v97
 v_cvt_pk_bf16_f32 v101, v98, v99
 buffer_store_dwordx2 v[100:101], v5, s[24:27], s58 offen offset:224 sc1
 s_add_u32 s58, s50, 393216
 v_accvgpr_read_b32 v72, a4
 v_accvgpr_read_b32 v73, a5
 v_accvgpr_read_b32 v74, a6
 v_accvgpr_read_b32 v75, a7
 v_cvt_pk_bf16_f32 v76, v72, v73
 v_cvt_pk_bf16_f32 v77, v74, v75
 buffer_store_dwordx2 v[76:77], v5, s[24:27], s58 offen offset:0 sc1
 v_accvgpr_read_b32 v104, a20
 v_accvgpr_read_b32 v105, a21
 v_accvgpr_read_b32 v106, a22
 v_accvgpr_read_b32 v107, a23
 v_cvt_pk_bf16_f32 v108, v104, v105
 v_cvt_pk_bf16_f32 v109, v106, v107
 buffer_store_dwordx2 v[108:109], v5, s[24:27], s58 offen offset:32 sc1
 v_accvgpr_read_b32 v72, a36
 v_accvgpr_read_b32 v73, a37
 v_accvgpr_read_b32 v74, a38
 v_accvgpr_read_b32 v75, a39
 v_cvt_pk_bf16_f32 v76, v72, v73
 v_cvt_pk_bf16_f32 v77, v74, v75
 buffer_store_dwordx2 v[76:77], v5, s[24:27], s58 offen offset:64 sc1
 v_accvgpr_read_b32 v104, a52
 v_accvgpr_read_b32 v105, a53
 v_accvgpr_read_b32 v106, a54
 v_accvgpr_read_b32 v107, a55
 v_cvt_pk_bf16_f32 v108, v104, v105
 v_cvt_pk_bf16_f32 v109, v106, v107
 buffer_store_dwordx2 v[108:109], v5, s[24:27], s58 offen offset:96 sc1
 v_accvgpr_read_b32 v72, a68
 v_accvgpr_read_b32 v73, a69
 v_accvgpr_read_b32 v74, a70
 v_accvgpr_read_b32 v75, a71
 v_cvt_pk_bf16_f32 v76, v72, v73
 v_cvt_pk_bf16_f32 v77, v74, v75
 buffer_store_dwordx2 v[76:77], v5, s[24:27], s58 offen offset:128 sc1
 v_accvgpr_read_b32 v104, a84
 v_accvgpr_read_b32 v105, a85
 v_accvgpr_read_b32 v106, a86
 v_accvgpr_read_b32 v107, a87
 v_cvt_pk_bf16_f32 v108, v104, v105
 v_cvt_pk_bf16_f32 v109, v106, v107
 buffer_store_dwordx2 v[108:109], v5, s[24:27], s58 offen offset:160 sc1
 v_accvgpr_read_b32 v72, a100
 v_accvgpr_read_b32 v73, a101
 v_accvgpr_read_b32 v74, a102
 v_accvgpr_read_b32 v75, a103
 v_cvt_pk_bf16_f32 v76, v72, v73
 v_cvt_pk_bf16_f32 v77, v74, v75
 buffer_store_dwordx2 v[76:77], v5, s[24:27], s58 offen offset:192 sc1
 v_accvgpr_read_b32 v104, a116
 v_accvgpr_read_b32 v105, a117
 v_accvgpr_read_b32 v106, a118
 v_accvgpr_read_b32 v107, a119
 v_cvt_pk_bf16_f32 v108, v104, v105
 v_cvt_pk_bf16_f32 v109, v106, v107
 buffer_store_dwordx2 v[108:109], v5, s[24:27], s58 offen offset:224 sc1
 s_add_u32 s58, s50, 786432
 v_accvgpr_read_b32 v80, a8
 v_accvgpr_read_b32 v81, a9
 v_accvgpr_read_b32 v82, a10
 v_accvgpr_read_b32 v83, a11
 v_cvt_pk_bf16_f32 v84, v80, v81
 v_cvt_pk_bf16_f32 v85, v82, v83
 buffer_store_dwordx2 v[84:85], v5, s[24:27], s58 offen offset:0 sc1
 v_accvgpr_read_b32 v112, a24
 v_accvgpr_read_b32 v113, a25
 v_accvgpr_read_b32 v114, a26
 v_accvgpr_read_b32 v115, a27
 v_cvt_pk_bf16_f32 v116, v112, v113
 v_cvt_pk_bf16_f32 v117, v114, v115
 buffer_store_dwordx2 v[116:117], v5, s[24:27], s58 offen offset:32 sc1
 v_accvgpr_read_b32 v80, a40
 v_accvgpr_read_b32 v81, a41
 v_accvgpr_read_b32 v82, a42
 v_accvgpr_read_b32 v83, a43
 v_cvt_pk_bf16_f32 v84, v80, v81
 v_cvt_pk_bf16_f32 v85, v82, v83
 buffer_store_dwordx2 v[84:85], v5, s[24:27], s58 offen offset:64 sc1
 v_accvgpr_read_b32 v112, a56
 v_accvgpr_read_b32 v113, a57
 v_accvgpr_read_b32 v114, a58
 v_accvgpr_read_b32 v115, a59
 v_cvt_pk_bf16_f32 v116, v112, v113
 v_cvt_pk_bf16_f32 v117, v114, v115
 buffer_store_dwordx2 v[116:117], v5, s[24:27], s58 offen offset:96 sc1
 v_accvgpr_read_b32 v80, a72
 v_accvgpr_read_b32 v81, a73
 v_accvgpr_read_b32 v82, a74
 v_accvgpr_read_b32 v83, a75
 v_cvt_pk_bf16_f32 v84, v80, v81
 v_cvt_pk_bf16_f32 v85, v82, v83
 buffer_store_dwordx2 v[84:85], v5, s[24:27], s58 offen offset:128 sc1
 v_accvgpr_read_b32 v112, a88
 v_accvgpr_read_b32 v113, a89
 v_accvgpr_read_b32 v114, a90
 v_accvgpr_read_b32 v115, a91
 v_cvt_pk_bf16_f32 v116, v112, v113
 v_cvt_pk_bf16_f32 v117, v114, v115
 buffer_store_dwordx2 v[116:117], v5, s[24:27], s58 offen offset:160 sc1
 v_accvgpr_read_b32 v80, a104
 v_accvgpr_read_b32 v81, a105
 v_accvgpr_read_b32 v82, a106
 v_accvgpr_read_b32 v83, a107
 v_cvt_pk_bf16_f32 v84, v80, v81
 v_cvt_pk_bf16_f32 v85, v82, v83
 buffer_store_dwordx2 v[84:85], v5, s[24:27], s58 offen offset:192 sc1
 v_accvgpr_read_b32 v112, a120
 v_accvgpr_read_b32 v113, a121
 v_accvgpr_read_b32 v114, a122
 v_accvgpr_read_b32 v115, a123
 v_cvt_pk_bf16_f32 v116, v112, v113
 v_cvt_pk_bf16_f32 v117, v114, v115
 buffer_store_dwordx2 v[116:117], v5, s[24:27], s58 offen offset:224 sc1
 s_add_u32 s58, s50, 1179648
 v_accvgpr_read_b32 v88, a12
 v_accvgpr_read_b32 v89, a13
 v_accvgpr_read_b32 v90, a14
 v_accvgpr_read_b32 v91, a15
 v_cvt_pk_bf16_f32 v92, v88, v89
 v_cvt_pk_bf16_f32 v93, v90, v91
 buffer_store_dwordx2 v[92:93], v5, s[24:27], s58 offen offset:0 sc1
 v_accvgpr_read_b32 v120, a28
 v_accvgpr_read_b32 v121, a29
 v_accvgpr_read_b32 v122, a30
 v_accvgpr_read_b32 v123, a31
 v_cvt_pk_bf16_f32 v124, v120, v121
 v_cvt_pk_bf16_f32 v125, v122, v123
 buffer_store_dwordx2 v[124:125], v5, s[24:27], s58 offen offset:32 sc1
 v_accvgpr_read_b32 v88, a44
 v_accvgpr_read_b32 v89, a45
 v_accvgpr_read_b32 v90, a46
 v_accvgpr_read_b32 v91, a47
 v_cvt_pk_bf16_f32 v92, v88, v89
 v_cvt_pk_bf16_f32 v93, v90, v91
 buffer_store_dwordx2 v[92:93], v5, s[24:27], s58 offen offset:64 sc1
 v_accvgpr_read_b32 v120, a60
 v_accvgpr_read_b32 v121, a61
 v_accvgpr_read_b32 v122, a62
 v_accvgpr_read_b32 v123, a63
 v_cvt_pk_bf16_f32 v124, v120, v121
 v_cvt_pk_bf16_f32 v125, v122, v123
 buffer_store_dwordx2 v[124:125], v5, s[24:27], s58 offen offset:96 sc1
 v_accvgpr_read_b32 v88, a76
 v_accvgpr_read_b32 v89, a77
 v_accvgpr_read_b32 v90, a78
 v_accvgpr_read_b32 v91, a79
 v_cvt_pk_bf16_f32 v92, v88, v89
 v_cvt_pk_bf16_f32 v93, v90, v91
 buffer_store_dwordx2 v[92:93], v5, s[24:27], s58 offen offset:128 sc1
 v_accvgpr_read_b32 v120, a92
 v_accvgpr_read_b32 v121, a93
 v_accvgpr_read_b32 v122, a94
 v_accvgpr_read_b32 v123, a95
 v_cvt_pk_bf16_f32 v124, v120, v121
 v_cvt_pk_bf16_f32 v125, v122, v123
 buffer_store_dwordx2 v[124:125], v5, s[24:27], s58 offen offset:160 sc1
 v_accvgpr_read_b32 v88, a108
 v_accvgpr_read_b32 v89, a109
 v_accvgpr_read_b32 v90, a110
 v_accvgpr_read_b32 v91, a111
 v_cvt_pk_bf16_f32 v92, v88, v89
 v_cvt_pk_bf16_f32 v93, v90, v91
 buffer_store_dwordx2 v[92:93], v5, s[24:27], s58 offen offset:192 sc1
 v_accvgpr_read_b32 v120, a124
 v_accvgpr_read_b32 v121, a125
 v_accvgpr_read_b32 v122, a126
 v_accvgpr_read_b32 v123, a127
 v_cvt_pk_bf16_f32 v124, v120, v121
 v_cvt_pk_bf16_f32 v125, v122, v123
 buffer_store_dwordx2 v[124:125], v5, s[24:27], s58 offen offset:224 sc1
 s_branch mega_kernel_sig91
mega_kernel_bup93:
 s_load_dwordx2 s[8:9], s[0:1], 120
 s_load_dwordx4 s[4:7], s[0:1], 64
 s_mov_b32 s43, 119304648
 s_mul_hi_u32 s45, s2, s43
 s_mul_i32 s44, s45, 36
 s_sub_u32 s44, s2, s44
 s_mov_b32 s46, 0
 s_waitcnt lgkmcnt(0)
 s_add_u32 s12, s8, 92274688
 s_addc_u32 s13, s9, 0
 s_and_b32 s13, s13, 0xffff
 s_mov_b32 s14, 2359296
 s_mov_b32 s15, 0x00020000
 s_mov_b32 s16, s4
 s_and_b32 s17, s5, 0xffff
 s_mov_b32 s18, 5308416
 s_mov_b32 s19, 0x00020000
 s_mov_b32 s20, s6
 s_and_b32 s21, s7, 0xffff
 s_mov_b32 s22, 5308416
 s_mov_b32 s23, 0x00020000
 s_add_u32 s24, s8, 96468992
 s_addc_u32 s25, s9, 0
 s_and_b32 s25, s25, 0xffff
 s_mov_b32 s26, 18874368
 s_mov_b32 s27, 0x00020000
 s_lshl_b32 s48, s44, 8
 s_mov_b32 s49, s48
 s_mov_b32 s50, s48
 s_mul_i32 s51, s46, 1152
 s_mul_i32 s52, s46, 5308416
 s_mul_i32 s53, s45, 147456
 s_add_u32 s53, s53, s51
 s_add_u32 s48, s48, s52
 s_add_u32 s49, s49, s52
 v_and_b32 v1, 63, v0
 v_lshrrev_b32 v2, 6, v0
 s_nop 0
 v_readfirstlane_b32 s54, v2
 v_lshrrev_b32 v3, 4, v1
 v_and_b32 v4, 15, v1
 v_lshrrev_b32 v5, 3, v1
 s_movk_i32 s55, 1152
 v_mul_lo_u32 v5, v5, s55
 v_and_b32 v6, 7, v1
 v_add_u32 v7, 0, v3
 v_and_b32 v7, 7, v7
 v_xor_b32 v7, v7, v6
 v_lshl_add_u32 v8, v7, 4, v5
 v_add_u32 v7, 4, v3
 v_and_b32 v7, 7, v7
 v_xor_b32 v7, v7, v6
 v_lshl_add_u32 v9, v7, 4, v5
 s_mul_i32 s56, s54, 36864
 s_add_u32 s53, s53, s56
 s_mov_b32 s57, 9216
 v_mul_lo_u32 v5, v3, s57
 v_lshrrev_b32 v6, 1, v4
 v_or_b32 v7, 0, v3
 v_xor_b32 v7, v7, v6
 v_lshlrev_b32 v7, 1, v7
 v_and_b32 v12, 1, v1
 v_or_b32 v7, v7, v12
 v_lshl_add_u32 v10, v7, 4, v5
 v_or_b32 v7, 4, v3
 v_xor_b32 v7, v7, v6
 v_lshlrev_b32 v7, 1, v7
 v_and_b32 v12, 1, v1
 v_or_b32 v7, v7, v12
 v_lshl_add_u32 v11, v7, 4, v5
 s_lshr_b32 s58, s54, 1
 s_and_b32 s59, s54, 1
 s_cmp_eq_u32 s58, 1
 s_cselect_b32 s28, s20, s16
 s_cselect_b32 s29, s21, s17
 s_mov_b32 s30, s18
 s_mov_b32 s31, s19
 s_cselect_b32 s60, s49, s48
 s_mul_i32 s61, s59, 294912
 s_add_u32 s60, s60, s61
 s_lshl_b32 s61, s58, 14
 s_lshl_b32 s62, s59, 13
 s_add_u32 s61, s61, s62
 s_add_u32 s61, s61, 16384
 s_lshl_b32 s62, s54, 12
 v_lshrrev_b32 v5, 1, v4
 s_lshr_b32 s58, s54, 1
 s_mul_i32 s58, s58, 8192
 v_lshl_add_u32 v6, v4, 7, s58
 v_add_u32 v7, 0, v3
 v_xor_b32 v7, v7, v5
 v_lshl_add_u32 v7, v7, 4, v6
 v_add_u32 v16, 0, v7
 v_add_u32 v18, 49152, v7
 v_add_u32 v20, 98304, v7
 v_add_u32 v7, 4, v3
 v_xor_b32 v7, v7, v5
 v_lshl_add_u32 v7, v7, 4, v6
 v_add_u32 v17, 0, v7
 v_add_u32 v19, 49152, v7
 v_add_u32 v21, 98304, v7
 v_lshrrev_b32 v5, 2, v4
 v_lshl_add_u32 v6, v3, 3, v5
 v_lshlrev_b32 v6, 8, v6
 v_and_b32 v7, 3, v1
 v_lshl_add_u32 v6, v7, 3, v6
 v_and_b32 v7, 1, v3
 v_lshl_or_b32 v5, v7, 2, v5
 s_and_b32 s58, s54, 1
 s_lshl_b32 s58, s58, 2
 v_add_u32 v6, 16384, v6
 s_add_u32 s59, s58, 0
 v_xor_b32 v7, s59, v5
 v_lshl_add_u32 v7, v7, 5, v6
 v_add_u32 v32, 0, v7
 v_add_u32 v36, 16384, v7
 v_add_u32 v40, 49152, v7
 v_add_u32 v44, 65536, v7
 v_add_u32 v48, 98304, v7
 v_add_u32 v52, 114688, v7
 s_add_u32 s59, s58, 1
 v_xor_b32 v7, s59, v5
 v_lshl_add_u32 v7, v7, 5, v6
 v_add_u32 v33, 0, v7
 v_add_u32 v37, 16384, v7
 v_add_u32 v41, 49152, v7
 v_add_u32 v45, 65536, v7
 v_add_u32 v49, 98304, v7
 v_add_u32 v53, 114688, v7
 s_add_u32 s59, s58, 2
 v_xor_b32 v7, s59, v5
 v_lshl_add_u32 v7, v7, 5, v6
 v_add_u32 v34, 0, v7
 v_add_u32 v38, 16384, v7
 v_add_u32 v42, 49152, v7
 v_add_u32 v46, 65536, v7
 v_add_u32 v50, 98304, v7
 v_add_u32 v54, 114688, v7
 s_add_u32 s59, s58, 3
 v_xor_b32 v7, s59, v5
 v_lshl_add_u32 v7, v7, 5, v6
 v_add_u32 v35, 0, v7
 v_add_u32 v39, 16384, v7
 v_add_u32 v43, 49152, v7
 v_add_u32 v47, 65536, v7
 v_add_u32 v51, 98304, v7
 v_add_u32 v55, 114688, v7
 v_accvgpr_write_b32 a0, 0
 v_accvgpr_write_b32 a1, 0
 v_accvgpr_write_b32 a2, 0
 v_accvgpr_write_b32 a3, 0
 v_accvgpr_write_b32 a4, 0
 v_accvgpr_write_b32 a5, 0
 v_accvgpr_write_b32 a6, 0
 v_accvgpr_write_b32 a7, 0
 v_accvgpr_write_b32 a8, 0
 v_accvgpr_write_b32 a9, 0
 v_accvgpr_write_b32 a10, 0
 v_accvgpr_write_b32 a11, 0
 v_accvgpr_write_b32 a12, 0
 v_accvgpr_write_b32 a13, 0
 v_accvgpr_write_b32 a14, 0
 v_accvgpr_write_b32 a15, 0
 v_accvgpr_write_b32 a16, 0
 v_accvgpr_write_b32 a17, 0
 v_accvgpr_write_b32 a18, 0
 v_accvgpr_write_b32 a19, 0
 v_accvgpr_write_b32 a20, 0
 v_accvgpr_write_b32 a21, 0
 v_accvgpr_write_b32 a22, 0
 v_accvgpr_write_b32 a23, 0
 v_accvgpr_write_b32 a24, 0
 v_accvgpr_write_b32 a25, 0
 v_accvgpr_write_b32 a26, 0
 v_accvgpr_write_b32 a27, 0
 v_accvgpr_write_b32 a28, 0
 v_accvgpr_write_b32 a29, 0
 v_accvgpr_write_b32 a30, 0
 v_accvgpr_write_b32 a31, 0
 v_accvgpr_write_b32 a32, 0
 v_accvgpr_write_b32 a33, 0
 v_accvgpr_write_b32 a34, 0
 v_accvgpr_write_b32 a35, 0
 v_accvgpr_write_b32 a36, 0
 v_accvgpr_write_b32 a37, 0
 v_accvgpr_write_b32 a38, 0
 v_accvgpr_write_b32 a39, 0
 v_accvgpr_write_b32 a40, 0
 v_accvgpr_write_b32 a41, 0
 v_accvgpr_write_b32 a42, 0
 v_accvgpr_write_b32 a43, 0
 v_accvgpr_write_b32 a44, 0
 v_accvgpr_write_b32 a45, 0
 v_accvgpr_write_b32 a46, 0
 v_accvgpr_write_b32 a47, 0
 v_accvgpr_write_b32 a48, 0
 v_accvgpr_write_b32 a49, 0
 v_accvgpr_write_b32 a50, 0
 v_accvgpr_write_b32 a51, 0
 v_accvgpr_write_b32 a52, 0
 v_accvgpr_write_b32 a53, 0
 v_accvgpr_write_b32 a54, 0
 v_accvgpr_write_b32 a55, 0
 v_accvgpr_write_b32 a56, 0
 v_accvgpr_write_b32 a57, 0
 v_accvgpr_write_b32 a58, 0
 v_accvgpr_write_b32 a59, 0
 v_accvgpr_write_b32 a60, 0
 v_accvgpr_write_b32 a61, 0
 v_accvgpr_write_b32 a62, 0
 v_accvgpr_write_b32 a63, 0
 v_accvgpr_write_b32 a64, 0
 v_accvgpr_write_b32 a65, 0
 v_accvgpr_write_b32 a66, 0
 v_accvgpr_write_b32 a67, 0
 v_accvgpr_write_b32 a68, 0
 v_accvgpr_write_b32 a69, 0
 v_accvgpr_write_b32 a70, 0
 v_accvgpr_write_b32 a71, 0
 v_accvgpr_write_b32 a72, 0
 v_accvgpr_write_b32 a73, 0
 v_accvgpr_write_b32 a74, 0
 v_accvgpr_write_b32 a75, 0
 v_accvgpr_write_b32 a76, 0
 v_accvgpr_write_b32 a77, 0
 v_accvgpr_write_b32 a78, 0
 v_accvgpr_write_b32 a79, 0
 v_accvgpr_write_b32 a80, 0
 v_accvgpr_write_b32 a81, 0
 v_accvgpr_write_b32 a82, 0
 v_accvgpr_write_b32 a83, 0
 v_accvgpr_write_b32 a84, 0
 v_accvgpr_write_b32 a85, 0
 v_accvgpr_write_b32 a86, 0
 v_accvgpr_write_b32 a87, 0
 v_accvgpr_write_b32 a88, 0
 v_accvgpr_write_b32 a89, 0
 v_accvgpr_write_b32 a90, 0
 v_accvgpr_write_b32 a91, 0
 v_accvgpr_write_b32 a92, 0
 v_accvgpr_write_b32 a93, 0
 v_accvgpr_write_b32 a94, 0
 v_accvgpr_write_b32 a95, 0
 v_accvgpr_write_b32 a96, 0
 v_accvgpr_write_b32 a97, 0
 v_accvgpr_write_b32 a98, 0
 v_accvgpr_write_b32 a99, 0
 v_accvgpr_write_b32 a100, 0
 v_accvgpr_write_b32 a101, 0
 v_accvgpr_write_b32 a102, 0
 v_accvgpr_write_b32 a103, 0
 v_accvgpr_write_b32 a104, 0
 v_accvgpr_write_b32 a105, 0
 v_accvgpr_write_b32 a106, 0
 v_accvgpr_write_b32 a107, 0
 v_accvgpr_write_b32 a108, 0
 v_accvgpr_write_b32 a109, 0
 v_accvgpr_write_b32 a110, 0
 v_accvgpr_write_b32 a111, 0
 v_accvgpr_write_b32 a112, 0
 v_accvgpr_write_b32 a113, 0
 v_accvgpr_write_b32 a114, 0
 v_accvgpr_write_b32 a115, 0
 v_accvgpr_write_b32 a116, 0
 v_accvgpr_write_b32 a117, 0
 v_accvgpr_write_b32 a118, 0
 v_accvgpr_write_b32 a119, 0
 v_accvgpr_write_b32 a120, 0
 v_accvgpr_write_b32 a121, 0
 v_accvgpr_write_b32 a122, 0
 v_accvgpr_write_b32 a123, 0
 v_accvgpr_write_b32 a124, 0
 v_accvgpr_write_b32 a125, 0
 v_accvgpr_write_b32 a126, 0
 v_accvgpr_write_b32 a127, 0
 s_add_u32 s63, s53, 0
 s_add_u32 m0, s62, 0
 s_nop 0
 buffer_load_dwordx4 v8, s[12:15], s63 offen lds
 s_add_u32 s63, s53, 9216
 s_add_u32 m0, s62, 1024
 s_nop 0
 buffer_load_dwordx4 v9, s[12:15], s63 offen lds
 s_add_u32 s63, s53, 18432
 s_add_u32 m0, s62, 2048
 s_nop 0
 buffer_load_dwordx4 v8, s[12:15], s63 offen lds
 s_add_u32 s63, s53, 27648
 s_add_u32 m0, s62, 3072
 s_nop 0
 buffer_load_dwordx4 v9, s[12:15], s63 offen lds
 s_add_u32 s63, s60, 0
 s_add_u32 m0, s61, 0
 s_nop 0
 buffer_load_dwordx4 v10, s[28:31], s63 offen lds
 s_add_u32 s63, s60, 36864
 s_add_u32 m0, s61, 1024
 s_nop 0
 buffer_load_dwordx4 v10, s[28:31], s63 offen lds
 s_add_u32 s63, s60, 73728
 s_add_u32 m0, s61, 2048
 s_nop 0
 buffer_load_dwordx4 v11, s[28:31], s63 offen lds
 s_add_u32 s63, s60, 110592
 s_add_u32 m0, s61, 3072
 s_nop 0
 buffer_load_dwordx4 v11, s[28:31], s63 offen lds
 s_add_u32 s63, s60, 147456
 s_add_u32 m0, s61, 4096
 s_nop 0
 buffer_load_dwordx4 v10, s[28:31], s63 offen lds
 s_add_u32 s63, s60, 184320
 s_add_u32 m0, s61, 5120
 s_nop 0
 buffer_load_dwordx4 v10, s[28:31], s63 offen lds
 s_add_u32 s63, s60, 221184
 s_add_u32 m0, s61, 6144
 s_nop 0
 buffer_load_dwordx4 v11, s[28:31], s63 offen lds
 s_add_u32 s63, s60, 258048
 s_add_u32 m0, s61, 7168
 s_nop 0
 buffer_load_dwordx4 v11, s[28:31], s63 offen lds
 s_add_u32 s63, s53, 128
 s_add_u32 m0, s62, 49152
 s_nop 0
 buffer_load_dwordx4 v8, s[12:15], s63 offen lds
 s_add_u32 s63, s53, 9344
 s_add_u32 m0, s62, 50176
 s_nop 0
 buffer_load_dwordx4 v9, s[12:15], s63 offen lds
 s_add_u32 s63, s53, 18560
 s_add_u32 m0, s62, 51200
 s_nop 0
 buffer_load_dwordx4 v8, s[12:15], s63 offen lds
 s_add_u32 s63, s53, 27776
 s_add_u32 m0, s62, 52224
 s_nop 0
 buffer_load_dwordx4 v9, s[12:15], s63 offen lds
 s_add_u32 s63, s60, 589824
 s_add_u32 m0, s61, 49152
 s_nop 0
 buffer_load_dwordx4 v10, s[28:31], s63 offen lds
 s_add_u32 s63, s60, 626688
 s_add_u32 m0, s61, 50176
 s_nop 0
 buffer_load_dwordx4 v10, s[28:31], s63 offen lds
 s_add_u32 s63, s60, 663552
 s_add_u32 m0, s61, 51200
 s_nop 0
 buffer_load_dwordx4 v11, s[28:31], s63 offen lds
 s_add_u32 s63, s60, 700416
 s_add_u32 m0, s61, 52224
 s_nop 0
 buffer_load_dwordx4 v11, s[28:31], s63 offen lds
 s_add_u32 s63, s60, 737280
 s_add_u32 m0, s61, 53248
 s_nop 0
 buffer_load_dwordx4 v10, s[28:31], s63 offen lds
 s_add_u32 s63, s60, 774144
 s_add_u32 m0, s61, 54272
 s_nop 0
 buffer_load_dwordx4 v10, s[28:31], s63 offen lds
 s_add_u32 s63, s60, 811008
 s_add_u32 m0, s61, 55296
 s_nop 0
 buffer_load_dwordx4 v11, s[28:31], s63 offen lds
 s_add_u32 s63, s60, 847872
 s_add_u32 m0, s61, 56320
 s_nop 0
 buffer_load_dwordx4 v11, s[28:31], s63 offen lds
 s_add_u32 s63, s53, 256
 s_add_u32 m0, s62, 98304
 s_nop 0
 buffer_load_dwordx4 v8, s[12:15], s63 offen lds
 s_add_u32 s63, s53, 9472
 s_add_u32 m0, s62, 99328
 s_nop 0
 buffer_load_dwordx4 v9, s[12:15], s63 offen lds
 s_add_u32 s63, s53, 18688
 s_add_u32 m0, s62, 100352
 s_nop 0
 buffer_load_dwordx4 v8, s[12:15], s63 offen lds
 s_add_u32 s63, s53, 27904
 s_add_u32 m0, s62, 101376
 s_nop 0
 buffer_load_dwordx4 v9, s[12:15], s63 offen lds
 s_add_u32 s63, s60, 1179648
 s_add_u32 m0, s61, 98304
 s_nop 0
 buffer_load_dwordx4 v10, s[28:31], s63 offen lds
 s_add_u32 s63, s60, 1216512
 s_add_u32 m0, s61, 99328
 s_nop 0
 buffer_load_dwordx4 v10, s[28:31], s63 offen lds
 s_add_u32 s63, s60, 1253376
 s_add_u32 m0, s61, 100352
 s_nop 0
 buffer_load_dwordx4 v11, s[28:31], s63 offen lds
 s_add_u32 s63, s60, 1290240
 s_add_u32 m0, s61, 101376
 s_nop 0
 buffer_load_dwordx4 v11, s[28:31], s63 offen lds
 s_add_u32 s63, s60, 1327104
 s_add_u32 m0, s61, 102400
 s_nop 0
 buffer_load_dwordx4 v10, s[28:31], s63 offen lds
 s_add_u32 s63, s60, 1363968
 s_add_u32 m0, s61, 103424
 s_nop 0
 buffer_load_dwordx4 v10, s[28:31], s63 offen lds
 s_add_u32 s63, s60, 1400832
 s_add_u32 m0, s61, 104448
 s_nop 0
 buffer_load_dwordx4 v11, s[28:31], s63 offen lds
 s_add_u32 s63, s60, 1437696
 s_add_u32 m0, s61, 105472
 s_nop 0
 buffer_load_dwordx4 v11, s[28:31], s63 offen lds
 s_waitcnt vmcnt(24)
 s_barrier
 ds_read_b128 v[64:67], v16 offset:0
 ds_read_b128 v[68:71], v16 offset:2048
 ds_read_b128 v[72:75], v16 offset:4096
 ds_read_b128 v[76:79], v16 offset:6144
 ds_read_b64_tr_b16 v[80:81], v32 offset:0
 ds_read_b64_tr_b16 v[82:83], v32 offset:1024
 ds_read_b64_tr_b16 v[84:85], v33 offset:0
 ds_read_b64_tr_b16 v[86:87], v33 offset:1024
 ds_read_b64_tr_b16 v[88:89], v34 offset:0
 ds_read_b64_tr_b16 v[90:91], v34 offset:1024
 ds_read_b64_tr_b16 v[92:93], v35 offset:0
 ds_read_b64_tr_b16 v[94:95], v35 offset:1024
 ds_read_b64_tr_b16 v[96:97], v36 offset:0
 ds_read_b64_tr_b16 v[98:99], v36 offset:1024
 ds_read_b64_tr_b16 v[100:101], v37 offset:0
 ds_read_b64_tr_b16 v[102:103], v37 offset:1024
 ds_read_b64_tr_b16 v[104:105], v38 offset:0
 ds_read_b64_tr_b16 v[106:107], v38 offset:1024
 ds_read_b64_tr_b16 v[108:109], v39 offset:0
 ds_read_b64_tr_b16 v[110:111], v39 offset:1024
 s_waitcnt lgkmcnt(0)
 v_mfma_f32_16x16x32_bf16 a[0:3], v[80:83], v[64:67], a[0:3]
 v_mfma_f32_16x16x32_bf16 a[4:7], v[80:83], v[68:71], a[4:7]
 ds_read_b128 v[112:115], v17 offset:0
 v_mfma_f32_16x16x32_bf16 a[8:11], v[80:83], v[72:75], a[8:11]
 v_mfma_f32_16x16x32_bf16 a[12:15], v[80:83], v[76:79], a[12:15]
 ds_read_b128 v[116:119], v17 offset:2048
 v_mfma_f32_16x16x32_bf16 a[16:19], v[84:87], v[64:67], a[16:19]
 ds_read_b128 v[120:123], v17 offset:4096
 v_mfma_f32_16x16x32_bf16 a[20:23], v[84:87], v[68:71], a[20:23]
 v_mfma_f32_16x16x32_bf16 a[24:27], v[84:87], v[72:75], a[24:27]
 ds_read_b128 v[124:127], v17 offset:6144
 v_mfma_f32_16x16x32_bf16 a[28:31], v[84:87], v[76:79], a[28:31]
 ds_read_b64_tr_b16 v[128:129], v32 offset:8192
 v_mfma_f32_16x16x32_bf16 a[32:35], v[88:91], v[64:67], a[32:35]
 v_mfma_f32_16x16x32_bf16 a[36:39], v[88:91], v[68:71], a[36:39]
 ds_read_b64_tr_b16 v[130:131], v32 offset:9216
 v_mfma_f32_16x16x32_bf16 a[40:43], v[88:91], v[72:75], a[40:43]
 v_mfma_f32_16x16x32_bf16 a[44:47], v[88:91], v[76:79], a[44:47]
 ds_read_b64_tr_b16 v[132:133], v33 offset:8192
 v_mfma_f32_16x16x32_bf16 a[48:51], v[92:95], v[64:67], a[48:51]
 ds_read_b64_tr_b16 v[134:135], v33 offset:9216
 v_mfma_f32_16x16x32_bf16 a[52:55], v[92:95], v[68:71], a[52:55]
 v_mfma_f32_16x16x32_bf16 a[56:59], v[92:95], v[72:75], a[56:59]
 ds_read_b64_tr_b16 v[136:137], v34 offset:8192
 v_mfma_f32_16x16x32_bf16 a[60:63], v[92:95], v[76:79], a[60:63]
 ds_read_b64_tr_b16 v[138:139], v34 offset:9216
 v_mfma_f32_16x16x32_bf16 a[64:67], v[96:99], v[64:67], a[64:67]
 v_mfma_f32_16x16x32_bf16 a[68:71], v[96:99], v[68:71], a[68:71]
 ds_read_b64_tr_b16 v[140:141], v35 offset:8192
 v_mfma_f32_16x16x32_bf16 a[72:75], v[96:99], v[72:75], a[72:75]
 v_mfma_f32_16x16x32_bf16 a[76:79], v[96:99], v[76:79], a[76:79]
 ds_read_b64_tr_b16 v[142:143], v35 offset:9216
 v_mfma_f32_16x16x32_bf16 a[80:83], v[100:103], v[64:67], a[80:83]
 ds_read_b64_tr_b16 v[144:145], v36 offset:8192
 v_mfma_f32_16x16x32_bf16 a[84:87], v[100:103], v[68:71], a[84:87]
 v_mfma_f32_16x16x32_bf16 a[88:91], v[100:103], v[72:75], a[88:91]
 ds_read_b64_tr_b16 v[146:147], v36 offset:9216
 v_mfma_f32_16x16x32_bf16 a[92:95], v[100:103], v[76:79], a[92:95]
 ds_read_b64_tr_b16 v[148:149], v37 offset:8192
 v_mfma_f32_16x16x32_bf16 a[96:99], v[104:107], v[64:67], a[96:99]
 v_mfma_f32_16x16x32_bf16 a[100:103], v[104:107], v[68:71], a[100:103]
 ds_read_b64_tr_b16 v[150:151], v37 offset:9216
 v_mfma_f32_16x16x32_bf16 a[104:107], v[104:107], v[72:75], a[104:107]
 v_mfma_f32_16x16x32_bf16 a[108:111], v[104:107], v[76:79], a[108:111]
 ds_read_b64_tr_b16 v[152:153], v38 offset:8192
 v_mfma_f32_16x16x32_bf16 a[112:115], v[108:111], v[64:67], a[112:115]
 ds_read_b64_tr_b16 v[154:155], v38 offset:9216
 v_mfma_f32_16x16x32_bf16 a[116:119], v[108:111], v[68:71], a[116:119]
 v_mfma_f32_16x16x32_bf16 a[120:123], v[108:111], v[72:75], a[120:123]
 ds_read_b64_tr_b16 v[156:157], v39 offset:8192
 v_mfma_f32_16x16x32_bf16 a[124:127], v[108:111], v[76:79], a[124:127]
 ds_read_b64_tr_b16 v[158:159], v39 offset:9216
 s_waitcnt lgkmcnt(0)
 s_waitcnt vmcnt(12)
 s_barrier
 v_mfma_f32_16x16x32_bf16 a[0:3], v[128:131], v[112:115], a[0:3]
 s_add_u32 s63, s53, 384
 s_add_u32 m0, s62, 0
 s_nop 0
 buffer_load_dwordx4 v8, s[12:15], s63 offen lds
 v_mfma_f32_16x16x32_bf16 a[4:7], v[128:131], v[116:119], a[4:7]
 s_add_u32 s63, s53, 9600
 s_add_u32 m0, s62, 1024
 s_nop 0
 buffer_load_dwordx4 v9, s[12:15], s63 offen lds
 v_mfma_f32_16x16x32_bf16 a[8:11], v[128:131], v[120:123], a[8:11]
 s_add_u32 s63, s53, 18816
 s_add_u32 m0, s62, 2048
 s_nop 0
 buffer_load_dwordx4 v8, s[12:15], s63 offen lds
 v_mfma_f32_16x16x32_bf16 a[12:15], v[128:131], v[124:127], a[12:15]
 s_add_u32 s63, s53, 28032
 s_add_u32 m0, s62, 3072
 s_nop 0
 buffer_load_dwordx4 v9, s[12:15], s63 offen lds
 v_mfma_f32_16x16x32_bf16 a[16:19], v[132:135], v[112:115], a[16:19]
 s_add_u32 s63, s60, 1769472
 s_add_u32 m0, s61, 0
 s_nop 0
 buffer_load_dwordx4 v10, s[28:31], s63 offen lds
 v_mfma_f32_16x16x32_bf16 a[20:23], v[132:135], v[116:119], a[20:23]
 s_add_u32 s63, s60, 1806336
 s_add_u32 m0, s61, 1024
 s_nop 0
 buffer_load_dwordx4 v10, s[28:31], s63 offen lds
 v_mfma_f32_16x16x32_bf16 a[24:27], v[132:135], v[120:123], a[24:27]
 s_add_u32 s63, s60, 1843200
 s_add_u32 m0, s61, 2048
 s_nop 0
 buffer_load_dwordx4 v11, s[28:31], s63 offen lds
 v_mfma_f32_16x16x32_bf16 a[28:31], v[132:135], v[124:127], a[28:31]
 s_add_u32 s63, s60, 1880064
 s_add_u32 m0, s61, 3072
 s_nop 0
 buffer_load_dwordx4 v11, s[28:31], s63 offen lds
 v_mfma_f32_16x16x32_bf16 a[32:35], v[136:139], v[112:115], a[32:35]
 s_add_u32 s63, s60, 1916928
 s_add_u32 m0, s61, 4096
 s_nop 0
 buffer_load_dwordx4 v10, s[28:31], s63 offen lds
 v_mfma_f32_16x16x32_bf16 a[36:39], v[136:139], v[116:119], a[36:39]
 s_add_u32 s63, s60, 1953792
 s_add_u32 m0, s61, 5120
 s_nop 0
 buffer_load_dwordx4 v10, s[28:31], s63 offen lds
 v_mfma_f32_16x16x32_bf16 a[40:43], v[136:139], v[120:123], a[40:43]
 s_add_u32 s63, s60, 1990656
 s_add_u32 m0, s61, 6144
 s_nop 0
 buffer_load_dwordx4 v11, s[28:31], s63 offen lds
 v_mfma_f32_16x16x32_bf16 a[44:47], v[136:139], v[124:127], a[44:47]
 s_add_u32 s63, s60, 2027520
 s_add_u32 m0, s61, 7168
 s_nop 0
 buffer_load_dwordx4 v11, s[28:31], s63 offen lds
 v_mfma_f32_16x16x32_bf16 a[48:51], v[140:143], v[112:115], a[48:51]
 ds_read_b128 v[64:67], v18 offset:0
 v_mfma_f32_16x16x32_bf16 a[52:55], v[140:143], v[116:119], a[52:55]
 ds_read_b128 v[68:71], v18 offset:2048
 v_mfma_f32_16x16x32_bf16 a[56:59], v[140:143], v[120:123], a[56:59]
 ds_read_b128 v[72:75], v18 offset:4096
 v_mfma_f32_16x16x32_bf16 a[60:63], v[140:143], v[124:127], a[60:63]
 ds_read_b128 v[76:79], v18 offset:6144
 v_mfma_f32_16x16x32_bf16 a[64:67], v[144:147], v[112:115], a[64:67]
 ds_read_b64_tr_b16 v[80:81], v40 offset:0
 v_mfma_f32_16x16x32_bf16 a[68:71], v[144:147], v[116:119], a[68:71]
 ds_read_b64_tr_b16 v[82:83], v40 offset:1024
 v_mfma_f32_16x16x32_bf16 a[72:75], v[144:147], v[120:123], a[72:75]
 ds_read_b64_tr_b16 v[84:85], v41 offset:0
 v_mfma_f32_16x16x32_bf16 a[76:79], v[144:147], v[124:127], a[76:79]
 ds_read_b64_tr_b16 v[86:87], v41 offset:1024
 v_mfma_f32_16x16x32_bf16 a[80:83], v[148:151], v[112:115], a[80:83]
 ds_read_b64_tr_b16 v[88:89], v42 offset:0
 v_mfma_f32_16x16x32_bf16 a[84:87], v[148:151], v[116:119], a[84:87]
 ds_read_b64_tr_b16 v[90:91], v42 offset:1024
 v_mfma_f32_16x16x32_bf16 a[88:91], v[148:151], v[120:123], a[88:91]
 ds_read_b64_tr_b16 v[92:93], v43 offset:0
 v_mfma_f32_16x16x32_bf16 a[92:95], v[148:151], v[124:127], a[92:95]
 ds_read_b64_tr_b16 v[94:95], v43 offset:1024
 v_mfma_f32_16x16x32_bf16 a[96:99], v[152:155], v[112:115], a[96:99]
 ds_read_b64_tr_b16 v[96:97], v44 offset:0
 v_mfma_f32_16x16x32_bf16 a[100:103], v[152:155], v[116:119], a[100:103]
 ds_read_b64_tr_b16 v[98:99], v44 offset:1024
 v_mfma_f32_16x16x32_bf16 a[104:107], v[152:155], v[120:123], a[104:107]
 ds_read_b64_tr_b16 v[100:101], v45 offset:0
 v_mfma_f32_16x16x32_bf16 a[108:111], v[152:155], v[124:127], a[108:111]
 ds_read_b64_tr_b16 v[102:103], v45 offset:1024
 v_mfma_f32_16x16x32_bf16 a[112:115], v[156:159], v[112:115], a[112:115]
 ds_read_b64_tr_b16 v[104:105], v46 offset:0
 v_mfma_f32_16x16x32_bf16 a[116:119], v[156:159], v[116:119], a[116:119]
 ds_read_b64_tr_b16 v[106:107], v46 offset:1024
 v_mfma_f32_16x16x32_bf16 a[120:123], v[156:159], v[120:123], a[120:123]
 ds_read_b64_tr_b16 v[108:109], v47 offset:0
 v_mfma_f32_16x16x32_bf16 a[124:127], v[156:159], v[124:127], a[124:127]
 ds_read_b64_tr_b16 v[110:111], v47 offset:1024
 s_waitcnt lgkmcnt(0)
 v_mfma_f32_16x16x32_bf16 a[0:3], v[80:83], v[64:67], a[0:3]
 v_mfma_f32_16x16x32_bf16 a[4:7], v[80:83], v[68:71], a[4:7]
 ds_read_b128 v[112:115], v19 offset:0
 v_mfma_f32_16x16x32_bf16 a[8:11], v[80:83], v[72:75], a[8:11]
 v_mfma_f32_16x16x32_bf16 a[12:15], v[80:83], v[76:79], a[12:15]
 ds_read_b128 v[116:119], v19 offset:2048
 v_mfma_f32_16x16x32_bf16 a[16:19], v[84:87], v[64:67], a[16:19]
 ds_read_b128 v[120:123], v19 offset:4096
 v_mfma_f32_16x16x32_bf16 a[20:23], v[84:87], v[68:71], a[20:23]
 v_mfma_f32_16x16x32_bf16 a[24:27], v[84:87], v[72:75], a[24:27]
 ds_read_b128 v[124:127], v19 offset:6144
 v_mfma_f32_16x16x32_bf16 a[28:31], v[84:87], v[76:79], a[28:31]
 ds_read_b64_tr_b16 v[128:129], v40 offset:8192
 v_mfma_f32_16x16x32_bf16 a[32:35], v[88:91], v[64:67], a[32:35]
 v_mfma_f32_16x16x32_bf16 a[36:39], v[88:91], v[68:71], a[36:39]
 ds_read_b64_tr_b16 v[130:131], v40 offset:9216
 v_mfma_f32_16x16x32_bf16 a[40:43], v[88:91], v[72:75], a[40:43]
 v_mfma_f32_16x16x32_bf16 a[44:47], v[88:91], v[76:79], a[44:47]
 ds_read_b64_tr_b16 v[132:133], v41 offset:8192
 v_mfma_f32_16x16x32_bf16 a[48:51], v[92:95], v[64:67], a[48:51]
 ds_read_b64_tr_b16 v[134:135], v41 offset:9216
 v_mfma_f32_16x16x32_bf16 a[52:55], v[92:95], v[68:71], a[52:55]
 v_mfma_f32_16x16x32_bf16 a[56:59], v[92:95], v[72:75], a[56:59]
 ds_read_b64_tr_b16 v[136:137], v42 offset:8192
 v_mfma_f32_16x16x32_bf16 a[60:63], v[92:95], v[76:79], a[60:63]
 ds_read_b64_tr_b16 v[138:139], v42 offset:9216
 v_mfma_f32_16x16x32_bf16 a[64:67], v[96:99], v[64:67], a[64:67]
 v_mfma_f32_16x16x32_bf16 a[68:71], v[96:99], v[68:71], a[68:71]
 ds_read_b64_tr_b16 v[140:141], v43 offset:8192
 v_mfma_f32_16x16x32_bf16 a[72:75], v[96:99], v[72:75], a[72:75]
 v_mfma_f32_16x16x32_bf16 a[76:79], v[96:99], v[76:79], a[76:79]
 ds_read_b64_tr_b16 v[142:143], v43 offset:9216
 v_mfma_f32_16x16x32_bf16 a[80:83], v[100:103], v[64:67], a[80:83]
 ds_read_b64_tr_b16 v[144:145], v44 offset:8192
 v_mfma_f32_16x16x32_bf16 a[84:87], v[100:103], v[68:71], a[84:87]
 v_mfma_f32_16x16x32_bf16 a[88:91], v[100:103], v[72:75], a[88:91]
 ds_read_b64_tr_b16 v[146:147], v44 offset:9216
 v_mfma_f32_16x16x32_bf16 a[92:95], v[100:103], v[76:79], a[92:95]
 ds_read_b64_tr_b16 v[148:149], v45 offset:8192
 v_mfma_f32_16x16x32_bf16 a[96:99], v[104:107], v[64:67], a[96:99]
 v_mfma_f32_16x16x32_bf16 a[100:103], v[104:107], v[68:71], a[100:103]
 ds_read_b64_tr_b16 v[150:151], v45 offset:9216
 v_mfma_f32_16x16x32_bf16 a[104:107], v[104:107], v[72:75], a[104:107]
 v_mfma_f32_16x16x32_bf16 a[108:111], v[104:107], v[76:79], a[108:111]
 ds_read_b64_tr_b16 v[152:153], v46 offset:8192
 v_mfma_f32_16x16x32_bf16 a[112:115], v[108:111], v[64:67], a[112:115]
 ds_read_b64_tr_b16 v[154:155], v46 offset:9216
 v_mfma_f32_16x16x32_bf16 a[116:119], v[108:111], v[68:71], a[116:119]
 v_mfma_f32_16x16x32_bf16 a[120:123], v[108:111], v[72:75], a[120:123]
 ds_read_b64_tr_b16 v[156:157], v47 offset:8192
 v_mfma_f32_16x16x32_bf16 a[124:127], v[108:111], v[76:79], a[124:127]
 ds_read_b64_tr_b16 v[158:159], v47 offset:9216
 s_waitcnt lgkmcnt(0)
 s_waitcnt vmcnt(12)
 s_barrier
 v_mfma_f32_16x16x32_bf16 a[0:3], v[128:131], v[112:115], a[0:3]
 s_add_u32 s63, s53, 512
 s_add_u32 m0, s62, 49152
 s_nop 0
 buffer_load_dwordx4 v8, s[12:15], s63 offen lds
 v_mfma_f32_16x16x32_bf16 a[4:7], v[128:131], v[116:119], a[4:7]
 s_add_u32 s63, s53, 9728
 s_add_u32 m0, s62, 50176
 s_nop 0
 buffer_load_dwordx4 v9, s[12:15], s63 offen lds
 v_mfma_f32_16x16x32_bf16 a[8:11], v[128:131], v[120:123], a[8:11]
 s_add_u32 s63, s53, 18944
 s_add_u32 m0, s62, 51200
 s_nop 0
 buffer_load_dwordx4 v8, s[12:15], s63 offen lds
 v_mfma_f32_16x16x32_bf16 a[12:15], v[128:131], v[124:127], a[12:15]
 s_add_u32 s63, s53, 28160
 s_add_u32 m0, s62, 52224
 s_nop 0
 buffer_load_dwordx4 v9, s[12:15], s63 offen lds
 v_mfma_f32_16x16x32_bf16 a[16:19], v[132:135], v[112:115], a[16:19]
 s_add_u32 s63, s60, 2359296
 s_add_u32 m0, s61, 49152
 s_nop 0
 buffer_load_dwordx4 v10, s[28:31], s63 offen lds
 v_mfma_f32_16x16x32_bf16 a[20:23], v[132:135], v[116:119], a[20:23]
 s_add_u32 s63, s60, 2396160
 s_add_u32 m0, s61, 50176
 s_nop 0
 buffer_load_dwordx4 v10, s[28:31], s63 offen lds
 v_mfma_f32_16x16x32_bf16 a[24:27], v[132:135], v[120:123], a[24:27]
 s_add_u32 s63, s60, 2433024
 s_add_u32 m0, s61, 51200
 s_nop 0
 buffer_load_dwordx4 v11, s[28:31], s63 offen lds
 v_mfma_f32_16x16x32_bf16 a[28:31], v[132:135], v[124:127], a[28:31]
 s_add_u32 s63, s60, 2469888
 s_add_u32 m0, s61, 52224
 s_nop 0
 buffer_load_dwordx4 v11, s[28:31], s63 offen lds
 v_mfma_f32_16x16x32_bf16 a[32:35], v[136:139], v[112:115], a[32:35]
 s_add_u32 s63, s60, 2506752
 s_add_u32 m0, s61, 53248
 s_nop 0
 buffer_load_dwordx4 v10, s[28:31], s63 offen lds
 v_mfma_f32_16x16x32_bf16 a[36:39], v[136:139], v[116:119], a[36:39]
 s_add_u32 s63, s60, 2543616
 s_add_u32 m0, s61, 54272
 s_nop 0
 buffer_load_dwordx4 v10, s[28:31], s63 offen lds
 v_mfma_f32_16x16x32_bf16 a[40:43], v[136:139], v[120:123], a[40:43]
 s_add_u32 s63, s60, 2580480
 s_add_u32 m0, s61, 55296
 s_nop 0
 buffer_load_dwordx4 v11, s[28:31], s63 offen lds
 v_mfma_f32_16x16x32_bf16 a[44:47], v[136:139], v[124:127], a[44:47]
 s_add_u32 s63, s60, 2617344
 s_add_u32 m0, s61, 56320
 s_nop 0
 buffer_load_dwordx4 v11, s[28:31], s63 offen lds
 v_mfma_f32_16x16x32_bf16 a[48:51], v[140:143], v[112:115], a[48:51]
 ds_read_b128 v[64:67], v20 offset:0
 v_mfma_f32_16x16x32_bf16 a[52:55], v[140:143], v[116:119], a[52:55]
 ds_read_b128 v[68:71], v20 offset:2048
 v_mfma_f32_16x16x32_bf16 a[56:59], v[140:143], v[120:123], a[56:59]
 ds_read_b128 v[72:75], v20 offset:4096
 v_mfma_f32_16x16x32_bf16 a[60:63], v[140:143], v[124:127], a[60:63]
 ds_read_b128 v[76:79], v20 offset:6144
 v_mfma_f32_16x16x32_bf16 a[64:67], v[144:147], v[112:115], a[64:67]
 ds_read_b64_tr_b16 v[80:81], v48 offset:0
 v_mfma_f32_16x16x32_bf16 a[68:71], v[144:147], v[116:119], a[68:71]
 ds_read_b64_tr_b16 v[82:83], v48 offset:1024
 v_mfma_f32_16x16x32_bf16 a[72:75], v[144:147], v[120:123], a[72:75]
 ds_read_b64_tr_b16 v[84:85], v49 offset:0
 v_mfma_f32_16x16x32_bf16 a[76:79], v[144:147], v[124:127], a[76:79]
 ds_read_b64_tr_b16 v[86:87], v49 offset:1024
 v_mfma_f32_16x16x32_bf16 a[80:83], v[148:151], v[112:115], a[80:83]
 ds_read_b64_tr_b16 v[88:89], v50 offset:0
 v_mfma_f32_16x16x32_bf16 a[84:87], v[148:151], v[116:119], a[84:87]
 ds_read_b64_tr_b16 v[90:91], v50 offset:1024
 v_mfma_f32_16x16x32_bf16 a[88:91], v[148:151], v[120:123], a[88:91]
 ds_read_b64_tr_b16 v[92:93], v51 offset:0
 v_mfma_f32_16x16x32_bf16 a[92:95], v[148:151], v[124:127], a[92:95]
 ds_read_b64_tr_b16 v[94:95], v51 offset:1024
 v_mfma_f32_16x16x32_bf16 a[96:99], v[152:155], v[112:115], a[96:99]
 ds_read_b64_tr_b16 v[96:97], v52 offset:0
 v_mfma_f32_16x16x32_bf16 a[100:103], v[152:155], v[116:119], a[100:103]
 ds_read_b64_tr_b16 v[98:99], v52 offset:1024
 v_mfma_f32_16x16x32_bf16 a[104:107], v[152:155], v[120:123], a[104:107]
 ds_read_b64_tr_b16 v[100:101], v53 offset:0
 v_mfma_f32_16x16x32_bf16 a[108:111], v[152:155], v[124:127], a[108:111]
 ds_read_b64_tr_b16 v[102:103], v53 offset:1024
 v_mfma_f32_16x16x32_bf16 a[112:115], v[156:159], v[112:115], a[112:115]
 ds_read_b64_tr_b16 v[104:105], v54 offset:0
 v_mfma_f32_16x16x32_bf16 a[116:119], v[156:159], v[116:119], a[116:119]
 ds_read_b64_tr_b16 v[106:107], v54 offset:1024
 v_mfma_f32_16x16x32_bf16 a[120:123], v[156:159], v[120:123], a[120:123]
 ds_read_b64_tr_b16 v[108:109], v55 offset:0
 v_mfma_f32_16x16x32_bf16 a[124:127], v[156:159], v[124:127], a[124:127]
 ds_read_b64_tr_b16 v[110:111], v55 offset:1024
 s_waitcnt lgkmcnt(0)
 v_mfma_f32_16x16x32_bf16 a[0:3], v[80:83], v[64:67], a[0:3]
 v_mfma_f32_16x16x32_bf16 a[4:7], v[80:83], v[68:71], a[4:7]
 ds_read_b128 v[112:115], v21 offset:0
 v_mfma_f32_16x16x32_bf16 a[8:11], v[80:83], v[72:75], a[8:11]
 v_mfma_f32_16x16x32_bf16 a[12:15], v[80:83], v[76:79], a[12:15]
 ds_read_b128 v[116:119], v21 offset:2048
 v_mfma_f32_16x16x32_bf16 a[16:19], v[84:87], v[64:67], a[16:19]
 ds_read_b128 v[120:123], v21 offset:4096
 v_mfma_f32_16x16x32_bf16 a[20:23], v[84:87], v[68:71], a[20:23]
 v_mfma_f32_16x16x32_bf16 a[24:27], v[84:87], v[72:75], a[24:27]
 ds_read_b128 v[124:127], v21 offset:6144
 v_mfma_f32_16x16x32_bf16 a[28:31], v[84:87], v[76:79], a[28:31]
 ds_read_b64_tr_b16 v[128:129], v48 offset:8192
 v_mfma_f32_16x16x32_bf16 a[32:35], v[88:91], v[64:67], a[32:35]
 v_mfma_f32_16x16x32_bf16 a[36:39], v[88:91], v[68:71], a[36:39]
 ds_read_b64_tr_b16 v[130:131], v48 offset:9216
 v_mfma_f32_16x16x32_bf16 a[40:43], v[88:91], v[72:75], a[40:43]
 v_mfma_f32_16x16x32_bf16 a[44:47], v[88:91], v[76:79], a[44:47]
 ds_read_b64_tr_b16 v[132:133], v49 offset:8192
 v_mfma_f32_16x16x32_bf16 a[48:51], v[92:95], v[64:67], a[48:51]
 ds_read_b64_tr_b16 v[134:135], v49 offset:9216
 v_mfma_f32_16x16x32_bf16 a[52:55], v[92:95], v[68:71], a[52:55]
 v_mfma_f32_16x16x32_bf16 a[56:59], v[92:95], v[72:75], a[56:59]
 ds_read_b64_tr_b16 v[136:137], v50 offset:8192
 v_mfma_f32_16x16x32_bf16 a[60:63], v[92:95], v[76:79], a[60:63]
 ds_read_b64_tr_b16 v[138:139], v50 offset:9216
 v_mfma_f32_16x16x32_bf16 a[64:67], v[96:99], v[64:67], a[64:67]
 v_mfma_f32_16x16x32_bf16 a[68:71], v[96:99], v[68:71], a[68:71]
 ds_read_b64_tr_b16 v[140:141], v51 offset:8192
 v_mfma_f32_16x16x32_bf16 a[72:75], v[96:99], v[72:75], a[72:75]
 v_mfma_f32_16x16x32_bf16 a[76:79], v[96:99], v[76:79], a[76:79]
 ds_read_b64_tr_b16 v[142:143], v51 offset:9216
 v_mfma_f32_16x16x32_bf16 a[80:83], v[100:103], v[64:67], a[80:83]
 ds_read_b64_tr_b16 v[144:145], v52 offset:8192
 v_mfma_f32_16x16x32_bf16 a[84:87], v[100:103], v[68:71], a[84:87]
 v_mfma_f32_16x16x32_bf16 a[88:91], v[100:103], v[72:75], a[88:91]
 ds_read_b64_tr_b16 v[146:147], v52 offset:9216
 v_mfma_f32_16x16x32_bf16 a[92:95], v[100:103], v[76:79], a[92:95]
 ds_read_b64_tr_b16 v[148:149], v53 offset:8192
 v_mfma_f32_16x16x32_bf16 a[96:99], v[104:107], v[64:67], a[96:99]
 v_mfma_f32_16x16x32_bf16 a[100:103], v[104:107], v[68:71], a[100:103]
 ds_read_b64_tr_b16 v[150:151], v53 offset:9216
 v_mfma_f32_16x16x32_bf16 a[104:107], v[104:107], v[72:75], a[104:107]
 v_mfma_f32_16x16x32_bf16 a[108:111], v[104:107], v[76:79], a[108:111]
 ds_read_b64_tr_b16 v[152:153], v54 offset:8192
 v_mfma_f32_16x16x32_bf16 a[112:115], v[108:111], v[64:67], a[112:115]
 ds_read_b64_tr_b16 v[154:155], v54 offset:9216
 v_mfma_f32_16x16x32_bf16 a[116:119], v[108:111], v[68:71], a[116:119]
 v_mfma_f32_16x16x32_bf16 a[120:123], v[108:111], v[72:75], a[120:123]
 ds_read_b64_tr_b16 v[156:157], v55 offset:8192
 v_mfma_f32_16x16x32_bf16 a[124:127], v[108:111], v[76:79], a[124:127]
 ds_read_b64_tr_b16 v[158:159], v55 offset:9216
 s_waitcnt lgkmcnt(0)
 s_waitcnt vmcnt(12)
 s_barrier
 v_mfma_f32_16x16x32_bf16 a[0:3], v[128:131], v[112:115], a[0:3]
 s_add_u32 s63, s53, 640
 s_add_u32 m0, s62, 98304
 s_nop 0
 buffer_load_dwordx4 v8, s[12:15], s63 offen lds
 v_mfma_f32_16x16x32_bf16 a[4:7], v[128:131], v[116:119], a[4:7]
 s_add_u32 s63, s53, 9856
 s_add_u32 m0, s62, 99328
 s_nop 0
 buffer_load_dwordx4 v9, s[12:15], s63 offen lds
 v_mfma_f32_16x16x32_bf16 a[8:11], v[128:131], v[120:123], a[8:11]
 s_add_u32 s63, s53, 19072
 s_add_u32 m0, s62, 100352
 s_nop 0
 buffer_load_dwordx4 v8, s[12:15], s63 offen lds
 v_mfma_f32_16x16x32_bf16 a[12:15], v[128:131], v[124:127], a[12:15]
 s_add_u32 s63, s53, 28288
 s_add_u32 m0, s62, 101376
 s_nop 0
 buffer_load_dwordx4 v9, s[12:15], s63 offen lds
 v_mfma_f32_16x16x32_bf16 a[16:19], v[132:135], v[112:115], a[16:19]
 s_add_u32 s63, s60, 2949120
 s_add_u32 m0, s61, 98304
 s_nop 0
 buffer_load_dwordx4 v10, s[28:31], s63 offen lds
 v_mfma_f32_16x16x32_bf16 a[20:23], v[132:135], v[116:119], a[20:23]
 s_add_u32 s63, s60, 2985984
 s_add_u32 m0, s61, 99328
 s_nop 0
 buffer_load_dwordx4 v10, s[28:31], s63 offen lds
 v_mfma_f32_16x16x32_bf16 a[24:27], v[132:135], v[120:123], a[24:27]
 s_add_u32 s63, s60, 3022848
 s_add_u32 m0, s61, 100352
 s_nop 0
 buffer_load_dwordx4 v11, s[28:31], s63 offen lds
 v_mfma_f32_16x16x32_bf16 a[28:31], v[132:135], v[124:127], a[28:31]
 s_add_u32 s63, s60, 3059712
 s_add_u32 m0, s61, 101376
 s_nop 0
 buffer_load_dwordx4 v11, s[28:31], s63 offen lds
 v_mfma_f32_16x16x32_bf16 a[32:35], v[136:139], v[112:115], a[32:35]
 s_add_u32 s63, s60, 3096576
 s_add_u32 m0, s61, 102400
 s_nop 0
 buffer_load_dwordx4 v10, s[28:31], s63 offen lds
 v_mfma_f32_16x16x32_bf16 a[36:39], v[136:139], v[116:119], a[36:39]
 s_add_u32 s63, s60, 3133440
 s_add_u32 m0, s61, 103424
 s_nop 0
 buffer_load_dwordx4 v10, s[28:31], s63 offen lds
 v_mfma_f32_16x16x32_bf16 a[40:43], v[136:139], v[120:123], a[40:43]
 s_add_u32 s63, s60, 3170304
 s_add_u32 m0, s61, 104448
 s_nop 0
 buffer_load_dwordx4 v11, s[28:31], s63 offen lds
 v_mfma_f32_16x16x32_bf16 a[44:47], v[136:139], v[124:127], a[44:47]
 s_add_u32 s63, s60, 3207168
 s_add_u32 m0, s61, 105472
 s_nop 0
 buffer_load_dwordx4 v11, s[28:31], s63 offen lds
 v_mfma_f32_16x16x32_bf16 a[48:51], v[140:143], v[112:115], a[48:51]
 ds_read_b128 v[64:67], v16 offset:0
 v_mfma_f32_16x16x32_bf16 a[52:55], v[140:143], v[116:119], a[52:55]
 ds_read_b128 v[68:71], v16 offset:2048
 v_mfma_f32_16x16x32_bf16 a[56:59], v[140:143], v[120:123], a[56:59]
 ds_read_b128 v[72:75], v16 offset:4096
 v_mfma_f32_16x16x32_bf16 a[60:63], v[140:143], v[124:127], a[60:63]
 ds_read_b128 v[76:79], v16 offset:6144
 v_mfma_f32_16x16x32_bf16 a[64:67], v[144:147], v[112:115], a[64:67]
 ds_read_b64_tr_b16 v[80:81], v32 offset:0
 v_mfma_f32_16x16x32_bf16 a[68:71], v[144:147], v[116:119], a[68:71]
 ds_read_b64_tr_b16 v[82:83], v32 offset:1024
 v_mfma_f32_16x16x32_bf16 a[72:75], v[144:147], v[120:123], a[72:75]
 ds_read_b64_tr_b16 v[84:85], v33 offset:0
 v_mfma_f32_16x16x32_bf16 a[76:79], v[144:147], v[124:127], a[76:79]
 ds_read_b64_tr_b16 v[86:87], v33 offset:1024
 v_mfma_f32_16x16x32_bf16 a[80:83], v[148:151], v[112:115], a[80:83]
 ds_read_b64_tr_b16 v[88:89], v34 offset:0
 v_mfma_f32_16x16x32_bf16 a[84:87], v[148:151], v[116:119], a[84:87]
 ds_read_b64_tr_b16 v[90:91], v34 offset:1024
 v_mfma_f32_16x16x32_bf16 a[88:91], v[148:151], v[120:123], a[88:91]
 ds_read_b64_tr_b16 v[92:93], v35 offset:0
 v_mfma_f32_16x16x32_bf16 a[92:95], v[148:151], v[124:127], a[92:95]
 ds_read_b64_tr_b16 v[94:95], v35 offset:1024
 v_mfma_f32_16x16x32_bf16 a[96:99], v[152:155], v[112:115], a[96:99]
 ds_read_b64_tr_b16 v[96:97], v36 offset:0
 v_mfma_f32_16x16x32_bf16 a[100:103], v[152:155], v[116:119], a[100:103]
 ds_read_b64_tr_b16 v[98:99], v36 offset:1024
 v_mfma_f32_16x16x32_bf16 a[104:107], v[152:155], v[120:123], a[104:107]
 ds_read_b64_tr_b16 v[100:101], v37 offset:0
 v_mfma_f32_16x16x32_bf16 a[108:111], v[152:155], v[124:127], a[108:111]
 ds_read_b64_tr_b16 v[102:103], v37 offset:1024
 v_mfma_f32_16x16x32_bf16 a[112:115], v[156:159], v[112:115], a[112:115]
 ds_read_b64_tr_b16 v[104:105], v38 offset:0
 v_mfma_f32_16x16x32_bf16 a[116:119], v[156:159], v[116:119], a[116:119]
 ds_read_b64_tr_b16 v[106:107], v38 offset:1024
 v_mfma_f32_16x16x32_bf16 a[120:123], v[156:159], v[120:123], a[120:123]
 ds_read_b64_tr_b16 v[108:109], v39 offset:0
 v_mfma_f32_16x16x32_bf16 a[124:127], v[156:159], v[124:127], a[124:127]
 ds_read_b64_tr_b16 v[110:111], v39 offset:1024
 s_waitcnt lgkmcnt(0)
 v_mfma_f32_16x16x32_bf16 a[0:3], v[80:83], v[64:67], a[0:3]
 v_mfma_f32_16x16x32_bf16 a[4:7], v[80:83], v[68:71], a[4:7]
 ds_read_b128 v[112:115], v17 offset:0
 v_mfma_f32_16x16x32_bf16 a[8:11], v[80:83], v[72:75], a[8:11]
 v_mfma_f32_16x16x32_bf16 a[12:15], v[80:83], v[76:79], a[12:15]
 ds_read_b128 v[116:119], v17 offset:2048
 v_mfma_f32_16x16x32_bf16 a[16:19], v[84:87], v[64:67], a[16:19]
 ds_read_b128 v[120:123], v17 offset:4096
 v_mfma_f32_16x16x32_bf16 a[20:23], v[84:87], v[68:71], a[20:23]
 v_mfma_f32_16x16x32_bf16 a[24:27], v[84:87], v[72:75], a[24:27]
 ds_read_b128 v[124:127], v17 offset:6144
 v_mfma_f32_16x16x32_bf16 a[28:31], v[84:87], v[76:79], a[28:31]
 ds_read_b64_tr_b16 v[128:129], v32 offset:8192
 v_mfma_f32_16x16x32_bf16 a[32:35], v[88:91], v[64:67], a[32:35]
 v_mfma_f32_16x16x32_bf16 a[36:39], v[88:91], v[68:71], a[36:39]
 ds_read_b64_tr_b16 v[130:131], v32 offset:9216
 v_mfma_f32_16x16x32_bf16 a[40:43], v[88:91], v[72:75], a[40:43]
 v_mfma_f32_16x16x32_bf16 a[44:47], v[88:91], v[76:79], a[44:47]
 ds_read_b64_tr_b16 v[132:133], v33 offset:8192
 v_mfma_f32_16x16x32_bf16 a[48:51], v[92:95], v[64:67], a[48:51]
 ds_read_b64_tr_b16 v[134:135], v33 offset:9216
 v_mfma_f32_16x16x32_bf16 a[52:55], v[92:95], v[68:71], a[52:55]
 v_mfma_f32_16x16x32_bf16 a[56:59], v[92:95], v[72:75], a[56:59]
 ds_read_b64_tr_b16 v[136:137], v34 offset:8192
 v_mfma_f32_16x16x32_bf16 a[60:63], v[92:95], v[76:79], a[60:63]
 ds_read_b64_tr_b16 v[138:139], v34 offset:9216
 v_mfma_f32_16x16x32_bf16 a[64:67], v[96:99], v[64:67], a[64:67]
 v_mfma_f32_16x16x32_bf16 a[68:71], v[96:99], v[68:71], a[68:71]
 ds_read_b64_tr_b16 v[140:141], v35 offset:8192
 v_mfma_f32_16x16x32_bf16 a[72:75], v[96:99], v[72:75], a[72:75]
 v_mfma_f32_16x16x32_bf16 a[76:79], v[96:99], v[76:79], a[76:79]
 ds_read_b64_tr_b16 v[142:143], v35 offset:9216
 v_mfma_f32_16x16x32_bf16 a[80:83], v[100:103], v[64:67], a[80:83]
 ds_read_b64_tr_b16 v[144:145], v36 offset:8192
 v_mfma_f32_16x16x32_bf16 a[84:87], v[100:103], v[68:71], a[84:87]
 v_mfma_f32_16x16x32_bf16 a[88:91], v[100:103], v[72:75], a[88:91]
 ds_read_b64_tr_b16 v[146:147], v36 offset:9216
 v_mfma_f32_16x16x32_bf16 a[92:95], v[100:103], v[76:79], a[92:95]
 ds_read_b64_tr_b16 v[148:149], v37 offset:8192
 v_mfma_f32_16x16x32_bf16 a[96:99], v[104:107], v[64:67], a[96:99]
 v_mfma_f32_16x16x32_bf16 a[100:103], v[104:107], v[68:71], a[100:103]
 ds_read_b64_tr_b16 v[150:151], v37 offset:9216
 v_mfma_f32_16x16x32_bf16 a[104:107], v[104:107], v[72:75], a[104:107]
 v_mfma_f32_16x16x32_bf16 a[108:111], v[104:107], v[76:79], a[108:111]
 ds_read_b64_tr_b16 v[152:153], v38 offset:8192
 v_mfma_f32_16x16x32_bf16 a[112:115], v[108:111], v[64:67], a[112:115]
 ds_read_b64_tr_b16 v[154:155], v38 offset:9216
 v_mfma_f32_16x16x32_bf16 a[116:119], v[108:111], v[68:71], a[116:119]
 v_mfma_f32_16x16x32_bf16 a[120:123], v[108:111], v[72:75], a[120:123]
 ds_read_b64_tr_b16 v[156:157], v39 offset:8192
 v_mfma_f32_16x16x32_bf16 a[124:127], v[108:111], v[76:79], a[124:127]
 ds_read_b64_tr_b16 v[158:159], v39 offset:9216
 s_waitcnt lgkmcnt(0)
 s_waitcnt vmcnt(12)
 s_barrier
 v_mfma_f32_16x16x32_bf16 a[0:3], v[128:131], v[112:115], a[0:3]
 s_add_u32 s63, s53, 768
 s_add_u32 m0, s62, 0
 s_nop 0
 buffer_load_dwordx4 v8, s[12:15], s63 offen lds
 v_mfma_f32_16x16x32_bf16 a[4:7], v[128:131], v[116:119], a[4:7]
 s_add_u32 s63, s53, 9984
 s_add_u32 m0, s62, 1024
 s_nop 0
 buffer_load_dwordx4 v9, s[12:15], s63 offen lds
 v_mfma_f32_16x16x32_bf16 a[8:11], v[128:131], v[120:123], a[8:11]
 s_add_u32 s63, s53, 19200
 s_add_u32 m0, s62, 2048
 s_nop 0
 buffer_load_dwordx4 v8, s[12:15], s63 offen lds
 v_mfma_f32_16x16x32_bf16 a[12:15], v[128:131], v[124:127], a[12:15]
 s_add_u32 s63, s53, 28416
 s_add_u32 m0, s62, 3072
 s_nop 0
 buffer_load_dwordx4 v9, s[12:15], s63 offen lds
 v_mfma_f32_16x16x32_bf16 a[16:19], v[132:135], v[112:115], a[16:19]
 s_add_u32 s63, s60, 3538944
 s_add_u32 m0, s61, 0
 s_nop 0
 buffer_load_dwordx4 v10, s[28:31], s63 offen lds
 v_mfma_f32_16x16x32_bf16 a[20:23], v[132:135], v[116:119], a[20:23]
 s_add_u32 s63, s60, 3575808
 s_add_u32 m0, s61, 1024
 s_nop 0
 buffer_load_dwordx4 v10, s[28:31], s63 offen lds
 v_mfma_f32_16x16x32_bf16 a[24:27], v[132:135], v[120:123], a[24:27]
 s_add_u32 s63, s60, 3612672
 s_add_u32 m0, s61, 2048
 s_nop 0
 buffer_load_dwordx4 v11, s[28:31], s63 offen lds
 v_mfma_f32_16x16x32_bf16 a[28:31], v[132:135], v[124:127], a[28:31]
 s_add_u32 s63, s60, 3649536
 s_add_u32 m0, s61, 3072
 s_nop 0
 buffer_load_dwordx4 v11, s[28:31], s63 offen lds
 v_mfma_f32_16x16x32_bf16 a[32:35], v[136:139], v[112:115], a[32:35]
 s_add_u32 s63, s60, 3686400
 s_add_u32 m0, s61, 4096
 s_nop 0
 buffer_load_dwordx4 v10, s[28:31], s63 offen lds
 v_mfma_f32_16x16x32_bf16 a[36:39], v[136:139], v[116:119], a[36:39]
 s_add_u32 s63, s60, 3723264
 s_add_u32 m0, s61, 5120
 s_nop 0
 buffer_load_dwordx4 v10, s[28:31], s63 offen lds
 v_mfma_f32_16x16x32_bf16 a[40:43], v[136:139], v[120:123], a[40:43]
 s_add_u32 s63, s60, 3760128
 s_add_u32 m0, s61, 6144
 s_nop 0
 buffer_load_dwordx4 v11, s[28:31], s63 offen lds
 v_mfma_f32_16x16x32_bf16 a[44:47], v[136:139], v[124:127], a[44:47]
 s_add_u32 s63, s60, 3796992
 s_add_u32 m0, s61, 7168
 s_nop 0
 buffer_load_dwordx4 v11, s[28:31], s63 offen lds
 v_mfma_f32_16x16x32_bf16 a[48:51], v[140:143], v[112:115], a[48:51]
 ds_read_b128 v[64:67], v18 offset:0
 v_mfma_f32_16x16x32_bf16 a[52:55], v[140:143], v[116:119], a[52:55]
 ds_read_b128 v[68:71], v18 offset:2048
 v_mfma_f32_16x16x32_bf16 a[56:59], v[140:143], v[120:123], a[56:59]
 ds_read_b128 v[72:75], v18 offset:4096
 v_mfma_f32_16x16x32_bf16 a[60:63], v[140:143], v[124:127], a[60:63]
 ds_read_b128 v[76:79], v18 offset:6144
 v_mfma_f32_16x16x32_bf16 a[64:67], v[144:147], v[112:115], a[64:67]
 ds_read_b64_tr_b16 v[80:81], v40 offset:0
 v_mfma_f32_16x16x32_bf16 a[68:71], v[144:147], v[116:119], a[68:71]
 ds_read_b64_tr_b16 v[82:83], v40 offset:1024
 v_mfma_f32_16x16x32_bf16 a[72:75], v[144:147], v[120:123], a[72:75]
 ds_read_b64_tr_b16 v[84:85], v41 offset:0
 v_mfma_f32_16x16x32_bf16 a[76:79], v[144:147], v[124:127], a[76:79]
 ds_read_b64_tr_b16 v[86:87], v41 offset:1024
 v_mfma_f32_16x16x32_bf16 a[80:83], v[148:151], v[112:115], a[80:83]
 ds_read_b64_tr_b16 v[88:89], v42 offset:0
 v_mfma_f32_16x16x32_bf16 a[84:87], v[148:151], v[116:119], a[84:87]
 ds_read_b64_tr_b16 v[90:91], v42 offset:1024
 v_mfma_f32_16x16x32_bf16 a[88:91], v[148:151], v[120:123], a[88:91]
 ds_read_b64_tr_b16 v[92:93], v43 offset:0
 v_mfma_f32_16x16x32_bf16 a[92:95], v[148:151], v[124:127], a[92:95]
 ds_read_b64_tr_b16 v[94:95], v43 offset:1024
 v_mfma_f32_16x16x32_bf16 a[96:99], v[152:155], v[112:115], a[96:99]
 ds_read_b64_tr_b16 v[96:97], v44 offset:0
 v_mfma_f32_16x16x32_bf16 a[100:103], v[152:155], v[116:119], a[100:103]
 ds_read_b64_tr_b16 v[98:99], v44 offset:1024
 v_mfma_f32_16x16x32_bf16 a[104:107], v[152:155], v[120:123], a[104:107]
 ds_read_b64_tr_b16 v[100:101], v45 offset:0
 v_mfma_f32_16x16x32_bf16 a[108:111], v[152:155], v[124:127], a[108:111]
 ds_read_b64_tr_b16 v[102:103], v45 offset:1024
 v_mfma_f32_16x16x32_bf16 a[112:115], v[156:159], v[112:115], a[112:115]
 ds_read_b64_tr_b16 v[104:105], v46 offset:0
 v_mfma_f32_16x16x32_bf16 a[116:119], v[156:159], v[116:119], a[116:119]
 ds_read_b64_tr_b16 v[106:107], v46 offset:1024
 v_mfma_f32_16x16x32_bf16 a[120:123], v[156:159], v[120:123], a[120:123]
 ds_read_b64_tr_b16 v[108:109], v47 offset:0
 v_mfma_f32_16x16x32_bf16 a[124:127], v[156:159], v[124:127], a[124:127]
 ds_read_b64_tr_b16 v[110:111], v47 offset:1024
 s_waitcnt lgkmcnt(0)
 v_mfma_f32_16x16x32_bf16 a[0:3], v[80:83], v[64:67], a[0:3]
 v_mfma_f32_16x16x32_bf16 a[4:7], v[80:83], v[68:71], a[4:7]
 ds_read_b128 v[112:115], v19 offset:0
 v_mfma_f32_16x16x32_bf16 a[8:11], v[80:83], v[72:75], a[8:11]
 v_mfma_f32_16x16x32_bf16 a[12:15], v[80:83], v[76:79], a[12:15]
 ds_read_b128 v[116:119], v19 offset:2048
 v_mfma_f32_16x16x32_bf16 a[16:19], v[84:87], v[64:67], a[16:19]
 ds_read_b128 v[120:123], v19 offset:4096
 v_mfma_f32_16x16x32_bf16 a[20:23], v[84:87], v[68:71], a[20:23]
 v_mfma_f32_16x16x32_bf16 a[24:27], v[84:87], v[72:75], a[24:27]
 ds_read_b128 v[124:127], v19 offset:6144
 v_mfma_f32_16x16x32_bf16 a[28:31], v[84:87], v[76:79], a[28:31]
 ds_read_b64_tr_b16 v[128:129], v40 offset:8192
 v_mfma_f32_16x16x32_bf16 a[32:35], v[88:91], v[64:67], a[32:35]
 v_mfma_f32_16x16x32_bf16 a[36:39], v[88:91], v[68:71], a[36:39]
 ds_read_b64_tr_b16 v[130:131], v40 offset:9216
 v_mfma_f32_16x16x32_bf16 a[40:43], v[88:91], v[72:75], a[40:43]
 v_mfma_f32_16x16x32_bf16 a[44:47], v[88:91], v[76:79], a[44:47]
 ds_read_b64_tr_b16 v[132:133], v41 offset:8192
 v_mfma_f32_16x16x32_bf16 a[48:51], v[92:95], v[64:67], a[48:51]
 ds_read_b64_tr_b16 v[134:135], v41 offset:9216
 v_mfma_f32_16x16x32_bf16 a[52:55], v[92:95], v[68:71], a[52:55]
 v_mfma_f32_16x16x32_bf16 a[56:59], v[92:95], v[72:75], a[56:59]
 ds_read_b64_tr_b16 v[136:137], v42 offset:8192
 v_mfma_f32_16x16x32_bf16 a[60:63], v[92:95], v[76:79], a[60:63]
 ds_read_b64_tr_b16 v[138:139], v42 offset:9216
 v_mfma_f32_16x16x32_bf16 a[64:67], v[96:99], v[64:67], a[64:67]
 v_mfma_f32_16x16x32_bf16 a[68:71], v[96:99], v[68:71], a[68:71]
 ds_read_b64_tr_b16 v[140:141], v43 offset:8192
 v_mfma_f32_16x16x32_bf16 a[72:75], v[96:99], v[72:75], a[72:75]
 v_mfma_f32_16x16x32_bf16 a[76:79], v[96:99], v[76:79], a[76:79]
 ds_read_b64_tr_b16 v[142:143], v43 offset:9216
 v_mfma_f32_16x16x32_bf16 a[80:83], v[100:103], v[64:67], a[80:83]
 ds_read_b64_tr_b16 v[144:145], v44 offset:8192
 v_mfma_f32_16x16x32_bf16 a[84:87], v[100:103], v[68:71], a[84:87]
 v_mfma_f32_16x16x32_bf16 a[88:91], v[100:103], v[72:75], a[88:91]
 ds_read_b64_tr_b16 v[146:147], v44 offset:9216
 v_mfma_f32_16x16x32_bf16 a[92:95], v[100:103], v[76:79], a[92:95]
 ds_read_b64_tr_b16 v[148:149], v45 offset:8192
 v_mfma_f32_16x16x32_bf16 a[96:99], v[104:107], v[64:67], a[96:99]
 v_mfma_f32_16x16x32_bf16 a[100:103], v[104:107], v[68:71], a[100:103]
 ds_read_b64_tr_b16 v[150:151], v45 offset:9216
 v_mfma_f32_16x16x32_bf16 a[104:107], v[104:107], v[72:75], a[104:107]
 v_mfma_f32_16x16x32_bf16 a[108:111], v[104:107], v[76:79], a[108:111]
 ds_read_b64_tr_b16 v[152:153], v46 offset:8192
 v_mfma_f32_16x16x32_bf16 a[112:115], v[108:111], v[64:67], a[112:115]
 ds_read_b64_tr_b16 v[154:155], v46 offset:9216
 v_mfma_f32_16x16x32_bf16 a[116:119], v[108:111], v[68:71], a[116:119]
 v_mfma_f32_16x16x32_bf16 a[120:123], v[108:111], v[72:75], a[120:123]
 ds_read_b64_tr_b16 v[156:157], v47 offset:8192
 v_mfma_f32_16x16x32_bf16 a[124:127], v[108:111], v[76:79], a[124:127]
 ds_read_b64_tr_b16 v[158:159], v47 offset:9216
 s_waitcnt lgkmcnt(0)
 s_waitcnt vmcnt(12)
 s_barrier
 v_mfma_f32_16x16x32_bf16 a[0:3], v[128:131], v[112:115], a[0:3]
 s_add_u32 s63, s53, 896
 s_add_u32 m0, s62, 49152
 s_nop 0
 buffer_load_dwordx4 v8, s[12:15], s63 offen lds
 v_mfma_f32_16x16x32_bf16 a[4:7], v[128:131], v[116:119], a[4:7]
 s_add_u32 s63, s53, 10112
 s_add_u32 m0, s62, 50176
 s_nop 0
 buffer_load_dwordx4 v9, s[12:15], s63 offen lds
 v_mfma_f32_16x16x32_bf16 a[8:11], v[128:131], v[120:123], a[8:11]
 s_add_u32 s63, s53, 19328
 s_add_u32 m0, s62, 51200
 s_nop 0
 buffer_load_dwordx4 v8, s[12:15], s63 offen lds
 v_mfma_f32_16x16x32_bf16 a[12:15], v[128:131], v[124:127], a[12:15]
 s_add_u32 s63, s53, 28544
 s_add_u32 m0, s62, 52224
 s_nop 0
 buffer_load_dwordx4 v9, s[12:15], s63 offen lds
 v_mfma_f32_16x16x32_bf16 a[16:19], v[132:135], v[112:115], a[16:19]
 s_add_u32 s63, s60, 4128768
 s_add_u32 m0, s61, 49152
 s_nop 0
 buffer_load_dwordx4 v10, s[28:31], s63 offen lds
 v_mfma_f32_16x16x32_bf16 a[20:23], v[132:135], v[116:119], a[20:23]
 s_add_u32 s63, s60, 4165632
 s_add_u32 m0, s61, 50176
 s_nop 0
 buffer_load_dwordx4 v10, s[28:31], s63 offen lds
 v_mfma_f32_16x16x32_bf16 a[24:27], v[132:135], v[120:123], a[24:27]
 s_add_u32 s63, s60, 4202496
 s_add_u32 m0, s61, 51200
 s_nop 0
 buffer_load_dwordx4 v11, s[28:31], s63 offen lds
 v_mfma_f32_16x16x32_bf16 a[28:31], v[132:135], v[124:127], a[28:31]
 s_add_u32 s63, s60, 4239360
 s_add_u32 m0, s61, 52224
 s_nop 0
 buffer_load_dwordx4 v11, s[28:31], s63 offen lds
 v_mfma_f32_16x16x32_bf16 a[32:35], v[136:139], v[112:115], a[32:35]
 s_add_u32 s63, s60, 4276224
 s_add_u32 m0, s61, 53248
 s_nop 0
 buffer_load_dwordx4 v10, s[28:31], s63 offen lds
 v_mfma_f32_16x16x32_bf16 a[36:39], v[136:139], v[116:119], a[36:39]
 s_add_u32 s63, s60, 4313088
 s_add_u32 m0, s61, 54272
 s_nop 0
 buffer_load_dwordx4 v10, s[28:31], s63 offen lds
 v_mfma_f32_16x16x32_bf16 a[40:43], v[136:139], v[120:123], a[40:43]
 s_add_u32 s63, s60, 4349952
 s_add_u32 m0, s61, 55296
 s_nop 0
 buffer_load_dwordx4 v11, s[28:31], s63 offen lds
 v_mfma_f32_16x16x32_bf16 a[44:47], v[136:139], v[124:127], a[44:47]
 s_add_u32 s63, s60, 4386816
 s_add_u32 m0, s61, 56320
 s_nop 0
 buffer_load_dwordx4 v11, s[28:31], s63 offen lds
 v_mfma_f32_16x16x32_bf16 a[48:51], v[140:143], v[112:115], a[48:51]
 ds_read_b128 v[64:67], v20 offset:0
 v_mfma_f32_16x16x32_bf16 a[52:55], v[140:143], v[116:119], a[52:55]
 ds_read_b128 v[68:71], v20 offset:2048
 v_mfma_f32_16x16x32_bf16 a[56:59], v[140:143], v[120:123], a[56:59]
 ds_read_b128 v[72:75], v20 offset:4096
 v_mfma_f32_16x16x32_bf16 a[60:63], v[140:143], v[124:127], a[60:63]
 ds_read_b128 v[76:79], v20 offset:6144
 v_mfma_f32_16x16x32_bf16 a[64:67], v[144:147], v[112:115], a[64:67]
 ds_read_b64_tr_b16 v[80:81], v48 offset:0
 v_mfma_f32_16x16x32_bf16 a[68:71], v[144:147], v[116:119], a[68:71]
 ds_read_b64_tr_b16 v[82:83], v48 offset:1024
 v_mfma_f32_16x16x32_bf16 a[72:75], v[144:147], v[120:123], a[72:75]
 ds_read_b64_tr_b16 v[84:85], v49 offset:0
 v_mfma_f32_16x16x32_bf16 a[76:79], v[144:147], v[124:127], a[76:79]
 ds_read_b64_tr_b16 v[86:87], v49 offset:1024
 v_mfma_f32_16x16x32_bf16 a[80:83], v[148:151], v[112:115], a[80:83]
 ds_read_b64_tr_b16 v[88:89], v50 offset:0
 v_mfma_f32_16x16x32_bf16 a[84:87], v[148:151], v[116:119], a[84:87]
 ds_read_b64_tr_b16 v[90:91], v50 offset:1024
 v_mfma_f32_16x16x32_bf16 a[88:91], v[148:151], v[120:123], a[88:91]
 ds_read_b64_tr_b16 v[92:93], v51 offset:0
 v_mfma_f32_16x16x32_bf16 a[92:95], v[148:151], v[124:127], a[92:95]
 ds_read_b64_tr_b16 v[94:95], v51 offset:1024
 v_mfma_f32_16x16x32_bf16 a[96:99], v[152:155], v[112:115], a[96:99]
 ds_read_b64_tr_b16 v[96:97], v52 offset:0
 v_mfma_f32_16x16x32_bf16 a[100:103], v[152:155], v[116:119], a[100:103]
 ds_read_b64_tr_b16 v[98:99], v52 offset:1024
 v_mfma_f32_16x16x32_bf16 a[104:107], v[152:155], v[120:123], a[104:107]
 ds_read_b64_tr_b16 v[100:101], v53 offset:0
 v_mfma_f32_16x16x32_bf16 a[108:111], v[152:155], v[124:127], a[108:111]
 ds_read_b64_tr_b16 v[102:103], v53 offset:1024
 v_mfma_f32_16x16x32_bf16 a[112:115], v[156:159], v[112:115], a[112:115]
 ds_read_b64_tr_b16 v[104:105], v54 offset:0
 v_mfma_f32_16x16x32_bf16 a[116:119], v[156:159], v[116:119], a[116:119]
 ds_read_b64_tr_b16 v[106:107], v54 offset:1024
 v_mfma_f32_16x16x32_bf16 a[120:123], v[156:159], v[120:123], a[120:123]
 ds_read_b64_tr_b16 v[108:109], v55 offset:0
 v_mfma_f32_16x16x32_bf16 a[124:127], v[156:159], v[124:127], a[124:127]
 ds_read_b64_tr_b16 v[110:111], v55 offset:1024
 s_waitcnt lgkmcnt(0)
 v_mfma_f32_16x16x32_bf16 a[0:3], v[80:83], v[64:67], a[0:3]
 v_mfma_f32_16x16x32_bf16 a[4:7], v[80:83], v[68:71], a[4:7]
 ds_read_b128 v[112:115], v21 offset:0
 v_mfma_f32_16x16x32_bf16 a[8:11], v[80:83], v[72:75], a[8:11]
 v_mfma_f32_16x16x32_bf16 a[12:15], v[80:83], v[76:79], a[12:15]
 ds_read_b128 v[116:119], v21 offset:2048
 v_mfma_f32_16x16x32_bf16 a[16:19], v[84:87], v[64:67], a[16:19]
 ds_read_b128 v[120:123], v21 offset:4096
 v_mfma_f32_16x16x32_bf16 a[20:23], v[84:87], v[68:71], a[20:23]
 v_mfma_f32_16x16x32_bf16 a[24:27], v[84:87], v[72:75], a[24:27]
 ds_read_b128 v[124:127], v21 offset:6144
 v_mfma_f32_16x16x32_bf16 a[28:31], v[84:87], v[76:79], a[28:31]
 ds_read_b64_tr_b16 v[128:129], v48 offset:8192
 v_mfma_f32_16x16x32_bf16 a[32:35], v[88:91], v[64:67], a[32:35]
 v_mfma_f32_16x16x32_bf16 a[36:39], v[88:91], v[68:71], a[36:39]
 ds_read_b64_tr_b16 v[130:131], v48 offset:9216
 v_mfma_f32_16x16x32_bf16 a[40:43], v[88:91], v[72:75], a[40:43]
 v_mfma_f32_16x16x32_bf16 a[44:47], v[88:91], v[76:79], a[44:47]
 ds_read_b64_tr_b16 v[132:133], v49 offset:8192
 v_mfma_f32_16x16x32_bf16 a[48:51], v[92:95], v[64:67], a[48:51]
 ds_read_b64_tr_b16 v[134:135], v49 offset:9216
 v_mfma_f32_16x16x32_bf16 a[52:55], v[92:95], v[68:71], a[52:55]
 v_mfma_f32_16x16x32_bf16 a[56:59], v[92:95], v[72:75], a[56:59]
 ds_read_b64_tr_b16 v[136:137], v50 offset:8192
 v_mfma_f32_16x16x32_bf16 a[60:63], v[92:95], v[76:79], a[60:63]
 ds_read_b64_tr_b16 v[138:139], v50 offset:9216
 v_mfma_f32_16x16x32_bf16 a[64:67], v[96:99], v[64:67], a[64:67]
 v_mfma_f32_16x16x32_bf16 a[68:71], v[96:99], v[68:71], a[68:71]
 ds_read_b64_tr_b16 v[140:141], v51 offset:8192
 v_mfma_f32_16x16x32_bf16 a[72:75], v[96:99], v[72:75], a[72:75]
 v_mfma_f32_16x16x32_bf16 a[76:79], v[96:99], v[76:79], a[76:79]
 ds_read_b64_tr_b16 v[142:143], v51 offset:9216
 v_mfma_f32_16x16x32_bf16 a[80:83], v[100:103], v[64:67], a[80:83]
 ds_read_b64_tr_b16 v[144:145], v52 offset:8192
 v_mfma_f32_16x16x32_bf16 a[84:87], v[100:103], v[68:71], a[84:87]
 v_mfma_f32_16x16x32_bf16 a[88:91], v[100:103], v[72:75], a[88:91]
 ds_read_b64_tr_b16 v[146:147], v52 offset:9216
 v_mfma_f32_16x16x32_bf16 a[92:95], v[100:103], v[76:79], a[92:95]
 ds_read_b64_tr_b16 v[148:149], v53 offset:8192
 v_mfma_f32_16x16x32_bf16 a[96:99], v[104:107], v[64:67], a[96:99]
 v_mfma_f32_16x16x32_bf16 a[100:103], v[104:107], v[68:71], a[100:103]
 ds_read_b64_tr_b16 v[150:151], v53 offset:9216
 v_mfma_f32_16x16x32_bf16 a[104:107], v[104:107], v[72:75], a[104:107]
 v_mfma_f32_16x16x32_bf16 a[108:111], v[104:107], v[76:79], a[108:111]
 ds_read_b64_tr_b16 v[152:153], v54 offset:8192
 v_mfma_f32_16x16x32_bf16 a[112:115], v[108:111], v[64:67], a[112:115]
 ds_read_b64_tr_b16 v[154:155], v54 offset:9216
 v_mfma_f32_16x16x32_bf16 a[116:119], v[108:111], v[68:71], a[116:119]
 v_mfma_f32_16x16x32_bf16 a[120:123], v[108:111], v[72:75], a[120:123]
 ds_read_b64_tr_b16 v[156:157], v55 offset:8192
 v_mfma_f32_16x16x32_bf16 a[124:127], v[108:111], v[76:79], a[124:127]
 ds_read_b64_tr_b16 v[158:159], v55 offset:9216
 s_waitcnt lgkmcnt(0)
 s_waitcnt vmcnt(12)
 s_barrier
 v_mfma_f32_16x16x32_bf16 a[0:3], v[128:131], v[112:115], a[0:3]
 s_add_u32 s63, s53, 1024
 s_add_u32 m0, s62, 98304
 s_nop 0
 buffer_load_dwordx4 v8, s[12:15], s63 offen lds
 v_mfma_f32_16x16x32_bf16 a[4:7], v[128:131], v[116:119], a[4:7]
 s_add_u32 s63, s53, 10240
 s_add_u32 m0, s62, 99328
 s_nop 0
 buffer_load_dwordx4 v9, s[12:15], s63 offen lds
 v_mfma_f32_16x16x32_bf16 a[8:11], v[128:131], v[120:123], a[8:11]
 s_add_u32 s63, s53, 19456
 s_add_u32 m0, s62, 100352
 s_nop 0
 buffer_load_dwordx4 v8, s[12:15], s63 offen lds
 v_mfma_f32_16x16x32_bf16 a[12:15], v[128:131], v[124:127], a[12:15]
 s_add_u32 s63, s53, 28672
 s_add_u32 m0, s62, 101376
 s_nop 0
 buffer_load_dwordx4 v9, s[12:15], s63 offen lds
 v_mfma_f32_16x16x32_bf16 a[16:19], v[132:135], v[112:115], a[16:19]
 s_add_u32 s63, s60, 4718592
 s_add_u32 m0, s61, 98304
 s_nop 0
 buffer_load_dwordx4 v10, s[28:31], s63 offen lds
 v_mfma_f32_16x16x32_bf16 a[20:23], v[132:135], v[116:119], a[20:23]
 s_add_u32 s63, s60, 4755456
 s_add_u32 m0, s61, 99328
 s_nop 0
 buffer_load_dwordx4 v10, s[28:31], s63 offen lds
 v_mfma_f32_16x16x32_bf16 a[24:27], v[132:135], v[120:123], a[24:27]
 s_add_u32 s63, s60, 4792320
 s_add_u32 m0, s61, 100352
 s_nop 0
 buffer_load_dwordx4 v11, s[28:31], s63 offen lds
 v_mfma_f32_16x16x32_bf16 a[28:31], v[132:135], v[124:127], a[28:31]
 s_add_u32 s63, s60, 4829184
 s_add_u32 m0, s61, 101376
 s_nop 0
 buffer_load_dwordx4 v11, s[28:31], s63 offen lds
 v_mfma_f32_16x16x32_bf16 a[32:35], v[136:139], v[112:115], a[32:35]
 s_add_u32 s63, s60, 4866048
 s_add_u32 m0, s61, 102400
 s_nop 0
 buffer_load_dwordx4 v10, s[28:31], s63 offen lds
 v_mfma_f32_16x16x32_bf16 a[36:39], v[136:139], v[116:119], a[36:39]
 s_add_u32 s63, s60, 4902912
 s_add_u32 m0, s61, 103424
 s_nop 0
 buffer_load_dwordx4 v10, s[28:31], s63 offen lds
 v_mfma_f32_16x16x32_bf16 a[40:43], v[136:139], v[120:123], a[40:43]
 s_add_u32 s63, s60, 4939776
 s_add_u32 m0, s61, 104448
 s_nop 0
 buffer_load_dwordx4 v11, s[28:31], s63 offen lds
 v_mfma_f32_16x16x32_bf16 a[44:47], v[136:139], v[124:127], a[44:47]
 s_add_u32 s63, s60, 4976640
 s_add_u32 m0, s61, 105472
 s_nop 0
 buffer_load_dwordx4 v11, s[28:31], s63 offen lds
 v_mfma_f32_16x16x32_bf16 a[48:51], v[140:143], v[112:115], a[48:51]
 ds_read_b128 v[64:67], v16 offset:0
 v_mfma_f32_16x16x32_bf16 a[52:55], v[140:143], v[116:119], a[52:55]
 ds_read_b128 v[68:71], v16 offset:2048
 v_mfma_f32_16x16x32_bf16 a[56:59], v[140:143], v[120:123], a[56:59]
 ds_read_b128 v[72:75], v16 offset:4096
 v_mfma_f32_16x16x32_bf16 a[60:63], v[140:143], v[124:127], a[60:63]
 ds_read_b128 v[76:79], v16 offset:6144
 v_mfma_f32_16x16x32_bf16 a[64:67], v[144:147], v[112:115], a[64:67]
 ds_read_b64_tr_b16 v[80:81], v32 offset:0
 v_mfma_f32_16x16x32_bf16 a[68:71], v[144:147], v[116:119], a[68:71]
 ds_read_b64_tr_b16 v[82:83], v32 offset:1024
 v_mfma_f32_16x16x32_bf16 a[72:75], v[144:147], v[120:123], a[72:75]
 ds_read_b64_tr_b16 v[84:85], v33 offset:0
 v_mfma_f32_16x16x32_bf16 a[76:79], v[144:147], v[124:127], a[76:79]
 ds_read_b64_tr_b16 v[86:87], v33 offset:1024
 v_mfma_f32_16x16x32_bf16 a[80:83], v[148:151], v[112:115], a[80:83]
 ds_read_b64_tr_b16 v[88:89], v34 offset:0
 v_mfma_f32_16x16x32_bf16 a[84:87], v[148:151], v[116:119], a[84:87]
 ds_read_b64_tr_b16 v[90:91], v34 offset:1024
 v_mfma_f32_16x16x32_bf16 a[88:91], v[148:151], v[120:123], a[88:91]
 ds_read_b64_tr_b16 v[92:93], v35 offset:0
 v_mfma_f32_16x16x32_bf16 a[92:95], v[148:151], v[124:127], a[92:95]
 ds_read_b64_tr_b16 v[94:95], v35 offset:1024
 v_mfma_f32_16x16x32_bf16 a[96:99], v[152:155], v[112:115], a[96:99]
 ds_read_b64_tr_b16 v[96:97], v36 offset:0
 v_mfma_f32_16x16x32_bf16 a[100:103], v[152:155], v[116:119], a[100:103]
 ds_read_b64_tr_b16 v[98:99], v36 offset:1024
 v_mfma_f32_16x16x32_bf16 a[104:107], v[152:155], v[120:123], a[104:107]
 ds_read_b64_tr_b16 v[100:101], v37 offset:0
 v_mfma_f32_16x16x32_bf16 a[108:111], v[152:155], v[124:127], a[108:111]
 ds_read_b64_tr_b16 v[102:103], v37 offset:1024
 v_mfma_f32_16x16x32_bf16 a[112:115], v[156:159], v[112:115], a[112:115]
 ds_read_b64_tr_b16 v[104:105], v38 offset:0
 v_mfma_f32_16x16x32_bf16 a[116:119], v[156:159], v[116:119], a[116:119]
 ds_read_b64_tr_b16 v[106:107], v38 offset:1024
 v_mfma_f32_16x16x32_bf16 a[120:123], v[156:159], v[120:123], a[120:123]
 ds_read_b64_tr_b16 v[108:109], v39 offset:0
 v_mfma_f32_16x16x32_bf16 a[124:127], v[156:159], v[124:127], a[124:127]
 ds_read_b64_tr_b16 v[110:111], v39 offset:1024
 s_waitcnt lgkmcnt(0)
 v_mfma_f32_16x16x32_bf16 a[0:3], v[80:83], v[64:67], a[0:3]
 v_mfma_f32_16x16x32_bf16 a[4:7], v[80:83], v[68:71], a[4:7]
 ds_read_b128 v[112:115], v17 offset:0
 v_mfma_f32_16x16x32_bf16 a[8:11], v[80:83], v[72:75], a[8:11]
 v_mfma_f32_16x16x32_bf16 a[12:15], v[80:83], v[76:79], a[12:15]
 ds_read_b128 v[116:119], v17 offset:2048
 v_mfma_f32_16x16x32_bf16 a[16:19], v[84:87], v[64:67], a[16:19]
 ds_read_b128 v[120:123], v17 offset:4096
 v_mfma_f32_16x16x32_bf16 a[20:23], v[84:87], v[68:71], a[20:23]
 v_mfma_f32_16x16x32_bf16 a[24:27], v[84:87], v[72:75], a[24:27]
 ds_read_b128 v[124:127], v17 offset:6144
 v_mfma_f32_16x16x32_bf16 a[28:31], v[84:87], v[76:79], a[28:31]
 ds_read_b64_tr_b16 v[128:129], v32 offset:8192
 v_mfma_f32_16x16x32_bf16 a[32:35], v[88:91], v[64:67], a[32:35]
 v_mfma_f32_16x16x32_bf16 a[36:39], v[88:91], v[68:71], a[36:39]
 ds_read_b64_tr_b16 v[130:131], v32 offset:9216
 v_mfma_f32_16x16x32_bf16 a[40:43], v[88:91], v[72:75], a[40:43]
 v_mfma_f32_16x16x32_bf16 a[44:47], v[88:91], v[76:79], a[44:47]
 ds_read_b64_tr_b16 v[132:133], v33 offset:8192
 v_mfma_f32_16x16x32_bf16 a[48:51], v[92:95], v[64:67], a[48:51]
 ds_read_b64_tr_b16 v[134:135], v33 offset:9216
 v_mfma_f32_16x16x32_bf16 a[52:55], v[92:95], v[68:71], a[52:55]
 v_mfma_f32_16x16x32_bf16 a[56:59], v[92:95], v[72:75], a[56:59]
 ds_read_b64_tr_b16 v[136:137], v34 offset:8192
 v_mfma_f32_16x16x32_bf16 a[60:63], v[92:95], v[76:79], a[60:63]
 ds_read_b64_tr_b16 v[138:139], v34 offset:9216
 v_mfma_f32_16x16x32_bf16 a[64:67], v[96:99], v[64:67], a[64:67]
 v_mfma_f32_16x16x32_bf16 a[68:71], v[96:99], v[68:71], a[68:71]
 ds_read_b64_tr_b16 v[140:141], v35 offset:8192
 v_mfma_f32_16x16x32_bf16 a[72:75], v[96:99], v[72:75], a[72:75]
 v_mfma_f32_16x16x32_bf16 a[76:79], v[96:99], v[76:79], a[76:79]
 ds_read_b64_tr_b16 v[142:143], v35 offset:9216
 v_mfma_f32_16x16x32_bf16 a[80:83], v[100:103], v[64:67], a[80:83]
 ds_read_b64_tr_b16 v[144:145], v36 offset:8192
 v_mfma_f32_16x16x32_bf16 a[84:87], v[100:103], v[68:71], a[84:87]
 v_mfma_f32_16x16x32_bf16 a[88:91], v[100:103], v[72:75], a[88:91]
 ds_read_b64_tr_b16 v[146:147], v36 offset:9216
 v_mfma_f32_16x16x32_bf16 a[92:95], v[100:103], v[76:79], a[92:95]
 ds_read_b64_tr_b16 v[148:149], v37 offset:8192
 v_mfma_f32_16x16x32_bf16 a[96:99], v[104:107], v[64:67], a[96:99]
 v_mfma_f32_16x16x32_bf16 a[100:103], v[104:107], v[68:71], a[100:103]
 ds_read_b64_tr_b16 v[150:151], v37 offset:9216
 v_mfma_f32_16x16x32_bf16 a[104:107], v[104:107], v[72:75], a[104:107]
 v_mfma_f32_16x16x32_bf16 a[108:111], v[104:107], v[76:79], a[108:111]
 ds_read_b64_tr_b16 v[152:153], v38 offset:8192
 v_mfma_f32_16x16x32_bf16 a[112:115], v[108:111], v[64:67], a[112:115]
 ds_read_b64_tr_b16 v[154:155], v38 offset:9216
 v_mfma_f32_16x16x32_bf16 a[116:119], v[108:111], v[68:71], a[116:119]
 v_mfma_f32_16x16x32_bf16 a[120:123], v[108:111], v[72:75], a[120:123]
 ds_read_b64_tr_b16 v[156:157], v39 offset:8192
 v_mfma_f32_16x16x32_bf16 a[124:127], v[108:111], v[76:79], a[124:127]
 ds_read_b64_tr_b16 v[158:159], v39 offset:9216
 s_waitcnt lgkmcnt(0)
 s_waitcnt vmcnt(12)
 s_barrier
 v_mfma_f32_16x16x32_bf16 a[0:3], v[128:131], v[112:115], a[0:3]
 v_mfma_f32_16x16x32_bf16 a[4:7], v[128:131], v[116:119], a[4:7]
 ds_read_b128 v[64:67], v18 offset:0
 v_mfma_f32_16x16x32_bf16 a[8:11], v[128:131], v[120:123], a[8:11]
 v_mfma_f32_16x16x32_bf16 a[12:15], v[128:131], v[124:127], a[12:15]
 ds_read_b128 v[68:71], v18 offset:2048
 v_mfma_f32_16x16x32_bf16 a[16:19], v[132:135], v[112:115], a[16:19]
 ds_read_b128 v[72:75], v18 offset:4096
 v_mfma_f32_16x16x32_bf16 a[20:23], v[132:135], v[116:119], a[20:23]
 v_mfma_f32_16x16x32_bf16 a[24:27], v[132:135], v[120:123], a[24:27]
 ds_read_b128 v[76:79], v18 offset:6144
 v_mfma_f32_16x16x32_bf16 a[28:31], v[132:135], v[124:127], a[28:31]
 ds_read_b64_tr_b16 v[80:81], v40 offset:0
 v_mfma_f32_16x16x32_bf16 a[32:35], v[136:139], v[112:115], a[32:35]
 v_mfma_f32_16x16x32_bf16 a[36:39], v[136:139], v[116:119], a[36:39]
 ds_read_b64_tr_b16 v[82:83], v40 offset:1024
 v_mfma_f32_16x16x32_bf16 a[40:43], v[136:139], v[120:123], a[40:43]
 v_mfma_f32_16x16x32_bf16 a[44:47], v[136:139], v[124:127], a[44:47]
 ds_read_b64_tr_b16 v[84:85], v41 offset:0
 v_mfma_f32_16x16x32_bf16 a[48:51], v[140:143], v[112:115], a[48:51]
 ds_read_b64_tr_b16 v[86:87], v41 offset:1024
 v_mfma_f32_16x16x32_bf16 a[52:55], v[140:143], v[116:119], a[52:55]
 v_mfma_f32_16x16x32_bf16 a[56:59], v[140:143], v[120:123], a[56:59]
 ds_read_b64_tr_b16 v[88:89], v42 offset:0
 v_mfma_f32_16x16x32_bf16 a[60:63], v[140:143], v[124:127], a[60:63]
 ds_read_b64_tr_b16 v[90:91], v42 offset:1024
 v_mfma_f32_16x16x32_bf16 a[64:67], v[144:147], v[112:115], a[64:67]
 v_mfma_f32_16x16x32_bf16 a[68:71], v[144:147], v[116:119], a[68:71]
 ds_read_b64_tr_b16 v[92:93], v43 offset:0
 v_mfma_f32_16x16x32_bf16 a[72:75], v[144:147], v[120:123], a[72:75]
 v_mfma_f32_16x16x32_bf16 a[76:79], v[144:147], v[124:127], a[76:79]
 ds_read_b64_tr_b16 v[94:95], v43 offset:1024
 v_mfma_f32_16x16x32_bf16 a[80:83], v[148:151], v[112:115], a[80:83]
 ds_read_b64_tr_b16 v[96:97], v44 offset:0
 v_mfma_f32_16x16x32_bf16 a[84:87], v[148:151], v[116:119], a[84:87]
 v_mfma_f32_16x16x32_bf16 a[88:91], v[148:151], v[120:123], a[88:91]
 ds_read_b64_tr_b16 v[98:99], v44 offset:1024
 v_mfma_f32_16x16x32_bf16 a[92:95], v[148:151], v[124:127], a[92:95]
 ds_read_b64_tr_b16 v[100:101], v45 offset:0
 v_mfma_f32_16x16x32_bf16 a[96:99], v[152:155], v[112:115], a[96:99]
 v_mfma_f32_16x16x32_bf16 a[100:103], v[152:155], v[116:119], a[100:103]
 ds_read_b64_tr_b16 v[102:103], v45 offset:1024
 v_mfma_f32_16x16x32_bf16 a[104:107], v[152:155], v[120:123], a[104:107]
 v_mfma_f32_16x16x32_bf16 a[108:111], v[152:155], v[124:127], a[108:111]
 ds_read_b64_tr_b16 v[104:105], v46 offset:0
 v_mfma_f32_16x16x32_bf16 a[112:115], v[156:159], v[112:115], a[112:115]
 ds_read_b64_tr_b16 v[106:107], v46 offset:1024
 v_mfma_f32_16x16x32_bf16 a[116:119], v[156:159], v[116:119], a[116:119]
 v_mfma_f32_16x16x32_bf16 a[120:123], v[156:159], v[120:123], a[120:123]
 ds_read_b64_tr_b16 v[108:109], v47 offset:0
 v_mfma_f32_16x16x32_bf16 a[124:127], v[156:159], v[124:127], a[124:127]
 ds_read_b64_tr_b16 v[110:111], v47 offset:1024
 s_waitcnt lgkmcnt(0)
 v_mfma_f32_16x16x32_bf16 a[0:3], v[80:83], v[64:67], a[0:3]
 v_mfma_f32_16x16x32_bf16 a[4:7], v[80:83], v[68:71], a[4:7]
 ds_read_b128 v[112:115], v19 offset:0
 v_mfma_f32_16x16x32_bf16 a[8:11], v[80:83], v[72:75], a[8:11]
 v_mfma_f32_16x16x32_bf16 a[12:15], v[80:83], v[76:79], a[12:15]
 ds_read_b128 v[116:119], v19 offset:2048
 v_mfma_f32_16x16x32_bf16 a[16:19], v[84:87], v[64:67], a[16:19]
 ds_read_b128 v[120:123], v19 offset:4096
 v_mfma_f32_16x16x32_bf16 a[20:23], v[84:87], v[68:71], a[20:23]
 v_mfma_f32_16x16x32_bf16 a[24:27], v[84:87], v[72:75], a[24:27]
 ds_read_b128 v[124:127], v19 offset:6144
 v_mfma_f32_16x16x32_bf16 a[28:31], v[84:87], v[76:79], a[28:31]
 ds_read_b64_tr_b16 v[128:129], v40 offset:8192
 v_mfma_f32_16x16x32_bf16 a[32:35], v[88:91], v[64:67], a[32:35]
 v_mfma_f32_16x16x32_bf16 a[36:39], v[88:91], v[68:71], a[36:39]
 ds_read_b64_tr_b16 v[130:131], v40 offset:9216
 v_mfma_f32_16x16x32_bf16 a[40:43], v[88:91], v[72:75], a[40:43]
 v_mfma_f32_16x16x32_bf16 a[44:47], v[88:91], v[76:79], a[44:47]
 ds_read_b64_tr_b16 v[132:133], v41 offset:8192
 v_mfma_f32_16x16x32_bf16 a[48:51], v[92:95], v[64:67], a[48:51]
 ds_read_b64_tr_b16 v[134:135], v41 offset:9216
 v_mfma_f32_16x16x32_bf16 a[52:55], v[92:95], v[68:71], a[52:55]
 v_mfma_f32_16x16x32_bf16 a[56:59], v[92:95], v[72:75], a[56:59]
 ds_read_b64_tr_b16 v[136:137], v42 offset:8192
 v_mfma_f32_16x16x32_bf16 a[60:63], v[92:95], v[76:79], a[60:63]
 ds_read_b64_tr_b16 v[138:139], v42 offset:9216
 v_mfma_f32_16x16x32_bf16 a[64:67], v[96:99], v[64:67], a[64:67]
 v_mfma_f32_16x16x32_bf16 a[68:71], v[96:99], v[68:71], a[68:71]
 ds_read_b64_tr_b16 v[140:141], v43 offset:8192
 v_mfma_f32_16x16x32_bf16 a[72:75], v[96:99], v[72:75], a[72:75]
 v_mfma_f32_16x16x32_bf16 a[76:79], v[96:99], v[76:79], a[76:79]
 ds_read_b64_tr_b16 v[142:143], v43 offset:9216
 v_mfma_f32_16x16x32_bf16 a[80:83], v[100:103], v[64:67], a[80:83]
 ds_read_b64_tr_b16 v[144:145], v44 offset:8192
 v_mfma_f32_16x16x32_bf16 a[84:87], v[100:103], v[68:71], a[84:87]
 v_mfma_f32_16x16x32_bf16 a[88:91], v[100:103], v[72:75], a[88:91]
 ds_read_b64_tr_b16 v[146:147], v44 offset:9216
 v_mfma_f32_16x16x32_bf16 a[92:95], v[100:103], v[76:79], a[92:95]
 ds_read_b64_tr_b16 v[148:149], v45 offset:8192
 v_mfma_f32_16x16x32_bf16 a[96:99], v[104:107], v[64:67], a[96:99]
 v_mfma_f32_16x16x32_bf16 a[100:103], v[104:107], v[68:71], a[100:103]
 ds_read_b64_tr_b16 v[150:151], v45 offset:9216
 v_mfma_f32_16x16x32_bf16 a[104:107], v[104:107], v[72:75], a[104:107]
 v_mfma_f32_16x16x32_bf16 a[108:111], v[104:107], v[76:79], a[108:111]
 ds_read_b64_tr_b16 v[152:153], v46 offset:8192
 v_mfma_f32_16x16x32_bf16 a[112:115], v[108:111], v[64:67], a[112:115]
 ds_read_b64_tr_b16 v[154:155], v46 offset:9216
 v_mfma_f32_16x16x32_bf16 a[116:119], v[108:111], v[68:71], a[116:119]
 v_mfma_f32_16x16x32_bf16 a[120:123], v[108:111], v[72:75], a[120:123]
 ds_read_b64_tr_b16 v[156:157], v47 offset:8192
 v_mfma_f32_16x16x32_bf16 a[124:127], v[108:111], v[76:79], a[124:127]
 ds_read_b64_tr_b16 v[158:159], v47 offset:9216
 s_waitcnt lgkmcnt(0)
 s_waitcnt vmcnt(0)
 s_barrier
 v_mfma_f32_16x16x32_bf16 a[0:3], v[128:131], v[112:115], a[0:3]
 v_mfma_f32_16x16x32_bf16 a[4:7], v[128:131], v[116:119], a[4:7]
 ds_read_b128 v[64:67], v20 offset:0
 v_mfma_f32_16x16x32_bf16 a[8:11], v[128:131], v[120:123], a[8:11]
 v_mfma_f32_16x16x32_bf16 a[12:15], v[128:131], v[124:127], a[12:15]
 ds_read_b128 v[68:71], v20 offset:2048
 v_mfma_f32_16x16x32_bf16 a[16:19], v[132:135], v[112:115], a[16:19]
 ds_read_b128 v[72:75], v20 offset:4096
 v_mfma_f32_16x16x32_bf16 a[20:23], v[132:135], v[116:119], a[20:23]
 v_mfma_f32_16x16x32_bf16 a[24:27], v[132:135], v[120:123], a[24:27]
 ds_read_b128 v[76:79], v20 offset:6144
 v_mfma_f32_16x16x32_bf16 a[28:31], v[132:135], v[124:127], a[28:31]
 ds_read_b64_tr_b16 v[80:81], v48 offset:0
 v_mfma_f32_16x16x32_bf16 a[32:35], v[136:139], v[112:115], a[32:35]
 v_mfma_f32_16x16x32_bf16 a[36:39], v[136:139], v[116:119], a[36:39]
 ds_read_b64_tr_b16 v[82:83], v48 offset:1024
 v_mfma_f32_16x16x32_bf16 a[40:43], v[136:139], v[120:123], a[40:43]
 v_mfma_f32_16x16x32_bf16 a[44:47], v[136:139], v[124:127], a[44:47]
 ds_read_b64_tr_b16 v[84:85], v49 offset:0
 v_mfma_f32_16x16x32_bf16 a[48:51], v[140:143], v[112:115], a[48:51]
 ds_read_b64_tr_b16 v[86:87], v49 offset:1024
 v_mfma_f32_16x16x32_bf16 a[52:55], v[140:143], v[116:119], a[52:55]
 v_mfma_f32_16x16x32_bf16 a[56:59], v[140:143], v[120:123], a[56:59]
 ds_read_b64_tr_b16 v[88:89], v50 offset:0
 v_mfma_f32_16x16x32_bf16 a[60:63], v[140:143], v[124:127], a[60:63]
 ds_read_b64_tr_b16 v[90:91], v50 offset:1024
 v_mfma_f32_16x16x32_bf16 a[64:67], v[144:147], v[112:115], a[64:67]
 v_mfma_f32_16x16x32_bf16 a[68:71], v[144:147], v[116:119], a[68:71]
 ds_read_b64_tr_b16 v[92:93], v51 offset:0
 v_mfma_f32_16x16x32_bf16 a[72:75], v[144:147], v[120:123], a[72:75]
 v_mfma_f32_16x16x32_bf16 a[76:79], v[144:147], v[124:127], a[76:79]
 ds_read_b64_tr_b16 v[94:95], v51 offset:1024
 v_mfma_f32_16x16x32_bf16 a[80:83], v[148:151], v[112:115], a[80:83]
 ds_read_b64_tr_b16 v[96:97], v52 offset:0
 v_mfma_f32_16x16x32_bf16 a[84:87], v[148:151], v[116:119], a[84:87]
 v_mfma_f32_16x16x32_bf16 a[88:91], v[148:151], v[120:123], a[88:91]
 ds_read_b64_tr_b16 v[98:99], v52 offset:1024
 v_mfma_f32_16x16x32_bf16 a[92:95], v[148:151], v[124:127], a[92:95]
 ds_read_b64_tr_b16 v[100:101], v53 offset:0
 v_mfma_f32_16x16x32_bf16 a[96:99], v[152:155], v[112:115], a[96:99]
 v_mfma_f32_16x16x32_bf16 a[100:103], v[152:155], v[116:119], a[100:103]
 ds_read_b64_tr_b16 v[102:103], v53 offset:1024
 v_mfma_f32_16x16x32_bf16 a[104:107], v[152:155], v[120:123], a[104:107]
 v_mfma_f32_16x16x32_bf16 a[108:111], v[152:155], v[124:127], a[108:111]
 ds_read_b64_tr_b16 v[104:105], v54 offset:0
 v_mfma_f32_16x16x32_bf16 a[112:115], v[156:159], v[112:115], a[112:115]
 ds_read_b64_tr_b16 v[106:107], v54 offset:1024
 v_mfma_f32_16x16x32_bf16 a[116:119], v[156:159], v[116:119], a[116:119]
 v_mfma_f32_16x16x32_bf16 a[120:123], v[156:159], v[120:123], a[120:123]
 ds_read_b64_tr_b16 v[108:109], v55 offset:0
 v_mfma_f32_16x16x32_bf16 a[124:127], v[156:159], v[124:127], a[124:127]
 ds_read_b64_tr_b16 v[110:111], v55 offset:1024
 s_waitcnt lgkmcnt(0)
 v_mfma_f32_16x16x32_bf16 a[0:3], v[80:83], v[64:67], a[0:3]
 v_mfma_f32_16x16x32_bf16 a[4:7], v[80:83], v[68:71], a[4:7]
 ds_read_b128 v[112:115], v21 offset:0
 v_mfma_f32_16x16x32_bf16 a[8:11], v[80:83], v[72:75], a[8:11]
 v_mfma_f32_16x16x32_bf16 a[12:15], v[80:83], v[76:79], a[12:15]
 ds_read_b128 v[116:119], v21 offset:2048
 v_mfma_f32_16x16x32_bf16 a[16:19], v[84:87], v[64:67], a[16:19]
 ds_read_b128 v[120:123], v21 offset:4096
 v_mfma_f32_16x16x32_bf16 a[20:23], v[84:87], v[68:71], a[20:23]
 v_mfma_f32_16x16x32_bf16 a[24:27], v[84:87], v[72:75], a[24:27]
 ds_read_b128 v[124:127], v21 offset:6144
 v_mfma_f32_16x16x32_bf16 a[28:31], v[84:87], v[76:79], a[28:31]
 ds_read_b64_tr_b16 v[128:129], v48 offset:8192
 v_mfma_f32_16x16x32_bf16 a[32:35], v[88:91], v[64:67], a[32:35]
 v_mfma_f32_16x16x32_bf16 a[36:39], v[88:91], v[68:71], a[36:39]
 ds_read_b64_tr_b16 v[130:131], v48 offset:9216
 v_mfma_f32_16x16x32_bf16 a[40:43], v[88:91], v[72:75], a[40:43]
 v_mfma_f32_16x16x32_bf16 a[44:47], v[88:91], v[76:79], a[44:47]
 ds_read_b64_tr_b16 v[132:133], v49 offset:8192
 v_mfma_f32_16x16x32_bf16 a[48:51], v[92:95], v[64:67], a[48:51]
 ds_read_b64_tr_b16 v[134:135], v49 offset:9216
 v_mfma_f32_16x16x32_bf16 a[52:55], v[92:95], v[68:71], a[52:55]
 v_mfma_f32_16x16x32_bf16 a[56:59], v[92:95], v[72:75], a[56:59]
 ds_read_b64_tr_b16 v[136:137], v50 offset:8192
 v_mfma_f32_16x16x32_bf16 a[60:63], v[92:95], v[76:79], a[60:63]
 ds_read_b64_tr_b16 v[138:139], v50 offset:9216
 v_mfma_f32_16x16x32_bf16 a[64:67], v[96:99], v[64:67], a[64:67]
 v_mfma_f32_16x16x32_bf16 a[68:71], v[96:99], v[68:71], a[68:71]
 ds_read_b64_tr_b16 v[140:141], v51 offset:8192
 v_mfma_f32_16x16x32_bf16 a[72:75], v[96:99], v[72:75], a[72:75]
 v_mfma_f32_16x16x32_bf16 a[76:79], v[96:99], v[76:79], a[76:79]
 ds_read_b64_tr_b16 v[142:143], v51 offset:9216
 v_mfma_f32_16x16x32_bf16 a[80:83], v[100:103], v[64:67], a[80:83]
 ds_read_b64_tr_b16 v[144:145], v52 offset:8192
 v_mfma_f32_16x16x32_bf16 a[84:87], v[100:103], v[68:71], a[84:87]
 v_mfma_f32_16x16x32_bf16 a[88:91], v[100:103], v[72:75], a[88:91]
 ds_read_b64_tr_b16 v[146:147], v52 offset:9216
 v_mfma_f32_16x16x32_bf16 a[92:95], v[100:103], v[76:79], a[92:95]
 ds_read_b64_tr_b16 v[148:149], v53 offset:8192
 v_mfma_f32_16x16x32_bf16 a[96:99], v[104:107], v[64:67], a[96:99]
 v_mfma_f32_16x16x32_bf16 a[100:103], v[104:107], v[68:71], a[100:103]
 ds_read_b64_tr_b16 v[150:151], v53 offset:9216
 v_mfma_f32_16x16x32_bf16 a[104:107], v[104:107], v[72:75], a[104:107]
 v_mfma_f32_16x16x32_bf16 a[108:111], v[104:107], v[76:79], a[108:111]
 ds_read_b64_tr_b16 v[152:153], v54 offset:8192
 v_mfma_f32_16x16x32_bf16 a[112:115], v[108:111], v[64:67], a[112:115]
 ds_read_b64_tr_b16 v[154:155], v54 offset:9216
 v_mfma_f32_16x16x32_bf16 a[116:119], v[108:111], v[68:71], a[116:119]
 v_mfma_f32_16x16x32_bf16 a[120:123], v[108:111], v[72:75], a[120:123]
 ds_read_b64_tr_b16 v[156:157], v55 offset:8192
 v_mfma_f32_16x16x32_bf16 a[124:127], v[108:111], v[76:79], a[124:127]
 ds_read_b64_tr_b16 v[158:159], v55 offset:9216
 s_waitcnt lgkmcnt(0)
 v_mfma_f32_16x16x32_bf16 a[0:3], v[128:131], v[112:115], a[0:3]
 v_mfma_f32_16x16x32_bf16 a[4:7], v[128:131], v[116:119], a[4:7]
 v_mfma_f32_16x16x32_bf16 a[8:11], v[128:131], v[120:123], a[8:11]
 v_mfma_f32_16x16x32_bf16 a[12:15], v[128:131], v[124:127], a[12:15]
 v_mfma_f32_16x16x32_bf16 a[16:19], v[132:135], v[112:115], a[16:19]
 v_mfma_f32_16x16x32_bf16 a[20:23], v[132:135], v[116:119], a[20:23]
 v_mfma_f32_16x16x32_bf16 a[24:27], v[132:135], v[120:123], a[24:27]
 v_mfma_f32_16x16x32_bf16 a[28:31], v[132:135], v[124:127], a[28:31]
 v_mfma_f32_16x16x32_bf16 a[32:35], v[136:139], v[112:115], a[32:35]
 v_mfma_f32_16x16x32_bf16 a[36:39], v[136:139], v[116:119], a[36:39]
 v_mfma_f32_16x16x32_bf16 a[40:43], v[136:139], v[120:123], a[40:43]
 v_mfma_f32_16x16x32_bf16 a[44:47], v[136:139], v[124:127], a[44:47]
 v_mfma_f32_16x16x32_bf16 a[48:51], v[140:143], v[112:115], a[48:51]
 v_mfma_f32_16x16x32_bf16 a[52:55], v[140:143], v[116:119], a[52:55]
 v_mfma_f32_16x16x32_bf16 a[56:59], v[140:143], v[120:123], a[56:59]
 v_mfma_f32_16x16x32_bf16 a[60:63], v[140:143], v[124:127], a[60:63]
 v_mfma_f32_16x16x32_bf16 a[64:67], v[144:147], v[112:115], a[64:67]
 v_mfma_f32_16x16x32_bf16 a[68:71], v[144:147], v[116:119], a[68:71]
 v_mfma_f32_16x16x32_bf16 a[72:75], v[144:147], v[120:123], a[72:75]
 v_mfma_f32_16x16x32_bf16 a[76:79], v[144:147], v[124:127], a[76:79]
 v_mfma_f32_16x16x32_bf16 a[80:83], v[148:151], v[112:115], a[80:83]
 v_mfma_f32_16x16x32_bf16 a[84:87], v[148:151], v[116:119], a[84:87]
 v_mfma_f32_16x16x32_bf16 a[88:91], v[148:151], v[120:123], a[88:91]
 v_mfma_f32_16x16x32_bf16 a[92:95], v[148:151], v[124:127], a[92:95]
 v_mfma_f32_16x16x32_bf16 a[96:99], v[152:155], v[112:115], a[96:99]
 v_mfma_f32_16x16x32_bf16 a[100:103], v[152:155], v[116:119], a[100:103]
 v_mfma_f32_16x16x32_bf16 a[104:107], v[152:155], v[120:123], a[104:107]
 v_mfma_f32_16x16x32_bf16 a[108:111], v[152:155], v[124:127], a[108:111]
 v_mfma_f32_16x16x32_bf16 a[112:115], v[156:159], v[112:115], a[112:115]
 v_mfma_f32_16x16x32_bf16 a[116:119], v[156:159], v[116:119], a[116:119]
 v_mfma_f32_16x16x32_bf16 a[120:123], v[156:159], v[120:123], a[120:123]
 v_mfma_f32_16x16x32_bf16 a[124:127], v[156:159], v[124:127], a[124:127]
 s_nop 7
 s_nop 7
 s_lshr_b32 s58, s54, 1
 s_lshl_b32 s58, s58, 6
 s_lshl_b32 s59, s45, 7
 s_add_u32 s58, s58, s59
 v_add_u32 v5, s58, v4
 s_movk_i32 s59, 9216
 v_mul_lo_u32 v5, v5, s59
 v_lshl_add_u32 v5, v3, 3, v5
 s_and_b32 s58, s54, 1
 s_lshl_b32 s58, s58, 7
 s_add_u32 s50, s50, s58
 s_mov_b32 s40, 0x3d372713
 s_mov_b32 s41, 0xc0135761
 s_add_u32 s58, s50, 0
 v_accvgpr_read_b32 v64, a0
 v_accvgpr_read_b32 v65, a1
 v_accvgpr_read_b32 v66, a2
 v_accvgpr_read_b32 v67, a3
 v_accvgpr_read_b32 v68, a64
 v_accvgpr_read_b32 v69, a65
 v_accvgpr_read_b32 v70, a66
 v_accvgpr_read_b32 v71, a67
 v_cvt_pk_bf16_f32 v72, v64, v65
 v_cvt_pk_bf16_f32 v73, v66, v67
 v_cvt_pk_bf16_f32 v74, v68, v69
 v_cvt_pk_bf16_f32 v75, v70, v71
 v_lshlrev_b32 v64, 16, v72
 v_lshlrev_b32 v68, 16, v74
 v_and_b32 v65, 0xffff0000, v72
 v_and_b32 v69, 0xffff0000, v74
 v_lshlrev_b32 v66, 16, v73
 v_lshlrev_b32 v70, 16, v75
 v_and_b32 v67, 0xffff0000, v73
 v_and_b32 v71, 0xffff0000, v75
 v_mul_f32 v76, v64, v64
 v_mul_f32 v76, v76, v64
 v_fma_f32 v76, v76, s40, v64
 v_mul_f32 v76, s41, v76
 v_exp_f32 v76, v76
 v_mul_f32 v77, v65, v65
 v_mul_f32 v77, v77, v65
 v_fma_f32 v77, v77, s40, v65
 v_mul_f32 v77, s41, v77
 v_exp_f32 v77, v77
 v_mul_f32 v78, v66, v66
 v_mul_f32 v78, v78, v66
 v_fma_f32 v78, v78, s40, v66
 v_mul_f32 v78, s41, v78
 v_exp_f32 v78, v78
 v_mul_f32 v79, v67, v67
 v_mul_f32 v79, v79, v67
 v_fma_f32 v79, v79, s40, v67
 v_mul_f32 v79, s41, v79
 v_exp_f32 v79, v79
 v_add_f32 v76, 1.0, v76
 v_add_f32 v77, 1.0, v77
 v_add_f32 v78, 1.0, v78
 v_add_f32 v79, 1.0, v79
 v_rcp_f32 v76, v76
 v_rcp_f32 v77, v77
 v_rcp_f32 v78, v78
 v_rcp_f32 v79, v79
 s_nop 0
 v_mul_f32 v64, v64, v76
 v_mul_f32 v65, v65, v77
 v_mul_f32 v66, v66, v78
 v_mul_f32 v67, v67, v79
 v_cvt_pk_bf16_f32 v72, v64, v65
 v_cvt_pk_bf16_f32 v73, v66, v67
 v_lshlrev_b32 v64, 16, v72
 v_and_b32 v65, 0xffff0000, v72
 v_lshlrev_b32 v66, 16, v73
 v_and_b32 v67, 0xffff0000, v73
 v_mul_f32 v64, v64, v68
 v_mul_f32 v65, v65, v69
 v_mul_f32 v66, v66, v70
 v_mul_f32 v67, v67, v71
 v_cvt_pk_bf16_f32 v80, v64, v65
 v_cvt_pk_bf16_f32 v81, v66, v67
 buffer_store_dwordx2 v[80:81], v5, s[24:27], s58 offen offset:0 sc1
 v_accvgpr_read_b32 v64, a16
 v_accvgpr_read_b32 v65, a17
 v_accvgpr_read_b32 v66, a18
 v_accvgpr_read_b32 v67, a19
 v_accvgpr_read_b32 v68, a80
 v_accvgpr_read_b32 v69, a81
 v_accvgpr_read_b32 v70, a82
 v_accvgpr_read_b32 v71, a83
 v_cvt_pk_bf16_f32 v72, v64, v65
 v_cvt_pk_bf16_f32 v73, v66, v67
 v_cvt_pk_bf16_f32 v74, v68, v69
 v_cvt_pk_bf16_f32 v75, v70, v71
 v_lshlrev_b32 v64, 16, v72
 v_lshlrev_b32 v68, 16, v74
 v_and_b32 v65, 0xffff0000, v72
 v_and_b32 v69, 0xffff0000, v74
 v_lshlrev_b32 v66, 16, v73
 v_lshlrev_b32 v70, 16, v75
 v_and_b32 v67, 0xffff0000, v73
 v_and_b32 v71, 0xffff0000, v75
 v_mul_f32 v76, v64, v64
 v_mul_f32 v76, v76, v64
 v_fma_f32 v76, v76, s40, v64
 v_mul_f32 v76, s41, v76
 v_exp_f32 v76, v76
 v_mul_f32 v77, v65, v65
 v_mul_f32 v77, v77, v65
 v_fma_f32 v77, v77, s40, v65
 v_mul_f32 v77, s41, v77
 v_exp_f32 v77, v77
 v_mul_f32 v78, v66, v66
 v_mul_f32 v78, v78, v66
 v_fma_f32 v78, v78, s40, v66
 v_mul_f32 v78, s41, v78
 v_exp_f32 v78, v78
 v_mul_f32 v79, v67, v67
 v_mul_f32 v79, v79, v67
 v_fma_f32 v79, v79, s40, v67
 v_mul_f32 v79, s41, v79
 v_exp_f32 v79, v79
 v_add_f32 v76, 1.0, v76
 v_add_f32 v77, 1.0, v77
 v_add_f32 v78, 1.0, v78
 v_add_f32 v79, 1.0, v79
 v_rcp_f32 v76, v76
 v_rcp_f32 v77, v77
 v_rcp_f32 v78, v78
 v_rcp_f32 v79, v79
 s_nop 0
 v_mul_f32 v64, v64, v76
 v_mul_f32 v65, v65, v77
 v_mul_f32 v66, v66, v78
 v_mul_f32 v67, v67, v79
 v_cvt_pk_bf16_f32 v72, v64, v65
 v_cvt_pk_bf16_f32 v73, v66, v67
 v_lshlrev_b32 v64, 16, v72
 v_and_b32 v65, 0xffff0000, v72
 v_lshlrev_b32 v66, 16, v73
 v_and_b32 v67, 0xffff0000, v73
 v_mul_f32 v64, v64, v68
 v_mul_f32 v65, v65, v69
 v_mul_f32 v66, v66, v70
 v_mul_f32 v67, v67, v71
 v_cvt_pk_bf16_f32 v80, v64, v65
 v_cvt_pk_bf16_f32 v81, v66, v67
 buffer_store_dwordx2 v[80:81], v5, s[24:27], s58 offen offset:32 sc1
 v_accvgpr_read_b32 v64, a32
 v_accvgpr_read_b32 v65, a33
 v_accvgpr_read_b32 v66, a34
 v_accvgpr_read_b32 v67, a35
 v_accvgpr_read_b32 v68, a96
 v_accvgpr_read_b32 v69, a97
 v_accvgpr_read_b32 v70, a98
 v_accvgpr_read_b32 v71, a99
 v_cvt_pk_bf16_f32 v72, v64, v65
 v_cvt_pk_bf16_f32 v73, v66, v67
 v_cvt_pk_bf16_f32 v74, v68, v69
 v_cvt_pk_bf16_f32 v75, v70, v71
 v_lshlrev_b32 v64, 16, v72
 v_lshlrev_b32 v68, 16, v74
 v_and_b32 v65, 0xffff0000, v72
 v_and_b32 v69, 0xffff0000, v74
 v_lshlrev_b32 v66, 16, v73
 v_lshlrev_b32 v70, 16, v75
 v_and_b32 v67, 0xffff0000, v73
 v_and_b32 v71, 0xffff0000, v75
 v_mul_f32 v76, v64, v64
 v_mul_f32 v76, v76, v64
 v_fma_f32 v76, v76, s40, v64
 v_mul_f32 v76, s41, v76
 v_exp_f32 v76, v76
 v_mul_f32 v77, v65, v65
 v_mul_f32 v77, v77, v65
 v_fma_f32 v77, v77, s40, v65
 v_mul_f32 v77, s41, v77
 v_exp_f32 v77, v77
 v_mul_f32 v78, v66, v66
 v_mul_f32 v78, v78, v66
 v_fma_f32 v78, v78, s40, v66
 v_mul_f32 v78, s41, v78
 v_exp_f32 v78, v78
 v_mul_f32 v79, v67, v67
 v_mul_f32 v79, v79, v67
 v_fma_f32 v79, v79, s40, v67
 v_mul_f32 v79, s41, v79
 v_exp_f32 v79, v79
 v_add_f32 v76, 1.0, v76
 v_add_f32 v77, 1.0, v77
 v_add_f32 v78, 1.0, v78
 v_add_f32 v79, 1.0, v79
 v_rcp_f32 v76, v76
 v_rcp_f32 v77, v77
 v_rcp_f32 v78, v78
 v_rcp_f32 v79, v79
 s_nop 0
 v_mul_f32 v64, v64, v76
 v_mul_f32 v65, v65, v77
 v_mul_f32 v66, v66, v78
 v_mul_f32 v67, v67, v79
 v_cvt_pk_bf16_f32 v72, v64, v65
 v_cvt_pk_bf16_f32 v73, v66, v67
 v_lshlrev_b32 v64, 16, v72
 v_and_b32 v65, 0xffff0000, v72
 v_lshlrev_b32 v66, 16, v73
 v_and_b32 v67, 0xffff0000, v73
 v_mul_f32 v64, v64, v68
 v_mul_f32 v65, v65, v69
 v_mul_f32 v66, v66, v70
 v_mul_f32 v67, v67, v71
 v_cvt_pk_bf16_f32 v80, v64, v65
 v_cvt_pk_bf16_f32 v81, v66, v67
 buffer_store_dwordx2 v[80:81], v5, s[24:27], s58 offen offset:64 sc1
 v_accvgpr_read_b32 v64, a48
 v_accvgpr_read_b32 v65, a49
 v_accvgpr_read_b32 v66, a50
 v_accvgpr_read_b32 v67, a51
 v_accvgpr_read_b32 v68, a112
 v_accvgpr_read_b32 v69, a113
 v_accvgpr_read_b32 v70, a114
 v_accvgpr_read_b32 v71, a115
 v_cvt_pk_bf16_f32 v72, v64, v65
 v_cvt_pk_bf16_f32 v73, v66, v67
 v_cvt_pk_bf16_f32 v74, v68, v69
 v_cvt_pk_bf16_f32 v75, v70, v71
 v_lshlrev_b32 v64, 16, v72
 v_lshlrev_b32 v68, 16, v74
 v_and_b32 v65, 0xffff0000, v72
 v_and_b32 v69, 0xffff0000, v74
 v_lshlrev_b32 v66, 16, v73
 v_lshlrev_b32 v70, 16, v75
 v_and_b32 v67, 0xffff0000, v73
 v_and_b32 v71, 0xffff0000, v75
 v_mul_f32 v76, v64, v64
 v_mul_f32 v76, v76, v64
 v_fma_f32 v76, v76, s40, v64
 v_mul_f32 v76, s41, v76
 v_exp_f32 v76, v76
 v_mul_f32 v77, v65, v65
 v_mul_f32 v77, v77, v65
 v_fma_f32 v77, v77, s40, v65
 v_mul_f32 v77, s41, v77
 v_exp_f32 v77, v77
 v_mul_f32 v78, v66, v66
 v_mul_f32 v78, v78, v66
 v_fma_f32 v78, v78, s40, v66
 v_mul_f32 v78, s41, v78
 v_exp_f32 v78, v78
 v_mul_f32 v79, v67, v67
 v_mul_f32 v79, v79, v67
 v_fma_f32 v79, v79, s40, v67
 v_mul_f32 v79, s41, v79
 v_exp_f32 v79, v79
 v_add_f32 v76, 1.0, v76
 v_add_f32 v77, 1.0, v77
 v_add_f32 v78, 1.0, v78
 v_add_f32 v79, 1.0, v79
 v_rcp_f32 v76, v76
 v_rcp_f32 v77, v77
 v_rcp_f32 v78, v78
 v_rcp_f32 v79, v79
 s_nop 0
 v_mul_f32 v64, v64, v76
 v_mul_f32 v65, v65, v77
 v_mul_f32 v66, v66, v78
 v_mul_f32 v67, v67, v79
 v_cvt_pk_bf16_f32 v72, v64, v65
 v_cvt_pk_bf16_f32 v73, v66, v67
 v_lshlrev_b32 v64, 16, v72
 v_and_b32 v65, 0xffff0000, v72
 v_lshlrev_b32 v66, 16, v73
 v_and_b32 v67, 0xffff0000, v73
 v_mul_f32 v64, v64, v68
 v_mul_f32 v65, v65, v69
 v_mul_f32 v66, v66, v70
 v_mul_f32 v67, v67, v71
 v_cvt_pk_bf16_f32 v80, v64, v65
 v_cvt_pk_bf16_f32 v81, v66, v67
 buffer_store_dwordx2 v[80:81], v5, s[24:27], s58 offen offset:96 sc1
 s_add_u32 s58, s50, 147456
 v_accvgpr_read_b32 v88, a4
 v_accvgpr_read_b32 v89, a5
 v_accvgpr_read_b32 v90, a6
 v_accvgpr_read_b32 v91, a7
 v_accvgpr_read_b32 v92, a68
 v_accvgpr_read_b32 v93, a69
 v_accvgpr_read_b32 v94, a70
 v_accvgpr_read_b32 v95, a71
 v_cvt_pk_bf16_f32 v96, v88, v89
 v_cvt_pk_bf16_f32 v97, v90, v91
 v_cvt_pk_bf16_f32 v98, v92, v93
 v_cvt_pk_bf16_f32 v99, v94, v95
 v_lshlrev_b32 v88, 16, v96
 v_lshlrev_b32 v92, 16, v98
 v_and_b32 v89, 0xffff0000, v96
 v_and_b32 v93, 0xffff0000, v98
 v_lshlrev_b32 v90, 16, v97
 v_lshlrev_b32 v94, 16, v99
 v_and_b32 v91, 0xffff0000, v97
 v_and_b32 v95, 0xffff0000, v99
 v_mul_f32 v100, v88, v88
 v_mul_f32 v100, v100, v88
 v_fma_f32 v100, v100, s40, v88
 v_mul_f32 v100, s41, v100
 v_exp_f32 v100, v100
 v_mul_f32 v101, v89, v89
 v_mul_f32 v101, v101, v89
 v_fma_f32 v101, v101, s40, v89
 v_mul_f32 v101, s41, v101
 v_exp_f32 v101, v101
 v_mul_f32 v102, v90, v90
 v_mul_f32 v102, v102, v90
 v_fma_f32 v102, v102, s40, v90
 v_mul_f32 v102, s41, v102
 v_exp_f32 v102, v102
 v_mul_f32 v103, v91, v91
 v_mul_f32 v103, v103, v91
 v_fma_f32 v103, v103, s40, v91
 v_mul_f32 v103, s41, v103
 v_exp_f32 v103, v103
 v_add_f32 v100, 1.0, v100
 v_add_f32 v101, 1.0, v101
 v_add_f32 v102, 1.0, v102
 v_add_f32 v103, 1.0, v103
 v_rcp_f32 v100, v100
 v_rcp_f32 v101, v101
 v_rcp_f32 v102, v102
 v_rcp_f32 v103, v103
 s_nop 0
 v_mul_f32 v88, v88, v100
 v_mul_f32 v89, v89, v101
 v_mul_f32 v90, v90, v102
 v_mul_f32 v91, v91, v103
 v_cvt_pk_bf16_f32 v96, v88, v89
 v_cvt_pk_bf16_f32 v97, v90, v91
 v_lshlrev_b32 v88, 16, v96
 v_and_b32 v89, 0xffff0000, v96
 v_lshlrev_b32 v90, 16, v97
 v_and_b32 v91, 0xffff0000, v97
 v_mul_f32 v88, v88, v92
 v_mul_f32 v89, v89, v93
 v_mul_f32 v90, v90, v94
 v_mul_f32 v91, v91, v95
 v_cvt_pk_bf16_f32 v104, v88, v89
 v_cvt_pk_bf16_f32 v105, v90, v91
 buffer_store_dwordx2 v[104:105], v5, s[24:27], s58 offen offset:0 sc1
 v_accvgpr_read_b32 v88, a20
 v_accvgpr_read_b32 v89, a21
 v_accvgpr_read_b32 v90, a22
 v_accvgpr_read_b32 v91, a23
 v_accvgpr_read_b32 v92, a84
 v_accvgpr_read_b32 v93, a85
 v_accvgpr_read_b32 v94, a86
 v_accvgpr_read_b32 v95, a87
 v_cvt_pk_bf16_f32 v96, v88, v89
 v_cvt_pk_bf16_f32 v97, v90, v91
 v_cvt_pk_bf16_f32 v98, v92, v93
 v_cvt_pk_bf16_f32 v99, v94, v95
 v_lshlrev_b32 v88, 16, v96
 v_lshlrev_b32 v92, 16, v98
 v_and_b32 v89, 0xffff0000, v96
 v_and_b32 v93, 0xffff0000, v98
 v_lshlrev_b32 v90, 16, v97
 v_lshlrev_b32 v94, 16, v99
 v_and_b32 v91, 0xffff0000, v97
 v_and_b32 v95, 0xffff0000, v99
 v_mul_f32 v100, v88, v88
 v_mul_f32 v100, v100, v88
 v_fma_f32 v100, v100, s40, v88
 v_mul_f32 v100, s41, v100
 v_exp_f32 v100, v100
 v_mul_f32 v101, v89, v89
 v_mul_f32 v101, v101, v89
 v_fma_f32 v101, v101, s40, v89
 v_mul_f32 v101, s41, v101
 v_exp_f32 v101, v101
 v_mul_f32 v102, v90, v90
 v_mul_f32 v102, v102, v90
 v_fma_f32 v102, v102, s40, v90
 v_mul_f32 v102, s41, v102
 v_exp_f32 v102, v102
 v_mul_f32 v103, v91, v91
 v_mul_f32 v103, v103, v91
 v_fma_f32 v103, v103, s40, v91
 v_mul_f32 v103, s41, v103
 v_exp_f32 v103, v103
 v_add_f32 v100, 1.0, v100
 v_add_f32 v101, 1.0, v101
 v_add_f32 v102, 1.0, v102
 v_add_f32 v103, 1.0, v103
 v_rcp_f32 v100, v100
 v_rcp_f32 v101, v101
 v_rcp_f32 v102, v102
 v_rcp_f32 v103, v103
 s_nop 0
 v_mul_f32 v88, v88, v100
 v_mul_f32 v89, v89, v101
 v_mul_f32 v90, v90, v102
 v_mul_f32 v91, v91, v103
 v_cvt_pk_bf16_f32 v96, v88, v89
 v_cvt_pk_bf16_f32 v97, v90, v91
 v_lshlrev_b32 v88, 16, v96
 v_and_b32 v89, 0xffff0000, v96
 v_lshlrev_b32 v90, 16, v97
 v_and_b32 v91, 0xffff0000, v97
 v_mul_f32 v88, v88, v92
 v_mul_f32 v89, v89, v93
 v_mul_f32 v90, v90, v94
 v_mul_f32 v91, v91, v95
 v_cvt_pk_bf16_f32 v104, v88, v89
 v_cvt_pk_bf16_f32 v105, v90, v91
 buffer_store_dwordx2 v[104:105], v5, s[24:27], s58 offen offset:32 sc1
 v_accvgpr_read_b32 v88, a36
 v_accvgpr_read_b32 v89, a37
 v_accvgpr_read_b32 v90, a38
 v_accvgpr_read_b32 v91, a39
 v_accvgpr_read_b32 v92, a100
 v_accvgpr_read_b32 v93, a101
 v_accvgpr_read_b32 v94, a102
 v_accvgpr_read_b32 v95, a103
 v_cvt_pk_bf16_f32 v96, v88, v89
 v_cvt_pk_bf16_f32 v97, v90, v91
 v_cvt_pk_bf16_f32 v98, v92, v93
 v_cvt_pk_bf16_f32 v99, v94, v95
 v_lshlrev_b32 v88, 16, v96
 v_lshlrev_b32 v92, 16, v98
 v_and_b32 v89, 0xffff0000, v96
 v_and_b32 v93, 0xffff0000, v98
 v_lshlrev_b32 v90, 16, v97
 v_lshlrev_b32 v94, 16, v99
 v_and_b32 v91, 0xffff0000, v97
 v_and_b32 v95, 0xffff0000, v99
 v_mul_f32 v100, v88, v88
 v_mul_f32 v100, v100, v88
 v_fma_f32 v100, v100, s40, v88
 v_mul_f32 v100, s41, v100
 v_exp_f32 v100, v100
 v_mul_f32 v101, v89, v89
 v_mul_f32 v101, v101, v89
 v_fma_f32 v101, v101, s40, v89
 v_mul_f32 v101, s41, v101
 v_exp_f32 v101, v101
 v_mul_f32 v102, v90, v90
 v_mul_f32 v102, v102, v90
 v_fma_f32 v102, v102, s40, v90
 v_mul_f32 v102, s41, v102
 v_exp_f32 v102, v102
 v_mul_f32 v103, v91, v91
 v_mul_f32 v103, v103, v91
 v_fma_f32 v103, v103, s40, v91
 v_mul_f32 v103, s41, v103
 v_exp_f32 v103, v103
 v_add_f32 v100, 1.0, v100
 v_add_f32 v101, 1.0, v101
 v_add_f32 v102, 1.0, v102
 v_add_f32 v103, 1.0, v103
 v_rcp_f32 v100, v100
 v_rcp_f32 v101, v101
 v_rcp_f32 v102, v102
 v_rcp_f32 v103, v103
 s_nop 0
 v_mul_f32 v88, v88, v100
 v_mul_f32 v89, v89, v101
 v_mul_f32 v90, v90, v102
 v_mul_f32 v91, v91, v103
 v_cvt_pk_bf16_f32 v96, v88, v89
 v_cvt_pk_bf16_f32 v97, v90, v91
 v_lshlrev_b32 v88, 16, v96
 v_and_b32 v89, 0xffff0000, v96
 v_lshlrev_b32 v90, 16, v97
 v_and_b32 v91, 0xffff0000, v97
 v_mul_f32 v88, v88, v92
 v_mul_f32 v89, v89, v93
 v_mul_f32 v90, v90, v94
 v_mul_f32 v91, v91, v95
 v_cvt_pk_bf16_f32 v104, v88, v89
 v_cvt_pk_bf16_f32 v105, v90, v91
 buffer_store_dwordx2 v[104:105], v5, s[24:27], s58 offen offset:64 sc1
 v_accvgpr_read_b32 v88, a52
 v_accvgpr_read_b32 v89, a53
 v_accvgpr_read_b32 v90, a54
 v_accvgpr_read_b32 v91, a55
 v_accvgpr_read_b32 v92, a116
 v_accvgpr_read_b32 v93, a117
 v_accvgpr_read_b32 v94, a118
 v_accvgpr_read_b32 v95, a119
 v_cvt_pk_bf16_f32 v96, v88, v89
 v_cvt_pk_bf16_f32 v97, v90, v91
 v_cvt_pk_bf16_f32 v98, v92, v93
 v_cvt_pk_bf16_f32 v99, v94, v95
 v_lshlrev_b32 v88, 16, v96
 v_lshlrev_b32 v92, 16, v98
 v_and_b32 v89, 0xffff0000, v96
 v_and_b32 v93, 0xffff0000, v98
 v_lshlrev_b32 v90, 16, v97
 v_lshlrev_b32 v94, 16, v99
 v_and_b32 v91, 0xffff0000, v97
 v_and_b32 v95, 0xffff0000, v99
 v_mul_f32 v100, v88, v88
 v_mul_f32 v100, v100, v88
 v_fma_f32 v100, v100, s40, v88
 v_mul_f32 v100, s41, v100
 v_exp_f32 v100, v100
 v_mul_f32 v101, v89, v89
 v_mul_f32 v101, v101, v89
 v_fma_f32 v101, v101, s40, v89
 v_mul_f32 v101, s41, v101
 v_exp_f32 v101, v101
 v_mul_f32 v102, v90, v90
 v_mul_f32 v102, v102, v90
 v_fma_f32 v102, v102, s40, v90
 v_mul_f32 v102, s41, v102
 v_exp_f32 v102, v102
 v_mul_f32 v103, v91, v91
 v_mul_f32 v103, v103, v91
 v_fma_f32 v103, v103, s40, v91
 v_mul_f32 v103, s41, v103
 v_exp_f32 v103, v103
 v_add_f32 v100, 1.0, v100
 v_add_f32 v101, 1.0, v101
 v_add_f32 v102, 1.0, v102
 v_add_f32 v103, 1.0, v103
 v_rcp_f32 v100, v100
 v_rcp_f32 v101, v101
 v_rcp_f32 v102, v102
 v_rcp_f32 v103, v103
 s_nop 0
 v_mul_f32 v88, v88, v100
 v_mul_f32 v89, v89, v101
 v_mul_f32 v90, v90, v102
 v_mul_f32 v91, v91, v103
 v_cvt_pk_bf16_f32 v96, v88, v89
 v_cvt_pk_bf16_f32 v97, v90, v91
 v_lshlrev_b32 v88, 16, v96
 v_and_b32 v89, 0xffff0000, v96
 v_lshlrev_b32 v90, 16, v97
 v_and_b32 v91, 0xffff0000, v97
 v_mul_f32 v88, v88, v92
 v_mul_f32 v89, v89, v93
 v_mul_f32 v90, v90, v94
 v_mul_f32 v91, v91, v95
 v_cvt_pk_bf16_f32 v104, v88, v89
 v_cvt_pk_bf16_f32 v105, v90, v91
 buffer_store_dwordx2 v[104:105], v5, s[24:27], s58 offen offset:96 sc1
 s_add_u32 s58, s50, 294912
 v_accvgpr_read_b32 v112, a8
 v_accvgpr_read_b32 v113, a9
 v_accvgpr_read_b32 v114, a10
 v_accvgpr_read_b32 v115, a11
 v_accvgpr_read_b32 v116, a72
 v_accvgpr_read_b32 v117, a73
 v_accvgpr_read_b32 v118, a74
 v_accvgpr_read_b32 v119, a75
 v_cvt_pk_bf16_f32 v120, v112, v113
 v_cvt_pk_bf16_f32 v121, v114, v115
 v_cvt_pk_bf16_f32 v122, v116, v117
 v_cvt_pk_bf16_f32 v123, v118, v119
 v_lshlrev_b32 v112, 16, v120
 v_lshlrev_b32 v116, 16, v122
 v_and_b32 v113, 0xffff0000, v120
 v_and_b32 v117, 0xffff0000, v122
 v_lshlrev_b32 v114, 16, v121
 v_lshlrev_b32 v118, 16, v123
 v_and_b32 v115, 0xffff0000, v121
 v_and_b32 v119, 0xffff0000, v123
 v_mul_f32 v124, v112, v112
 v_mul_f32 v124, v124, v112
 v_fma_f32 v124, v124, s40, v112
 v_mul_f32 v124, s41, v124
 v_exp_f32 v124, v124
 v_mul_f32 v125, v113, v113
 v_mul_f32 v125, v125, v113
 v_fma_f32 v125, v125, s40, v113
 v_mul_f32 v125, s41, v125
 v_exp_f32 v125, v125
 v_mul_f32 v126, v114, v114
 v_mul_f32 v126, v126, v114
 v_fma_f32 v126, v126, s40, v114
 v_mul_f32 v126, s41, v126
 v_exp_f32 v126, v126
 v_mul_f32 v127, v115, v115
 v_mul_f32 v127, v127, v115
 v_fma_f32 v127, v127, s40, v115
 v_mul_f32 v127, s41, v127
 v_exp_f32 v127, v127
 v_add_f32 v124, 1.0, v124
 v_add_f32 v125, 1.0, v125
 v_add_f32 v126, 1.0, v126
 v_add_f32 v127, 1.0, v127
 v_rcp_f32 v124, v124
 v_rcp_f32 v125, v125
 v_rcp_f32 v126, v126
 v_rcp_f32 v127, v127
 s_nop 0
 v_mul_f32 v112, v112, v124
 v_mul_f32 v113, v113, v125
 v_mul_f32 v114, v114, v126
 v_mul_f32 v115, v115, v127
 v_cvt_pk_bf16_f32 v120, v112, v113
 v_cvt_pk_bf16_f32 v121, v114, v115
 v_lshlrev_b32 v112, 16, v120
 v_and_b32 v113, 0xffff0000, v120
 v_lshlrev_b32 v114, 16, v121
 v_and_b32 v115, 0xffff0000, v121
 v_mul_f32 v112, v112, v116
 v_mul_f32 v113, v113, v117
 v_mul_f32 v114, v114, v118
 v_mul_f32 v115, v115, v119
 v_cvt_pk_bf16_f32 v128, v112, v113
 v_cvt_pk_bf16_f32 v129, v114, v115
 buffer_store_dwordx2 v[128:129], v5, s[24:27], s58 offen offset:0 sc1
 v_accvgpr_read_b32 v112, a24
 v_accvgpr_read_b32 v113, a25
 v_accvgpr_read_b32 v114, a26
 v_accvgpr_read_b32 v115, a27
 v_accvgpr_read_b32 v116, a88
 v_accvgpr_read_b32 v117, a89
 v_accvgpr_read_b32 v118, a90
 v_accvgpr_read_b32 v119, a91
 v_cvt_pk_bf16_f32 v120, v112, v113
 v_cvt_pk_bf16_f32 v121, v114, v115
 v_cvt_pk_bf16_f32 v122, v116, v117
 v_cvt_pk_bf16_f32 v123, v118, v119
 v_lshlrev_b32 v112, 16, v120
 v_lshlrev_b32 v116, 16, v122
 v_and_b32 v113, 0xffff0000, v120
 v_and_b32 v117, 0xffff0000, v122
 v_lshlrev_b32 v114, 16, v121
 v_lshlrev_b32 v118, 16, v123
 v_and_b32 v115, 0xffff0000, v121
 v_and_b32 v119, 0xffff0000, v123
 v_mul_f32 v124, v112, v112
 v_mul_f32 v124, v124, v112
 v_fma_f32 v124, v124, s40, v112
 v_mul_f32 v124, s41, v124
 v_exp_f32 v124, v124
 v_mul_f32 v125, v113, v113
 v_mul_f32 v125, v125, v113
 v_fma_f32 v125, v125, s40, v113
 v_mul_f32 v125, s41, v125
 v_exp_f32 v125, v125
 v_mul_f32 v126, v114, v114
 v_mul_f32 v126, v126, v114
 v_fma_f32 v126, v126, s40, v114
 v_mul_f32 v126, s41, v126
 v_exp_f32 v126, v126
 v_mul_f32 v127, v115, v115
 v_mul_f32 v127, v127, v115
 v_fma_f32 v127, v127, s40, v115
 v_mul_f32 v127, s41, v127
 v_exp_f32 v127, v127
 v_add_f32 v124, 1.0, v124
 v_add_f32 v125, 1.0, v125
 v_add_f32 v126, 1.0, v126
 v_add_f32 v127, 1.0, v127
 v_rcp_f32 v124, v124
 v_rcp_f32 v125, v125
 v_rcp_f32 v126, v126
 v_rcp_f32 v127, v127
 s_nop 0
 v_mul_f32 v112, v112, v124
 v_mul_f32 v113, v113, v125
 v_mul_f32 v114, v114, v126
 v_mul_f32 v115, v115, v127
 v_cvt_pk_bf16_f32 v120, v112, v113
 v_cvt_pk_bf16_f32 v121, v114, v115
 v_lshlrev_b32 v112, 16, v120
 v_and_b32 v113, 0xffff0000, v120
 v_lshlrev_b32 v114, 16, v121
 v_and_b32 v115, 0xffff0000, v121
 v_mul_f32 v112, v112, v116
 v_mul_f32 v113, v113, v117
 v_mul_f32 v114, v114, v118
 v_mul_f32 v115, v115, v119
 v_cvt_pk_bf16_f32 v128, v112, v113
 v_cvt_pk_bf16_f32 v129, v114, v115
 buffer_store_dwordx2 v[128:129], v5, s[24:27], s58 offen offset:32 sc1
 v_accvgpr_read_b32 v112, a40
 v_accvgpr_read_b32 v113, a41
 v_accvgpr_read_b32 v114, a42
 v_accvgpr_read_b32 v115, a43
 v_accvgpr_read_b32 v116, a104
 v_accvgpr_read_b32 v117, a105
 v_accvgpr_read_b32 v118, a106
 v_accvgpr_read_b32 v119, a107
 v_cvt_pk_bf16_f32 v120, v112, v113
 v_cvt_pk_bf16_f32 v121, v114, v115
 v_cvt_pk_bf16_f32 v122, v116, v117
 v_cvt_pk_bf16_f32 v123, v118, v119
 v_lshlrev_b32 v112, 16, v120
 v_lshlrev_b32 v116, 16, v122
 v_and_b32 v113, 0xffff0000, v120
 v_and_b32 v117, 0xffff0000, v122
 v_lshlrev_b32 v114, 16, v121
 v_lshlrev_b32 v118, 16, v123
 v_and_b32 v115, 0xffff0000, v121
 v_and_b32 v119, 0xffff0000, v123
 v_mul_f32 v124, v112, v112
 v_mul_f32 v124, v124, v112
 v_fma_f32 v124, v124, s40, v112
 v_mul_f32 v124, s41, v124
 v_exp_f32 v124, v124
 v_mul_f32 v125, v113, v113
 v_mul_f32 v125, v125, v113
 v_fma_f32 v125, v125, s40, v113
 v_mul_f32 v125, s41, v125
 v_exp_f32 v125, v125
 v_mul_f32 v126, v114, v114
 v_mul_f32 v126, v126, v114
 v_fma_f32 v126, v126, s40, v114
 v_mul_f32 v126, s41, v126
 v_exp_f32 v126, v126
 v_mul_f32 v127, v115, v115
 v_mul_f32 v127, v127, v115
 v_fma_f32 v127, v127, s40, v115
 v_mul_f32 v127, s41, v127
 v_exp_f32 v127, v127
 v_add_f32 v124, 1.0, v124
 v_add_f32 v125, 1.0, v125
 v_add_f32 v126, 1.0, v126
 v_add_f32 v127, 1.0, v127
 v_rcp_f32 v124, v124
 v_rcp_f32 v125, v125
 v_rcp_f32 v126, v126
 v_rcp_f32 v127, v127
 s_nop 0
 v_mul_f32 v112, v112, v124
 v_mul_f32 v113, v113, v125
 v_mul_f32 v114, v114, v126
 v_mul_f32 v115, v115, v127
 v_cvt_pk_bf16_f32 v120, v112, v113
 v_cvt_pk_bf16_f32 v121, v114, v115
 v_lshlrev_b32 v112, 16, v120
 v_and_b32 v113, 0xffff0000, v120
 v_lshlrev_b32 v114, 16, v121
 v_and_b32 v115, 0xffff0000, v121
 v_mul_f32 v112, v112, v116
 v_mul_f32 v113, v113, v117
 v_mul_f32 v114, v114, v118
 v_mul_f32 v115, v115, v119
 v_cvt_pk_bf16_f32 v128, v112, v113
 v_cvt_pk_bf16_f32 v129, v114, v115
 buffer_store_dwordx2 v[128:129], v5, s[24:27], s58 offen offset:64 sc1
 v_accvgpr_read_b32 v112, a56
 v_accvgpr_read_b32 v113, a57
 v_accvgpr_read_b32 v114, a58
 v_accvgpr_read_b32 v115, a59
 v_accvgpr_read_b32 v116, a120
 v_accvgpr_read_b32 v117, a121
 v_accvgpr_read_b32 v118, a122
 v_accvgpr_read_b32 v119, a123
 v_cvt_pk_bf16_f32 v120, v112, v113
 v_cvt_pk_bf16_f32 v121, v114, v115
 v_cvt_pk_bf16_f32 v122, v116, v117
 v_cvt_pk_bf16_f32 v123, v118, v119
 v_lshlrev_b32 v112, 16, v120
 v_lshlrev_b32 v116, 16, v122
 v_and_b32 v113, 0xffff0000, v120
 v_and_b32 v117, 0xffff0000, v122
 v_lshlrev_b32 v114, 16, v121
 v_lshlrev_b32 v118, 16, v123
 v_and_b32 v115, 0xffff0000, v121
 v_and_b32 v119, 0xffff0000, v123
 v_mul_f32 v124, v112, v112
 v_mul_f32 v124, v124, v112
 v_fma_f32 v124, v124, s40, v112
 v_mul_f32 v124, s41, v124
 v_exp_f32 v124, v124
 v_mul_f32 v125, v113, v113
 v_mul_f32 v125, v125, v113
 v_fma_f32 v125, v125, s40, v113
 v_mul_f32 v125, s41, v125
 v_exp_f32 v125, v125
 v_mul_f32 v126, v114, v114
 v_mul_f32 v126, v126, v114
 v_fma_f32 v126, v126, s40, v114
 v_mul_f32 v126, s41, v126
 v_exp_f32 v126, v126
 v_mul_f32 v127, v115, v115
 v_mul_f32 v127, v127, v115
 v_fma_f32 v127, v127, s40, v115
 v_mul_f32 v127, s41, v127
 v_exp_f32 v127, v127
 v_add_f32 v124, 1.0, v124
 v_add_f32 v125, 1.0, v125
 v_add_f32 v126, 1.0, v126
 v_add_f32 v127, 1.0, v127
 v_rcp_f32 v124, v124
 v_rcp_f32 v125, v125
 v_rcp_f32 v126, v126
 v_rcp_f32 v127, v127
 s_nop 0
 v_mul_f32 v112, v112, v124
 v_mul_f32 v113, v113, v125
 v_mul_f32 v114, v114, v126
 v_mul_f32 v115, v115, v127
 v_cvt_pk_bf16_f32 v120, v112, v113
 v_cvt_pk_bf16_f32 v121, v114, v115
 v_lshlrev_b32 v112, 16, v120
 v_and_b32 v113, 0xffff0000, v120
 v_lshlrev_b32 v114, 16, v121
 v_and_b32 v115, 0xffff0000, v121
 v_mul_f32 v112, v112, v116
 v_mul_f32 v113, v113, v117
 v_mul_f32 v114, v114, v118
 v_mul_f32 v115, v115, v119
 v_cvt_pk_bf16_f32 v128, v112, v113
 v_cvt_pk_bf16_f32 v129, v114, v115
 buffer_store_dwordx2 v[128:129], v5, s[24:27], s58 offen offset:96 sc1
 s_add_u32 s58, s50, 442368
 v_accvgpr_read_b32 v136, a12
 v_accvgpr_read_b32 v137, a13
 v_accvgpr_read_b32 v138, a14
 v_accvgpr_read_b32 v139, a15
 v_accvgpr_read_b32 v140, a76
 v_accvgpr_read_b32 v141, a77
 v_accvgpr_read_b32 v142, a78
 v_accvgpr_read_b32 v143, a79
 v_cvt_pk_bf16_f32 v144, v136, v137
 v_cvt_pk_bf16_f32 v145, v138, v139
 v_cvt_pk_bf16_f32 v146, v140, v141
 v_cvt_pk_bf16_f32 v147, v142, v143
 v_lshlrev_b32 v136, 16, v144
 v_lshlrev_b32 v140, 16, v146
 v_and_b32 v137, 0xffff0000, v144
 v_and_b32 v141, 0xffff0000, v146
 v_lshlrev_b32 v138, 16, v145
 v_lshlrev_b32 v142, 16, v147
 v_and_b32 v139, 0xffff0000, v145
 v_and_b32 v143, 0xffff0000, v147
 v_mul_f32 v148, v136, v136
 v_mul_f32 v148, v148, v136
 v_fma_f32 v148, v148, s40, v136
 v_mul_f32 v148, s41, v148
 v_exp_f32 v148, v148
 v_mul_f32 v149, v137, v137
 v_mul_f32 v149, v149, v137
 v_fma_f32 v149, v149, s40, v137
 v_mul_f32 v149, s41, v149
 v_exp_f32 v149, v149
 v_mul_f32 v150, v138, v138
 v_mul_f32 v150, v150, v138
 v_fma_f32 v150, v150, s40, v138
 v_mul_f32 v150, s41, v150
 v_exp_f32 v150, v150
 v_mul_f32 v151, v139, v139
 v_mul_f32 v151, v151, v139
 v_fma_f32 v151, v151, s40, v139
 v_mul_f32 v151, s41, v151
 v_exp_f32 v151, v151
 v_add_f32 v148, 1.0, v148
 v_add_f32 v149, 1.0, v149
 v_add_f32 v150, 1.0, v150
 v_add_f32 v151, 1.0, v151
 v_rcp_f32 v148, v148
 v_rcp_f32 v149, v149
 v_rcp_f32 v150, v150
 v_rcp_f32 v151, v151
 s_nop 0
 v_mul_f32 v136, v136, v148
 v_mul_f32 v137, v137, v149
 v_mul_f32 v138, v138, v150
 v_mul_f32 v139, v139, v151
 v_cvt_pk_bf16_f32 v144, v136, v137
 v_cvt_pk_bf16_f32 v145, v138, v139
 v_lshlrev_b32 v136, 16, v144
 v_and_b32 v137, 0xffff0000, v144
 v_lshlrev_b32 v138, 16, v145
 v_and_b32 v139, 0xffff0000, v145
 v_mul_f32 v136, v136, v140
 v_mul_f32 v137, v137, v141
 v_mul_f32 v138, v138, v142
 v_mul_f32 v139, v139, v143
 v_cvt_pk_bf16_f32 v152, v136, v137
 v_cvt_pk_bf16_f32 v153, v138, v139
 buffer_store_dwordx2 v[152:153], v5, s[24:27], s58 offen offset:0 sc1
 v_accvgpr_read_b32 v136, a28
 v_accvgpr_read_b32 v137, a29
 v_accvgpr_read_b32 v138, a30
 v_accvgpr_read_b32 v139, a31
 v_accvgpr_read_b32 v140, a92
 v_accvgpr_read_b32 v141, a93
 v_accvgpr_read_b32 v142, a94
 v_accvgpr_read_b32 v143, a95
 v_cvt_pk_bf16_f32 v144, v136, v137
 v_cvt_pk_bf16_f32 v145, v138, v139
 v_cvt_pk_bf16_f32 v146, v140, v141
 v_cvt_pk_bf16_f32 v147, v142, v143
 v_lshlrev_b32 v136, 16, v144
 v_lshlrev_b32 v140, 16, v146
 v_and_b32 v137, 0xffff0000, v144
 v_and_b32 v141, 0xffff0000, v146
 v_lshlrev_b32 v138, 16, v145
 v_lshlrev_b32 v142, 16, v147
 v_and_b32 v139, 0xffff0000, v145
 v_and_b32 v143, 0xffff0000, v147
 v_mul_f32 v148, v136, v136
 v_mul_f32 v148, v148, v136
 v_fma_f32 v148, v148, s40, v136
 v_mul_f32 v148, s41, v148
 v_exp_f32 v148, v148
 v_mul_f32 v149, v137, v137
 v_mul_f32 v149, v149, v137
 v_fma_f32 v149, v149, s40, v137
 v_mul_f32 v149, s41, v149
 v_exp_f32 v149, v149
 v_mul_f32 v150, v138, v138
 v_mul_f32 v150, v150, v138
 v_fma_f32 v150, v150, s40, v138
 v_mul_f32 v150, s41, v150
 v_exp_f32 v150, v150
 v_mul_f32 v151, v139, v139
 v_mul_f32 v151, v151, v139
 v_fma_f32 v151, v151, s40, v139
 v_mul_f32 v151, s41, v151
 v_exp_f32 v151, v151
 v_add_f32 v148, 1.0, v148
 v_add_f32 v149, 1.0, v149
 v_add_f32 v150, 1.0, v150
 v_add_f32 v151, 1.0, v151
 v_rcp_f32 v148, v148
 v_rcp_f32 v149, v149
 v_rcp_f32 v150, v150
 v_rcp_f32 v151, v151
 s_nop 0
 v_mul_f32 v136, v136, v148
 v_mul_f32 v137, v137, v149
 v_mul_f32 v138, v138, v150
 v_mul_f32 v139, v139, v151
 v_cvt_pk_bf16_f32 v144, v136, v137
 v_cvt_pk_bf16_f32 v145, v138, v139
 v_lshlrev_b32 v136, 16, v144
 v_and_b32 v137, 0xffff0000, v144
 v_lshlrev_b32 v138, 16, v145
 v_and_b32 v139, 0xffff0000, v145
 v_mul_f32 v136, v136, v140
 v_mul_f32 v137, v137, v141
 v_mul_f32 v138, v138, v142
 v_mul_f32 v139, v139, v143
 v_cvt_pk_bf16_f32 v152, v136, v137
 v_cvt_pk_bf16_f32 v153, v138, v139
 buffer_store_dwordx2 v[152:153], v5, s[24:27], s58 offen offset:32 sc1
 v_accvgpr_read_b32 v136, a44
 v_accvgpr_read_b32 v137, a45
 v_accvgpr_read_b32 v138, a46
 v_accvgpr_read_b32 v139, a47
 v_accvgpr_read_b32 v140, a108
 v_accvgpr_read_b32 v141, a109
 v_accvgpr_read_b32 v142, a110
 v_accvgpr_read_b32 v143, a111
 v_cvt_pk_bf16_f32 v144, v136, v137
 v_cvt_pk_bf16_f32 v145, v138, v139
 v_cvt_pk_bf16_f32 v146, v140, v141
 v_cvt_pk_bf16_f32 v147, v142, v143
 v_lshlrev_b32 v136, 16, v144
 v_lshlrev_b32 v140, 16, v146
 v_and_b32 v137, 0xffff0000, v144
 v_and_b32 v141, 0xffff0000, v146
 v_lshlrev_b32 v138, 16, v145
 v_lshlrev_b32 v142, 16, v147
 v_and_b32 v139, 0xffff0000, v145
 v_and_b32 v143, 0xffff0000, v147
 v_mul_f32 v148, v136, v136
 v_mul_f32 v148, v148, v136
 v_fma_f32 v148, v148, s40, v136
 v_mul_f32 v148, s41, v148
 v_exp_f32 v148, v148
 v_mul_f32 v149, v137, v137
 v_mul_f32 v149, v149, v137
 v_fma_f32 v149, v149, s40, v137
 v_mul_f32 v149, s41, v149
 v_exp_f32 v149, v149
 v_mul_f32 v150, v138, v138
 v_mul_f32 v150, v150, v138
 v_fma_f32 v150, v150, s40, v138
 v_mul_f32 v150, s41, v150
 v_exp_f32 v150, v150
 v_mul_f32 v151, v139, v139
 v_mul_f32 v151, v151, v139
 v_fma_f32 v151, v151, s40, v139
 v_mul_f32 v151, s41, v151
 v_exp_f32 v151, v151
 v_add_f32 v148, 1.0, v148
 v_add_f32 v149, 1.0, v149
 v_add_f32 v150, 1.0, v150
 v_add_f32 v151, 1.0, v151
 v_rcp_f32 v148, v148
 v_rcp_f32 v149, v149
 v_rcp_f32 v150, v150
 v_rcp_f32 v151, v151
 s_nop 0
 v_mul_f32 v136, v136, v148
 v_mul_f32 v137, v137, v149
 v_mul_f32 v138, v138, v150
 v_mul_f32 v139, v139, v151
 v_cvt_pk_bf16_f32 v144, v136, v137
 v_cvt_pk_bf16_f32 v145, v138, v139
 v_lshlrev_b32 v136, 16, v144
 v_and_b32 v137, 0xffff0000, v144
 v_lshlrev_b32 v138, 16, v145
 v_and_b32 v139, 0xffff0000, v145
 v_mul_f32 v136, v136, v140
 v_mul_f32 v137, v137, v141
 v_mul_f32 v138, v138, v142
 v_mul_f32 v139, v139, v143
 v_cvt_pk_bf16_f32 v152, v136, v137
 v_cvt_pk_bf16_f32 v153, v138, v139
 buffer_store_dwordx2 v[152:153], v5, s[24:27], s58 offen offset:64 sc1
 v_accvgpr_read_b32 v136, a60
 v_accvgpr_read_b32 v137, a61
 v_accvgpr_read_b32 v138, a62
 v_accvgpr_read_b32 v139, a63
 v_accvgpr_read_b32 v140, a124
 v_accvgpr_read_b32 v141, a125
 v_accvgpr_read_b32 v142, a126
 v_accvgpr_read_b32 v143, a127
 v_cvt_pk_bf16_f32 v144, v136, v137
 v_cvt_pk_bf16_f32 v145, v138, v139
 v_cvt_pk_bf16_f32 v146, v140, v141
 v_cvt_pk_bf16_f32 v147, v142, v143
 v_lshlrev_b32 v136, 16, v144
 v_lshlrev_b32 v140, 16, v146
 v_and_b32 v137, 0xffff0000, v144
 v_and_b32 v141, 0xffff0000, v146
 v_lshlrev_b32 v138, 16, v145
 v_lshlrev_b32 v142, 16, v147
 v_and_b32 v139, 0xffff0000, v145
 v_and_b32 v143, 0xffff0000, v147
 v_mul_f32 v148, v136, v136
 v_mul_f32 v148, v148, v136
 v_fma_f32 v148, v148, s40, v136
 v_mul_f32 v148, s41, v148
 v_exp_f32 v148, v148
 v_mul_f32 v149, v137, v137
 v_mul_f32 v149, v149, v137
 v_fma_f32 v149, v149, s40, v137
 v_mul_f32 v149, s41, v149
 v_exp_f32 v149, v149
 v_mul_f32 v150, v138, v138
 v_mul_f32 v150, v150, v138
 v_fma_f32 v150, v150, s40, v138
 v_mul_f32 v150, s41, v150
 v_exp_f32 v150, v150
 v_mul_f32 v151, v139, v139
 v_mul_f32 v151, v151, v139
 v_fma_f32 v151, v151, s40, v139
 v_mul_f32 v151, s41, v151
 v_exp_f32 v151, v151
 v_add_f32 v148, 1.0, v148
 v_add_f32 v149, 1.0, v149
 v_add_f32 v150, 1.0, v150
 v_add_f32 v151, 1.0, v151
 v_rcp_f32 v148, v148
 v_rcp_f32 v149, v149
 v_rcp_f32 v150, v150
 v_rcp_f32 v151, v151
 s_nop 0
 v_mul_f32 v136, v136, v148
 v_mul_f32 v137, v137, v149
 v_mul_f32 v138, v138, v150
 v_mul_f32 v139, v139, v151
 v_cvt_pk_bf16_f32 v144, v136, v137
 v_cvt_pk_bf16_f32 v145, v138, v139
 v_lshlrev_b32 v136, 16, v144
 v_and_b32 v137, 0xffff0000, v144
 v_lshlrev_b32 v138, 16, v145
 v_and_b32 v139, 0xffff0000, v145
 v_mul_f32 v136, v136, v140
 v_mul_f32 v137, v137, v141
 v_mul_f32 v138, v138, v142
 v_mul_f32 v139, v139, v143
 v_cvt_pk_bf16_f32 v152, v136, v137
 v_cvt_pk_bf16_f32 v153, v138, v139
 buffer_store_dwordx2 v[152:153], v5, s[24:27], s58 offen offset:96 sc1
 s_branch mega_kernel_sig91
mega_kernel_sig91:
 s_waitcnt vmcnt(0)
 s_barrier
 s_cmp_lg_u32 s93, 0
 s_cbranch_scc1 mega_kernel_ns94
 s_cmp_eq_u32 s95, -1
 s_cbranch_scc1 mega_kernel_ns94
 s_load_dwordx2 s[12:13], s[0:1], 120
 s_waitcnt lgkmcnt(0)
 s_add_u32 s16, s12, 264241152
 s_addc_u32 s17, s13, 0
 s_and_b32 s17, s17, 0xffff
 s_mov_b32 s18, 12288
 s_mov_b32 s19, 0x00020000
 s_mov_b64 exec, 1
 v_mov_b32 v2, 1
 buffer_atomic_add v2, off, s[16:19], s95 sc1
 s_mov_b64 exec, -1
mega_kernel_ns94:
 s_add_u32 s101, s101, 1
mega_kernel_loop2:
 s_cmp_eq_u32 s101, 0
 s_cbranch_scc1 mega_kernel_nc95
 s_barrier
 s_cmp_lg_u32 s93, 0
 s_cbranch_scc1 mega_kernel_w96
 s_mov_b64 exec, 1
 v_mov_b32 v2, 1
 buffer_load_dword v2, off, s[96:99], 0 offset:0 sc1
 v_mov_b32 v3, 163824
 s_waitcnt vmcnt(0)
 ds_write_b32 v3, v2
 s_waitcnt lgkmcnt(0)
 s_mov_b64 exec, -1
mega_kernel_w96:
 s_barrier
 v_mov_b32 v3, 163824
 ds_read_b32 v2, v3
 s_waitcnt lgkmcnt(0)
 v_readfirstlane_b32 s40, v2
 s_nop 3
 s_cmp_lt_u32 s40, 32
 s_cbranch_scc1 mega_kernel_rec3
mega_kernel_nc95:
 s_barrier
 s_cmp_lg_u32 s93, 0
 s_cbranch_scc1 mega_kernel_w97
 s_mov_b64 exec, 1
 v_mov_b32 v2, 1
 buffer_atomic_add v2, off, s[96:99], 0 offset:128 sc0 sc1
 v_mov_b32 v3, 163824
 s_waitcnt vmcnt(0)
 ds_write_b32 v3, v2
 s_waitcnt lgkmcnt(0)
 s_mov_b64 exec, -1
mega_kernel_w97:
 s_barrier
 v_mov_b32 v3, 163824
 ds_read_b32 v2, v3
 s_waitcnt lgkmcnt(0)
 v_readfirstlane_b32 s92, v2
 s_nop 3
 s_mov_b32 s80, -1
 s_mov_b32 s82, -1
 s_cmp_ge_u32 s92, 27
 s_cbranch_scc1 mega_kernel_t103
 s_mov_b32 s2, s92
 s_mov_b32 s95, 8192
 s_branch mega_kernel_bmod100
mega_kernel_t103:
 s_cmp_ge_u32 s92, 32
 s_cbranch_scc1 mega_kernel_t104
 s_sub_u32 s2, s92, 27
 s_mov_b32 s95, 8256
 s_mov_b32 s80, 8192
 s_mov_b32 s81, 27
 s_mov_b32 s88, 8
 s_branch mega_kernel_go99
mega_kernel_t104:
 s_cmp_ge_u32 s92, 288
 s_cbranch_scc1 mega_kernel_t105
 s_sub_u32 s2, s92, 32
 s_lshr_b32 s95, s2, 4
 s_add_u32 s95, s95, 144
 s_lshl_b32 s95, s95, 6
 s_mov_b32 s80, 8192
 s_mov_b32 s81, 27
 s_mov_b32 s88, 6
 s_branch mega_kernel_go99
mega_kernel_t105:
 s_cmp_ge_u32 s92, 1056
 s_cbranch_scc1 mega_kernel_post98
 s_sub_u32 s83, s92, 288
 s_mov_b32 s43, 89478486
 s_mul_hi_u32 s84, s83, s43
 s_mul_i32 s85, s84, 48
 s_sub_u32 s85, s83, s85
 s_add_u32 s86, s85, 16
 s_sub_u32 s87, s85, 32
 s_cmp_lt_u32 s85, 32
 s_cselect_b32 s86, s86, s87
 s_cselect_b32 s87, 0, 16
 s_add_u32 s87, s87, s84
 s_lshl_b32 s95, s87, 6
 s_mul_i32 s2, s84, 48
 s_add_u32 s2, s2, s86
 s_add_u32 s80, s84, 144
 s_lshl_b32 s80, s80, 6
 s_mov_b32 s81, 16
 s_cmp_lt_u32 s83, 96
 s_cbranch_scc1 mega_kernel_q106
 s_mov_b32 s82, 0
 s_mov_b32 s83, 32
mega_kernel_q106:
 s_mov_b32 s88, 7
 s_branch mega_kernel_go99
mega_kernel_post98:
 s_sub_u32 s84, s92, 1056
 s_mov_b32 s43, 26188825
 s_mul_hi_u32 s85, s84, s43
 s_cmp_ge_u32 s85, 21
 s_cbranch_scc1 mega_kernel_end1
 s_mul_i32 s86, s85, 164
 s_sub_u32 s86, s84, s86
 s_cmp_ge_u32 s86, 16
 s_cbranch_scc1 mega_kernel_n107
 s_sub_u32 s85, s85, 5
 s_cmp_ge_u32 s85, 16
 s_cbranch_scc1 mega_kernel_loop2
 s_mul_i32 s2, s85, 16
 s_add_u32 s2, s2, s86
 s_sub_u32 s2, s2, 0
 s_add_u32 s80, s85, 112
 s_lshl_b32 s80, s80, 6
 s_mov_b32 s81, 32
 s_mov_b32 s95, -1
 s_mov_b32 s88, 0
 s_branch mega_kernel_go99
mega_kernel_n107:
 s_cmp_ge_u32 s86, 48
 s_cbranch_scc1 mega_kernel_n108
 s_sub_u32 s85, s85, 4
 s_cmp_ge_u32 s85, 16
 s_cbranch_scc1 mega_kernel_loop2
 s_mul_i32 s2, s85, 32
 s_add_u32 s2, s2, s86
 s_sub_u32 s2, s2, 16
 s_add_u32 s80, s85, 96
 s_lshl_b32 s80, s80, 6
 s_mov_b32 s81, 36
 s_add_u32 s95, s85, 112
 s_lshl_b32 s95, s95, 6
 s_mov_b32 s88, 1
 s_branch mega_kernel_go99
mega_kernel_n108:
 s_cmp_ge_u32 s86, 84
 s_cbranch_scc1 mega_kernel_n109
 s_sub_u32 s85, s85, 3
 s_cmp_ge_u32 s85, 16
 s_cbranch_scc1 mega_kernel_loop2
 s_mul_i32 s2, s85, 36
 s_add_u32 s2, s2, s86
 s_sub_u32 s2, s2, 48
 s_add_u32 s80, s85, 80
 s_lshl_b32 s80, s80, 6
 s_mov_b32 s81, 16
 s_add_u32 s95, s85, 96
 s_lshl_b32 s95, s95, 6
 s_mov_b32 s88, 2
 s_branch mega_kernel_go99
mega_kernel_n109:
 s_cmp_ge_u32 s86, 100
 s_cbranch_scc1 mega_kernel_n110
 s_sub_u32 s85, s85, 2
 s_cmp_ge_u32 s85, 16
 s_cbranch_scc1 mega_kernel_loop2
 s_mul_i32 s2, s85, 16
 s_add_u32 s2, s2, s86
 s_sub_u32 s2, s2, 84
 s_add_u32 s80, s85, 64
 s_lshl_b32 s80, s80, 6
 s_mov_b32 s81, 32
 s_add_u32 s95, s85, 80
 s_lshl_b32 s95, s95, 6
 s_mov_b32 s88, 3
 s_branch mega_kernel_go99
mega_kernel_n110:
 s_cmp_ge_u32 s86, 132
 s_cbranch_scc1 mega_kernel_n111
 s_sub_u32 s85, s85, 1
 s_cmp_ge_u32 s85, 16
 s_cbranch_scc1 mega_kernel_loop2
 s_mul_i32 s2, s85, 32
 s_add_u32 s2, s2, s86
 s_sub_u32 s2, s2, 100
 s_add_u32 s80, s85, 48
 s_lshl_b32 s80, s80, 6
 s_mov_b32 s81, 32
 s_add_u32 s95, s85, 64
 s_lshl_b32 s95, s95, 6
 s_mov_b32 s88, 4
 s_branch mega_kernel_go99
mega_kernel_n111:
 s_cmp_ge_u32 s86, 164
 s_cbranch_scc1 mega_kernel_n112
 s_sub_u32 s85, s85, 0
 s_cmp_ge_u32 s85, 16
 s_cbranch_scc1 mega_kernel_loop2
 s_mul_i32 s2, s85, 32
 s_add_u32 s2, s2, s86
 s_sub_u32 s2, s2, 132
 s_add_u32 s80, s85, 16
 s_lshl_b32 s80, s80, 6
 s_mov_b32 s81, 16
 s_add_u32 s82, s85, 32
 s_lshl_b32 s82, s82, 6
 s_mov_b32 s83, 128
 s_add_u32 s95, s85, 48
 s_lshl_b32 s95, s95, 6
 s_mov_b32 s88, 5
 s_branch mega_kernel_go99
mega_kernel_n112:
mega_kernel_go99:
 s_cmp_lg_u32 s93, 0
 s_cbranch_scc1 mega_kernel_w113
 s_load_dwordx2 s[12:13], s[0:1], 120
 s_waitcnt lgkmcnt(0)
 s_add_u32 s16, s12, 264241152
 s_addc_u32 s17, s13, 0
 s_and_b32 s17, s17, 0xffff
 s_mov_b32 s18, 12288
 s_mov_b32 s19, 0x00020000
 s_cmp_eq_u32 s82, -1
 s_cselect_b32 s82, s80, s82
 s_cselect_b32 s83, s81, s83
 s_mov_b32 s89, 0
mega_kernel_p114:
 buffer_load_dword v2, off, s[16:19], s80 sc1
 buffer_load_dword v3, off, s[16:19], s82 sc1
 s_waitcnt vmcnt(0)
 v_readfirstlane_b32 s40, v2
 v_readfirstlane_b32 s41, v3
 s_nop 3
 s_cmp_ge_u32 s40, s81
 s_cselect_b32 s42, 1, 0
 s_cmp_ge_u32 s41, s83
 s_cselect_b32 s42, s42, 0
 s_cmp_eq_u32 s42, 1
 s_cbranch_scc1 mega_kernel_w113
 s_sleep 3
 s_add_u32 s89, s89, 1
 s_cmp_lt_u32 s89, 4000000
 s_cbranch_scc1 mega_kernel_p114
mega_kernel_w113:
 s_barrier
 s_cmp_eq_u32 s88, 0
 s_cbranch_scc1 mega_kernel_bfin116
 s_cmp_eq_u32 s88, 1
 s_cbranch_scc1 mega_kernel_bdown117
 s_cmp_eq_u32 s88, 2
 s_cbranch_scc1 mega_kernel_bup93
 s_cmp_eq_u32 s88, 3
 s_cbranch_scc1 mega_kernel_bln2118
 s_cmp_eq_u32 s88, 4
 s_cbranch_scc1 mega_kernel_bwo119
 s_cmp_eq_u32 s88, 5
 s_cbranch_scc1 mega_kernel_batt120
 s_cmp_eq_u32 s88, 6
 s_cbranch_scc1 mega_kernel_bln1102
 s_cmp_eq_u32 s88, 7
 s_cbranch_scc1 mega_kernel_bqkv92
 s_cmp_eq_u32 s88, 8
 s_cbranch_scc1 mega_kernel_bfill101
mega_kernel_batt120:
 s_load_dwordx2 s[12:13], s[0:1], 120
 v_and_b32 v1, 63, v0
 v_lshrrev_b32 v2, 6, v0
 s_nop 0
 v_readfirstlane_b32 s14, v2
 v_lshrrev_b32 v3, 4, v1
 v_and_b32 v4, 15, v1
 s_lshr_b32 s15, s2, 3
 s_and_b32 s16, s2, 7
 s_lshl_b32 s16, s16, 2
 s_add_u32 s16, s16, s14
 s_lshl_b32 s17, s16, 8
 s_waitcnt lgkmcnt(0)
 s_add_u32 s24, s12, 4194304
 s_addc_u32 s25, s13, 0
 s_and_b32 s25, s25, 0xffff
 s_mov_b32 s26, 50331648
 s_mov_b32 s27, 0x00020000
 s_add_u32 s28, s12, 58720256
 s_addc_u32 s29, s13, 0
 s_and_b32 s29, s29, 0xffff
 s_mov_b32 s30, 8388608
 s_mov_b32 s31, 0x00020000
 s_add_u32 s32, s12, 69206016
 s_addc_u32 s33, s13, 0
 s_and_b32 s33, s33, 0xffff
 s_mov_b32 s34, 16777216
 s_mov_b32 s35, 0x00020000
 s_mul_i32 s18, s15, 786432
 s_add_u32 s18, s18, s17
 s_lshl_b32 s19, s15, 17
 s_add_u32 s19, s19, s17
 s_mul_i32 s20, s14, 10240
 s_movk_i32 s21, 24576
 v_mul_lo_u32 v5, v4, s21
 v_lshl_add_u32 v5, v3, 4, v5
 v_and_b32 v6, 7, v1
 v_lshlrev_b32 v6, 14, v6
 v_lshl_add_u32 v6, v3, 4, v6
 v_lshrrev_b32 v7, 1, v4
 v_or_b32 v8, 0, v3
 v_xor_b32 v7, v7, v8
 v_lshlrev_b32 v7, 1, v7
 v_and_b32 v8, 1, v1
 v_or_b32 v7, v7, v8
 v_mul_lo_u32 v8, v3, s21
 v_lshl_add_u32 v9, v7, 4, v8
 v_lshlrev_b32 v8, 14, v3
 v_lshl_add_u32 v11, v7, 4, v8
 v_lshrrev_b32 v7, 1, v4
 v_or_b32 v8, 4, v3
 v_xor_b32 v7, v7, v8
 v_lshlrev_b32 v7, 1, v7
 v_and_b32 v8, 1, v1
 v_or_b32 v7, v7, v8
 v_mul_lo_u32 v8, v3, s21
 v_lshl_add_u32 v10, v7, 4, v8
 v_lshlrev_b32 v8, 14, v3
 v_lshl_add_u32 v12, v7, 4, v8
 s_add_u32 s22, s18, 16384
 s_add_u32 m0, s20, 0
 s_nop 0
 buffer_load_dwordx4 v9, s[24:27], s22 offen lds
 s_add_u32 s22, s18, 114688
 s_add_u32 m0, s20, 1024
 s_nop 0
 buffer_load_dwordx4 v10, s[24:27], s22 offen lds
 s_add_u32 s22, s18, 212992
 s_add_u32 m0, s20, 2048
 s_nop 0
 buffer_load_dwordx4 v9, s[24:27], s22 offen lds
 s_add_u32 s22, s18, 311296
 s_add_u32 m0, s20, 3072
 s_nop 0
 buffer_load_dwordx4 v10, s[24:27], s22 offen lds
 s_add_u32 s22, s18, 409600
 s_add_u32 m0, s20, 4096
 s_nop 0
 buffer_load_dwordx4 v9, s[24:27], s22 offen lds
 s_add_u32 s22, s18, 507904
 s_add_u32 m0, s20, 5120
 s_nop 0
 buffer_load_dwordx4 v10, s[24:27], s22 offen lds
 s_add_u32 s22, s18, 606208
 s_add_u32 m0, s20, 6144
 s_nop 0
 buffer_load_dwordx4 v9, s[24:27], s22 offen lds
 s_add_u32 s22, s18, 704512
 s_add_u32 m0, s20, 7168
 s_nop 0
 buffer_load_dwordx4 v10, s[24:27], s22 offen lds
 s_add_u32 s22, s19, 8192
 s_add_u32 m0, s20, 8192
 s_nop 0
 buffer_load_dwordx4 v11, s[28:31], s22 offen lds
 s_add_u32 s22, s19, 73728
 s_add_u32 m0, s20, 9216
 s_nop 0
 buffer_load_dwordx4 v12, s[28:31], s22 offen lds
 s_add_u32 s22, s18, 0
 buffer_load_dwordx4 v[16:19], v5, s[24:27], s22 offen offset:0
 buffer_load_dwordx4 v[20:23], v5, s[24:27], s22 offen offset:64
 buffer_load_dwordx4 v[24:27], v5, s[24:27], s22 offen offset:128
 buffer_load_dwordx4 v[28:31], v5, s[24:27], s22 offen offset:192
 s_add_u32 s22, s18, 393216
 buffer_load_dwordx4 v[32:35], v5, s[24:27], s22 offen offset:0
 buffer_load_dwordx4 v[36:39], v5, s[24:27], s22 offen offset:64
 buffer_load_dwordx4 v[40:43], v5, s[24:27], s22 offen offset:128
 buffer_load_dwordx4 v[44:47], v5, s[24:27], s22 offen offset:192
 buffer_load_dwordx4 v[48:51], v6, s[28:31], s19 offen offset:0
 buffer_load_dwordx4 v[52:55], v6, s[28:31], s19 offen offset:64
 buffer_load_dwordx4 v[56:59], v6, s[28:31], s19 offen offset:128
 buffer_load_dwordx4 v[60:63], v6, s[28:31], s19 offen offset:192
 s_add_u32 s22, s18, 8192
 buffer_load_dwordx4 v[64:67], v5, s[24:27], s22 offen offset:0
 buffer_load_dwordx4 v[68:71], v5, s[24:27], s22 offen offset:64
 buffer_load_dwordx4 v[72:75], v5, s[24:27], s22 offen offset:128
 buffer_load_dwordx4 v[76:79], v5, s[24:27], s22 offen offset:192
 s_add_u32 s22, s18, 401408
 buffer_load_dwordx4 v[80:83], v5, s[24:27], s22 offen offset:0
 buffer_load_dwordx4 v[84:87], v5, s[24:27], s22 offen offset:64
 buffer_load_dwordx4 v[88:91], v5, s[24:27], s22 offen offset:128
 buffer_load_dwordx4 v[92:95], v5, s[24:27], s22 offen offset:192
 v_mov_b32 v96, 0
 v_mov_b32 v97, 0
 v_mov_b32 v98, 0
 v_mov_b32 v99, 0
 v_mov_b32 v100, 0
 v_mov_b32 v101, 0
 v_mov_b32 v102, 0
 v_mov_b32 v103, 0
 v_mov_b32 v104, 0
 v_mov_b32 v105, 0
 v_mov_b32 v106, 0
 v_mov_b32 v107, 0
 v_mov_b32 v108, 0
 v_mov_b32 v109, 0
 v_mov_b32 v110, 0
 v_mov_b32 v111, 0
 v_mov_b32 v112, 0
 v_mov_b32 v113, 0
 v_mov_b32 v114, 0
 v_mov_b32 v115, 0
 v_mov_b32 v116, 0
 v_mov_b32 v117, 0
 v_mov_b32 v118, 0
 v_mov_b32 v119, 0
 v_lshl_add_u32 v7, v3, 2, 0
 v_cmp_gt_u32 s[40:41], v7, v4
 v_lshl_add_u32 v7, v3, 2, 1
 v_cmp_gt_u32 s[42:43], v7, v4
 v_lshl_add_u32 v7, v3, 2, 2
 v_cmp_gt_u32 s[44:45], v7, v4
 v_lshl_add_u32 v7, v3, 2, 3
 v_cmp_gt_u32 s[46:47], v7, v4
 v_cmp_lt_u32 s[48:49], 31, v1
 v_lshrrev_b32 v7, 2, v4
 v_lshl_add_u32 v7, v3, 2, v7
 v_and_b32 v8, 7, v7
 v_lshlrev_b32 v13, 8, v7
 v_lshl_add_u32 v13, v8, 5, v13
 v_and_b32 v14, 3, v1
 v_lshl_add_u32 v13, v14, 3, v13
 v_add_u32 v13, s20, v13
 v_lshlrev_b32 v15, 8, v8
 v_lshl_add_u32 v15, v8, 5, v15
 v_lshl_add_u32 v15, v14, 3, v15
 s_add_u32 s22, s20, 8192
 v_add_u32 v15, s22, v15
 s_mov_b32 s52, 0x3db504f3
 s_mov_b32 s53, 0x3fb8aa3b
 s_waitcnt vmcnt(0)
 v_mfma_f32_16x16x32_bf16 v[96:99], v[48:51], v[16:19], v[96:99]
 v_mfma_f32_16x16x32_bf16 v[96:99], v[52:55], v[20:23], v[96:99]
 v_mfma_f32_16x16x32_bf16 v[96:99], v[56:59], v[24:27], v[96:99]
 v_mfma_f32_16x16x32_bf16 v[96:99], v[60:63], v[28:31], v[96:99]
 v_mfma_f32_16x16x32_bf16 v[100:103], v[64:67], v[16:19], v[100:103]
 v_mfma_f32_16x16x32_bf16 v[100:103], v[68:71], v[20:23], v[100:103]
 v_mfma_f32_16x16x32_bf16 v[100:103], v[72:75], v[24:27], v[100:103]
 v_mfma_f32_16x16x32_bf16 v[100:103], v[76:79], v[28:31], v[100:103]
 v_mfma_f32_16x16x32_bf16 v[108:111], v[48:51], v[32:35], v[108:111]
 v_mfma_f32_16x16x32_bf16 v[108:111], v[52:55], v[36:39], v[108:111]
 v_mfma_f32_16x16x32_bf16 v[108:111], v[56:59], v[40:43], v[108:111]
 v_mfma_f32_16x16x32_bf16 v[108:111], v[60:63], v[44:47], v[108:111]
 v_mfma_f32_16x16x32_bf16 v[112:115], v[64:67], v[32:35], v[112:115]
 v_mfma_f32_16x16x32_bf16 v[112:115], v[68:71], v[36:39], v[112:115]
 v_mfma_f32_16x16x32_bf16 v[112:115], v[72:75], v[40:43], v[112:115]
 v_mfma_f32_16x16x32_bf16 v[112:115], v[76:79], v[44:47], v[112:115]
 v_mfma_f32_16x16x32_bf16 v[116:119], v[80:83], v[32:35], v[116:119]
 v_mfma_f32_16x16x32_bf16 v[116:119], v[84:87], v[36:39], v[116:119]
 v_mfma_f32_16x16x32_bf16 v[116:119], v[88:91], v[40:43], v[116:119]
 v_mfma_f32_16x16x32_bf16 v[116:119], v[92:95], v[44:47], v[116:119]
 v_xor_b32 v120, 0, v13
 v_xor_b32 v121, 0, v15
 ds_read_b64_tr_b16 v[16:17], v120
 ds_read_b64_tr_b16 v[18:19], v120 offset:4096
 ds_read_b64_tr_b16 v[20:21], v121
 v_xor_b32 v120, 32, v13
 v_xor_b32 v121, 32, v15
 ds_read_b64_tr_b16 v[24:25], v120
 ds_read_b64_tr_b16 v[26:27], v120 offset:4096
 ds_read_b64_tr_b16 v[28:29], v121
 v_xor_b32 v120, 64, v13
 v_xor_b32 v121, 64, v15
 ds_read_b64_tr_b16 v[32:33], v120
 ds_read_b64_tr_b16 v[34:35], v120 offset:4096
 ds_read_b64_tr_b16 v[36:37], v121
 v_xor_b32 v120, 96, v13
 v_xor_b32 v121, 96, v15
 ds_read_b64_tr_b16 v[40:41], v120
 ds_read_b64_tr_b16 v[42:43], v120 offset:4096
 ds_read_b64_tr_b16 v[44:45], v121
 v_xor_b32 v120, 128, v13
 v_xor_b32 v121, 128, v15
 ds_read_b64_tr_b16 v[48:49], v120
 ds_read_b64_tr_b16 v[50:51], v120 offset:4096
 ds_read_b64_tr_b16 v[52:53], v121
 v_xor_b32 v120, 160, v13
 v_xor_b32 v121, 160, v15
 ds_read_b64_tr_b16 v[56:57], v120
 ds_read_b64_tr_b16 v[58:59], v120 offset:4096
 ds_read_b64_tr_b16 v[60:61], v121
 v_xor_b32 v120, 192, v13
 v_xor_b32 v121, 192, v15
 ds_read_b64_tr_b16 v[64:65], v120
 ds_read_b64_tr_b16 v[66:67], v120 offset:4096
 ds_read_b64_tr_b16 v[68:69], v121
 v_xor_b32 v120, 224, v13
 v_xor_b32 v121, 224, v15
 ds_read_b64_tr_b16 v[72:73], v120
 ds_read_b64_tr_b16 v[74:75], v120 offset:4096
 ds_read_b64_tr_b16 v[76:77], v121
 v_mov_b32 v124, 0xff800000
 v_cvt_pk_bf16_f32 v144, v96, v97
 v_cvt_pk_bf16_f32 v145, v98, v99
 v_cvt_pk_bf16_f32 v146, v100, v101
 v_cvt_pk_bf16_f32 v147, v102, v103
 v_cvt_pk_bf16_f32 v148, v104, v105
 v_cvt_pk_bf16_f32 v149, v106, v107
 v_lshlrev_b32 v96, 16, v144
 v_and_b32 v97, 0xffff0000, v144
 v_lshlrev_b32 v98, 16, v145
 v_and_b32 v99, 0xffff0000, v145
 v_lshlrev_b32 v100, 16, v146
 v_and_b32 v101, 0xffff0000, v146
 v_lshlrev_b32 v102, 16, v147
 v_and_b32 v103, 0xffff0000, v147
 v_lshlrev_b32 v104, 16, v148
 v_and_b32 v105, 0xffff0000, v148
 v_lshlrev_b32 v106, 16, v149
 v_and_b32 v107, 0xffff0000, v149
 v_mul_f32 v96, s52, v96
 v_mul_f32 v97, s52, v97
 v_mul_f32 v98, s52, v98
 v_mul_f32 v99, s52, v99
 v_mul_f32 v100, s52, v100
 v_mul_f32 v101, s52, v101
 v_mul_f32 v102, s52, v102
 v_mul_f32 v103, s52, v103
 v_mul_f32 v104, s52, v104
 v_mul_f32 v105, s52, v105
 v_mul_f32 v106, s52, v106
 v_mul_f32 v107, s52, v107
 v_cvt_pk_bf16_f32 v144, v96, v97
 v_cvt_pk_bf16_f32 v145, v98, v99
 v_cvt_pk_bf16_f32 v146, v100, v101
 v_cvt_pk_bf16_f32 v147, v102, v103
 v_cvt_pk_bf16_f32 v148, v104, v105
 v_cvt_pk_bf16_f32 v149, v106, v107
 v_lshlrev_b32 v96, 16, v144
 v_and_b32 v97, 0xffff0000, v144
 v_lshlrev_b32 v98, 16, v145
 v_and_b32 v99, 0xffff0000, v145
 v_lshlrev_b32 v100, 16, v146
 v_and_b32 v101, 0xffff0000, v146
 v_lshlrev_b32 v102, 16, v147
 v_and_b32 v103, 0xffff0000, v147
 v_lshlrev_b32 v104, 16, v148
 v_and_b32 v105, 0xffff0000, v148
 v_lshlrev_b32 v106, 16, v149
 v_and_b32 v107, 0xffff0000, v149
 v_cndmask_b32 v96, v96, v124, s[48:49]
 v_cndmask_b32 v97, v97, v124, s[48:49]
 v_cndmask_b32 v98, v98, v124, s[48:49]
 v_cndmask_b32 v99, v99, v124, s[48:49]
 v_cndmask_b32 v100, v100, v124, s[40:41]
 v_cndmask_b32 v101, v101, v124, s[42:43]
 v_cndmask_b32 v102, v102, v124, s[44:45]
 v_cndmask_b32 v103, v103, v124, s[46:47]
 v_mov_b32 v104, v124
 v_mov_b32 v105, v124
 v_mov_b32 v106, v124
 v_mov_b32 v107, v124
 v_max3_f32 v144, v96, v97, v98
 v_max3_f32 v145, v99, v100, v101
 v_max3_f32 v146, v102, v103, v104
 v_max3_f32 v147, v105, v106, v107
 v_max3_f32 v144, v144, v145, v146
 v_max_f32 v144, v144, v147
 v_mov_b32 v145, v144
 s_nop 1
 v_permlane32_swap_b32 v144, v145
 v_max_f32 v144, v144, v145
 v_mov_b32 v145, v144
 s_nop 1
 v_permlane16_swap_b32 v144, v145
 v_max_f32 v144, v144, v145
 v_mul_f32 v144, s53, v144
 v_fma_f32 v96, v96, s53, -v144
 v_fma_f32 v97, v97, s53, -v144
 v_fma_f32 v98, v98, s53, -v144
 v_fma_f32 v99, v99, s53, -v144
 v_fma_f32 v100, v100, s53, -v144
 v_fma_f32 v101, v101, s53, -v144
 v_fma_f32 v102, v102, s53, -v144
 v_fma_f32 v103, v103, s53, -v144
 v_fma_f32 v104, v104, s53, -v144
 v_fma_f32 v105, v105, s53, -v144
 v_fma_f32 v106, v106, s53, -v144
 v_fma_f32 v107, v107, s53, -v144
 v_exp_f32 v96, v96
 v_exp_f32 v97, v97
 v_exp_f32 v98, v98
 v_exp_f32 v99, v99
 v_exp_f32 v100, v100
 v_exp_f32 v101, v101
 v_exp_f32 v102, v102
 v_exp_f32 v103, v103
 v_exp_f32 v104, v104
 v_exp_f32 v105, v105
 v_exp_f32 v106, v106
 v_exp_f32 v107, v107
 s_nop 0
 v_add_f32 v144, v96, v97
 v_add_f32 v145, v98, v99
 v_add_f32 v146, v100, v101
 v_add_f32 v147, v102, v103
 v_add_f32 v148, v104, v105
 v_add_f32 v149, v106, v107
 v_add_f32 v144, v144, v145
 v_add_f32 v146, v146, v147
 v_add_f32 v148, v148, v149
 v_add_f32 v144, v144, v146
 v_add_f32 v144, v144, v148
 v_mov_b32 v145, v144
 s_nop 1
 v_permlane32_swap_b32 v144, v145
 v_add_f32 v144, v144, v145
 v_mov_b32 v145, v144
 s_nop 1
 v_permlane16_swap_b32 v144, v145
 v_add_f32 v144, v144, v145
 v_rcp_f32 v145, v144
 s_nop 0
 v_mul_f32 v96, v96, v145
 v_mul_f32 v97, v97, v145
 v_mul_f32 v98, v98, v145
 v_mul_f32 v99, v99, v145
 v_mul_f32 v100, v100, v145
 v_mul_f32 v101, v101, v145
 v_mul_f32 v102, v102, v145
 v_mul_f32 v103, v103, v145
 v_mul_f32 v104, v104, v145
 v_mul_f32 v105, v105, v145
 v_mul_f32 v106, v106, v145
 v_mul_f32 v107, v107, v145
 v_cvt_pk_bf16_f32 v132, v96, v97
 v_cvt_pk_bf16_f32 v133, v98, v99
 v_cvt_pk_bf16_f32 v128, v100, v101
 v_cvt_pk_bf16_f32 v129, v102, v103
 v_cvt_pk_bf16_f32 v130, v104, v105
 v_cvt_pk_bf16_f32 v131, v106, v107
 v_cvt_pk_bf16_f32 v144, v108, v109
 v_cvt_pk_bf16_f32 v145, v110, v111
 v_cvt_pk_bf16_f32 v146, v112, v113
 v_cvt_pk_bf16_f32 v147, v114, v115
 v_cvt_pk_bf16_f32 v148, v116, v117
 v_cvt_pk_bf16_f32 v149, v118, v119
 v_lshlrev_b32 v108, 16, v144
 v_and_b32 v109, 0xffff0000, v144
 v_lshlrev_b32 v110, 16, v145
 v_and_b32 v111, 0xffff0000, v145
 v_lshlrev_b32 v112, 16, v146
 v_and_b32 v113, 0xffff0000, v146
 v_lshlrev_b32 v114, 16, v147
 v_and_b32 v115, 0xffff0000, v147
 v_lshlrev_b32 v116, 16, v148
 v_and_b32 v117, 0xffff0000, v148
 v_lshlrev_b32 v118, 16, v149
 v_and_b32 v119, 0xffff0000, v149
 v_mul_f32 v108, s52, v108
 v_mul_f32 v109, s52, v109
 v_mul_f32 v110, s52, v110
 v_mul_f32 v111, s52, v111
 v_mul_f32 v112, s52, v112
 v_mul_f32 v113, s52, v113
 v_mul_f32 v114, s52, v114
 v_mul_f32 v115, s52, v115
 v_mul_f32 v116, s52, v116
 v_mul_f32 v117, s52, v117
 v_mul_f32 v118, s52, v118
 v_mul_f32 v119, s52, v119
 v_cvt_pk_bf16_f32 v144, v108, v109
 v_cvt_pk_bf16_f32 v145, v110, v111
 v_cvt_pk_bf16_f32 v146, v112, v113
 v_cvt_pk_bf16_f32 v147, v114, v115
 v_cvt_pk_bf16_f32 v148, v116, v117
 v_cvt_pk_bf16_f32 v149, v118, v119
 v_lshlrev_b32 v108, 16, v144
 v_and_b32 v109, 0xffff0000, v144
 v_lshlrev_b32 v110, 16, v145
 v_and_b32 v111, 0xffff0000, v145
 v_lshlrev_b32 v112, 16, v146
 v_and_b32 v113, 0xffff0000, v146
 v_lshlrev_b32 v114, 16, v147
 v_and_b32 v115, 0xffff0000, v147
 v_lshlrev_b32 v116, 16, v148
 v_and_b32 v117, 0xffff0000, v148
 v_lshlrev_b32 v118, 16, v149
 v_and_b32 v119, 0xffff0000, v149
 v_cndmask_b32 v108, v108, v124, s[48:49]
 v_cndmask_b32 v109, v109, v124, s[48:49]
 v_cndmask_b32 v110, v110, v124, s[48:49]
 v_cndmask_b32 v111, v111, v124, s[48:49]
 v_cndmask_b32 v116, v116, v124, s[40:41]
 v_cndmask_b32 v117, v117, v124, s[42:43]
 v_cndmask_b32 v118, v118, v124, s[44:45]
 v_cndmask_b32 v119, v119, v124, s[46:47]
 v_max3_f32 v144, v108, v109, v110
 v_max3_f32 v145, v111, v112, v113
 v_max3_f32 v146, v114, v115, v116
 v_max3_f32 v147, v117, v118, v119
 v_max3_f32 v144, v144, v145, v146
 v_max_f32 v144, v144, v147
 v_mov_b32 v145, v144
 s_nop 1
 v_permlane32_swap_b32 v144, v145
 v_max_f32 v144, v144, v145
 v_mov_b32 v145, v144
 s_nop 1
 v_permlane16_swap_b32 v144, v145
 v_max_f32 v144, v144, v145
 v_mul_f32 v144, s53, v144
 v_fma_f32 v108, v108, s53, -v144
 v_fma_f32 v109, v109, s53, -v144
 v_fma_f32 v110, v110, s53, -v144
 v_fma_f32 v111, v111, s53, -v144
 v_fma_f32 v112, v112, s53, -v144
 v_fma_f32 v113, v113, s53, -v144
 v_fma_f32 v114, v114, s53, -v144
 v_fma_f32 v115, v115, s53, -v144
 v_fma_f32 v116, v116, s53, -v144
 v_fma_f32 v117, v117, s53, -v144
 v_fma_f32 v118, v118, s53, -v144
 v_fma_f32 v119, v119, s53, -v144
 v_exp_f32 v108, v108
 v_exp_f32 v109, v109
 v_exp_f32 v110, v110
 v_exp_f32 v111, v111
 v_exp_f32 v112, v112
 v_exp_f32 v113, v113
 v_exp_f32 v114, v114
 v_exp_f32 v115, v115
 v_exp_f32 v116, v116
 v_exp_f32 v117, v117
 v_exp_f32 v118, v118
 v_exp_f32 v119, v119
 s_nop 0
 v_add_f32 v144, v108, v109
 v_add_f32 v145, v110, v111
 v_add_f32 v146, v112, v113
 v_add_f32 v147, v114, v115
 v_add_f32 v148, v116, v117
 v_add_f32 v149, v118, v119
 v_add_f32 v144, v144, v145
 v_add_f32 v146, v146, v147
 v_add_f32 v148, v148, v149
 v_add_f32 v144, v144, v146
 v_add_f32 v144, v144, v148
 v_mov_b32 v145, v144
 s_nop 1
 v_permlane32_swap_b32 v144, v145
 v_add_f32 v144, v144, v145
 v_mov_b32 v145, v144
 s_nop 1
 v_permlane16_swap_b32 v144, v145
 v_add_f32 v144, v144, v145
 v_rcp_f32 v145, v144
 s_nop 0
 v_mul_f32 v108, v108, v145
 v_mul_f32 v109, v109, v145
 v_mul_f32 v110, v110, v145
 v_mul_f32 v111, v111, v145
 v_mul_f32 v112, v112, v145
 v_mul_f32 v113, v113, v145
 v_mul_f32 v114, v114, v145
 v_mul_f32 v115, v115, v145
 v_mul_f32 v116, v116, v145
 v_mul_f32 v117, v117, v145
 v_mul_f32 v118, v118, v145
 v_mul_f32 v119, v119, v145
 v_cvt_pk_bf16_f32 v140, v108, v109
 v_cvt_pk_bf16_f32 v141, v110, v111
 v_cvt_pk_bf16_f32 v136, v112, v113
 v_cvt_pk_bf16_f32 v137, v114, v115
 v_cvt_pk_bf16_f32 v138, v116, v117
 v_cvt_pk_bf16_f32 v139, v118, v119
 v_lshlrev_b32 v5, 13, v4
 v_lshl_add_u32 v5, v3, 3, v5
 s_lshl_b32 s22, s15, 18
 s_add_u32 s22, s22, s17
 s_waitcnt lgkmcnt(0)
 v_mov_b32 v80, 0
 v_mov_b32 v81, 0
 v_mov_b32 v82, 0
 v_mov_b32 v83, 0
 v_mov_b32 v84, 0
 v_mov_b32 v85, 0
 v_mov_b32 v86, 0
 v_mov_b32 v87, 0
 v_mov_b32 v88, 0
 v_mov_b32 v89, 0
 v_mov_b32 v90, 0
 v_mov_b32 v91, 0
 v_mov_b32 v92, 0
 v_mov_b32 v93, 0
 v_mov_b32 v94, 0
 v_mov_b32 v95, 0
 v_mov_b32 v96, 0
 v_mov_b32 v97, 0
 v_mov_b32 v98, 0
 v_mov_b32 v99, 0
 v_mov_b32 v100, 0
 v_mov_b32 v101, 0
 v_mov_b32 v102, 0
 v_mov_b32 v103, 0
 v_mov_b32 v104, 0
 v_mov_b32 v105, 0
 v_mov_b32 v106, 0
 v_mov_b32 v107, 0
 v_mov_b32 v108, 0
 v_mov_b32 v109, 0
 v_mov_b32 v110, 0
 v_mov_b32 v111, 0
 s_nop 1
 v_mfma_f32_16x16x32_bf16 v[80:83], v[16:19], v[128:131], v[80:83]
 v_mfma_f32_16x16x32_bf16 v[84:87], v[24:27], v[128:131], v[84:87]
 v_mfma_f32_16x16x32_bf16 v[88:91], v[32:35], v[128:131], v[88:91]
 v_mfma_f32_16x16x32_bf16 v[92:95], v[40:43], v[128:131], v[92:95]
 v_mfma_f32_16x16x32_bf16 v[96:99], v[48:51], v[128:131], v[96:99]
 v_mfma_f32_16x16x32_bf16 v[100:103], v[56:59], v[128:131], v[100:103]
 v_mfma_f32_16x16x32_bf16 v[104:107], v[64:67], v[128:131], v[104:107]
 v_mfma_f32_16x16x32_bf16 v[108:111], v[72:75], v[128:131], v[108:111]
 v_mfma_f32_16x16x16_bf16 v[80:83], v[20:21], v[132:133], v[80:83]
 v_mfma_f32_16x16x16_bf16 v[84:87], v[28:29], v[132:133], v[84:87]
 v_mfma_f32_16x16x16_bf16 v[88:91], v[36:37], v[132:133], v[88:91]
 v_mfma_f32_16x16x16_bf16 v[92:95], v[44:45], v[132:133], v[92:95]
 v_mfma_f32_16x16x16_bf16 v[96:99], v[52:53], v[132:133], v[96:99]
 v_mfma_f32_16x16x16_bf16 v[100:103], v[60:61], v[132:133], v[100:103]
 v_mfma_f32_16x16x16_bf16 v[104:107], v[68:69], v[132:133], v[104:107]
 v_mfma_f32_16x16x16_bf16 v[108:111], v[76:77], v[132:133], v[108:111]
 s_nop 7
 s_add_u32 s23, s22, 0
 v_cvt_pk_bf16_f32 v150, v80, v81
 v_cvt_pk_bf16_f32 v151, v82, v83
 buffer_store_dwordx2 v[150:151], v5, s[32:35], s23 offen offset:0 sc1
 v_cvt_pk_bf16_f32 v152, v84, v85
 v_cvt_pk_bf16_f32 v153, v86, v87
 buffer_store_dwordx2 v[152:153], v5, s[32:35], s23 offen offset:32 sc1
 v_cvt_pk_bf16_f32 v154, v88, v89
 v_cvt_pk_bf16_f32 v155, v90, v91
 buffer_store_dwordx2 v[154:155], v5, s[32:35], s23 offen offset:64 sc1
 v_cvt_pk_bf16_f32 v156, v92, v93
 v_cvt_pk_bf16_f32 v157, v94, v95
 buffer_store_dwordx2 v[156:157], v5, s[32:35], s23 offen offset:96 sc1
 v_cvt_pk_bf16_f32 v158, v96, v97
 v_cvt_pk_bf16_f32 v159, v98, v99
 buffer_store_dwordx2 v[158:159], v5, s[32:35], s23 offen offset:128 sc1
 v_cvt_pk_bf16_f32 v160, v100, v101
 v_cvt_pk_bf16_f32 v161, v102, v103
 buffer_store_dwordx2 v[160:161], v5, s[32:35], s23 offen offset:160 sc1
 v_cvt_pk_bf16_f32 v162, v104, v105
 v_cvt_pk_bf16_f32 v163, v106, v107
 buffer_store_dwordx2 v[162:163], v5, s[32:35], s23 offen offset:192 sc1
 v_cvt_pk_bf16_f32 v164, v108, v109
 v_cvt_pk_bf16_f32 v165, v110, v111
 buffer_store_dwordx2 v[164:165], v5, s[32:35], s23 offen offset:224 sc1
 v_mov_b32 v80, 0
 v_mov_b32 v81, 0
 v_mov_b32 v82, 0
 v_mov_b32 v83, 0
 v_mov_b32 v84, 0
 v_mov_b32 v85, 0
 v_mov_b32 v86, 0
 v_mov_b32 v87, 0
 v_mov_b32 v88, 0
 v_mov_b32 v89, 0
 v_mov_b32 v90, 0
 v_mov_b32 v91, 0
 v_mov_b32 v92, 0
 v_mov_b32 v93, 0
 v_mov_b32 v94, 0
 v_mov_b32 v95, 0
 v_mov_b32 v96, 0
 v_mov_b32 v97, 0
 v_mov_b32 v98, 0
 v_mov_b32 v99, 0
 v_mov_b32 v100, 0
 v_mov_b32 v101, 0
 v_mov_b32 v102, 0
 v_mov_b32 v103, 0
 v_mov_b32 v104, 0
 v_mov_b32 v105, 0
 v_mov_b32 v106, 0
 v_mov_b32 v107, 0
 v_mov_b32 v108, 0
 v_mov_b32 v109, 0
 v_mov_b32 v110, 0
 v_mov_b32 v111, 0
 s_nop 1
 v_mfma_f32_16x16x32_bf16 v[80:83], v[16:19], v[136:139], v[80:83]
 v_mfma_f32_16x16x32_bf16 v[84:87], v[24:27], v[136:139], v[84:87]
 v_mfma_f32_16x16x32_bf16 v[88:91], v[32:35], v[136:139], v[88:91]
 v_mfma_f32_16x16x32_bf16 v[92:95], v[40:43], v[136:139], v[92:95]
 v_mfma_f32_16x16x32_bf16 v[96:99], v[48:51], v[136:139], v[96:99]
 v_mfma_f32_16x16x32_bf16 v[100:103], v[56:59], v[136:139], v[100:103]
 v_mfma_f32_16x16x32_bf16 v[104:107], v[64:67], v[136:139], v[104:107]
 v_mfma_f32_16x16x32_bf16 v[108:111], v[72:75], v[136:139], v[108:111]
 v_mfma_f32_16x16x16_bf16 v[80:83], v[20:21], v[140:141], v[80:83]
 v_mfma_f32_16x16x16_bf16 v[84:87], v[28:29], v[140:141], v[84:87]
 v_mfma_f32_16x16x16_bf16 v[88:91], v[36:37], v[140:141], v[88:91]
 v_mfma_f32_16x16x16_bf16 v[92:95], v[44:45], v[140:141], v[92:95]
 v_mfma_f32_16x16x16_bf16 v[96:99], v[52:53], v[140:141], v[96:99]
 v_mfma_f32_16x16x16_bf16 v[100:103], v[60:61], v[140:141], v[100:103]
 v_mfma_f32_16x16x16_bf16 v[104:107], v[68:69], v[140:141], v[104:107]
 v_mfma_f32_16x16x16_bf16 v[108:111], v[76:77], v[140:141], v[108:111]
 s_nop 7
 s_add_u32 s23, s22, 131072
 v_cvt_pk_bf16_f32 v150, v80, v81
 v_cvt_pk_bf16_f32 v151, v82, v83
 buffer_store_dwordx2 v[150:151], v5, s[32:35], s23 offen offset:0 sc1
 v_cvt_pk_bf16_f32 v152, v84, v85
 v_cvt_pk_bf16_f32 v153, v86, v87
 buffer_store_dwordx2 v[152:153], v5, s[32:35], s23 offen offset:32 sc1
 v_cvt_pk_bf16_f32 v154, v88, v89
 v_cvt_pk_bf16_f32 v155, v90, v91
 buffer_store_dwordx2 v[154:155], v5, s[32:35], s23 offen offset:64 sc1
 v_cvt_pk_bf16_f32 v156, v92, v93
 v_cvt_pk_bf16_f32 v157, v94, v95
 buffer_store_dwordx2 v[156:157], v5, s[32:35], s23 offen offset:96 sc1
 v_cvt_pk_bf16_f32 v158, v96, v97
 v_cvt_pk_bf16_f32 v159, v98, v99
 buffer_store_dwordx2 v[158:159], v5, s[32:35], s23 offen offset:128 sc1
 v_cvt_pk_bf16_f32 v160, v100, v101
 v_cvt_pk_bf16_f32 v161, v102, v103
 buffer_store_dwordx2 v[160:161], v5, s[32:35], s23 offen offset:160 sc1
 v_cvt_pk_bf16_f32 v162, v104, v105
 v_cvt_pk_bf16_f32 v163, v106, v107
 buffer_store_dwordx2 v[162:163], v5, s[32:35], s23 offen offset:192 sc1
 v_cvt_pk_bf16_f32 v164, v108, v109
 v_cvt_pk_bf16_f32 v165, v110, v111
 buffer_store_dwordx2 v[164:165], v5, s[32:35], s23 offen offset:224 sc1
 s_branch mega_kernel_sig91
mega_kernel_bwo119:
 s_load_dwordx2 s[8:9], s[0:1], 120
 s_load_dwordx2 s[4:5], s[0:1], 40
 s_mov_b32 s43, 1073741825
 s_mul_hi_u32 s45, s2, s43
 s_mul_i32 s44, s45, 4
 s_sub_u32 s44, s2, s44
 s_and_b32 s46, s45, 7
 s_lshr_b32 s45, s45, 3
 s_waitcnt lgkmcnt(0)
 s_add_u32 s12, s8, 69206016
 s_addc_u32 s13, s9, 0
 s_and_b32 s13, s13, 0xffff
 s_mov_b32 s14, 16777216
 s_mov_b32 s15, 0x00020000
 s_mov_b32 s16, s4
 s_and_b32 s17, s5, 0xffff
 s_mov_b32 s18, 4718592
 s_mov_b32 s19, 0x00020000
 s_add_u32 s24, s8, 186646528
 s_addc_u32 s25, s9, 0
 s_and_b32 s25, s25, 0xffff
 s_mov_b32 s26, 37748736
 s_mov_b32 s27, 0x00020000
 s_mul_i32 s48, s44, 288
 s_mul_i32 s50, s44, 576
 s_mul_i32 s51, s46, 1024
 s_mul_i32 s52, s46, 589824
 s_mul_i32 s53, s45, 1048576
 s_add_u32 s53, s53, s51
 s_add_u32 s48, s48, s52
 v_and_b32 v1, 63, v0
 v_lshrrev_b32 v2, 6, v0
 s_nop 0
 v_readfirstlane_b32 s54, v2
 v_lshrrev_b32 v3, 4, v1
 v_and_b32 v4, 15, v1
 v_lshrrev_b32 v5, 3, v1
 s_movk_i32 s55, 8192
 v_mul_lo_u32 v5, v5, s55
 v_and_b32 v6, 7, v1
 v_add_u32 v7, 0, v3
 v_and_b32 v7, 7, v7
 v_xor_b32 v7, v7, v6
 v_lshl_add_u32 v8, v7, 4, v5
 v_add_u32 v7, 4, v3
 v_and_b32 v7, 7, v7
 v_xor_b32 v7, v7, v6
 v_lshl_add_u32 v9, v7, 4, v5
 s_mul_i32 s56, s54, 262144
 s_add_u32 s53, s53, s56
 s_mov_b32 s57, 1152
 s_mov_b32 s62, 0xe38f
 s_add_u32 s58, s54, 0
 s_lshl_b32 s58, s58, 6
 v_add_u32 v5, s58, v1
 v_mul_lo_u32 v6, v5, s62
 v_lshrrev_b32 v6, 20, v6
 v_mul_u32_u24 v7, 18, v6
 v_sub_u32 v7, v5, v7
 v_mul_lo_u32 v6, v6, s57
 v_lshl_add_u32 v10, v7, 4, v6
 s_add_u32 s58, s54, 4
 s_lshl_b32 s58, s58, 6
 v_add_u32 v5, s58, v1
 v_mul_lo_u32 v6, v5, s62
 v_lshrrev_b32 v6, 20, v6
 v_mul_u32_u24 v7, 18, v6
 v_sub_u32 v7, v5, v7
 v_mul_lo_u32 v6, v6, s57
 v_lshl_add_u32 v11, v7, 4, v6
 s_add_u32 s58, s54, 8
 s_lshl_b32 s58, s58, 6
 v_add_u32 v5, s58, v1
 v_mul_lo_u32 v6, v5, s62
 v_lshrrev_b32 v6, 20, v6
 v_mul_u32_u24 v7, 18, v6
 v_sub_u32 v7, v5, v7
 v_mul_lo_u32 v6, v6, s57
 v_lshl_add_u32 v12, v7, 4, v6
 s_add_u32 s58, s54, 12
 s_lshl_b32 s58, s58, 6
 v_add_u32 v5, s58, v1
 v_mul_lo_u32 v6, v5, s62
 v_lshrrev_b32 v6, 20, v6
 v_mul_u32_u24 v7, 18, v6
 v_sub_u32 v7, v5, v7
 v_mul_lo_u32 v6, v6, s57
 v_lshl_add_u32 v13, v7, 4, v6
 s_and_b32 s58, s54, 1
 s_add_u32 s58, s58, 16
 s_lshl_b32 s58, s58, 6
 v_add_u32 v5, s58, v1
 v_mul_lo_u32 v6, v5, s62
 v_lshrrev_b32 v6, 20, v6
 v_mul_u32_u24 v7, 18, v6
 v_sub_u32 v7, v5, v7
 v_mul_lo_u32 v6, v6, s57
 v_lshl_add_u32 v14, v7, 4, v6
 s_mov_b32 s28, s16
 s_mov_b32 s29, s17
 s_mov_b32 s30, s18
 s_mov_b32 s31, s19
 s_mov_b32 s60, s48
 s_lshl_b32 s62, s54, 12
 v_lshrrev_b32 v5, 1, v4
 s_mul_i32 s58, s54, 4096
 v_lshl_add_u32 v6, v4, 7, s58
 v_and_b32 v7, 1, v3
 v_lshl_add_u32 v6, v7, 3, v6
 v_lshrrev_b32 v7, 1, v3
 v_xor_b32 v5, v7, v5
 v_xor_b32 v7, 0, v5
 v_lshl_add_u32 v7, v7, 4, v6
 v_add_u32 v16, 0, v7
 v_add_u32 v20, 34816, v7
 v_add_u32 v24, 69632, v7
 v_xor_b32 v7, 2, v5
 v_lshl_add_u32 v7, v7, 4, v6
 v_add_u32 v17, 0, v7
 v_add_u32 v21, 34816, v7
 v_add_u32 v25, 69632, v7
 v_xor_b32 v7, 4, v5
 v_lshl_add_u32 v7, v7, 4, v6
 v_add_u32 v18, 0, v7
 v_add_u32 v22, 34816, v7
 v_add_u32 v26, 69632, v7
 v_xor_b32 v7, 6, v5
 v_lshl_add_u32 v7, v7, 4, v6
 v_add_u32 v19, 0, v7
 v_add_u32 v23, 34816, v7
 v_add_u32 v27, 69632, v7
 v_lshrrev_b32 v5, 2, v4
 v_lshl_add_u32 v5, v3, 2, v5
 v_mul_u32_u24 v5, 288, v5
 v_and_b32 v7, 3, v1
 v_lshl_add_u32 v5, v7, 3, v5
 v_add_u32 v32, 16384, v5
 v_add_u32 v33, 51200, v5
 v_add_u32 v34, 86016, v5
 v_accvgpr_write_b32 a0, 0
 v_accvgpr_write_b32 a1, 0
 v_accvgpr_write_b32 a2, 0
 v_accvgpr_write_b32 a3, 0
 v_accvgpr_write_b32 a4, 0
 v_accvgpr_write_b32 a5, 0
 v_accvgpr_write_b32 a6, 0
 v_accvgpr_write_b32 a7, 0
 v_accvgpr_write_b32 a8, 0
 v_accvgpr_write_b32 a9, 0
 v_accvgpr_write_b32 a10, 0
 v_accvgpr_write_b32 a11, 0
 v_accvgpr_write_b32 a12, 0
 v_accvgpr_write_b32 a13, 0
 v_accvgpr_write_b32 a14, 0
 v_accvgpr_write_b32 a15, 0
 v_accvgpr_write_b32 a16, 0
 v_accvgpr_write_b32 a17, 0
 v_accvgpr_write_b32 a18, 0
 v_accvgpr_write_b32 a19, 0
 v_accvgpr_write_b32 a20, 0
 v_accvgpr_write_b32 a21, 0
 v_accvgpr_write_b32 a22, 0
 v_accvgpr_write_b32 a23, 0
 v_accvgpr_write_b32 a24, 0
 v_accvgpr_write_b32 a25, 0
 v_accvgpr_write_b32 a26, 0
 v_accvgpr_write_b32 a27, 0
 v_accvgpr_write_b32 a28, 0
 v_accvgpr_write_b32 a29, 0
 v_accvgpr_write_b32 a30, 0
 v_accvgpr_write_b32 a31, 0
 v_accvgpr_write_b32 a32, 0
 v_accvgpr_write_b32 a33, 0
 v_accvgpr_write_b32 a34, 0
 v_accvgpr_write_b32 a35, 0
 v_accvgpr_write_b32 a36, 0
 v_accvgpr_write_b32 a37, 0
 v_accvgpr_write_b32 a38, 0
 v_accvgpr_write_b32 a39, 0
 v_accvgpr_write_b32 a40, 0
 v_accvgpr_write_b32 a41, 0
 v_accvgpr_write_b32 a42, 0
 v_accvgpr_write_b32 a43, 0
 v_accvgpr_write_b32 a44, 0
 v_accvgpr_write_b32 a45, 0
 v_accvgpr_write_b32 a46, 0
 v_accvgpr_write_b32 a47, 0
 v_accvgpr_write_b32 a48, 0
 v_accvgpr_write_b32 a49, 0
 v_accvgpr_write_b32 a50, 0
 v_accvgpr_write_b32 a51, 0
 v_accvgpr_write_b32 a52, 0
 v_accvgpr_write_b32 a53, 0
 v_accvgpr_write_b32 a54, 0
 v_accvgpr_write_b32 a55, 0
 v_accvgpr_write_b32 a56, 0
 v_accvgpr_write_b32 a57, 0
 v_accvgpr_write_b32 a58, 0
 v_accvgpr_write_b32 a59, 0
 v_accvgpr_write_b32 a60, 0
 v_accvgpr_write_b32 a61, 0
 v_accvgpr_write_b32 a62, 0
 v_accvgpr_write_b32 a63, 0
 v_accvgpr_write_b32 a64, 0
 v_accvgpr_write_b32 a65, 0
 v_accvgpr_write_b32 a66, 0
 v_accvgpr_write_b32 a67, 0
 v_accvgpr_write_b32 a68, 0
 v_accvgpr_write_b32 a69, 0
 v_accvgpr_write_b32 a70, 0
 v_accvgpr_write_b32 a71, 0
 s_add_u32 s63, s53, 0
 s_add_u32 m0, s62, 0
 s_nop 0
 buffer_load_dwordx4 v8, s[12:15], s63 offen lds
 s_add_u32 s63, s53, 65536
 s_add_u32 m0, s62, 1024
 s_nop 0
 buffer_load_dwordx4 v9, s[12:15], s63 offen lds
 s_add_u32 s63, s53, 131072
 s_add_u32 m0, s62, 2048
 s_nop 0
 buffer_load_dwordx4 v8, s[12:15], s63 offen lds
 s_add_u32 s63, s53, 196608
 s_add_u32 m0, s62, 3072
 s_nop 0
 buffer_load_dwordx4 v9, s[12:15], s63 offen lds
 s_add_u32 s63, s60, 0
 s_lshl_b32 m0, s54, 10
 s_add_u32 m0, m0, 16384
 s_nop 0
 buffer_load_dwordx4 v10, s[28:31], s63 offen lds
 s_add_u32 s63, s60, 0
 s_lshl_b32 m0, s54, 10
 s_add_u32 m0, m0, 20480
 s_nop 0
 buffer_load_dwordx4 v11, s[28:31], s63 offen lds
 s_add_u32 s63, s60, 0
 s_lshl_b32 m0, s54, 10
 s_add_u32 m0, m0, 24576
 s_nop 0
 buffer_load_dwordx4 v12, s[28:31], s63 offen lds
 s_add_u32 s63, s60, 0
 s_lshl_b32 m0, s54, 10
 s_add_u32 m0, m0, 28672
 s_nop 0
 buffer_load_dwordx4 v13, s[28:31], s63 offen lds
 s_add_u32 s63, s60, 0
 s_and_b32 m0, s54, 1
 s_lshl_b32 m0, m0, 10
 s_add_u32 m0, m0, 32768
 s_nop 0
 buffer_load_dwordx4 v14, s[28:31], s63 offen lds
 s_add_u32 s63, s53, 128
 s_add_u32 m0, s62, 34816
 s_nop 0
 buffer_load_dwordx4 v8, s[12:15], s63 offen lds
 s_add_u32 s63, s53, 65664
 s_add_u32 m0, s62, 35840
 s_nop 0
 buffer_load_dwordx4 v9, s[12:15], s63 offen lds
 s_add_u32 s63, s53, 131200
 s_add_u32 m0, s62, 36864
 s_nop 0
 buffer_load_dwordx4 v8, s[12:15], s63 offen lds
 s_add_u32 s63, s53, 196736
 s_add_u32 m0, s62, 37888
 s_nop 0
 buffer_load_dwordx4 v9, s[12:15], s63 offen lds
 s_add_u32 s63, s60, 73728
 s_lshl_b32 m0, s54, 10
 s_add_u32 m0, m0, 51200
 s_nop 0
 buffer_load_dwordx4 v10, s[28:31], s63 offen lds
 s_add_u32 s63, s60, 73728
 s_lshl_b32 m0, s54, 10
 s_add_u32 m0, m0, 55296
 s_nop 0
 buffer_load_dwordx4 v11, s[28:31], s63 offen lds
 s_add_u32 s63, s60, 73728
 s_lshl_b32 m0, s54, 10
 s_add_u32 m0, m0, 59392
 s_nop 0
 buffer_load_dwordx4 v12, s[28:31], s63 offen lds
 s_add_u32 s63, s60, 73728
 s_lshl_b32 m0, s54, 10
 s_add_u32 m0, m0, 63488
 s_nop 0
 buffer_load_dwordx4 v13, s[28:31], s63 offen lds
 s_add_u32 s63, s60, 73728
 s_and_b32 m0, s54, 1
 s_lshl_b32 m0, m0, 10
 s_add_u32 m0, m0, 67584
 s_nop 0
 buffer_load_dwordx4 v14, s[28:31], s63 offen lds
 s_add_u32 s63, s53, 256
 s_add_u32 m0, s62, 69632
 s_nop 0
 buffer_load_dwordx4 v8, s[12:15], s63 offen lds
 s_add_u32 s63, s53, 65792
 s_add_u32 m0, s62, 70656
 s_nop 0
 buffer_load_dwordx4 v9, s[12:15], s63 offen lds
 s_add_u32 s63, s53, 131328
 s_add_u32 m0, s62, 71680
 s_nop 0
 buffer_load_dwordx4 v8, s[12:15], s63 offen lds
 s_add_u32 s63, s53, 196864
 s_add_u32 m0, s62, 72704
 s_nop 0
 buffer_load_dwordx4 v9, s[12:15], s63 offen lds
 s_add_u32 s63, s60, 147456
 s_lshl_b32 m0, s54, 10
 s_add_u32 m0, m0, 86016
 s_nop 0
 buffer_load_dwordx4 v10, s[28:31], s63 offen lds
 s_add_u32 s63, s60, 147456
 s_lshl_b32 m0, s54, 10
 s_add_u32 m0, m0, 90112
 s_nop 0
 buffer_load_dwordx4 v11, s[28:31], s63 offen lds
 s_add_u32 s63, s60, 147456
 s_lshl_b32 m0, s54, 10
 s_add_u32 m0, m0, 94208
 s_nop 0
 buffer_load_dwordx4 v12, s[28:31], s63 offen lds
 s_add_u32 s63, s60, 147456
 s_lshl_b32 m0, s54, 10
 s_add_u32 m0, m0, 98304
 s_nop 0
 buffer_load_dwordx4 v13, s[28:31], s63 offen lds
 s_add_u32 s63, s60, 147456
 s_and_b32 m0, s54, 1
 s_lshl_b32 m0, m0, 10
 s_add_u32 m0, m0, 102400
 s_nop 0
 buffer_load_dwordx4 v14, s[28:31], s63 offen lds
 s_waitcnt vmcnt(18)
 s_barrier
 ds_read_b64 v[64:65], v16 offset:0
 ds_read_b64 v[66:67], v17 offset:0
 ds_read_b64 v[68:69], v16 offset:2048
 ds_read_b64 v[70:71], v17 offset:2048
 ds_read_b64_tr_b16 v[72:73], v32 offset:0
 ds_read_b64_tr_b16 v[74:75], v32 offset:4608
 ds_read_b64_tr_b16 v[76:77], v32 offset:32
 ds_read_b64_tr_b16 v[78:79], v32 offset:4640
 ds_read_b64_tr_b16 v[80:81], v32 offset:64
 ds_read_b64_tr_b16 v[82:83], v32 offset:4672
 ds_read_b64_tr_b16 v[84:85], v32 offset:96
 ds_read_b64_tr_b16 v[86:87], v32 offset:4704
 ds_read_b64_tr_b16 v[88:89], v32 offset:128
 ds_read_b64_tr_b16 v[90:91], v32 offset:4736
 ds_read_b64_tr_b16 v[92:93], v32 offset:160
 ds_read_b64_tr_b16 v[94:95], v32 offset:4768
 ds_read_b64_tr_b16 v[96:97], v32 offset:192
 ds_read_b64_tr_b16 v[98:99], v32 offset:4800
 ds_read_b64_tr_b16 v[100:101], v32 offset:224
 ds_read_b64_tr_b16 v[102:103], v32 offset:4832
 ds_read_b64_tr_b16 v[104:105], v32 offset:256
 ds_read_b64_tr_b16 v[106:107], v32 offset:4864
 s_waitcnt lgkmcnt(0)
 v_mfma_f32_16x16x32_bf16 a[0:3], v[72:75], v[64:67], a[0:3]
 ds_read_b64 v[108:109], v18 offset:0
 v_mfma_f32_16x16x32_bf16 a[4:7], v[72:75], v[68:71], a[4:7]
 ds_read_b64 v[110:111], v19 offset:0
 v_mfma_f32_16x16x32_bf16 a[8:11], v[76:79], v[64:67], a[8:11]
 ds_read_b64 v[112:113], v18 offset:2048
 v_mfma_f32_16x16x32_bf16 a[12:15], v[76:79], v[68:71], a[12:15]
 ds_read_b64 v[114:115], v19 offset:2048
 v_mfma_f32_16x16x32_bf16 a[16:19], v[80:83], v[64:67], a[16:19]
 ds_read_b64_tr_b16 v[116:117], v32 offset:9216
 ds_read_b64_tr_b16 v[118:119], v32 offset:13824
 v_mfma_f32_16x16x32_bf16 a[20:23], v[80:83], v[68:71], a[20:23]
 ds_read_b64_tr_b16 v[120:121], v32 offset:9248
 v_mfma_f32_16x16x32_bf16 a[24:27], v[84:87], v[64:67], a[24:27]
 ds_read_b64_tr_b16 v[122:123], v32 offset:13856
 v_mfma_f32_16x16x32_bf16 a[28:31], v[84:87], v[68:71], a[28:31]
 ds_read_b64_tr_b16 v[124:125], v32 offset:9280
 v_mfma_f32_16x16x32_bf16 a[32:35], v[88:91], v[64:67], a[32:35]
 ds_read_b64_tr_b16 v[126:127], v32 offset:13888
 ds_read_b64_tr_b16 v[128:129], v32 offset:9312
 v_mfma_f32_16x16x32_bf16 a[36:39], v[88:91], v[68:71], a[36:39]
 ds_read_b64_tr_b16 v[130:131], v32 offset:13920
 v_mfma_f32_16x16x32_bf16 a[40:43], v[92:95], v[64:67], a[40:43]
 ds_read_b64_tr_b16 v[132:133], v32 offset:9344
 v_mfma_f32_16x16x32_bf16 a[44:47], v[92:95], v[68:71], a[44:47]
 ds_read_b64_tr_b16 v[134:135], v32 offset:13952
 v_mfma_f32_16x16x32_bf16 a[48:51], v[96:99], v[64:67], a[48:51]
 ds_read_b64_tr_b16 v[136:137], v32 offset:9376
 v_mfma_f32_16x16x32_bf16 a[52:55], v[96:99], v[68:71], a[52:55]
 ds_read_b64_tr_b16 v[138:139], v32 offset:13984
 ds_read_b64_tr_b16 v[140:141], v32 offset:9408
 v_mfma_f32_16x16x32_bf16 a[56:59], v[100:103], v[64:67], a[56:59]
 ds_read_b64_tr_b16 v[142:143], v32 offset:14016
 v_mfma_f32_16x16x32_bf16 a[60:63], v[100:103], v[68:71], a[60:63]
 ds_read_b64_tr_b16 v[144:145], v32 offset:9440
 v_mfma_f32_16x16x32_bf16 a[64:67], v[104:107], v[64:67], a[64:67]
 ds_read_b64_tr_b16 v[146:147], v32 offset:14048
 v_mfma_f32_16x16x32_bf16 a[68:71], v[104:107], v[68:71], a[68:71]
 ds_read_b64_tr_b16 v[148:149], v32 offset:9472
 ds_read_b64_tr_b16 v[150:151], v32 offset:14080
 s_waitcnt lgkmcnt(0)
 s_waitcnt vmcnt(9)
 s_barrier
 v_mfma_f32_16x16x32_bf16 a[0:3], v[116:119], v[108:111], a[0:3]
 s_add_u32 s63, s53, 384
 s_add_u32 m0, s62, 0
 s_nop 0
 buffer_load_dwordx4 v8, s[12:15], s63 offen lds
 v_mfma_f32_16x16x32_bf16 a[4:7], v[116:119], v[112:115], a[4:7]
 s_add_u32 s63, s53, 65920
 s_add_u32 m0, s62, 1024
 s_nop 0
 buffer_load_dwordx4 v9, s[12:15], s63 offen lds
 s_add_u32 s63, s53, 131456
 s_add_u32 m0, s62, 2048
 s_nop 0
 buffer_load_dwordx4 v8, s[12:15], s63 offen lds
 v_mfma_f32_16x16x32_bf16 a[8:11], v[120:123], v[108:111], a[8:11]
 s_add_u32 s63, s53, 196992
 s_add_u32 m0, s62, 3072
 s_nop 0
 buffer_load_dwordx4 v9, s[12:15], s63 offen lds
 s_add_u32 s63, s60, 221184
 s_lshl_b32 m0, s54, 10
 s_add_u32 m0, m0, 16384
 s_nop 0
 buffer_load_dwordx4 v10, s[28:31], s63 offen lds
 v_mfma_f32_16x16x32_bf16 a[12:15], v[120:123], v[112:115], a[12:15]
 s_add_u32 s63, s60, 221184
 s_lshl_b32 m0, s54, 10
 s_add_u32 m0, m0, 20480
 s_nop 0
 buffer_load_dwordx4 v11, s[28:31], s63 offen lds
 v_mfma_f32_16x16x32_bf16 a[16:19], v[124:127], v[108:111], a[16:19]
 s_add_u32 s63, s60, 221184
 s_lshl_b32 m0, s54, 10
 s_add_u32 m0, m0, 24576
 s_nop 0
 buffer_load_dwordx4 v12, s[28:31], s63 offen lds
 s_add_u32 s63, s60, 221184
 s_lshl_b32 m0, s54, 10
 s_add_u32 m0, m0, 28672
 s_nop 0
 buffer_load_dwordx4 v13, s[28:31], s63 offen lds
 v_mfma_f32_16x16x32_bf16 a[20:23], v[124:127], v[112:115], a[20:23]
 s_add_u32 s63, s60, 221184
 s_and_b32 m0, s54, 1
 s_lshl_b32 m0, m0, 10
 s_add_u32 m0, m0, 32768
 s_nop 0
 buffer_load_dwordx4 v14, s[28:31], s63 offen lds
 ds_read_b64 v[64:65], v20 offset:0
 v_mfma_f32_16x16x32_bf16 a[24:27], v[128:131], v[108:111], a[24:27]
 ds_read_b64 v[66:67], v21 offset:0
 ds_read_b64 v[68:69], v20 offset:2048
 v_mfma_f32_16x16x32_bf16 a[28:31], v[128:131], v[112:115], a[28:31]
 ds_read_b64 v[70:71], v21 offset:2048
 v_mfma_f32_16x16x32_bf16 a[32:35], v[132:135], v[108:111], a[32:35]
 ds_read_b64_tr_b16 v[72:73], v33 offset:0
 ds_read_b64_tr_b16 v[74:75], v33 offset:4608
 v_mfma_f32_16x16x32_bf16 a[36:39], v[132:135], v[112:115], a[36:39]
 ds_read_b64_tr_b16 v[76:77], v33 offset:32
 ds_read_b64_tr_b16 v[78:79], v33 offset:4640
 v_mfma_f32_16x16x32_bf16 a[40:43], v[136:139], v[108:111], a[40:43]
 ds_read_b64_tr_b16 v[80:81], v33 offset:64
 v_mfma_f32_16x16x32_bf16 a[44:47], v[136:139], v[112:115], a[44:47]
 ds_read_b64_tr_b16 v[82:83], v33 offset:4672
 ds_read_b64_tr_b16 v[84:85], v33 offset:96
 v_mfma_f32_16x16x32_bf16 a[48:51], v[140:143], v[108:111], a[48:51]
 ds_read_b64_tr_b16 v[86:87], v33 offset:4704
 ds_read_b64_tr_b16 v[88:89], v33 offset:128
 v_mfma_f32_16x16x32_bf16 a[52:55], v[140:143], v[112:115], a[52:55]
 ds_read_b64_tr_b16 v[90:91], v33 offset:4736
 ds_read_b64_tr_b16 v[92:93], v33 offset:160
 v_mfma_f32_16x16x32_bf16 a[56:59], v[144:147], v[108:111], a[56:59]
 ds_read_b64_tr_b16 v[94:95], v33 offset:4768
 v_mfma_f32_16x16x32_bf16 a[60:63], v[144:147], v[112:115], a[60:63]
 ds_read_b64_tr_b16 v[96:97], v33 offset:192
 ds_read_b64_tr_b16 v[98:99], v33 offset:4800
 v_mfma_f32_16x16x32_bf16 a[64:67], v[148:151], v[108:111], a[64:67]
 ds_read_b64_tr_b16 v[100:101], v33 offset:224
 ds_read_b64_tr_b16 v[102:103], v33 offset:4832
 v_mfma_f32_16x16x32_bf16 a[68:71], v[148:151], v[112:115], a[68:71]
 ds_read_b64_tr_b16 v[104:105], v33 offset:256
 ds_read_b64_tr_b16 v[106:107], v33 offset:4864
 s_waitcnt lgkmcnt(0)
 v_mfma_f32_16x16x32_bf16 a[0:3], v[72:75], v[64:67], a[0:3]
 ds_read_b64 v[108:109], v22 offset:0
 v_mfma_f32_16x16x32_bf16 a[4:7], v[72:75], v[68:71], a[4:7]
 ds_read_b64 v[110:111], v23 offset:0
 v_mfma_f32_16x16x32_bf16 a[8:11], v[76:79], v[64:67], a[8:11]
 ds_read_b64 v[112:113], v22 offset:2048
 v_mfma_f32_16x16x32_bf16 a[12:15], v[76:79], v[68:71], a[12:15]
 ds_read_b64 v[114:115], v23 offset:2048
 v_mfma_f32_16x16x32_bf16 a[16:19], v[80:83], v[64:67], a[16:19]
 ds_read_b64_tr_b16 v[116:117], v33 offset:9216
 ds_read_b64_tr_b16 v[118:119], v33 offset:13824
 v_mfma_f32_16x16x32_bf16 a[20:23], v[80:83], v[68:71], a[20:23]
 ds_read_b64_tr_b16 v[120:121], v33 offset:9248
 v_mfma_f32_16x16x32_bf16 a[24:27], v[84:87], v[64:67], a[24:27]
 ds_read_b64_tr_b16 v[122:123], v33 offset:13856
 v_mfma_f32_16x16x32_bf16 a[28:31], v[84:87], v[68:71], a[28:31]
 ds_read_b64_tr_b16 v[124:125], v33 offset:9280
 v_mfma_f32_16x16x32_bf16 a[32:35], v[88:91], v[64:67], a[32:35]
 ds_read_b64_tr_b16 v[126:127], v33 offset:13888
 ds_read_b64_tr_b16 v[128:129], v33 offset:9312
 v_mfma_f32_16x16x32_bf16 a[36:39], v[88:91], v[68:71], a[36:39]
 ds_read_b64_tr_b16 v[130:131], v33 offset:13920
 v_mfma_f32_16x16x32_bf16 a[40:43], v[92:95], v[64:67], a[40:43]
 ds_read_b64_tr_b16 v[132:133], v33 offset:9344
 v_mfma_f32_16x16x32_bf16 a[44:47], v[92:95], v[68:71], a[44:47]
 ds_read_b64_tr_b16 v[134:135], v33 offset:13952
 v_mfma_f32_16x16x32_bf16 a[48:51], v[96:99], v[64:67], a[48:51]
 ds_read_b64_tr_b16 v[136:137], v33 offset:9376
 v_mfma_f32_16x16x32_bf16 a[52:55], v[96:99], v[68:71], a[52:55]
 ds_read_b64_tr_b16 v[138:139], v33 offset:13984
 ds_read_b64_tr_b16 v[140:141], v33 offset:9408
 v_mfma_f32_16x16x32_bf16 a[56:59], v[100:103], v[64:67], a[56:59]
 ds_read_b64_tr_b16 v[142:143], v33 offset:14016
 v_mfma_f32_16x16x32_bf16 a[60:63], v[100:103], v[68:71], a[60:63]
 ds_read_b64_tr_b16 v[144:145], v33 offset:9440
 v_mfma_f32_16x16x32_bf16 a[64:67], v[104:107], v[64:67], a[64:67]
 ds_read_b64_tr_b16 v[146:147], v33 offset:14048
 v_mfma_f32_16x16x32_bf16 a[68:71], v[104:107], v[68:71], a[68:71]
 ds_read_b64_tr_b16 v[148:149], v33 offset:9472
 ds_read_b64_tr_b16 v[150:151], v33 offset:14080
 s_waitcnt lgkmcnt(0)
 s_waitcnt vmcnt(9)
 s_barrier
 v_mfma_f32_16x16x32_bf16 a[0:3], v[116:119], v[108:111], a[0:3]
 s_add_u32 s63, s53, 512
 s_add_u32 m0, s62, 34816
 s_nop 0
 buffer_load_dwordx4 v8, s[12:15], s63 offen lds
 v_mfma_f32_16x16x32_bf16 a[4:7], v[116:119], v[112:115], a[4:7]
 s_add_u32 s63, s53, 66048
 s_add_u32 m0, s62, 35840
 s_nop 0
 buffer_load_dwordx4 v9, s[12:15], s63 offen lds
 s_add_u32 s63, s53, 131584
 s_add_u32 m0, s62, 36864
 s_nop 0
 buffer_load_dwordx4 v8, s[12:15], s63 offen lds
 v_mfma_f32_16x16x32_bf16 a[8:11], v[120:123], v[108:111], a[8:11]
 s_add_u32 s63, s53, 197120
 s_add_u32 m0, s62, 37888
 s_nop 0
 buffer_load_dwordx4 v9, s[12:15], s63 offen lds
 s_add_u32 s63, s60, 294912
 s_lshl_b32 m0, s54, 10
 s_add_u32 m0, m0, 51200
 s_nop 0
 buffer_load_dwordx4 v10, s[28:31], s63 offen lds
 v_mfma_f32_16x16x32_bf16 a[12:15], v[120:123], v[112:115], a[12:15]
 s_add_u32 s63, s60, 294912
 s_lshl_b32 m0, s54, 10
 s_add_u32 m0, m0, 55296
 s_nop 0
 buffer_load_dwordx4 v11, s[28:31], s63 offen lds
 v_mfma_f32_16x16x32_bf16 a[16:19], v[124:127], v[108:111], a[16:19]
 s_add_u32 s63, s60, 294912
 s_lshl_b32 m0, s54, 10
 s_add_u32 m0, m0, 59392
 s_nop 0
 buffer_load_dwordx4 v12, s[28:31], s63 offen lds
 s_add_u32 s63, s60, 294912
 s_lshl_b32 m0, s54, 10
 s_add_u32 m0, m0, 63488
 s_nop 0
 buffer_load_dwordx4 v13, s[28:31], s63 offen lds
 v_mfma_f32_16x16x32_bf16 a[20:23], v[124:127], v[112:115], a[20:23]
 s_add_u32 s63, s60, 294912
 s_and_b32 m0, s54, 1
 s_lshl_b32 m0, m0, 10
 s_add_u32 m0, m0, 67584
 s_nop 0
 buffer_load_dwordx4 v14, s[28:31], s63 offen lds
 ds_read_b64 v[64:65], v24 offset:0
 v_mfma_f32_16x16x32_bf16 a[24:27], v[128:131], v[108:111], a[24:27]
 ds_read_b64 v[66:67], v25 offset:0
 ds_read_b64 v[68:69], v24 offset:2048
 v_mfma_f32_16x16x32_bf16 a[28:31], v[128:131], v[112:115], a[28:31]
 ds_read_b64 v[70:71], v25 offset:2048
 v_mfma_f32_16x16x32_bf16 a[32:35], v[132:135], v[108:111], a[32:35]
 ds_read_b64_tr_b16 v[72:73], v34 offset:0
 ds_read_b64_tr_b16 v[74:75], v34 offset:4608
 v_mfma_f32_16x16x32_bf16 a[36:39], v[132:135], v[112:115], a[36:39]
 ds_read_b64_tr_b16 v[76:77], v34 offset:32
 ds_read_b64_tr_b16 v[78:79], v34 offset:4640
 v_mfma_f32_16x16x32_bf16 a[40:43], v[136:139], v[108:111], a[40:43]
 ds_read_b64_tr_b16 v[80:81], v34 offset:64
 v_mfma_f32_16x16x32_bf16 a[44:47], v[136:139], v[112:115], a[44:47]
 ds_read_b64_tr_b16 v[82:83], v34 offset:4672
 ds_read_b64_tr_b16 v[84:85], v34 offset:96
 v_mfma_f32_16x16x32_bf16 a[48:51], v[140:143], v[108:111], a[48:51]
 ds_read_b64_tr_b16 v[86:87], v34 offset:4704
 ds_read_b64_tr_b16 v[88:89], v34 offset:128
 v_mfma_f32_16x16x32_bf16 a[52:55], v[140:143], v[112:115], a[52:55]
 ds_read_b64_tr_b16 v[90:91], v34 offset:4736
 ds_read_b64_tr_b16 v[92:93], v34 offset:160
 v_mfma_f32_16x16x32_bf16 a[56:59], v[144:147], v[108:111], a[56:59]
 ds_read_b64_tr_b16 v[94:95], v34 offset:4768
 v_mfma_f32_16x16x32_bf16 a[60:63], v[144:147], v[112:115], a[60:63]
 ds_read_b64_tr_b16 v[96:97], v34 offset:192
 ds_read_b64_tr_b16 v[98:99], v34 offset:4800
 v_mfma_f32_16x16x32_bf16 a[64:67], v[148:151], v[108:111], a[64:67]
 ds_read_b64_tr_b16 v[100:101], v34 offset:224
 ds_read_b64_tr_b16 v[102:103], v34 offset:4832
 v_mfma_f32_16x16x32_bf16 a[68:71], v[148:151], v[112:115], a[68:71]
 ds_read_b64_tr_b16 v[104:105], v34 offset:256
 ds_read_b64_tr_b16 v[106:107], v34 offset:4864
 s_waitcnt lgkmcnt(0)
 v_mfma_f32_16x16x32_bf16 a[0:3], v[72:75], v[64:67], a[0:3]
 ds_read_b64 v[108:109], v26 offset:0
 v_mfma_f32_16x16x32_bf16 a[4:7], v[72:75], v[68:71], a[4:7]
 ds_read_b64 v[110:111], v27 offset:0
 v_mfma_f32_16x16x32_bf16 a[8:11], v[76:79], v[64:67], a[8:11]
 ds_read_b64 v[112:113], v26 offset:2048
 v_mfma_f32_16x16x32_bf16 a[12:15], v[76:79], v[68:71], a[12:15]
 ds_read_b64 v[114:115], v27 offset:2048
 v_mfma_f32_16x16x32_bf16 a[16:19], v[80:83], v[64:67], a[16:19]
 ds_read_b64_tr_b16 v[116:117], v34 offset:9216
 ds_read_b64_tr_b16 v[118:119], v34 offset:13824
 v_mfma_f32_16x16x32_bf16 a[20:23], v[80:83], v[68:71], a[20:23]
 ds_read_b64_tr_b16 v[120:121], v34 offset:9248
 v_mfma_f32_16x16x32_bf16 a[24:27], v[84:87], v[64:67], a[24:27]
 ds_read_b64_tr_b16 v[122:123], v34 offset:13856
 v_mfma_f32_16x16x32_bf16 a[28:31], v[84:87], v[68:71], a[28:31]
 ds_read_b64_tr_b16 v[124:125], v34 offset:9280
 v_mfma_f32_16x16x32_bf16 a[32:35], v[88:91], v[64:67], a[32:35]
 ds_read_b64_tr_b16 v[126:127], v34 offset:13888
 ds_read_b64_tr_b16 v[128:129], v34 offset:9312
 v_mfma_f32_16x16x32_bf16 a[36:39], v[88:91], v[68:71], a[36:39]
 ds_read_b64_tr_b16 v[130:131], v34 offset:13920
 v_mfma_f32_16x16x32_bf16 a[40:43], v[92:95], v[64:67], a[40:43]
 ds_read_b64_tr_b16 v[132:133], v34 offset:9344
 v_mfma_f32_16x16x32_bf16 a[44:47], v[92:95], v[68:71], a[44:47]
 ds_read_b64_tr_b16 v[134:135], v34 offset:13952
 v_mfma_f32_16x16x32_bf16 a[48:51], v[96:99], v[64:67], a[48:51]
 ds_read_b64_tr_b16 v[136:137], v34 offset:9376
 v_mfma_f32_16x16x32_bf16 a[52:55], v[96:99], v[68:71], a[52:55]
 ds_read_b64_tr_b16 v[138:139], v34 offset:13984
 ds_read_b64_tr_b16 v[140:141], v34 offset:9408
 v_mfma_f32_16x16x32_bf16 a[56:59], v[100:103], v[64:67], a[56:59]
 ds_read_b64_tr_b16 v[142:143], v34 offset:14016
 v_mfma_f32_16x16x32_bf16 a[60:63], v[100:103], v[68:71], a[60:63]
 ds_read_b64_tr_b16 v[144:145], v34 offset:9440
 v_mfma_f32_16x16x32_bf16 a[64:67], v[104:107], v[64:67], a[64:67]
 ds_read_b64_tr_b16 v[146:147], v34 offset:14048
 v_mfma_f32_16x16x32_bf16 a[68:71], v[104:107], v[68:71], a[68:71]
 ds_read_b64_tr_b16 v[148:149], v34 offset:9472
 ds_read_b64_tr_b16 v[150:151], v34 offset:14080
 s_waitcnt lgkmcnt(0)
 s_waitcnt vmcnt(9)
 s_barrier
 v_mfma_f32_16x16x32_bf16 a[0:3], v[116:119], v[108:111], a[0:3]
 s_add_u32 s63, s53, 640
 s_add_u32 m0, s62, 69632
 s_nop 0
 buffer_load_dwordx4 v8, s[12:15], s63 offen lds
 v_mfma_f32_16x16x32_bf16 a[4:7], v[116:119], v[112:115], a[4:7]
 s_add_u32 s63, s53, 66176
 s_add_u32 m0, s62, 70656
 s_nop 0
 buffer_load_dwordx4 v9, s[12:15], s63 offen lds
 s_add_u32 s63, s53, 131712
 s_add_u32 m0, s62, 71680
 s_nop 0
 buffer_load_dwordx4 v8, s[12:15], s63 offen lds
 v_mfma_f32_16x16x32_bf16 a[8:11], v[120:123], v[108:111], a[8:11]
 s_add_u32 s63, s53, 197248
 s_add_u32 m0, s62, 72704
 s_nop 0
 buffer_load_dwordx4 v9, s[12:15], s63 offen lds
 s_add_u32 s63, s60, 368640
 s_lshl_b32 m0, s54, 10
 s_add_u32 m0, m0, 86016
 s_nop 0
 buffer_load_dwordx4 v10, s[28:31], s63 offen lds
 v_mfma_f32_16x16x32_bf16 a[12:15], v[120:123], v[112:115], a[12:15]
 s_add_u32 s63, s60, 368640
 s_lshl_b32 m0, s54, 10
 s_add_u32 m0, m0, 90112
 s_nop 0
 buffer_load_dwordx4 v11, s[28:31], s63 offen lds
 v_mfma_f32_16x16x32_bf16 a[16:19], v[124:127], v[108:111], a[16:19]
 s_add_u32 s63, s60, 368640
 s_lshl_b32 m0, s54, 10
 s_add_u32 m0, m0, 94208
 s_nop 0
 buffer_load_dwordx4 v12, s[28:31], s63 offen lds
 s_add_u32 s63, s60, 368640
 s_lshl_b32 m0, s54, 10
 s_add_u32 m0, m0, 98304
 s_nop 0
 buffer_load_dwordx4 v13, s[28:31], s63 offen lds
 v_mfma_f32_16x16x32_bf16 a[20:23], v[124:127], v[112:115], a[20:23]
 s_add_u32 s63, s60, 368640
 s_and_b32 m0, s54, 1
 s_lshl_b32 m0, m0, 10
 s_add_u32 m0, m0, 102400
 s_nop 0
 buffer_load_dwordx4 v14, s[28:31], s63 offen lds
 ds_read_b64 v[64:65], v16 offset:0
 v_mfma_f32_16x16x32_bf16 a[24:27], v[128:131], v[108:111], a[24:27]
 ds_read_b64 v[66:67], v17 offset:0
 ds_read_b64 v[68:69], v16 offset:2048
 v_mfma_f32_16x16x32_bf16 a[28:31], v[128:131], v[112:115], a[28:31]
 ds_read_b64 v[70:71], v17 offset:2048
 v_mfma_f32_16x16x32_bf16 a[32:35], v[132:135], v[108:111], a[32:35]
 ds_read_b64_tr_b16 v[72:73], v32 offset:0
 ds_read_b64_tr_b16 v[74:75], v32 offset:4608
 v_mfma_f32_16x16x32_bf16 a[36:39], v[132:135], v[112:115], a[36:39]
 ds_read_b64_tr_b16 v[76:77], v32 offset:32
 ds_read_b64_tr_b16 v[78:79], v32 offset:4640
 v_mfma_f32_16x16x32_bf16 a[40:43], v[136:139], v[108:111], a[40:43]
 ds_read_b64_tr_b16 v[80:81], v32 offset:64
 v_mfma_f32_16x16x32_bf16 a[44:47], v[136:139], v[112:115], a[44:47]
 ds_read_b64_tr_b16 v[82:83], v32 offset:4672
 ds_read_b64_tr_b16 v[84:85], v32 offset:96
 v_mfma_f32_16x16x32_bf16 a[48:51], v[140:143], v[108:111], a[48:51]
 ds_read_b64_tr_b16 v[86:87], v32 offset:4704
 ds_read_b64_tr_b16 v[88:89], v32 offset:128
 v_mfma_f32_16x16x32_bf16 a[52:55], v[140:143], v[112:115], a[52:55]
 ds_read_b64_tr_b16 v[90:91], v32 offset:4736
 ds_read_b64_tr_b16 v[92:93], v32 offset:160
 v_mfma_f32_16x16x32_bf16 a[56:59], v[144:147], v[108:111], a[56:59]
 ds_read_b64_tr_b16 v[94:95], v32 offset:4768
 v_mfma_f32_16x16x32_bf16 a[60:63], v[144:147], v[112:115], a[60:63]
 ds_read_b64_tr_b16 v[96:97], v32 offset:192
 ds_read_b64_tr_b16 v[98:99], v32 offset:4800
 v_mfma_f32_16x16x32_bf16 a[64:67], v[148:151], v[108:111], a[64:67]
 ds_read_b64_tr_b16 v[100:101], v32 offset:224
 ds_read_b64_tr_b16 v[102:103], v32 offset:4832
 v_mfma_f32_16x16x32_bf16 a[68:71], v[148:151], v[112:115], a[68:71]
 ds_read_b64_tr_b16 v[104:105], v32 offset:256
 ds_read_b64_tr_b16 v[106:107], v32 offset:4864
 s_waitcnt lgkmcnt(0)
 v_mfma_f32_16x16x32_bf16 a[0:3], v[72:75], v[64:67], a[0:3]
 ds_read_b64 v[108:109], v18 offset:0
 v_mfma_f32_16x16x32_bf16 a[4:7], v[72:75], v[68:71], a[4:7]
 ds_read_b64 v[110:111], v19 offset:0
 v_mfma_f32_16x16x32_bf16 a[8:11], v[76:79], v[64:67], a[8:11]
 ds_read_b64 v[112:113], v18 offset:2048
 v_mfma_f32_16x16x32_bf16 a[12:15], v[76:79], v[68:71], a[12:15]
 ds_read_b64 v[114:115], v19 offset:2048
 v_mfma_f32_16x16x32_bf16 a[16:19], v[80:83], v[64:67], a[16:19]
 ds_read_b64_tr_b16 v[116:117], v32 offset:9216
 ds_read_b64_tr_b16 v[118:119], v32 offset:13824
 v_mfma_f32_16x16x32_bf16 a[20:23], v[80:83], v[68:71], a[20:23]
 ds_read_b64_tr_b16 v[120:121], v32 offset:9248
 v_mfma_f32_16x16x32_bf16 a[24:27], v[84:87], v[64:67], a[24:27]
 ds_read_b64_tr_b16 v[122:123], v32 offset:13856
 v_mfma_f32_16x16x32_bf16 a[28:31], v[84:87], v[68:71], a[28:31]
 ds_read_b64_tr_b16 v[124:125], v32 offset:9280
 v_mfma_f32_16x16x32_bf16 a[32:35], v[88:91], v[64:67], a[32:35]
 ds_read_b64_tr_b16 v[126:127], v32 offset:13888
 ds_read_b64_tr_b16 v[128:129], v32 offset:9312
 v_mfma_f32_16x16x32_bf16 a[36:39], v[88:91], v[68:71], a[36:39]
 ds_read_b64_tr_b16 v[130:131], v32 offset:13920
 v_mfma_f32_16x16x32_bf16 a[40:43], v[92:95], v[64:67], a[40:43]
 ds_read_b64_tr_b16 v[132:133], v32 offset:9344
 v_mfma_f32_16x16x32_bf16 a[44:47], v[92:95], v[68:71], a[44:47]
 ds_read_b64_tr_b16 v[134:135], v32 offset:13952
 v_mfma_f32_16x16x32_bf16 a[48:51], v[96:99], v[64:67], a[48:51]
 ds_read_b64_tr_b16 v[136:137], v32 offset:9376
 v_mfma_f32_16x16x32_bf16 a[52:55], v[96:99], v[68:71], a[52:55]
 ds_read_b64_tr_b16 v[138:139], v32 offset:13984
 ds_read_b64_tr_b16 v[140:141], v32 offset:9408
 v_mfma_f32_16x16x32_bf16 a[56:59], v[100:103], v[64:67], a[56:59]
 ds_read_b64_tr_b16 v[142:143], v32 offset:14016
 v_mfma_f32_16x16x32_bf16 a[60:63], v[100:103], v[68:71], a[60:63]
 ds_read_b64_tr_b16 v[144:145], v32 offset:9440
 v_mfma_f32_16x16x32_bf16 a[64:67], v[104:107], v[64:67], a[64:67]
 ds_read_b64_tr_b16 v[146:147], v32 offset:14048
 v_mfma_f32_16x16x32_bf16 a[68:71], v[104:107], v[68:71], a[68:71]
 ds_read_b64_tr_b16 v[148:149], v32 offset:9472
 ds_read_b64_tr_b16 v[150:151], v32 offset:14080
 s_waitcnt lgkmcnt(0)
 s_waitcnt vmcnt(9)
 s_barrier
 v_mfma_f32_16x16x32_bf16 a[0:3], v[116:119], v[108:111], a[0:3]
 s_add_u32 s63, s53, 768
 s_add_u32 m0, s62, 0
 s_nop 0
 buffer_load_dwordx4 v8, s[12:15], s63 offen lds
 v_mfma_f32_16x16x32_bf16 a[4:7], v[116:119], v[112:115], a[4:7]
 s_add_u32 s63, s53, 66304
 s_add_u32 m0, s62, 1024
 s_nop 0
 buffer_load_dwordx4 v9, s[12:15], s63 offen lds
 s_add_u32 s63, s53, 131840
 s_add_u32 m0, s62, 2048
 s_nop 0
 buffer_load_dwordx4 v8, s[12:15], s63 offen lds
 v_mfma_f32_16x16x32_bf16 a[8:11], v[120:123], v[108:111], a[8:11]
 s_add_u32 s63, s53, 197376
 s_add_u32 m0, s62, 3072
 s_nop 0
 buffer_load_dwordx4 v9, s[12:15], s63 offen lds
 s_add_u32 s63, s60, 442368
 s_lshl_b32 m0, s54, 10
 s_add_u32 m0, m0, 16384
 s_nop 0
 buffer_load_dwordx4 v10, s[28:31], s63 offen lds
 v_mfma_f32_16x16x32_bf16 a[12:15], v[120:123], v[112:115], a[12:15]
 s_add_u32 s63, s60, 442368
 s_lshl_b32 m0, s54, 10
 s_add_u32 m0, m0, 20480
 s_nop 0
 buffer_load_dwordx4 v11, s[28:31], s63 offen lds
 v_mfma_f32_16x16x32_bf16 a[16:19], v[124:127], v[108:111], a[16:19]
 s_add_u32 s63, s60, 442368
 s_lshl_b32 m0, s54, 10
 s_add_u32 m0, m0, 24576
 s_nop 0
 buffer_load_dwordx4 v12, s[28:31], s63 offen lds
 s_add_u32 s63, s60, 442368
 s_lshl_b32 m0, s54, 10
 s_add_u32 m0, m0, 28672
 s_nop 0
 buffer_load_dwordx4 v13, s[28:31], s63 offen lds
 v_mfma_f32_16x16x32_bf16 a[20:23], v[124:127], v[112:115], a[20:23]
 s_add_u32 s63, s60, 442368
 s_and_b32 m0, s54, 1
 s_lshl_b32 m0, m0, 10
 s_add_u32 m0, m0, 32768
 s_nop 0
 buffer_load_dwordx4 v14, s[28:31], s63 offen lds
 ds_read_b64 v[64:65], v20 offset:0
 v_mfma_f32_16x16x32_bf16 a[24:27], v[128:131], v[108:111], a[24:27]
 ds_read_b64 v[66:67], v21 offset:0
 ds_read_b64 v[68:69], v20 offset:2048
 v_mfma_f32_16x16x32_bf16 a[28:31], v[128:131], v[112:115], a[28:31]
 ds_read_b64 v[70:71], v21 offset:2048
 v_mfma_f32_16x16x32_bf16 a[32:35], v[132:135], v[108:111], a[32:35]
 ds_read_b64_tr_b16 v[72:73], v33 offset:0
 ds_read_b64_tr_b16 v[74:75], v33 offset:4608
 v_mfma_f32_16x16x32_bf16 a[36:39], v[132:135], v[112:115], a[36:39]
 ds_read_b64_tr_b16 v[76:77], v33 offset:32
 ds_read_b64_tr_b16 v[78:79], v33 offset:4640
 v_mfma_f32_16x16x32_bf16 a[40:43], v[136:139], v[108:111], a[40:43]
 ds_read_b64_tr_b16 v[80:81], v33 offset:64
 v_mfma_f32_16x16x32_bf16 a[44:47], v[136:139], v[112:115], a[44:47]
 ds_read_b64_tr_b16 v[82:83], v33 offset:4672
 ds_read_b64_tr_b16 v[84:85], v33 offset:96
 v_mfma_f32_16x16x32_bf16 a[48:51], v[140:143], v[108:111], a[48:51]
 ds_read_b64_tr_b16 v[86:87], v33 offset:4704
 ds_read_b64_tr_b16 v[88:89], v33 offset:128
 v_mfma_f32_16x16x32_bf16 a[52:55], v[140:143], v[112:115], a[52:55]
 ds_read_b64_tr_b16 v[90:91], v33 offset:4736
 ds_read_b64_tr_b16 v[92:93], v33 offset:160
 v_mfma_f32_16x16x32_bf16 a[56:59], v[144:147], v[108:111], a[56:59]
 ds_read_b64_tr_b16 v[94:95], v33 offset:4768
 v_mfma_f32_16x16x32_bf16 a[60:63], v[144:147], v[112:115], a[60:63]
 ds_read_b64_tr_b16 v[96:97], v33 offset:192
 ds_read_b64_tr_b16 v[98:99], v33 offset:4800
 v_mfma_f32_16x16x32_bf16 a[64:67], v[148:151], v[108:111], a[64:67]
 ds_read_b64_tr_b16 v[100:101], v33 offset:224
 ds_read_b64_tr_b16 v[102:103], v33 offset:4832
 v_mfma_f32_16x16x32_bf16 a[68:71], v[148:151], v[112:115], a[68:71]
 ds_read_b64_tr_b16 v[104:105], v33 offset:256
 ds_read_b64_tr_b16 v[106:107], v33 offset:4864
 s_waitcnt lgkmcnt(0)
 v_mfma_f32_16x16x32_bf16 a[0:3], v[72:75], v[64:67], a[0:3]
 ds_read_b64 v[108:109], v22 offset:0
 v_mfma_f32_16x16x32_bf16 a[4:7], v[72:75], v[68:71], a[4:7]
 ds_read_b64 v[110:111], v23 offset:0
 v_mfma_f32_16x16x32_bf16 a[8:11], v[76:79], v[64:67], a[8:11]
 ds_read_b64 v[112:113], v22 offset:2048
 v_mfma_f32_16x16x32_bf16 a[12:15], v[76:79], v[68:71], a[12:15]
 ds_read_b64 v[114:115], v23 offset:2048
 v_mfma_f32_16x16x32_bf16 a[16:19], v[80:83], v[64:67], a[16:19]
 ds_read_b64_tr_b16 v[116:117], v33 offset:9216
 ds_read_b64_tr_b16 v[118:119], v33 offset:13824
 v_mfma_f32_16x16x32_bf16 a[20:23], v[80:83], v[68:71], a[20:23]
 ds_read_b64_tr_b16 v[120:121], v33 offset:9248
 v_mfma_f32_16x16x32_bf16 a[24:27], v[84:87], v[64:67], a[24:27]
 ds_read_b64_tr_b16 v[122:123], v33 offset:13856
 v_mfma_f32_16x16x32_bf16 a[28:31], v[84:87], v[68:71], a[28:31]
 ds_read_b64_tr_b16 v[124:125], v33 offset:9280
 v_mfma_f32_16x16x32_bf16 a[32:35], v[88:91], v[64:67], a[32:35]
 ds_read_b64_tr_b16 v[126:127], v33 offset:13888
 ds_read_b64_tr_b16 v[128:129], v33 offset:9312
 v_mfma_f32_16x16x32_bf16 a[36:39], v[88:91], v[68:71], a[36:39]
 ds_read_b64_tr_b16 v[130:131], v33 offset:13920
 v_mfma_f32_16x16x32_bf16 a[40:43], v[92:95], v[64:67], a[40:43]
 ds_read_b64_tr_b16 v[132:133], v33 offset:9344
 v_mfma_f32_16x16x32_bf16 a[44:47], v[92:95], v[68:71], a[44:47]
 ds_read_b64_tr_b16 v[134:135], v33 offset:13952
 v_mfma_f32_16x16x32_bf16 a[48:51], v[96:99], v[64:67], a[48:51]
 ds_read_b64_tr_b16 v[136:137], v33 offset:9376
 v_mfma_f32_16x16x32_bf16 a[52:55], v[96:99], v[68:71], a[52:55]
 ds_read_b64_tr_b16 v[138:139], v33 offset:13984
 ds_read_b64_tr_b16 v[140:141], v33 offset:9408
 v_mfma_f32_16x16x32_bf16 a[56:59], v[100:103], v[64:67], a[56:59]
 ds_read_b64_tr_b16 v[142:143], v33 offset:14016
 v_mfma_f32_16x16x32_bf16 a[60:63], v[100:103], v[68:71], a[60:63]
 ds_read_b64_tr_b16 v[144:145], v33 offset:9440
 v_mfma_f32_16x16x32_bf16 a[64:67], v[104:107], v[64:67], a[64:67]
 ds_read_b64_tr_b16 v[146:147], v33 offset:14048
 v_mfma_f32_16x16x32_bf16 a[68:71], v[104:107], v[68:71], a[68:71]
 ds_read_b64_tr_b16 v[148:149], v33 offset:9472
 ds_read_b64_tr_b16 v[150:151], v33 offset:14080
 s_waitcnt lgkmcnt(0)
 s_waitcnt vmcnt(9)
 s_barrier
 v_mfma_f32_16x16x32_bf16 a[0:3], v[116:119], v[108:111], a[0:3]
 s_add_u32 s63, s53, 896
 s_add_u32 m0, s62, 34816
 s_nop 0
 buffer_load_dwordx4 v8, s[12:15], s63 offen lds
 v_mfma_f32_16x16x32_bf16 a[4:7], v[116:119], v[112:115], a[4:7]
 s_add_u32 s63, s53, 66432
 s_add_u32 m0, s62, 35840
 s_nop 0
 buffer_load_dwordx4 v9, s[12:15], s63 offen lds
 s_add_u32 s63, s53, 131968
 s_add_u32 m0, s62, 36864
 s_nop 0
 buffer_load_dwordx4 v8, s[12:15], s63 offen lds
 v_mfma_f32_16x16x32_bf16 a[8:11], v[120:123], v[108:111], a[8:11]
 s_add_u32 s63, s53, 197504
 s_add_u32 m0, s62, 37888
 s_nop 0
 buffer_load_dwordx4 v9, s[12:15], s63 offen lds
 s_add_u32 s63, s60, 516096
 s_lshl_b32 m0, s54, 10
 s_add_u32 m0, m0, 51200
 s_nop 0
 buffer_load_dwordx4 v10, s[28:31], s63 offen lds
 v_mfma_f32_16x16x32_bf16 a[12:15], v[120:123], v[112:115], a[12:15]
 s_add_u32 s63, s60, 516096
 s_lshl_b32 m0, s54, 10
 s_add_u32 m0, m0, 55296
 s_nop 0
 buffer_load_dwordx4 v11, s[28:31], s63 offen lds
 v_mfma_f32_16x16x32_bf16 a[16:19], v[124:127], v[108:111], a[16:19]
 s_add_u32 s63, s60, 516096
 s_lshl_b32 m0, s54, 10
 s_add_u32 m0, m0, 59392
 s_nop 0
 buffer_load_dwordx4 v12, s[28:31], s63 offen lds
 s_add_u32 s63, s60, 516096
 s_lshl_b32 m0, s54, 10
 s_add_u32 m0, m0, 63488
 s_nop 0
 buffer_load_dwordx4 v13, s[28:31], s63 offen lds
 v_mfma_f32_16x16x32_bf16 a[20:23], v[124:127], v[112:115], a[20:23]
 s_add_u32 s63, s60, 516096
 s_and_b32 m0, s54, 1
 s_lshl_b32 m0, m0, 10
 s_add_u32 m0, m0, 67584
 s_nop 0
 buffer_load_dwordx4 v14, s[28:31], s63 offen lds
 ds_read_b64 v[64:65], v24 offset:0
 v_mfma_f32_16x16x32_bf16 a[24:27], v[128:131], v[108:111], a[24:27]
 ds_read_b64 v[66:67], v25 offset:0
 ds_read_b64 v[68:69], v24 offset:2048
 v_mfma_f32_16x16x32_bf16 a[28:31], v[128:131], v[112:115], a[28:31]
 ds_read_b64 v[70:71], v25 offset:2048
 v_mfma_f32_16x16x32_bf16 a[32:35], v[132:135], v[108:111], a[32:35]
 ds_read_b64_tr_b16 v[72:73], v34 offset:0
 ds_read_b64_tr_b16 v[74:75], v34 offset:4608
 v_mfma_f32_16x16x32_bf16 a[36:39], v[132:135], v[112:115], a[36:39]
 ds_read_b64_tr_b16 v[76:77], v34 offset:32
 ds_read_b64_tr_b16 v[78:79], v34 offset:4640
 v_mfma_f32_16x16x32_bf16 a[40:43], v[136:139], v[108:111], a[40:43]
 ds_read_b64_tr_b16 v[80:81], v34 offset:64
 v_mfma_f32_16x16x32_bf16 a[44:47], v[136:139], v[112:115], a[44:47]
 ds_read_b64_tr_b16 v[82:83], v34 offset:4672
 ds_read_b64_tr_b16 v[84:85], v34 offset:96
 v_mfma_f32_16x16x32_bf16 a[48:51], v[140:143], v[108:111], a[48:51]
 ds_read_b64_tr_b16 v[86:87], v34 offset:4704
 ds_read_b64_tr_b16 v[88:89], v34 offset:128
 v_mfma_f32_16x16x32_bf16 a[52:55], v[140:143], v[112:115], a[52:55]
 ds_read_b64_tr_b16 v[90:91], v34 offset:4736
 ds_read_b64_tr_b16 v[92:93], v34 offset:160
 v_mfma_f32_16x16x32_bf16 a[56:59], v[144:147], v[108:111], a[56:59]
 ds_read_b64_tr_b16 v[94:95], v34 offset:4768
 v_mfma_f32_16x16x32_bf16 a[60:63], v[144:147], v[112:115], a[60:63]
 ds_read_b64_tr_b16 v[96:97], v34 offset:192
 ds_read_b64_tr_b16 v[98:99], v34 offset:4800
 v_mfma_f32_16x16x32_bf16 a[64:67], v[148:151], v[108:111], a[64:67]
 ds_read_b64_tr_b16 v[100:101], v34 offset:224
 ds_read_b64_tr_b16 v[102:103], v34 offset:4832
 v_mfma_f32_16x16x32_bf16 a[68:71], v[148:151], v[112:115], a[68:71]
 ds_read_b64_tr_b16 v[104:105], v34 offset:256
 ds_read_b64_tr_b16 v[106:107], v34 offset:4864
 s_waitcnt lgkmcnt(0)
 v_mfma_f32_16x16x32_bf16 a[0:3], v[72:75], v[64:67], a[0:3]
 ds_read_b64 v[108:109], v26 offset:0
 v_mfma_f32_16x16x32_bf16 a[4:7], v[72:75], v[68:71], a[4:7]
 ds_read_b64 v[110:111], v27 offset:0
 v_mfma_f32_16x16x32_bf16 a[8:11], v[76:79], v[64:67], a[8:11]
 ds_read_b64 v[112:113], v26 offset:2048
 v_mfma_f32_16x16x32_bf16 a[12:15], v[76:79], v[68:71], a[12:15]
 ds_read_b64 v[114:115], v27 offset:2048
 v_mfma_f32_16x16x32_bf16 a[16:19], v[80:83], v[64:67], a[16:19]
 ds_read_b64_tr_b16 v[116:117], v34 offset:9216
 ds_read_b64_tr_b16 v[118:119], v34 offset:13824
 v_mfma_f32_16x16x32_bf16 a[20:23], v[80:83], v[68:71], a[20:23]
 ds_read_b64_tr_b16 v[120:121], v34 offset:9248
 v_mfma_f32_16x16x32_bf16 a[24:27], v[84:87], v[64:67], a[24:27]
 ds_read_b64_tr_b16 v[122:123], v34 offset:13856
 v_mfma_f32_16x16x32_bf16 a[28:31], v[84:87], v[68:71], a[28:31]
 ds_read_b64_tr_b16 v[124:125], v34 offset:9280
 v_mfma_f32_16x16x32_bf16 a[32:35], v[88:91], v[64:67], a[32:35]
 ds_read_b64_tr_b16 v[126:127], v34 offset:13888
 ds_read_b64_tr_b16 v[128:129], v34 offset:9312
 v_mfma_f32_16x16x32_bf16 a[36:39], v[88:91], v[68:71], a[36:39]
 ds_read_b64_tr_b16 v[130:131], v34 offset:13920
 v_mfma_f32_16x16x32_bf16 a[40:43], v[92:95], v[64:67], a[40:43]
 ds_read_b64_tr_b16 v[132:133], v34 offset:9344
 v_mfma_f32_16x16x32_bf16 a[44:47], v[92:95], v[68:71], a[44:47]
 ds_read_b64_tr_b16 v[134:135], v34 offset:13952
 v_mfma_f32_16x16x32_bf16 a[48:51], v[96:99], v[64:67], a[48:51]
 ds_read_b64_tr_b16 v[136:137], v34 offset:9376
 v_mfma_f32_16x16x32_bf16 a[52:55], v[96:99], v[68:71], a[52:55]
 ds_read_b64_tr_b16 v[138:139], v34 offset:13984
 ds_read_b64_tr_b16 v[140:141], v34 offset:9408
 v_mfma_f32_16x16x32_bf16 a[56:59], v[100:103], v[64:67], a[56:59]
 ds_read_b64_tr_b16 v[142:143], v34 offset:14016
 v_mfma_f32_16x16x32_bf16 a[60:63], v[100:103], v[68:71], a[60:63]
 ds_read_b64_tr_b16 v[144:145], v34 offset:9440
 v_mfma_f32_16x16x32_bf16 a[64:67], v[104:107], v[64:67], a[64:67]
 ds_read_b64_tr_b16 v[146:147], v34 offset:14048
 v_mfma_f32_16x16x32_bf16 a[68:71], v[104:107], v[68:71], a[68:71]
 ds_read_b64_tr_b16 v[148:149], v34 offset:9472
 ds_read_b64_tr_b16 v[150:151], v34 offset:14080
 s_waitcnt lgkmcnt(0)
 s_waitcnt vmcnt(9)
 s_barrier
 v_mfma_f32_16x16x32_bf16 a[0:3], v[116:119], v[108:111], a[0:3]
 ds_read_b64 v[64:65], v16 offset:0
 v_mfma_f32_16x16x32_bf16 a[4:7], v[116:119], v[112:115], a[4:7]
 ds_read_b64 v[66:67], v17 offset:0
 v_mfma_f32_16x16x32_bf16 a[8:11], v[120:123], v[108:111], a[8:11]
 ds_read_b64 v[68:69], v16 offset:2048
 v_mfma_f32_16x16x32_bf16 a[12:15], v[120:123], v[112:115], a[12:15]
 ds_read_b64 v[70:71], v17 offset:2048
 v_mfma_f32_16x16x32_bf16 a[16:19], v[124:127], v[108:111], a[16:19]
 ds_read_b64_tr_b16 v[72:73], v32 offset:0
 ds_read_b64_tr_b16 v[74:75], v32 offset:4608
 v_mfma_f32_16x16x32_bf16 a[20:23], v[124:127], v[112:115], a[20:23]
 ds_read_b64_tr_b16 v[76:77], v32 offset:32
 v_mfma_f32_16x16x32_bf16 a[24:27], v[128:131], v[108:111], a[24:27]
 ds_read_b64_tr_b16 v[78:79], v32 offset:4640
 v_mfma_f32_16x16x32_bf16 a[28:31], v[128:131], v[112:115], a[28:31]
 ds_read_b64_tr_b16 v[80:81], v32 offset:64
 v_mfma_f32_16x16x32_bf16 a[32:35], v[132:135], v[108:111], a[32:35]
 ds_read_b64_tr_b16 v[82:83], v32 offset:4672
 ds_read_b64_tr_b16 v[84:85], v32 offset:96
 v_mfma_f32_16x16x32_bf16 a[36:39], v[132:135], v[112:115], a[36:39]
 ds_read_b64_tr_b16 v[86:87], v32 offset:4704
 v_mfma_f32_16x16x32_bf16 a[40:43], v[136:139], v[108:111], a[40:43]
 ds_read_b64_tr_b16 v[88:89], v32 offset:128
 v_mfma_f32_16x16x32_bf16 a[44:47], v[136:139], v[112:115], a[44:47]
 ds_read_b64_tr_b16 v[90:91], v32 offset:4736
 v_mfma_f32_16x16x32_bf16 a[48:51], v[140:143], v[108:111], a[48:51]
 ds_read_b64_tr_b16 v[92:93], v32 offset:160
 v_mfma_f32_16x16x32_bf16 a[52:55], v[140:143], v[112:115], a[52:55]
 ds_read_b64_tr_b16 v[94:95], v32 offset:4768
 ds_read_b64_tr_b16 v[96:97], v32 offset:192
 v_mfma_f32_16x16x32_bf16 a[56:59], v[144:147], v[108:111], a[56:59]
 ds_read_b64_tr_b16 v[98:99], v32 offset:4800
 v_mfma_f32_16x16x32_bf16 a[60:63], v[144:147], v[112:115], a[60:63]
 ds_read_b64_tr_b16 v[100:101], v32 offset:224
 v_mfma_f32_16x16x32_bf16 a[64:67], v[148:151], v[108:111], a[64:67]
 ds_read_b64_tr_b16 v[102:103], v32 offset:4832
 v_mfma_f32_16x16x32_bf16 a[68:71], v[148:151], v[112:115], a[68:71]
 ds_read_b64_tr_b16 v[104:105], v32 offset:256
 ds_read_b64_tr_b16 v[106:107], v32 offset:4864
 s_waitcnt lgkmcnt(0)
 v_mfma_f32_16x16x32_bf16 a[0:3], v[72:75], v[64:67], a[0:3]
 ds_read_b64 v[108:109], v18 offset:0
 v_mfma_f32_16x16x32_bf16 a[4:7], v[72:75], v[68:71], a[4:7]
 ds_read_b64 v[110:111], v19 offset:0
 v_mfma_f32_16x16x32_bf16 a[8:11], v[76:79], v[64:67], a[8:11]
 ds_read_b64 v[112:113], v18 offset:2048
 v_mfma_f32_16x16x32_bf16 a[12:15], v[76:79], v[68:71], a[12:15]
 ds_read_b64 v[114:115], v19 offset:2048
 v_mfma_f32_16x16x32_bf16 a[16:19], v[80:83], v[64:67], a[16:19]
 ds_read_b64_tr_b16 v[116:117], v32 offset:9216
 ds_read_b64_tr_b16 v[118:119], v32 offset:13824
 v_mfma_f32_16x16x32_bf16 a[20:23], v[80:83], v[68:71], a[20:23]
 ds_read_b64_tr_b16 v[120:121], v32 offset:9248
 v_mfma_f32_16x16x32_bf16 a[24:27], v[84:87], v[64:67], a[24:27]
 ds_read_b64_tr_b16 v[122:123], v32 offset:13856
 v_mfma_f32_16x16x32_bf16 a[28:31], v[84:87], v[68:71], a[28:31]
 ds_read_b64_tr_b16 v[124:125], v32 offset:9280
 v_mfma_f32_16x16x32_bf16 a[32:35], v[88:91], v[64:67], a[32:35]
 ds_read_b64_tr_b16 v[126:127], v32 offset:13888
 ds_read_b64_tr_b16 v[128:129], v32 offset:9312
 v_mfma_f32_16x16x32_bf16 a[36:39], v[88:91], v[68:71], a[36:39]
 ds_read_b64_tr_b16 v[130:131], v32 offset:13920
 v_mfma_f32_16x16x32_bf16 a[40:43], v[92:95], v[64:67], a[40:43]
 ds_read_b64_tr_b16 v[132:133], v32 offset:9344
 v_mfma_f32_16x16x32_bf16 a[44:47], v[92:95], v[68:71], a[44:47]
 ds_read_b64_tr_b16 v[134:135], v32 offset:13952
 v_mfma_f32_16x16x32_bf16 a[48:51], v[96:99], v[64:67], a[48:51]
 ds_read_b64_tr_b16 v[136:137], v32 offset:9376
 v_mfma_f32_16x16x32_bf16 a[52:55], v[96:99], v[68:71], a[52:55]
 ds_read_b64_tr_b16 v[138:139], v32 offset:13984
 ds_read_b64_tr_b16 v[140:141], v32 offset:9408
 v_mfma_f32_16x16x32_bf16 a[56:59], v[100:103], v[64:67], a[56:59]
 ds_read_b64_tr_b16 v[142:143], v32 offset:14016
 v_mfma_f32_16x16x32_bf16 a[60:63], v[100:103], v[68:71], a[60:63]
 ds_read_b64_tr_b16 v[144:145], v32 offset:9440
 v_mfma_f32_16x16x32_bf16 a[64:67], v[104:107], v[64:67], a[64:67]
 ds_read_b64_tr_b16 v[146:147], v32 offset:14048
 v_mfma_f32_16x16x32_bf16 a[68:71], v[104:107], v[68:71], a[68:71]
 ds_read_b64_tr_b16 v[148:149], v32 offset:9472
 ds_read_b64_tr_b16 v[150:151], v32 offset:14080
 s_waitcnt lgkmcnt(0)
 s_waitcnt vmcnt(0)
 s_barrier
 v_mfma_f32_16x16x32_bf16 a[0:3], v[116:119], v[108:111], a[0:3]
 ds_read_b64 v[64:65], v20 offset:0
 v_mfma_f32_16x16x32_bf16 a[4:7], v[116:119], v[112:115], a[4:7]
 ds_read_b64 v[66:67], v21 offset:0
 v_mfma_f32_16x16x32_bf16 a[8:11], v[120:123], v[108:111], a[8:11]
 ds_read_b64 v[68:69], v20 offset:2048
 v_mfma_f32_16x16x32_bf16 a[12:15], v[120:123], v[112:115], a[12:15]
 ds_read_b64 v[70:71], v21 offset:2048
 v_mfma_f32_16x16x32_bf16 a[16:19], v[124:127], v[108:111], a[16:19]
 ds_read_b64_tr_b16 v[72:73], v33 offset:0
 ds_read_b64_tr_b16 v[74:75], v33 offset:4608
 v_mfma_f32_16x16x32_bf16 a[20:23], v[124:127], v[112:115], a[20:23]
 ds_read_b64_tr_b16 v[76:77], v33 offset:32
 v_mfma_f32_16x16x32_bf16 a[24:27], v[128:131], v[108:111], a[24:27]
 ds_read_b64_tr_b16 v[78:79], v33 offset:4640
 v_mfma_f32_16x16x32_bf16 a[28:31], v[128:131], v[112:115], a[28:31]
 ds_read_b64_tr_b16 v[80:81], v33 offset:64
 v_mfma_f32_16x16x32_bf16 a[32:35], v[132:135], v[108:111], a[32:35]
 ds_read_b64_tr_b16 v[82:83], v33 offset:4672
 ds_read_b64_tr_b16 v[84:85], v33 offset:96
 v_mfma_f32_16x16x32_bf16 a[36:39], v[132:135], v[112:115], a[36:39]
 ds_read_b64_tr_b16 v[86:87], v33 offset:4704
 v_mfma_f32_16x16x32_bf16 a[40:43], v[136:139], v[108:111], a[40:43]
 ds_read_b64_tr_b16 v[88:89], v33 offset:128
 v_mfma_f32_16x16x32_bf16 a[44:47], v[136:139], v[112:115], a[44:47]
 ds_read_b64_tr_b16 v[90:91], v33 offset:4736
 v_mfma_f32_16x16x32_bf16 a[48:51], v[140:143], v[108:111], a[48:51]
 ds_read_b64_tr_b16 v[92:93], v33 offset:160
 v_mfma_f32_16x16x32_bf16 a[52:55], v[140:143], v[112:115], a[52:55]
 ds_read_b64_tr_b16 v[94:95], v33 offset:4768
 ds_read_b64_tr_b16 v[96:97], v33 offset:192
 v_mfma_f32_16x16x32_bf16 a[56:59], v[144:147], v[108:111], a[56:59]
 ds_read_b64_tr_b16 v[98:99], v33 offset:4800
 v_mfma_f32_16x16x32_bf16 a[60:63], v[144:147], v[112:115], a[60:63]
 ds_read_b64_tr_b16 v[100:101], v33 offset:224
 v_mfma_f32_16x16x32_bf16 a[64:67], v[148:151], v[108:111], a[64:67]
 ds_read_b64_tr_b16 v[102:103], v33 offset:4832
 v_mfma_f32_16x16x32_bf16 a[68:71], v[148:151], v[112:115], a[68:71]
 ds_read_b64_tr_b16 v[104:105], v33 offset:256
 ds_read_b64_tr_b16 v[106:107], v33 offset:4864
 s_waitcnt lgkmcnt(0)
 v_mfma_f32_16x16x32_bf16 a[0:3], v[72:75], v[64:67], a[0:3]
 ds_read_b64 v[108:109], v22 offset:0
 v_mfma_f32_16x16x32_bf16 a[4:7], v[72:75], v[68:71], a[4:7]
 ds_read_b64 v[110:111], v23 offset:0
 v_mfma_f32_16x16x32_bf16 a[8:11], v[76:79], v[64:67], a[8:11]
 ds_read_b64 v[112:113], v22 offset:2048
 v_mfma_f32_16x16x32_bf16 a[12:15], v[76:79], v[68:71], a[12:15]
 ds_read_b64 v[114:115], v23 offset:2048
 v_mfma_f32_16x16x32_bf16 a[16:19], v[80:83], v[64:67], a[16:19]
 ds_read_b64_tr_b16 v[116:117], v33 offset:9216
 ds_read_b64_tr_b16 v[118:119], v33 offset:13824
 v_mfma_f32_16x16x32_bf16 a[20:23], v[80:83], v[68:71], a[20:23]
 ds_read_b64_tr_b16 v[120:121], v33 offset:9248
 v_mfma_f32_16x16x32_bf16 a[24:27], v[84:87], v[64:67], a[24:27]
 ds_read_b64_tr_b16 v[122:123], v33 offset:13856
 v_mfma_f32_16x16x32_bf16 a[28:31], v[84:87], v[68:71], a[28:31]
 ds_read_b64_tr_b16 v[124:125], v33 offset:9280
 v_mfma_f32_16x16x32_bf16 a[32:35], v[88:91], v[64:67], a[32:35]
 ds_read_b64_tr_b16 v[126:127], v33 offset:13888
 ds_read_b64_tr_b16 v[128:129], v33 offset:9312
 v_mfma_f32_16x16x32_bf16 a[36:39], v[88:91], v[68:71], a[36:39]
 ds_read_b64_tr_b16 v[130:131], v33 offset:13920
 v_mfma_f32_16x16x32_bf16 a[40:43], v[92:95], v[64:67], a[40:43]
 ds_read_b64_tr_b16 v[132:133], v33 offset:9344
 v_mfma_f32_16x16x32_bf16 a[44:47], v[92:95], v[68:71], a[44:47]
 ds_read_b64_tr_b16 v[134:135], v33 offset:13952
 v_mfma_f32_16x16x32_bf16 a[48:51], v[96:99], v[64:67], a[48:51]
 ds_read_b64_tr_b16 v[136:137], v33 offset:9376
 v_mfma_f32_16x16x32_bf16 a[52:55], v[96:99], v[68:71], a[52:55]
 ds_read_b64_tr_b16 v[138:139], v33 offset:13984
 ds_read_b64_tr_b16 v[140:141], v33 offset:9408
 v_mfma_f32_16x16x32_bf16 a[56:59], v[100:103], v[64:67], a[56:59]
 ds_read_b64_tr_b16 v[142:143], v33 offset:14016
 v_mfma_f32_16x16x32_bf16 a[60:63], v[100:103], v[68:71], a[60:63]
 ds_read_b64_tr_b16 v[144:145], v33 offset:9440
 v_mfma_f32_16x16x32_bf16 a[64:67], v[104:107], v[64:67], a[64:67]
 ds_read_b64_tr_b16 v[146:147], v33 offset:14048
 v_mfma_f32_16x16x32_bf16 a[68:71], v[104:107], v[68:71], a[68:71]
 ds_read_b64_tr_b16 v[148:149], v33 offset:9472
 ds_read_b64_tr_b16 v[150:151], v33 offset:14080
 s_waitcnt lgkmcnt(0)
 v_mfma_f32_16x16x32_bf16 a[0:3], v[116:119], v[108:111], a[0:3]
 v_mfma_f32_16x16x32_bf16 a[4:7], v[116:119], v[112:115], a[4:7]
 v_mfma_f32_16x16x32_bf16 a[8:11], v[120:123], v[108:111], a[8:11]
 v_mfma_f32_16x16x32_bf16 a[12:15], v[120:123], v[112:115], a[12:15]
 v_mfma_f32_16x16x32_bf16 a[16:19], v[124:127], v[108:111], a[16:19]
 v_mfma_f32_16x16x32_bf16 a[20:23], v[124:127], v[112:115], a[20:23]
 v_mfma_f32_16x16x32_bf16 a[24:27], v[128:131], v[108:111], a[24:27]
 v_mfma_f32_16x16x32_bf16 a[28:31], v[128:131], v[112:115], a[28:31]
 v_mfma_f32_16x16x32_bf16 a[32:35], v[132:135], v[108:111], a[32:35]
 v_mfma_f32_16x16x32_bf16 a[36:39], v[132:135], v[112:115], a[36:39]
 v_mfma_f32_16x16x32_bf16 a[40:43], v[136:139], v[108:111], a[40:43]
 v_mfma_f32_16x16x32_bf16 a[44:47], v[136:139], v[112:115], a[44:47]
 v_mfma_f32_16x16x32_bf16 a[48:51], v[140:143], v[108:111], a[48:51]
 v_mfma_f32_16x16x32_bf16 a[52:55], v[140:143], v[112:115], a[52:55]
 v_mfma_f32_16x16x32_bf16 a[56:59], v[144:147], v[108:111], a[56:59]
 v_mfma_f32_16x16x32_bf16 a[60:63], v[144:147], v[112:115], a[60:63]
 v_mfma_f32_16x16x32_bf16 a[64:67], v[148:151], v[108:111], a[64:67]
 v_mfma_f32_16x16x32_bf16 a[68:71], v[148:151], v[112:115], a[68:71]
 s_nop 7
 s_nop 7
 s_lshl_b32 s58, s54, 5
 s_lshl_b32 s59, s45, 7
 s_add_u32 s58, s58, s59
 v_add_u32 v5, s58, v4
 s_movk_i32 s59, 2304
 v_mul_lo_u32 v5, v5, s59
 v_lshl_add_u32 v5, v3, 4, v5
 s_mul_i32 s58, s46, 4718592
 s_add_u32 s50, s50, s58
 s_add_u32 s58, s50, 0
 v_accvgpr_read_b32 v64, a0
 v_accvgpr_read_b32 v65, a1
 v_accvgpr_read_b32 v66, a2
 v_accvgpr_read_b32 v67, a3
 buffer_store_dwordx4 v[64:67], v5, s[24:27], s58 offen offset:0 sc1
 v_accvgpr_read_b32 v72, a8
 v_accvgpr_read_b32 v73, a9
 v_accvgpr_read_b32 v74, a10
 v_accvgpr_read_b32 v75, a11
 buffer_store_dwordx4 v[72:75], v5, s[24:27], s58 offen offset:64 sc1
 v_accvgpr_read_b32 v80, a16
 v_accvgpr_read_b32 v81, a17
 v_accvgpr_read_b32 v82, a18
 v_accvgpr_read_b32 v83, a19
 buffer_store_dwordx4 v[80:83], v5, s[24:27], s58 offen offset:128 sc1
 v_accvgpr_read_b32 v88, a24
 v_accvgpr_read_b32 v89, a25
 v_accvgpr_read_b32 v90, a26
 v_accvgpr_read_b32 v91, a27
 buffer_store_dwordx4 v[88:91], v5, s[24:27], s58 offen offset:192 sc1
 v_accvgpr_read_b32 v64, a32
 v_accvgpr_read_b32 v65, a33
 v_accvgpr_read_b32 v66, a34
 v_accvgpr_read_b32 v67, a35
 buffer_store_dwordx4 v[64:67], v5, s[24:27], s58 offen offset:256 sc1
 v_accvgpr_read_b32 v72, a40
 v_accvgpr_read_b32 v73, a41
 v_accvgpr_read_b32 v74, a42
 v_accvgpr_read_b32 v75, a43
 buffer_store_dwordx4 v[72:75], v5, s[24:27], s58 offen offset:320 sc1
 v_accvgpr_read_b32 v80, a48
 v_accvgpr_read_b32 v81, a49
 v_accvgpr_read_b32 v82, a50
 v_accvgpr_read_b32 v83, a51
 buffer_store_dwordx4 v[80:83], v5, s[24:27], s58 offen offset:384 sc1
 v_accvgpr_read_b32 v88, a56
 v_accvgpr_read_b32 v89, a57
 v_accvgpr_read_b32 v90, a58
 v_accvgpr_read_b32 v91, a59
 buffer_store_dwordx4 v[88:91], v5, s[24:27], s58 offen offset:448 sc1
 v_accvgpr_read_b32 v64, a64
 v_accvgpr_read_b32 v65, a65
 v_accvgpr_read_b32 v66, a66
 v_accvgpr_read_b32 v67, a67
 buffer_store_dwordx4 v[64:67], v5, s[24:27], s58 offen offset:512 sc1
 s_add_u32 s58, s50, 36864
 v_accvgpr_read_b32 v68, a4
 v_accvgpr_read_b32 v69, a5
 v_accvgpr_read_b32 v70, a6
 v_accvgpr_read_b32 v71, a7
 buffer_store_dwordx4 v[68:71], v5, s[24:27], s58 offen offset:0 sc1
 v_accvgpr_read_b32 v76, a12
 v_accvgpr_read_b32 v77, a13
 v_accvgpr_read_b32 v78, a14
 v_accvgpr_read_b32 v79, a15
 buffer_store_dwordx4 v[76:79], v5, s[24:27], s58 offen offset:64 sc1
 v_accvgpr_read_b32 v84, a20
 v_accvgpr_read_b32 v85, a21
 v_accvgpr_read_b32 v86, a22
 v_accvgpr_read_b32 v87, a23
 buffer_store_dwordx4 v[84:87], v5, s[24:27], s58 offen offset:128 sc1
 v_accvgpr_read_b32 v92, a28
 v_accvgpr_read_b32 v93, a29
 v_accvgpr_read_b32 v94, a30
 v_accvgpr_read_b32 v95, a31
 buffer_store_dwordx4 v[92:95], v5, s[24:27], s58 offen offset:192 sc1
 v_accvgpr_read_b32 v68, a36
 v_accvgpr_read_b32 v69, a37
 v_accvgpr_read_b32 v70, a38
 v_accvgpr_read_b32 v71, a39
 buffer_store_dwordx4 v[68:71], v5, s[24:27], s58 offen offset:256 sc1
 v_accvgpr_read_b32 v76, a44
 v_accvgpr_read_b32 v77, a45
 v_accvgpr_read_b32 v78, a46
 v_accvgpr_read_b32 v79, a47
 buffer_store_dwordx4 v[76:79], v5, s[24:27], s58 offen offset:320 sc1
 v_accvgpr_read_b32 v84, a52
 v_accvgpr_read_b32 v85, a53
 v_accvgpr_read_b32 v86, a54
 v_accvgpr_read_b32 v87, a55
 buffer_store_dwordx4 v[84:87], v5, s[24:27], s58 offen offset:384 sc1
 v_accvgpr_read_b32 v92, a60
 v_accvgpr_read_b32 v93, a61
 v_accvgpr_read_b32 v94, a62
 v_accvgpr_read_b32 v95, a63
 buffer_store_dwordx4 v[92:95], v5, s[24:27], s58 offen offset:448 sc1
 v_accvgpr_read_b32 v68, a68
 v_accvgpr_read_b32 v69, a69
 v_accvgpr_read_b32 v70, a70
 v_accvgpr_read_b32 v71, a71
 buffer_store_dwordx4 v[68:71], v5, s[24:27], s58 offen offset:512 sc1
 s_branch mega_kernel_sig91
mega_kernel_bln2118:
 s_load_dwordx2 s[4:5], s[0:1], 0
 s_load_dwordx2 s[8:9], s[0:1], 120
 s_waitcnt lgkmcnt(0)
 s_mov_b32 s12, s4
 s_and_b32 s13, s5, 0xffff
 s_mov_b32 s14, 2359296
 s_mov_b32 s15, 0x00020000
 s_add_u32 s16, s8, 0
 s_addc_u32 s17, s9, 0
 s_and_b32 s17, s17, 0xffff
 s_mov_b32 s18, 13824
 s_mov_b32 s19, 0x00020000
 s_add_u32 s20, s8, 92274688
 s_addc_u32 s21, s9, 0
 s_and_b32 s21, s21, 0xffff
 s_mov_b32 s22, 2359296
 s_mov_b32 s23, 0x00020000
 s_add_u32 s24, s8, 88080384
 s_addc_u32 s25, s9, 0
 s_and_b32 s25, s25, 0xffff
 s_mov_b32 s26, 2359296
 s_mov_b32 s27, 0x00020000
 s_add_u32 s28, s8, 186646528
 s_addc_u32 s29, s9, 0
 s_and_b32 s29, s29, 0xffff
 s_mov_b32 s30, 37748736
 s_mov_b32 s31, 0x00020000
 v_lshrrev_b32 v1, 5, v0
 s_lshl_b32 s32, s2, 3
 v_add_u32 v1, s32, v1
 s_movk_i32 s33, 1152
 v_mul_lo_u32 v4, v1, s33
 v_and_b32 v2, 31, v0
 v_lshl_add_u32 v1, v2, 2, v4
 v_lshlrev_b32 v3, 3, v2
 v_lshl_add_u32 v4, v4, 1, v3
 buffer_load_dword v8, v1, s[12:15], 0 offen offset:0
 buffer_load_dword v9, v1, s[12:15], 0 offen offset:128
 buffer_load_dword v10, v1, s[12:15], 0 offen offset:256
 buffer_load_dword v11, v1, s[12:15], 0 offen offset:384
 buffer_load_dword v12, v1, s[12:15], 0 offen offset:512
 buffer_load_dword v13, v1, s[12:15], 0 offen offset:640
 buffer_load_dword v14, v1, s[12:15], 0 offen offset:768
 buffer_load_dword v15, v1, s[12:15], 0 offen offset:896
 buffer_load_dword v16, v1, s[12:15], 0 offen offset:1024
 s_mov_b32 s41, 9216
 buffer_load_dwordx2 v[20:21], v3, s[16:19], s41 offen offset:0
 buffer_load_dwordx2 v[22:23], v3, s[16:19], s41 offen offset:256
 buffer_load_dwordx2 v[24:25], v3, s[16:19], s41 offen offset:512
 buffer_load_dwordx2 v[26:27], v3, s[16:19], s41 offen offset:768
 buffer_load_dwordx2 v[28:29], v3, s[16:19], s41 offen offset:1024
 buffer_load_dwordx2 v[30:31], v3, s[16:19], s41 offen offset:1280
 buffer_load_dwordx2 v[32:33], v3, s[16:19], s41 offen offset:1536
 buffer_load_dwordx2 v[34:35], v3, s[16:19], s41 offen offset:1792
 buffer_load_dwordx2 v[36:37], v3, s[16:19], s41 offen offset:2048
 s_mov_b32 s41, 6912
 buffer_load_dwordx2 v[40:41], v3, s[16:19], s41 offen offset:0
 buffer_load_dwordx2 v[42:43], v3, s[16:19], s41 offen offset:256
 buffer_load_dwordx2 v[44:45], v3, s[16:19], s41 offen offset:512
 buffer_load_dwordx2 v[46:47], v3, s[16:19], s41 offen offset:768
 buffer_load_dwordx2 v[48:49], v3, s[16:19], s41 offen offset:1024
 buffer_load_dwordx2 v[50:51], v3, s[16:19], s41 offen offset:1280
 buffer_load_dwordx2 v[52:53], v3, s[16:19], s41 offen offset:1536
 buffer_load_dwordx2 v[54:55], v3, s[16:19], s41 offen offset:1792
 buffer_load_dwordx2 v[56:57], v3, s[16:19], s41 offen offset:2048
 s_mov_b32 s41, 4608
 buffer_load_dwordx2 v[72:73], v3, s[16:19], s41 offen offset:0
 buffer_load_dwordx2 v[74:75], v3, s[16:19], s41 offen offset:256
 buffer_load_dwordx2 v[76:77], v3, s[16:19], s41 offen offset:512
 buffer_load_dwordx2 v[78:79], v3, s[16:19], s41 offen offset:768
 buffer_load_dwordx2 v[80:81], v3, s[16:19], s41 offen offset:1024
 buffer_load_dwordx2 v[82:83], v3, s[16:19], s41 offen offset:1280
 buffer_load_dwordx2 v[84:85], v3, s[16:19], s41 offen offset:1536
 buffer_load_dwordx2 v[86:87], v3, s[16:19], s41 offen offset:1792
 buffer_load_dwordx2 v[88:89], v3, s[16:19], s41 offen offset:2048
 s_mov_b32 s42, 0
 buffer_load_dwordx2 v[92:93], v4, s[28:31], s42 offen offset:0
 buffer_load_dwordx2 v[94:95], v4, s[28:31], s42 offen offset:256
 buffer_load_dwordx2 v[96:97], v4, s[28:31], s42 offen offset:512
 buffer_load_dwordx2 v[98:99], v4, s[28:31], s42 offen offset:768
 buffer_load_dwordx2 v[100:101], v4, s[28:31], s42 offen offset:1024
 buffer_load_dwordx2 v[102:103], v4, s[28:31], s42 offen offset:1280
 buffer_load_dwordx2 v[104:105], v4, s[28:31], s42 offen offset:1536
 buffer_load_dwordx2 v[106:107], v4, s[28:31], s42 offen offset:1792
 buffer_load_dwordx2 v[108:109], v4, s[28:31], s42 offen offset:2048
 s_mov_b32 s42, 4718592
 buffer_load_dwordx2 v[110:111], v4, s[28:31], s42 offen offset:0
 buffer_load_dwordx2 v[112:113], v4, s[28:31], s42 offen offset:256
 buffer_load_dwordx2 v[114:115], v4, s[28:31], s42 offen offset:512
 buffer_load_dwordx2 v[116:117], v4, s[28:31], s42 offen offset:768
 buffer_load_dwordx2 v[118:119], v4, s[28:31], s42 offen offset:1024
 buffer_load_dwordx2 v[120:121], v4, s[28:31], s42 offen offset:1280
 buffer_load_dwordx2 v[122:123], v4, s[28:31], s42 offen offset:1536
 buffer_load_dwordx2 v[124:125], v4, s[28:31], s42 offen offset:1792
 buffer_load_dwordx2 v[126:127], v4, s[28:31], s42 offen offset:2048
 s_mov_b32 s42, 9437184
 buffer_load_dwordx2 v[128:129], v4, s[28:31], s42 offen offset:0
 buffer_load_dwordx2 v[130:131], v4, s[28:31], s42 offen offset:256
 buffer_load_dwordx2 v[132:133], v4, s[28:31], s42 offen offset:512
 buffer_load_dwordx2 v[134:135], v4, s[28:31], s42 offen offset:768
 buffer_load_dwordx2 v[136:137], v4, s[28:31], s42 offen offset:1024
 buffer_load_dwordx2 v[138:139], v4, s[28:31], s42 offen offset:1280
 buffer_load_dwordx2 v[140:141], v4, s[28:31], s42 offen offset:1536
 buffer_load_dwordx2 v[142:143], v4, s[28:31], s42 offen offset:1792
 buffer_load_dwordx2 v[144:145], v4, s[28:31], s42 offen offset:2048
 s_mov_b32 s42, 14155776
 buffer_load_dwordx2 v[146:147], v4, s[28:31], s42 offen offset:0
 buffer_load_dwordx2 v[148:149], v4, s[28:31], s42 offen offset:256
 buffer_load_dwordx2 v[150:151], v4, s[28:31], s42 offen offset:512
 buffer_load_dwordx2 v[152:153], v4, s[28:31], s42 offen offset:768
 buffer_load_dwordx2 v[154:155], v4, s[28:31], s42 offen offset:1024
 buffer_load_dwordx2 v[156:157], v4, s[28:31], s42 offen offset:1280
 buffer_load_dwordx2 v[158:159], v4, s[28:31], s42 offen offset:1536
 buffer_load_dwordx2 v[160:161], v4, s[28:31], s42 offen offset:1792
 buffer_load_dwordx2 v[162:163], v4, s[28:31], s42 offen offset:2048
 s_mov_b32 s42, 18874368
 buffer_load_dwordx2 v[164:165], v4, s[28:31], s42 offen offset:0
 buffer_load_dwordx2 v[166:167], v4, s[28:31], s42 offen offset:256
 buffer_load_dwordx2 v[168:169], v4, s[28:31], s42 offen offset:512
 buffer_load_dwordx2 v[170:171], v4, s[28:31], s42 offen offset:768
 buffer_load_dwordx2 v[172:173], v4, s[28:31], s42 offen offset:1024
 buffer_load_dwordx2 v[174:175], v4, s[28:31], s42 offen offset:1280
 buffer_load_dwordx2 v[176:177], v4, s[28:31], s42 offen offset:1536
 buffer_load_dwordx2 v[178:179], v4, s[28:31], s42 offen offset:1792
 buffer_load_dwordx2 v[180:181], v4, s[28:31], s42 offen offset:2048
 s_mov_b32 s42, 23592960
 buffer_load_dwordx2 v[182:183], v4, s[28:31], s42 offen offset:0
 buffer_load_dwordx2 v[184:185], v4, s[28:31], s42 offen offset:256
 buffer_load_dwordx2 v[186:187], v4, s[28:31], s42 offen offset:512
 buffer_load_dwordx2 v[188:189], v4, s[28:31], s42 offen offset:768
 buffer_load_dwordx2 v[190:191], v4, s[28:31], s42 offen offset:1024
 buffer_load_dwordx2 v[192:193], v4, s[28:31], s42 offen offset:1280
 buffer_load_dwordx2 v[194:195], v4, s[28:31], s42 offen offset:1536
 buffer_load_dwordx2 v[196:197], v4, s[28:31], s42 offen offset:1792
 buffer_load_dwordx2 v[198:199], v4, s[28:31], s42 offen offset:2048
 s_mov_b32 s42, 28311552
 buffer_load_dwordx2 v[200:201], v4, s[28:31], s42 offen offset:0
 buffer_load_dwordx2 v[202:203], v4, s[28:31], s42 offen offset:256
 buffer_load_dwordx2 v[204:205], v4, s[28:31], s42 offen offset:512
 buffer_load_dwordx2 v[206:207], v4, s[28:31], s42 offen offset:768
 buffer_load_dwordx2 v[208:209], v4, s[28:31], s42 offen offset:1024
 buffer_load_dwordx2 v[210:211], v4, s[28:31], s42 offen offset:1280
 buffer_load_dwordx2 v[212:213], v4, s[28:31], s42 offen offset:1536
 buffer_load_dwordx2 v[214:215], v4, s[28:31], s42 offen offset:1792
 buffer_load_dwordx2 v[216:217], v4, s[28:31], s42 offen offset:2048
 s_mov_b32 s42, 33030144
 buffer_load_dwordx2 v[218:219], v4, s[28:31], s42 offen offset:0
 buffer_load_dwordx2 v[220:221], v4, s[28:31], s42 offen offset:256
 buffer_load_dwordx2 v[222:223], v4, s[28:31], s42 offen offset:512
 buffer_load_dwordx2 v[224:225], v4, s[28:31], s42 offen offset:768
 buffer_load_dwordx2 v[226:227], v4, s[28:31], s42 offen offset:1024
 buffer_load_dwordx2 v[228:229], v4, s[28:31], s42 offen offset:1280
 buffer_load_dwordx2 v[230:231], v4, s[28:31], s42 offen offset:1536
 buffer_load_dwordx2 v[232:233], v4, s[28:31], s42 offen offset:1792
 buffer_load_dwordx2 v[234:235], v4, s[28:31], s42 offen offset:2048
 s_waitcnt vmcnt(0)
 v_add_f32 v92, v92, v110
 v_add_f32 v93, v93, v111
 v_add_f32 v94, v94, v112
 v_add_f32 v95, v95, v113
 v_add_f32 v96, v96, v114
 v_add_f32 v97, v97, v115
 v_add_f32 v98, v98, v116
 v_add_f32 v99, v99, v117
 v_add_f32 v100, v100, v118
 v_add_f32 v101, v101, v119
 v_add_f32 v102, v102, v120
 v_add_f32 v103, v103, v121
 v_add_f32 v104, v104, v122
 v_add_f32 v105, v105, v123
 v_add_f32 v106, v106, v124
 v_add_f32 v107, v107, v125
 v_add_f32 v108, v108, v126
 v_add_f32 v109, v109, v127
 v_add_f32 v128, v128, v146
 v_add_f32 v129, v129, v147
 v_add_f32 v130, v130, v148
 v_add_f32 v131, v131, v149
 v_add_f32 v132, v132, v150
 v_add_f32 v133, v133, v151
 v_add_f32 v134, v134, v152
 v_add_f32 v135, v135, v153
 v_add_f32 v136, v136, v154
 v_add_f32 v137, v137, v155
 v_add_f32 v138, v138, v156
 v_add_f32 v139, v139, v157
 v_add_f32 v140, v140, v158
 v_add_f32 v141, v141, v159
 v_add_f32 v142, v142, v160
 v_add_f32 v143, v143, v161
 v_add_f32 v144, v144, v162
 v_add_f32 v145, v145, v163
 v_add_f32 v164, v164, v182
 v_add_f32 v165, v165, v183
 v_add_f32 v166, v166, v184
 v_add_f32 v167, v167, v185
 v_add_f32 v168, v168, v186
 v_add_f32 v169, v169, v187
 v_add_f32 v170, v170, v188
 v_add_f32 v171, v171, v189
 v_add_f32 v172, v172, v190
 v_add_f32 v173, v173, v191
 v_add_f32 v174, v174, v192
 v_add_f32 v175, v175, v193
 v_add_f32 v176, v176, v194
 v_add_f32 v177, v177, v195
 v_add_f32 v178, v178, v196
 v_add_f32 v179, v179, v197
 v_add_f32 v180, v180, v198
 v_add_f32 v181, v181, v199
 v_add_f32 v200, v200, v218
 v_add_f32 v201, v201, v219
 v_add_f32 v202, v202, v220
 v_add_f32 v203, v203, v221
 v_add_f32 v204, v204, v222
 v_add_f32 v205, v205, v223
 v_add_f32 v206, v206, v224
 v_add_f32 v207, v207, v225
 v_add_f32 v208, v208, v226
 v_add_f32 v209, v209, v227
 v_add_f32 v210, v210, v228
 v_add_f32 v211, v211, v229
 v_add_f32 v212, v212, v230
 v_add_f32 v213, v213, v231
 v_add_f32 v214, v214, v232
 v_add_f32 v215, v215, v233
 v_add_f32 v216, v216, v234
 v_add_f32 v217, v217, v235
 v_add_f32 v92, v92, v128
 v_add_f32 v93, v93, v129
 v_add_f32 v94, v94, v130
 v_add_f32 v95, v95, v131
 v_add_f32 v96, v96, v132
 v_add_f32 v97, v97, v133
 v_add_f32 v98, v98, v134
 v_add_f32 v99, v99, v135
 v_add_f32 v100, v100, v136
 v_add_f32 v101, v101, v137
 v_add_f32 v102, v102, v138
 v_add_f32 v103, v103, v139
 v_add_f32 v104, v104, v140
 v_add_f32 v105, v105, v141
 v_add_f32 v106, v106, v142
 v_add_f32 v107, v107, v143
 v_add_f32 v108, v108, v144
 v_add_f32 v109, v109, v145
 v_add_f32 v164, v164, v200
 v_add_f32 v165, v165, v201
 v_add_f32 v166, v166, v202
 v_add_f32 v167, v167, v203
 v_add_f32 v168, v168, v204
 v_add_f32 v169, v169, v205
 v_add_f32 v170, v170, v206
 v_add_f32 v171, v171, v207
 v_add_f32 v172, v172, v208
 v_add_f32 v173, v173, v209
 v_add_f32 v174, v174, v210
 v_add_f32 v175, v175, v211
 v_add_f32 v176, v176, v212
 v_add_f32 v177, v177, v213
 v_add_f32 v178, v178, v214
 v_add_f32 v179, v179, v215
 v_add_f32 v180, v180, v216
 v_add_f32 v181, v181, v217
 v_add_f32 v92, v92, v164
 v_add_f32 v93, v93, v165
 v_add_f32 v94, v94, v166
 v_add_f32 v95, v95, v167
 v_add_f32 v96, v96, v168
 v_add_f32 v97, v97, v169
 v_add_f32 v98, v98, v170
 v_add_f32 v99, v99, v171
 v_add_f32 v100, v100, v172
 v_add_f32 v101, v101, v173
 v_add_f32 v102, v102, v174
 v_add_f32 v103, v103, v175
 v_add_f32 v104, v104, v176
 v_add_f32 v105, v105, v177
 v_add_f32 v106, v106, v178
 v_add_f32 v107, v107, v179
 v_add_f32 v108, v108, v180
 v_add_f32 v109, v109, v181
 v_cvt_pk_bf16_f32 v110, v92, v93
 v_lshlrev_b32 v92, 16, v110
 v_and_b32 v93, 0xffff0000, v110
 v_mul_f32 v92, v92, v72
 v_mul_f32 v93, v93, v73
 v_cvt_pk_bf16_f32 v110, v92, v93
 v_lshlrev_b32 v92, 16, v110
 v_and_b32 v93, 0xffff0000, v110
 v_lshlrev_b32 v110, 16, v8
 v_and_b32 v111, 0xffff0000, v8
 v_add_f32 v92, v92, v110
 v_add_f32 v93, v93, v111
 v_cvt_pk_bf16_f32 v8, v92, v93
 v_cvt_pk_bf16_f32 v110, v94, v95
 v_lshlrev_b32 v94, 16, v110
 v_and_b32 v95, 0xffff0000, v110
 v_mul_f32 v94, v94, v74
 v_mul_f32 v95, v95, v75
 v_cvt_pk_bf16_f32 v110, v94, v95
 v_lshlrev_b32 v94, 16, v110
 v_and_b32 v95, 0xffff0000, v110
 v_lshlrev_b32 v110, 16, v9
 v_and_b32 v111, 0xffff0000, v9
 v_add_f32 v94, v94, v110
 v_add_f32 v95, v95, v111
 v_cvt_pk_bf16_f32 v9, v94, v95
 v_cvt_pk_bf16_f32 v110, v96, v97
 v_lshlrev_b32 v96, 16, v110
 v_and_b32 v97, 0xffff0000, v110
 v_mul_f32 v96, v96, v76
 v_mul_f32 v97, v97, v77
 v_cvt_pk_bf16_f32 v110, v96, v97
 v_lshlrev_b32 v96, 16, v110
 v_and_b32 v97, 0xffff0000, v110
 v_lshlrev_b32 v110, 16, v10
 v_and_b32 v111, 0xffff0000, v10
 v_add_f32 v96, v96, v110
 v_add_f32 v97, v97, v111
 v_cvt_pk_bf16_f32 v10, v96, v97
 v_cvt_pk_bf16_f32 v110, v98, v99
 v_lshlrev_b32 v98, 16, v110
 v_and_b32 v99, 0xffff0000, v110
 v_mul_f32 v98, v98, v78
 v_mul_f32 v99, v99, v79
 v_cvt_pk_bf16_f32 v110, v98, v99
 v_lshlrev_b32 v98, 16, v110
 v_and_b32 v99, 0xffff0000, v110
 v_lshlrev_b32 v110, 16, v11
 v_and_b32 v111, 0xffff0000, v11
 v_add_f32 v98, v98, v110
 v_add_f32 v99, v99, v111
 v_cvt_pk_bf16_f32 v11, v98, v99
 v_cvt_pk_bf16_f32 v110, v100, v101
 v_lshlrev_b32 v100, 16, v110
 v_and_b32 v101, 0xffff0000, v110
 v_mul_f32 v100, v100, v80
 v_mul_f32 v101, v101, v81
 v_cvt_pk_bf16_f32 v110, v100, v101
 v_lshlrev_b32 v100, 16, v110
 v_and_b32 v101, 0xffff0000, v110
 v_lshlrev_b32 v110, 16, v12
 v_and_b32 v111, 0xffff0000, v12
 v_add_f32 v100, v100, v110
 v_add_f32 v101, v101, v111
 v_cvt_pk_bf16_f32 v12, v100, v101
 v_cvt_pk_bf16_f32 v110, v102, v103
 v_lshlrev_b32 v102, 16, v110
 v_and_b32 v103, 0xffff0000, v110
 v_mul_f32 v102, v102, v82
 v_mul_f32 v103, v103, v83
 v_cvt_pk_bf16_f32 v110, v102, v103
 v_lshlrev_b32 v102, 16, v110
 v_and_b32 v103, 0xffff0000, v110
 v_lshlrev_b32 v110, 16, v13
 v_and_b32 v111, 0xffff0000, v13
 v_add_f32 v102, v102, v110
 v_add_f32 v103, v103, v111
 v_cvt_pk_bf16_f32 v13, v102, v103
 v_cvt_pk_bf16_f32 v110, v104, v105
 v_lshlrev_b32 v104, 16, v110
 v_and_b32 v105, 0xffff0000, v110
 v_mul_f32 v104, v104, v84
 v_mul_f32 v105, v105, v85
 v_cvt_pk_bf16_f32 v110, v104, v105
 v_lshlrev_b32 v104, 16, v110
 v_and_b32 v105, 0xffff0000, v110
 v_lshlrev_b32 v110, 16, v14
 v_and_b32 v111, 0xffff0000, v14
 v_add_f32 v104, v104, v110
 v_add_f32 v105, v105, v111
 v_cvt_pk_bf16_f32 v14, v104, v105
 v_cvt_pk_bf16_f32 v110, v106, v107
 v_lshlrev_b32 v106, 16, v110
 v_and_b32 v107, 0xffff0000, v110
 v_mul_f32 v106, v106, v86
 v_mul_f32 v107, v107, v87
 v_cvt_pk_bf16_f32 v110, v106, v107
 v_lshlrev_b32 v106, 16, v110
 v_and_b32 v107, 0xffff0000, v110
 v_lshlrev_b32 v110, 16, v15
 v_and_b32 v111, 0xffff0000, v15
 v_add_f32 v106, v106, v110
 v_add_f32 v107, v107, v111
 v_cvt_pk_bf16_f32 v15, v106, v107
 v_cvt_pk_bf16_f32 v110, v108, v109
 v_lshlrev_b32 v108, 16, v110
 v_and_b32 v109, 0xffff0000, v110
 v_mul_f32 v108, v108, v88
 v_mul_f32 v109, v109, v89
 v_cvt_pk_bf16_f32 v110, v108, v109
 v_lshlrev_b32 v108, 16, v110
 v_and_b32 v109, 0xffff0000, v110
 v_lshlrev_b32 v110, 16, v16
 v_and_b32 v111, 0xffff0000, v16
 v_add_f32 v108, v108, v110
 v_add_f32 v109, v109, v111
 v_cvt_pk_bf16_f32 v16, v108, v109
 buffer_store_dword v8, v1, s[24:27], 0 offen offset:0 sc1
 buffer_store_dword v9, v1, s[24:27], 0 offen offset:128 sc1
 buffer_store_dword v10, v1, s[24:27], 0 offen offset:256 sc1
 buffer_store_dword v11, v1, s[24:27], 0 offen offset:384 sc1
 buffer_store_dword v12, v1, s[24:27], 0 offen offset:512 sc1
 buffer_store_dword v13, v1, s[24:27], 0 offen offset:640 sc1
 buffer_store_dword v14, v1, s[24:27], 0 offen offset:768 sc1
 buffer_store_dword v15, v1, s[24:27], 0 offen offset:896 sc1
 buffer_store_dword v16, v1, s[24:27], 0 offen offset:1024 sc1
 v_mov_b32 v60, 0
 v_mov_b32 v61, 0
 v_lshlrev_b32 v62, 16, v8
 v_and_b32 v63, 0xffff0000, v8
 v_add_f32 v60, v60, v62
 v_add_f32 v61, v61, v63
 v_lshlrev_b32 v62, 16, v9
 v_and_b32 v63, 0xffff0000, v9
 v_add_f32 v60, v60, v62
 v_add_f32 v61, v61, v63
 v_lshlrev_b32 v62, 16, v10
 v_and_b32 v63, 0xffff0000, v10
 v_add_f32 v60, v60, v62
 v_add_f32 v61, v61, v63
 v_lshlrev_b32 v62, 16, v11
 v_and_b32 v63, 0xffff0000, v11
 v_add_f32 v60, v60, v62
 v_add_f32 v61, v61, v63
 v_lshlrev_b32 v62, 16, v12
 v_and_b32 v63, 0xffff0000, v12
 v_add_f32 v60, v60, v62
 v_add_f32 v61, v61, v63
 v_lshlrev_b32 v62, 16, v13
 v_and_b32 v63, 0xffff0000, v13
 v_add_f32 v60, v60, v62
 v_add_f32 v61, v61, v63
 v_lshlrev_b32 v62, 16, v14
 v_and_b32 v63, 0xffff0000, v14
 v_add_f32 v60, v60, v62
 v_add_f32 v61, v61, v63
 v_lshlrev_b32 v62, 16, v15
 v_and_b32 v63, 0xffff0000, v15
 v_add_f32 v60, v60, v62
 v_add_f32 v61, v61, v63
 v_lshlrev_b32 v62, 16, v16
 v_and_b32 v63, 0xffff0000, v16
 v_add_f32 v60, v60, v62
 v_add_f32 v61, v61, v63
 v_add_f32 v60, v60, v61
 ds_swizzle_b32 v62, v60 offset:1055
 s_waitcnt lgkmcnt(0)
 v_add_f32 v60, v60, v62
 ds_swizzle_b32 v62, v60 offset:2079
 s_waitcnt lgkmcnt(0)
 v_add_f32 v60, v60, v62
 ds_swizzle_b32 v62, v60 offset:4127
 s_waitcnt lgkmcnt(0)
 v_add_f32 v60, v60, v62
 ds_swizzle_b32 v62, v60 offset:8223
 s_waitcnt lgkmcnt(0)
 v_add_f32 v60, v60, v62
 ds_swizzle_b32 v62, v60 offset:16415
 s_waitcnt lgkmcnt(0)
 v_add_f32 v60, v60, v62
 s_mov_b32 s40, 0x3ae38e39
 v_mul_f32 v60, s40, v60
 v_mov_b32 v61, 0
 v_mov_b32 v64, 0
 v_lshlrev_b32 v62, 16, v8
 v_and_b32 v63, 0xffff0000, v8
 v_sub_f32 v62, v62, v60
 v_sub_f32 v63, v63, v60
 v_fmac_f32 v61, v62, v62
 v_fmac_f32 v64, v63, v63
 v_lshlrev_b32 v62, 16, v9
 v_and_b32 v63, 0xffff0000, v9
 v_sub_f32 v62, v62, v60
 v_sub_f32 v63, v63, v60
 v_fmac_f32 v61, v62, v62
 v_fmac_f32 v64, v63, v63
 v_lshlrev_b32 v62, 16, v10
 v_and_b32 v63, 0xffff0000, v10
 v_sub_f32 v62, v62, v60
 v_sub_f32 v63, v63, v60
 v_fmac_f32 v61, v62, v62
 v_fmac_f32 v64, v63, v63
 v_lshlrev_b32 v62, 16, v11
 v_and_b32 v63, 0xffff0000, v11
 v_sub_f32 v62, v62, v60
 v_sub_f32 v63, v63, v60
 v_fmac_f32 v61, v62, v62
 v_fmac_f32 v64, v63, v63
 v_lshlrev_b32 v62, 16, v12
 v_and_b32 v63, 0xffff0000, v12
 v_sub_f32 v62, v62, v60
 v_sub_f32 v63, v63, v60
 v_fmac_f32 v61, v62, v62
 v_fmac_f32 v64, v63, v63
 v_lshlrev_b32 v62, 16, v13
 v_and_b32 v63, 0xffff0000, v13
 v_sub_f32 v62, v62, v60
 v_sub_f32 v63, v63, v60
 v_fmac_f32 v61, v62, v62
 v_fmac_f32 v64, v63, v63
 v_lshlrev_b32 v62, 16, v14
 v_and_b32 v63, 0xffff0000, v14
 v_sub_f32 v62, v62, v60
 v_sub_f32 v63, v63, v60
 v_fmac_f32 v61, v62, v62
 v_fmac_f32 v64, v63, v63
 v_lshlrev_b32 v62, 16, v15
 v_and_b32 v63, 0xffff0000, v15
 v_sub_f32 v62, v62, v60
 v_sub_f32 v63, v63, v60
 v_fmac_f32 v61, v62, v62
 v_fmac_f32 v64, v63, v63
 v_lshlrev_b32 v62, 16, v16
 v_and_b32 v63, 0xffff0000, v16
 v_sub_f32 v62, v62, v60
 v_sub_f32 v63, v63, v60
 v_fmac_f32 v61, v62, v62
 v_fmac_f32 v64, v63, v63
 v_add_f32 v61, v61, v64
 ds_swizzle_b32 v62, v61 offset:1055
 s_waitcnt lgkmcnt(0)
 v_add_f32 v61, v61, v62
 ds_swizzle_b32 v62, v61 offset:2079
 s_waitcnt lgkmcnt(0)
 v_add_f32 v61, v61, v62
 ds_swizzle_b32 v62, v61 offset:4127
 s_waitcnt lgkmcnt(0)
 v_add_f32 v61, v61, v62
 ds_swizzle_b32 v62, v61 offset:8223
 s_waitcnt lgkmcnt(0)
 v_add_f32 v61, v61, v62
 ds_swizzle_b32 v62, v61 offset:16415
 s_waitcnt lgkmcnt(0)
 v_add_f32 v61, v61, v62
 v_mul_f32 v61, s40, v61
 v_cvt_pk_bf16_f32 v62, v60, v61
 v_lshlrev_b32 v60, 16, v62
 v_and_b32 v61, 0xffff0000, v62
 v_add_f32 v61, 0x3727c5ac, v61
 v_cvt_pk_bf16_f32 v62, v61, v61
 v_lshlrev_b32 v61, 16, v62
 v_sqrt_f32 v61, v61
 s_nop 0
 v_cvt_pk_bf16_f32 v62, v61, v61
 v_lshlrev_b32 v61, 16, v62
 v_rcp_f32 v64, v61
 s_waitcnt vmcnt(0)
 v_lshlrev_b32 v62, 16, v8
 v_and_b32 v63, 0xffff0000, v8
 v_sub_f32 v62, v62, v60
 v_sub_f32 v63, v63, v60
 v_cvt_pk_bf16_f32 v65, v62, v63
 v_lshlrev_b32 v62, 16, v65
 v_and_b32 v63, 0xffff0000, v65
 v_mul_f32 v66, v62, v64
 v_mul_f32 v67, v63, v64
 v_fma_f32 v68, -v66, v61, v62
 v_fma_f32 v69, -v67, v61, v63
 v_fma_f32 v66, v68, v64, v66
 v_fma_f32 v67, v69, v64, v67
 v_cvt_pk_bf16_f32 v65, v66, v67
 v_lshlrev_b32 v62, 16, v65
 v_and_b32 v63, 0xffff0000, v65
 v_mul_f32 v62, v62, v20
 v_mul_f32 v63, v63, v21
 v_cvt_pk_bf16_f32 v65, v62, v63
 v_lshlrev_b32 v62, 16, v65
 v_and_b32 v63, 0xffff0000, v65
 v_add_f32 v62, v62, v40
 v_add_f32 v63, v63, v41
 v_cvt_pk_bf16_f32 v8, v62, v63
 v_lshlrev_b32 v62, 16, v9
 v_and_b32 v63, 0xffff0000, v9
 v_sub_f32 v62, v62, v60
 v_sub_f32 v63, v63, v60
 v_cvt_pk_bf16_f32 v65, v62, v63
 v_lshlrev_b32 v62, 16, v65
 v_and_b32 v63, 0xffff0000, v65
 v_mul_f32 v66, v62, v64
 v_mul_f32 v67, v63, v64
 v_fma_f32 v68, -v66, v61, v62
 v_fma_f32 v69, -v67, v61, v63
 v_fma_f32 v66, v68, v64, v66
 v_fma_f32 v67, v69, v64, v67
 v_cvt_pk_bf16_f32 v65, v66, v67
 v_lshlrev_b32 v62, 16, v65
 v_and_b32 v63, 0xffff0000, v65
 v_mul_f32 v62, v62, v22
 v_mul_f32 v63, v63, v23
 v_cvt_pk_bf16_f32 v65, v62, v63
 v_lshlrev_b32 v62, 16, v65
 v_and_b32 v63, 0xffff0000, v65
 v_add_f32 v62, v62, v42
 v_add_f32 v63, v63, v43
 v_cvt_pk_bf16_f32 v9, v62, v63
 v_lshlrev_b32 v62, 16, v10
 v_and_b32 v63, 0xffff0000, v10
 v_sub_f32 v62, v62, v60
 v_sub_f32 v63, v63, v60
 v_cvt_pk_bf16_f32 v65, v62, v63
 v_lshlrev_b32 v62, 16, v65
 v_and_b32 v63, 0xffff0000, v65
 v_mul_f32 v66, v62, v64
 v_mul_f32 v67, v63, v64
 v_fma_f32 v68, -v66, v61, v62
 v_fma_f32 v69, -v67, v61, v63
 v_fma_f32 v66, v68, v64, v66
 v_fma_f32 v67, v69, v64, v67
 v_cvt_pk_bf16_f32 v65, v66, v67
 v_lshlrev_b32 v62, 16, v65
 v_and_b32 v63, 0xffff0000, v65
 v_mul_f32 v62, v62, v24
 v_mul_f32 v63, v63, v25
 v_cvt_pk_bf16_f32 v65, v62, v63
 v_lshlrev_b32 v62, 16, v65
 v_and_b32 v63, 0xffff0000, v65
 v_add_f32 v62, v62, v44
 v_add_f32 v63, v63, v45
 v_cvt_pk_bf16_f32 v10, v62, v63
 v_lshlrev_b32 v62, 16, v11
 v_and_b32 v63, 0xffff0000, v11
 v_sub_f32 v62, v62, v60
 v_sub_f32 v63, v63, v60
 v_cvt_pk_bf16_f32 v65, v62, v63
 v_lshlrev_b32 v62, 16, v65
 v_and_b32 v63, 0xffff0000, v65
 v_mul_f32 v66, v62, v64
 v_mul_f32 v67, v63, v64
 v_fma_f32 v68, -v66, v61, v62
 v_fma_f32 v69, -v67, v61, v63
 v_fma_f32 v66, v68, v64, v66
 v_fma_f32 v67, v69, v64, v67
 v_cvt_pk_bf16_f32 v65, v66, v67
 v_lshlrev_b32 v62, 16, v65
 v_and_b32 v63, 0xffff0000, v65
 v_mul_f32 v62, v62, v26
 v_mul_f32 v63, v63, v27
 v_cvt_pk_bf16_f32 v65, v62, v63
 v_lshlrev_b32 v62, 16, v65
 v_and_b32 v63, 0xffff0000, v65
 v_add_f32 v62, v62, v46
 v_add_f32 v63, v63, v47
 v_cvt_pk_bf16_f32 v11, v62, v63
 v_lshlrev_b32 v62, 16, v12
 v_and_b32 v63, 0xffff0000, v12
 v_sub_f32 v62, v62, v60
 v_sub_f32 v63, v63, v60
 v_cvt_pk_bf16_f32 v65, v62, v63
 v_lshlrev_b32 v62, 16, v65
 v_and_b32 v63, 0xffff0000, v65
 v_mul_f32 v66, v62, v64
 v_mul_f32 v67, v63, v64
 v_fma_f32 v68, -v66, v61, v62
 v_fma_f32 v69, -v67, v61, v63
 v_fma_f32 v66, v68, v64, v66
 v_fma_f32 v67, v69, v64, v67
 v_cvt_pk_bf16_f32 v65, v66, v67
 v_lshlrev_b32 v62, 16, v65
 v_and_b32 v63, 0xffff0000, v65
 v_mul_f32 v62, v62, v28
 v_mul_f32 v63, v63, v29
 v_cvt_pk_bf16_f32 v65, v62, v63
 v_lshlrev_b32 v62, 16, v65
 v_and_b32 v63, 0xffff0000, v65
 v_add_f32 v62, v62, v48
 v_add_f32 v63, v63, v49
 v_cvt_pk_bf16_f32 v12, v62, v63
 v_lshlrev_b32 v62, 16, v13
 v_and_b32 v63, 0xffff0000, v13
 v_sub_f32 v62, v62, v60
 v_sub_f32 v63, v63, v60
 v_cvt_pk_bf16_f32 v65, v62, v63
 v_lshlrev_b32 v62, 16, v65
 v_and_b32 v63, 0xffff0000, v65
 v_mul_f32 v66, v62, v64
 v_mul_f32 v67, v63, v64
 v_fma_f32 v68, -v66, v61, v62
 v_fma_f32 v69, -v67, v61, v63
 v_fma_f32 v66, v68, v64, v66
 v_fma_f32 v67, v69, v64, v67
 v_cvt_pk_bf16_f32 v65, v66, v67
 v_lshlrev_b32 v62, 16, v65
 v_and_b32 v63, 0xffff0000, v65
 v_mul_f32 v62, v62, v30
 v_mul_f32 v63, v63, v31
 v_cvt_pk_bf16_f32 v65, v62, v63
 v_lshlrev_b32 v62, 16, v65
 v_and_b32 v63, 0xffff0000, v65
 v_add_f32 v62, v62, v50
 v_add_f32 v63, v63, v51
 v_cvt_pk_bf16_f32 v13, v62, v63
 v_lshlrev_b32 v62, 16, v14
 v_and_b32 v63, 0xffff0000, v14
 v_sub_f32 v62, v62, v60
 v_sub_f32 v63, v63, v60
 v_cvt_pk_bf16_f32 v65, v62, v63
 v_lshlrev_b32 v62, 16, v65
 v_and_b32 v63, 0xffff0000, v65
 v_mul_f32 v66, v62, v64
 v_mul_f32 v67, v63, v64
 v_fma_f32 v68, -v66, v61, v62
 v_fma_f32 v69, -v67, v61, v63
 v_fma_f32 v66, v68, v64, v66
 v_fma_f32 v67, v69, v64, v67
 v_cvt_pk_bf16_f32 v65, v66, v67
 v_lshlrev_b32 v62, 16, v65
 v_and_b32 v63, 0xffff0000, v65
 v_mul_f32 v62, v62, v32
 v_mul_f32 v63, v63, v33
 v_cvt_pk_bf16_f32 v65, v62, v63
 v_lshlrev_b32 v62, 16, v65
 v_and_b32 v63, 0xffff0000, v65
 v_add_f32 v62, v62, v52
 v_add_f32 v63, v63, v53
 v_cvt_pk_bf16_f32 v14, v62, v63
 v_lshlrev_b32 v62, 16, v15
 v_and_b32 v63, 0xffff0000, v15
 v_sub_f32 v62, v62, v60
 v_sub_f32 v63, v63, v60
 v_cvt_pk_bf16_f32 v65, v62, v63
 v_lshlrev_b32 v62, 16, v65
 v_and_b32 v63, 0xffff0000, v65
 v_mul_f32 v66, v62, v64
 v_mul_f32 v67, v63, v64
 v_fma_f32 v68, -v66, v61, v62
 v_fma_f32 v69, -v67, v61, v63
 v_fma_f32 v66, v68, v64, v66
 v_fma_f32 v67, v69, v64, v67
 v_cvt_pk_bf16_f32 v65, v66, v67
 v_lshlrev_b32 v62, 16, v65
 v_and_b32 v63, 0xffff0000, v65
 v_mul_f32 v62, v62, v34
 v_mul_f32 v63, v63, v35
 v_cvt_pk_bf16_f32 v65, v62, v63
 v_lshlrev_b32 v62, 16, v65
 v_and_b32 v63, 0xffff0000, v65
 v_add_f32 v62, v62, v54
 v_add_f32 v63, v63, v55
 v_cvt_pk_bf16_f32 v15, v62, v63
 v_lshlrev_b32 v62, 16, v16
 v_and_b32 v63, 0xffff0000, v16
 v_sub_f32 v62, v62, v60
 v_sub_f32 v63, v63, v60
 v_cvt_pk_bf16_f32 v65, v62, v63
 v_lshlrev_b32 v62, 16, v65
 v_and_b32 v63, 0xffff0000, v65
 v_mul_f32 v66, v62, v64
 v_mul_f32 v67, v63, v64
 v_fma_f32 v68, -v66, v61, v62
 v_fma_f32 v69, -v67, v61, v63
 v_fma_f32 v66, v68, v64, v66
 v_fma_f32 v67, v69, v64, v67
 v_cvt_pk_bf16_f32 v65, v66, v67
 v_lshlrev_b32 v62, 16, v65
 v_and_b32 v63, 0xffff0000, v65
 v_mul_f32 v62, v62, v36
 v_mul_f32 v63, v63, v37
 v_cvt_pk_bf16_f32 v65, v62, v63
 v_lshlrev_b32 v62, 16, v65
 v_and_b32 v63, 0xffff0000, v65
 v_add_f32 v62, v62, v56
 v_add_f32 v63, v63, v57
 v_cvt_pk_bf16_f32 v16, v62, v63
 buffer_store_dword v8, v1, s[20:23], 0 offen offset:0 sc1
 buffer_store_dword v9, v1, s[20:23], 0 offen offset:128 sc1
 buffer_store_dword v10, v1, s[20:23], 0 offen offset:256 sc1
 buffer_store_dword v11, v1, s[20:23], 0 offen offset:384 sc1
 buffer_store_dword v12, v1, s[20:23], 0 offen offset:512 sc1
 buffer_store_dword v13, v1, s[20:23], 0 offen offset:640 sc1
 buffer_store_dword v14, v1, s[20:23], 0 offen offset:768 sc1
 buffer_store_dword v15, v1, s[20:23], 0 offen offset:896 sc1
 buffer_store_dword v16, v1, s[20:23], 0 offen offset:1024 sc1
 s_branch mega_kernel_sig91
mega_kernel_bdown117:
 s_load_dwordx2 s[8:9], s[0:1], 120
 s_load_dwordx2 s[4:5], s[0:1], 80
 s_mov_b32 s43, 1073741825
 s_mul_hi_u32 s45, s2, s43
 s_mul_i32 s44, s45, 4
 s_sub_u32 s44, s2, s44
 s_and_b32 s46, s45, 7
 s_lshr_b32 s45, s45, 3
 s_waitcnt lgkmcnt(0)
 s_add_u32 s12, s8, 96468992
 s_addc_u32 s13, s9, 0
 s_and_b32 s13, s13, 0xffff
 s_mov_b32 s14, 18874368
 s_mov_b32 s15, 0x00020000
 s_mov_b32 s16, s4
 s_and_b32 s17, s5, 0xffff
 s_mov_b32 s18, 5308416
 s_mov_b32 s19, 0x00020000
 s_add_u32 s24, s8, 225443840
 s_addc_u32 s25, s9, 0
 s_and_b32 s25, s25, 0xffff
 s_mov_b32 s26, 37748736
 s_mov_b32 s27, 0x00020000
 s_mul_i32 s48, s44, 288
 s_mul_i32 s50, s44, 576
 s_mul_i32 s51, s46, 1152
 s_mul_i32 s52, s46, 663552
 s_mul_i32 s53, s45, 1179648
 s_add_u32 s53, s53, s51
 s_add_u32 s48, s48, s52
 v_and_b32 v1, 63, v0
 v_lshrrev_b32 v2, 6, v0
 s_nop 0
 v_readfirstlane_b32 s54, v2
 v_lshrrev_b32 v3, 4, v1
 v_and_b32 v4, 15, v1
 v_lshrrev_b32 v5, 3, v1
 s_movk_i32 s55, 9216
 v_mul_lo_u32 v5, v5, s55
 v_and_b32 v6, 7, v1
 v_add_u32 v7, 0, v3
 v_and_b32 v7, 7, v7
 v_xor_b32 v7, v7, v6
 v_lshl_add_u32 v8, v7, 4, v5
 v_add_u32 v7, 4, v3
 v_and_b32 v7, 7, v7
 v_xor_b32 v7, v7, v6
 v_lshl_add_u32 v9, v7, 4, v5
 s_mul_i32 s56, s54, 294912
 s_add_u32 s53, s53, s56
 s_mov_b32 s57, 1152
 s_mov_b32 s62, 0xe38f
 s_add_u32 s58, s54, 0
 s_lshl_b32 s58, s58, 6
 v_add_u32 v5, s58, v1
 v_mul_lo_u32 v6, v5, s62
 v_lshrrev_b32 v6, 20, v6
 v_mul_u32_u24 v7, 18, v6
 v_sub_u32 v7, v5, v7
 v_mul_lo_u32 v6, v6, s57
 v_lshl_add_u32 v10, v7, 4, v6
 s_add_u32 s58, s54, 4
 s_lshl_b32 s58, s58, 6
 v_add_u32 v5, s58, v1
 v_mul_lo_u32 v6, v5, s62
 v_lshrrev_b32 v6, 20, v6
 v_mul_u32_u24 v7, 18, v6
 v_sub_u32 v7, v5, v7
 v_mul_lo_u32 v6, v6, s57
 v_lshl_add_u32 v11, v7, 4, v6
 s_add_u32 s58, s54, 8
 s_lshl_b32 s58, s58, 6
 v_add_u32 v5, s58, v1
 v_mul_lo_u32 v6, v5, s62
 v_lshrrev_b32 v6, 20, v6
 v_mul_u32_u24 v7, 18, v6
 v_sub_u32 v7, v5, v7
 v_mul_lo_u32 v6, v6, s57
 v_lshl_add_u32 v12, v7, 4, v6
 s_add_u32 s58, s54, 12
 s_lshl_b32 s58, s58, 6
 v_add_u32 v5, s58, v1
 v_mul_lo_u32 v6, v5, s62
 v_lshrrev_b32 v6, 20, v6
 v_mul_u32_u24 v7, 18, v6
 v_sub_u32 v7, v5, v7
 v_mul_lo_u32 v6, v6, s57
 v_lshl_add_u32 v13, v7, 4, v6
 s_and_b32 s58, s54, 1
 s_add_u32 s58, s58, 16
 s_lshl_b32 s58, s58, 6
 v_add_u32 v5, s58, v1
 v_mul_lo_u32 v6, v5, s62
 v_lshrrev_b32 v6, 20, v6
 v_mul_u32_u24 v7, 18, v6
 v_sub_u32 v7, v5, v7
 v_mul_lo_u32 v6, v6, s57
 v_lshl_add_u32 v14, v7, 4, v6
 s_mov_b32 s28, s16
 s_mov_b32 s29, s17
 s_mov_b32 s30, s18
 s_mov_b32 s31, s19
 s_mov_b32 s60, s48
 s_lshl_b32 s62, s54, 12
 v_lshrrev_b32 v5, 1, v4
 s_mul_i32 s58, s54, 4096
 v_lshl_add_u32 v6, v4, 7, s58
 v_and_b32 v7, 1, v3
 v_lshl_add_u32 v6, v7, 3, v6
 v_lshrrev_b32 v7, 1, v3
 v_xor_b32 v5, v7, v5
 v_xor_b32 v7, 0, v5
 v_lshl_add_u32 v7, v7, 4, v6
 v_add_u32 v16, 0, v7
 v_add_u32 v20, 34816, v7
 v_add_u32 v24, 69632, v7
 v_xor_b32 v7, 2, v5
 v_lshl_add_u32 v7, v7, 4, v6
 v_add_u32 v17, 0, v7
 v_add_u32 v21, 34816, v7
 v_add_u32 v25, 69632, v7
 v_xor_b32 v7, 4, v5
 v_lshl_add_u32 v7, v7, 4, v6
 v_add_u32 v18, 0, v7
 v_add_u32 v22, 34816, v7
 v_add_u32 v26, 69632, v7
 v_xor_b32 v7, 6, v5
 v_lshl_add_u32 v7, v7, 4, v6
 v_add_u32 v19, 0, v7
 v_add_u32 v23, 34816, v7
 v_add_u32 v27, 69632, v7
 v_lshrrev_b32 v5, 2, v4
 v_lshl_add_u32 v5, v3, 2, v5
 v_mul_u32_u24 v5, 288, v5
 v_and_b32 v7, 3, v1
 v_lshl_add_u32 v5, v7, 3, v5
 v_add_u32 v32, 16384, v5
 v_add_u32 v33, 51200, v5
 v_add_u32 v34, 86016, v5
 v_accvgpr_write_b32 a0, 0
 v_accvgpr_write_b32 a1, 0
 v_accvgpr_write_b32 a2, 0
 v_accvgpr_write_b32 a3, 0
 v_accvgpr_write_b32 a4, 0
 v_accvgpr_write_b32 a5, 0
 v_accvgpr_write_b32 a6, 0
 v_accvgpr_write_b32 a7, 0
 v_accvgpr_write_b32 a8, 0
 v_accvgpr_write_b32 a9, 0
 v_accvgpr_write_b32 a10, 0
 v_accvgpr_write_b32 a11, 0
 v_accvgpr_write_b32 a12, 0
 v_accvgpr_write_b32 a13, 0
 v_accvgpr_write_b32 a14, 0
 v_accvgpr_write_b32 a15, 0
 v_accvgpr_write_b32 a16, 0
 v_accvgpr_write_b32 a17, 0
 v_accvgpr_write_b32 a18, 0
 v_accvgpr_write_b32 a19, 0
 v_accvgpr_write_b32 a20, 0
 v_accvgpr_write_b32 a21, 0
 v_accvgpr_write_b32 a22, 0
 v_accvgpr_write_b32 a23, 0
 v_accvgpr_write_b32 a24, 0
 v_accvgpr_write_b32 a25, 0
 v_accvgpr_write_b32 a26, 0
 v_accvgpr_write_b32 a27, 0
 v_accvgpr_write_b32 a28, 0
 v_accvgpr_write_b32 a29, 0
 v_accvgpr_write_b32 a30, 0
 v_accvgpr_write_b32 a31, 0
 v_accvgpr_write_b32 a32, 0
 v_accvgpr_write_b32 a33, 0
 v_accvgpr_write_b32 a34, 0
 v_accvgpr_write_b32 a35, 0
 v_accvgpr_write_b32 a36, 0
 v_accvgpr_write_b32 a37, 0
 v_accvgpr_write_b32 a38, 0
 v_accvgpr_write_b32 a39, 0
 v_accvgpr_write_b32 a40, 0
 v_accvgpr_write_b32 a41, 0
 v_accvgpr_write_b32 a42, 0
 v_accvgpr_write_b32 a43, 0
 v_accvgpr_write_b32 a44, 0
 v_accvgpr_write_b32 a45, 0
 v_accvgpr_write_b32 a46, 0
 v_accvgpr_write_b32 a47, 0
 v_accvgpr_write_b32 a48, 0
 v_accvgpr_write_b32 a49, 0
 v_accvgpr_write_b32 a50, 0
 v_accvgpr_write_b32 a51, 0
 v_accvgpr_write_b32 a52, 0
 v_accvgpr_write_b32 a53, 0
 v_accvgpr_write_b32 a54, 0
 v_accvgpr_write_b32 a55, 0
 v_accvgpr_write_b32 a56, 0
 v_accvgpr_write_b32 a57, 0
 v_accvgpr_write_b32 a58, 0
 v_accvgpr_write_b32 a59, 0
 v_accvgpr_write_b32 a60, 0
 v_accvgpr_write_b32 a61, 0
 v_accvgpr_write_b32 a62, 0
 v_accvgpr_write_b32 a63, 0
 v_accvgpr_write_b32 a64, 0
 v_accvgpr_write_b32 a65, 0
 v_accvgpr_write_b32 a66, 0
 v_accvgpr_write_b32 a67, 0
 v_accvgpr_write_b32 a68, 0
 v_accvgpr_write_b32 a69, 0
 v_accvgpr_write_b32 a70, 0
 v_accvgpr_write_b32 a71, 0
 s_add_u32 s63, s53, 0
 s_add_u32 m0, s62, 0
 s_nop 0
 buffer_load_dwordx4 v8, s[12:15], s63 offen lds
 s_add_u32 s63, s53, 73728
 s_add_u32 m0, s62, 1024
 s_nop 0
 buffer_load_dwordx4 v9, s[12:15], s63 offen lds
 s_add_u32 s63, s53, 147456
 s_add_u32 m0, s62, 2048
 s_nop 0
 buffer_load_dwordx4 v8, s[12:15], s63 offen lds
 s_add_u32 s63, s53, 221184
 s_add_u32 m0, s62, 3072
 s_nop 0
 buffer_load_dwordx4 v9, s[12:15], s63 offen lds
 s_add_u32 s63, s60, 0
 s_lshl_b32 m0, s54, 10
 s_add_u32 m0, m0, 16384
 s_nop 0
 buffer_load_dwordx4 v10, s[28:31], s63 offen lds
 s_add_u32 s63, s60, 0
 s_lshl_b32 m0, s54, 10
 s_add_u32 m0, m0, 20480
 s_nop 0
 buffer_load_dwordx4 v11, s[28:31], s63 offen lds
 s_add_u32 s63, s60, 0
 s_lshl_b32 m0, s54, 10
 s_add_u32 m0, m0, 24576
 s_nop 0
 buffer_load_dwordx4 v12, s[28:31], s63 offen lds
 s_add_u32 s63, s60, 0
 s_lshl_b32 m0, s54, 10
 s_add_u32 m0, m0, 28672
 s_nop 0
 buffer_load_dwordx4 v13, s[28:31], s63 offen lds
 s_add_u32 s63, s60, 0
 s_and_b32 m0, s54, 1
 s_lshl_b32 m0, m0, 10
 s_add_u32 m0, m0, 32768
 s_nop 0
 buffer_load_dwordx4 v14, s[28:31], s63 offen lds
 s_add_u32 s63, s53, 128
 s_add_u32 m0, s62, 34816
 s_nop 0
 buffer_load_dwordx4 v8, s[12:15], s63 offen lds
 s_add_u32 s63, s53, 73856
 s_add_u32 m0, s62, 35840
 s_nop 0
 buffer_load_dwordx4 v9, s[12:15], s63 offen lds
 s_add_u32 s63, s53, 147584
 s_add_u32 m0, s62, 36864
 s_nop 0
 buffer_load_dwordx4 v8, s[12:15], s63 offen lds
 s_add_u32 s63, s53, 221312
 s_add_u32 m0, s62, 37888
 s_nop 0
 buffer_load_dwordx4 v9, s[12:15], s63 offen lds
 s_add_u32 s63, s60, 73728
 s_lshl_b32 m0, s54, 10
 s_add_u32 m0, m0, 51200
 s_nop 0
 buffer_load_dwordx4 v10, s[28:31], s63 offen lds
 s_add_u32 s63, s60, 73728
 s_lshl_b32 m0, s54, 10
 s_add_u32 m0, m0, 55296
 s_nop 0
 buffer_load_dwordx4 v11, s[28:31], s63 offen lds
 s_add_u32 s63, s60, 73728
 s_lshl_b32 m0, s54, 10
 s_add_u32 m0, m0, 59392
 s_nop 0
 buffer_load_dwordx4 v12, s[28:31], s63 offen lds
 s_add_u32 s63, s60, 73728
 s_lshl_b32 m0, s54, 10
 s_add_u32 m0, m0, 63488
 s_nop 0
 buffer_load_dwordx4 v13, s[28:31], s63 offen lds
 s_add_u32 s63, s60, 73728
 s_and_b32 m0, s54, 1
 s_lshl_b32 m0, m0, 10
 s_add_u32 m0, m0, 67584
 s_nop 0
 buffer_load_dwordx4 v14, s[28:31], s63 offen lds
 s_add_u32 s63, s53, 256
 s_add_u32 m0, s62, 69632
 s_nop 0
 buffer_load_dwordx4 v8, s[12:15], s63 offen lds
 s_add_u32 s63, s53, 73984
 s_add_u32 m0, s62, 70656
 s_nop 0
 buffer_load_dwordx4 v9, s[12:15], s63 offen lds
 s_add_u32 s63, s53, 147712
 s_add_u32 m0, s62, 71680
 s_nop 0
 buffer_load_dwordx4 v8, s[12:15], s63 offen lds
 s_add_u32 s63, s53, 221440
 s_add_u32 m0, s62, 72704
 s_nop 0
 buffer_load_dwordx4 v9, s[12:15], s63 offen lds
 s_add_u32 s63, s60, 147456
 s_lshl_b32 m0, s54, 10
 s_add_u32 m0, m0, 86016
 s_nop 0
 buffer_load_dwordx4 v10, s[28:31], s63 offen lds
 s_add_u32 s63, s60, 147456
 s_lshl_b32 m0, s54, 10
 s_add_u32 m0, m0, 90112
 s_nop 0
 buffer_load_dwordx4 v11, s[28:31], s63 offen lds
 s_add_u32 s63, s60, 147456
 s_lshl_b32 m0, s54, 10
 s_add_u32 m0, m0, 94208
 s_nop 0
 buffer_load_dwordx4 v12, s[28:31], s63 offen lds
 s_add_u32 s63, s60, 147456
 s_lshl_b32 m0, s54, 10
 s_add_u32 m0, m0, 98304
 s_nop 0
 buffer_load_dwordx4 v13, s[28:31], s63 offen lds
 s_add_u32 s63, s60, 147456
 s_and_b32 m0, s54, 1
 s_lshl_b32 m0, m0, 10
 s_add_u32 m0, m0, 102400
 s_nop 0
 buffer_load_dwordx4 v14, s[28:31], s63 offen lds
 s_waitcnt vmcnt(18)
 s_barrier
 ds_read_b64 v[64:65], v16 offset:0
 ds_read_b64 v[66:67], v17 offset:0
 ds_read_b64 v[68:69], v16 offset:2048
 ds_read_b64 v[70:71], v17 offset:2048
 ds_read_b64_tr_b16 v[72:73], v32 offset:0
 ds_read_b64_tr_b16 v[74:75], v32 offset:4608
 ds_read_b64_tr_b16 v[76:77], v32 offset:32
 ds_read_b64_tr_b16 v[78:79], v32 offset:4640
 ds_read_b64_tr_b16 v[80:81], v32 offset:64
 ds_read_b64_tr_b16 v[82:83], v32 offset:4672
 ds_read_b64_tr_b16 v[84:85], v32 offset:96
 ds_read_b64_tr_b16 v[86:87], v32 offset:4704
 ds_read_b64_tr_b16 v[88:89], v32 offset:128
 ds_read_b64_tr_b16 v[90:91], v32 offset:4736
 ds_read_b64_tr_b16 v[92:93], v32 offset:160
 ds_read_b64_tr_b16 v[94:95], v32 offset:4768
 ds_read_b64_tr_b16 v[96:97], v32 offset:192
 ds_read_b64_tr_b16 v[98:99], v32 offset:4800
 ds_read_b64_tr_b16 v[100:101], v32 offset:224
 ds_read_b64_tr_b16 v[102:103], v32 offset:4832
 ds_read_b64_tr_b16 v[104:105], v32 offset:256
 ds_read_b64_tr_b16 v[106:107], v32 offset:4864
 s_waitcnt lgkmcnt(0)
 v_mfma_f32_16x16x32_bf16 a[0:3], v[72:75], v[64:67], a[0:3]
 ds_read_b64 v[108:109], v18 offset:0
 v_mfma_f32_16x16x32_bf16 a[4:7], v[72:75], v[68:71], a[4:7]
 ds_read_b64 v[110:111], v19 offset:0
 v_mfma_f32_16x16x32_bf16 a[8:11], v[76:79], v[64:67], a[8:11]
 ds_read_b64 v[112:113], v18 offset:2048
 v_mfma_f32_16x16x32_bf16 a[12:15], v[76:79], v[68:71], a[12:15]
 ds_read_b64 v[114:115], v19 offset:2048
 v_mfma_f32_16x16x32_bf16 a[16:19], v[80:83], v[64:67], a[16:19]
 ds_read_b64_tr_b16 v[116:117], v32 offset:9216
 ds_read_b64_tr_b16 v[118:119], v32 offset:13824
 v_mfma_f32_16x16x32_bf16 a[20:23], v[80:83], v[68:71], a[20:23]
 ds_read_b64_tr_b16 v[120:121], v32 offset:9248
 v_mfma_f32_16x16x32_bf16 a[24:27], v[84:87], v[64:67], a[24:27]
 ds_read_b64_tr_b16 v[122:123], v32 offset:13856
 v_mfma_f32_16x16x32_bf16 a[28:31], v[84:87], v[68:71], a[28:31]
 ds_read_b64_tr_b16 v[124:125], v32 offset:9280
 v_mfma_f32_16x16x32_bf16 a[32:35], v[88:91], v[64:67], a[32:35]
 ds_read_b64_tr_b16 v[126:127], v32 offset:13888
 ds_read_b64_tr_b16 v[128:129], v32 offset:9312
 v_mfma_f32_16x16x32_bf16 a[36:39], v[88:91], v[68:71], a[36:39]
 ds_read_b64_tr_b16 v[130:131], v32 offset:13920
 v_mfma_f32_16x16x32_bf16 a[40:43], v[92:95], v[64:67], a[40:43]
 ds_read_b64_tr_b16 v[132:133], v32 offset:9344
 v_mfma_f32_16x16x32_bf16 a[44:47], v[92:95], v[68:71], a[44:47]
 ds_read_b64_tr_b16 v[134:135], v32 offset:13952
 v_mfma_f32_16x16x32_bf16 a[48:51], v[96:99], v[64:67], a[48:51]
 ds_read_b64_tr_b16 v[136:137], v32 offset:9376
 v_mfma_f32_16x16x32_bf16 a[52:55], v[96:99], v[68:71], a[52:55]
 ds_read_b64_tr_b16 v[138:139], v32 offset:13984
 ds_read_b64_tr_b16 v[140:141], v32 offset:9408
 v_mfma_f32_16x16x32_bf16 a[56:59], v[100:103], v[64:67], a[56:59]
 ds_read_b64_tr_b16 v[142:143], v32 offset:14016
 v_mfma_f32_16x16x32_bf16 a[60:63], v[100:103], v[68:71], a[60:63]
 ds_read_b64_tr_b16 v[144:145], v32 offset:9440
 v_mfma_f32_16x16x32_bf16 a[64:67], v[104:107], v[64:67], a[64:67]
 ds_read_b64_tr_b16 v[146:147], v32 offset:14048
 v_mfma_f32_16x16x32_bf16 a[68:71], v[104:107], v[68:71], a[68:71]
 ds_read_b64_tr_b16 v[148:149], v32 offset:9472
 ds_read_b64_tr_b16 v[150:151], v32 offset:14080
 s_waitcnt lgkmcnt(0)
 s_waitcnt vmcnt(9)
 s_barrier
 v_mfma_f32_16x16x32_bf16 a[0:3], v[116:119], v[108:111], a[0:3]
 s_add_u32 s63, s53, 384
 s_add_u32 m0, s62, 0
 s_nop 0
 buffer_load_dwordx4 v8, s[12:15], s63 offen lds
 v_mfma_f32_16x16x32_bf16 a[4:7], v[116:119], v[112:115], a[4:7]
 s_add_u32 s63, s53, 74112
 s_add_u32 m0, s62, 1024
 s_nop 0
 buffer_load_dwordx4 v9, s[12:15], s63 offen lds
 s_add_u32 s63, s53, 147840
 s_add_u32 m0, s62, 2048
 s_nop 0
 buffer_load_dwordx4 v8, s[12:15], s63 offen lds
 v_mfma_f32_16x16x32_bf16 a[8:11], v[120:123], v[108:111], a[8:11]
 s_add_u32 s63, s53, 221568
 s_add_u32 m0, s62, 3072
 s_nop 0
 buffer_load_dwordx4 v9, s[12:15], s63 offen lds
 s_add_u32 s63, s60, 221184
 s_lshl_b32 m0, s54, 10
 s_add_u32 m0, m0, 16384
 s_nop 0
 buffer_load_dwordx4 v10, s[28:31], s63 offen lds
 v_mfma_f32_16x16x32_bf16 a[12:15], v[120:123], v[112:115], a[12:15]
 s_add_u32 s63, s60, 221184
 s_lshl_b32 m0, s54, 10
 s_add_u32 m0, m0, 20480
 s_nop 0
 buffer_load_dwordx4 v11, s[28:31], s63 offen lds
 v_mfma_f32_16x16x32_bf16 a[16:19], v[124:127], v[108:111], a[16:19]
 s_add_u32 s63, s60, 221184
 s_lshl_b32 m0, s54, 10
 s_add_u32 m0, m0, 24576
 s_nop 0
 buffer_load_dwordx4 v12, s[28:31], s63 offen lds
 s_add_u32 s63, s60, 221184
 s_lshl_b32 m0, s54, 10
 s_add_u32 m0, m0, 28672
 s_nop 0
 buffer_load_dwordx4 v13, s[28:31], s63 offen lds
 v_mfma_f32_16x16x32_bf16 a[20:23], v[124:127], v[112:115], a[20:23]
 s_add_u32 s63, s60, 221184
 s_and_b32 m0, s54, 1
 s_lshl_b32 m0, m0, 10
 s_add_u32 m0, m0, 32768
 s_nop 0
 buffer_load_dwordx4 v14, s[28:31], s63 offen lds
 ds_read_b64 v[64:65], v20 offset:0
 v_mfma_f32_16x16x32_bf16 a[24:27], v[128:131], v[108:111], a[24:27]
 ds_read_b64 v[66:67], v21 offset:0
 ds_read_b64 v[68:69], v20 offset:2048
 v_mfma_f32_16x16x32_bf16 a[28:31], v[128:131], v[112:115], a[28:31]
 ds_read_b64 v[70:71], v21 offset:2048
 v_mfma_f32_16x16x32_bf16 a[32:35], v[132:135], v[108:111], a[32:35]
 ds_read_b64_tr_b16 v[72:73], v33 offset:0
 ds_read_b64_tr_b16 v[74:75], v33 offset:4608
 v_mfma_f32_16x16x32_bf16 a[36:39], v[132:135], v[112:115], a[36:39]
 ds_read_b64_tr_b16 v[76:77], v33 offset:32
 ds_read_b64_tr_b16 v[78:79], v33 offset:4640
 v_mfma_f32_16x16x32_bf16 a[40:43], v[136:139], v[108:111], a[40:43]
 ds_read_b64_tr_b16 v[80:81], v33 offset:64
 v_mfma_f32_16x16x32_bf16 a[44:47], v[136:139], v[112:115], a[44:47]
 ds_read_b64_tr_b16 v[82:83], v33 offset:4672
 ds_read_b64_tr_b16 v[84:85], v33 offset:96
 v_mfma_f32_16x16x32_bf16 a[48:51], v[140:143], v[108:111], a[48:51]
 ds_read_b64_tr_b16 v[86:87], v33 offset:4704
 ds_read_b64_tr_b16 v[88:89], v33 offset:128
 v_mfma_f32_16x16x32_bf16 a[52:55], v[140:143], v[112:115], a[52:55]
 ds_read_b64_tr_b16 v[90:91], v33 offset:4736
 ds_read_b64_tr_b16 v[92:93], v33 offset:160
 v_mfma_f32_16x16x32_bf16 a[56:59], v[144:147], v[108:111], a[56:59]
 ds_read_b64_tr_b16 v[94:95], v33 offset:4768
 v_mfma_f32_16x16x32_bf16 a[60:63], v[144:147], v[112:115], a[60:63]
 ds_read_b64_tr_b16 v[96:97], v33 offset:192
 ds_read_b64_tr_b16 v[98:99], v33 offset:4800
 v_mfma_f32_16x16x32_bf16 a[64:67], v[148:151], v[108:111], a[64:67]
 ds_read_b64_tr_b16 v[100:101], v33 offset:224
 ds_read_b64_tr_b16 v[102:103], v33 offset:4832
 v_mfma_f32_16x16x32_bf16 a[68:71], v[148:151], v[112:115], a[68:71]
 ds_read_b64_tr_b16 v[104:105], v33 offset:256
 ds_read_b64_tr_b16 v[106:107], v33 offset:4864
 s_waitcnt lgkmcnt(0)
 v_mfma_f32_16x16x32_bf16 a[0:3], v[72:75], v[64:67], a[0:3]
 ds_read_b64 v[108:109], v22 offset:0
 v_mfma_f32_16x16x32_bf16 a[4:7], v[72:75], v[68:71], a[4:7]
 ds_read_b64 v[110:111], v23 offset:0
 v_mfma_f32_16x16x32_bf16 a[8:11], v[76:79], v[64:67], a[8:11]
 ds_read_b64 v[112:113], v22 offset:2048
 v_mfma_f32_16x16x32_bf16 a[12:15], v[76:79], v[68:71], a[12:15]
 ds_read_b64 v[114:115], v23 offset:2048
 v_mfma_f32_16x16x32_bf16 a[16:19], v[80:83], v[64:67], a[16:19]
 ds_read_b64_tr_b16 v[116:117], v33 offset:9216
 ds_read_b64_tr_b16 v[118:119], v33 offset:13824
 v_mfma_f32_16x16x32_bf16 a[20:23], v[80:83], v[68:71], a[20:23]
 ds_read_b64_tr_b16 v[120:121], v33 offset:9248
 v_mfma_f32_16x16x32_bf16 a[24:27], v[84:87], v[64:67], a[24:27]
 ds_read_b64_tr_b16 v[122:123], v33 offset:13856
 v_mfma_f32_16x16x32_bf16 a[28:31], v[84:87], v[68:71], a[28:31]
 ds_read_b64_tr_b16 v[124:125], v33 offset:9280
 v_mfma_f32_16x16x32_bf16 a[32:35], v[88:91], v[64:67], a[32:35]
 ds_read_b64_tr_b16 v[126:127], v33 offset:13888
 ds_read_b64_tr_b16 v[128:129], v33 offset:9312
 v_mfma_f32_16x16x32_bf16 a[36:39], v[88:91], v[68:71], a[36:39]
 ds_read_b64_tr_b16 v[130:131], v33 offset:13920
 v_mfma_f32_16x16x32_bf16 a[40:43], v[92:95], v[64:67], a[40:43]
 ds_read_b64_tr_b16 v[132:133], v33 offset:9344
 v_mfma_f32_16x16x32_bf16 a[44:47], v[92:95], v[68:71], a[44:47]
 ds_read_b64_tr_b16 v[134:135], v33 offset:13952
 v_mfma_f32_16x16x32_bf16 a[48:51], v[96:99], v[64:67], a[48:51]
 ds_read_b64_tr_b16 v[136:137], v33 offset:9376
 v_mfma_f32_16x16x32_bf16 a[52:55], v[96:99], v[68:71], a[52:55]
 ds_read_b64_tr_b16 v[138:139], v33 offset:13984
 ds_read_b64_tr_b16 v[140:141], v33 offset:9408
 v_mfma_f32_16x16x32_bf16 a[56:59], v[100:103], v[64:67], a[56:59]
 ds_read_b64_tr_b16 v[142:143], v33 offset:14016
 v_mfma_f32_16x16x32_bf16 a[60:63], v[100:103], v[68:71], a[60:63]
 ds_read_b64_tr_b16 v[144:145], v33 offset:9440
 v_mfma_f32_16x16x32_bf16 a[64:67], v[104:107], v[64:67], a[64:67]
 ds_read_b64_tr_b16 v[146:147], v33 offset:14048
 v_mfma_f32_16x16x32_bf16 a[68:71], v[104:107], v[68:71], a[68:71]
 ds_read_b64_tr_b16 v[148:149], v33 offset:9472
 ds_read_b64_tr_b16 v[150:151], v33 offset:14080
 s_waitcnt lgkmcnt(0)
 s_waitcnt vmcnt(9)
 s_barrier
 v_mfma_f32_16x16x32_bf16 a[0:3], v[116:119], v[108:111], a[0:3]
 s_add_u32 s63, s53, 512
 s_add_u32 m0, s62, 34816
 s_nop 0
 buffer_load_dwordx4 v8, s[12:15], s63 offen lds
 v_mfma_f32_16x16x32_bf16 a[4:7], v[116:119], v[112:115], a[4:7]
 s_add_u32 s63, s53, 74240
 s_add_u32 m0, s62, 35840
 s_nop 0
 buffer_load_dwordx4 v9, s[12:15], s63 offen lds
 s_add_u32 s63, s53, 147968
 s_add_u32 m0, s62, 36864
 s_nop 0
 buffer_load_dwordx4 v8, s[12:15], s63 offen lds
 v_mfma_f32_16x16x32_bf16 a[8:11], v[120:123], v[108:111], a[8:11]
 s_add_u32 s63, s53, 221696
 s_add_u32 m0, s62, 37888
 s_nop 0
 buffer_load_dwordx4 v9, s[12:15], s63 offen lds
 s_add_u32 s63, s60, 294912
 s_lshl_b32 m0, s54, 10
 s_add_u32 m0, m0, 51200
 s_nop 0
 buffer_load_dwordx4 v10, s[28:31], s63 offen lds
 v_mfma_f32_16x16x32_bf16 a[12:15], v[120:123], v[112:115], a[12:15]
 s_add_u32 s63, s60, 294912
 s_lshl_b32 m0, s54, 10
 s_add_u32 m0, m0, 55296
 s_nop 0
 buffer_load_dwordx4 v11, s[28:31], s63 offen lds
 v_mfma_f32_16x16x32_bf16 a[16:19], v[124:127], v[108:111], a[16:19]
 s_add_u32 s63, s60, 294912
 s_lshl_b32 m0, s54, 10
 s_add_u32 m0, m0, 59392
 s_nop 0
 buffer_load_dwordx4 v12, s[28:31], s63 offen lds
 s_add_u32 s63, s60, 294912
 s_lshl_b32 m0, s54, 10
 s_add_u32 m0, m0, 63488
 s_nop 0
 buffer_load_dwordx4 v13, s[28:31], s63 offen lds
 v_mfma_f32_16x16x32_bf16 a[20:23], v[124:127], v[112:115], a[20:23]
 s_add_u32 s63, s60, 294912
 s_and_b32 m0, s54, 1
 s_lshl_b32 m0, m0, 10
 s_add_u32 m0, m0, 67584
 s_nop 0
 buffer_load_dwordx4 v14, s[28:31], s63 offen lds
 ds_read_b64 v[64:65], v24 offset:0
 v_mfma_f32_16x16x32_bf16 a[24:27], v[128:131], v[108:111], a[24:27]
 ds_read_b64 v[66:67], v25 offset:0
 ds_read_b64 v[68:69], v24 offset:2048
 v_mfma_f32_16x16x32_bf16 a[28:31], v[128:131], v[112:115], a[28:31]
 ds_read_b64 v[70:71], v25 offset:2048
 v_mfma_f32_16x16x32_bf16 a[32:35], v[132:135], v[108:111], a[32:35]
 ds_read_b64_tr_b16 v[72:73], v34 offset:0
 ds_read_b64_tr_b16 v[74:75], v34 offset:4608
 v_mfma_f32_16x16x32_bf16 a[36:39], v[132:135], v[112:115], a[36:39]
 ds_read_b64_tr_b16 v[76:77], v34 offset:32
 ds_read_b64_tr_b16 v[78:79], v34 offset:4640
 v_mfma_f32_16x16x32_bf16 a[40:43], v[136:139], v[108:111], a[40:43]
 ds_read_b64_tr_b16 v[80:81], v34 offset:64
 v_mfma_f32_16x16x32_bf16 a[44:47], v[136:139], v[112:115], a[44:47]
 ds_read_b64_tr_b16 v[82:83], v34 offset:4672
 ds_read_b64_tr_b16 v[84:85], v34 offset:96
 v_mfma_f32_16x16x32_bf16 a[48:51], v[140:143], v[108:111], a[48:51]
 ds_read_b64_tr_b16 v[86:87], v34 offset:4704
 ds_read_b64_tr_b16 v[88:89], v34 offset:128
 v_mfma_f32_16x16x32_bf16 a[52:55], v[140:143], v[112:115], a[52:55]
 ds_read_b64_tr_b16 v[90:91], v34 offset:4736
 ds_read_b64_tr_b16 v[92:93], v34 offset:160
 v_mfma_f32_16x16x32_bf16 a[56:59], v[144:147], v[108:111], a[56:59]
 ds_read_b64_tr_b16 v[94:95], v34 offset:4768
 v_mfma_f32_16x16x32_bf16 a[60:63], v[144:147], v[112:115], a[60:63]
 ds_read_b64_tr_b16 v[96:97], v34 offset:192
 ds_read_b64_tr_b16 v[98:99], v34 offset:4800
 v_mfma_f32_16x16x32_bf16 a[64:67], v[148:151], v[108:111], a[64:67]
 ds_read_b64_tr_b16 v[100:101], v34 offset:224
 ds_read_b64_tr_b16 v[102:103], v34 offset:4832
 v_mfma_f32_16x16x32_bf16 a[68:71], v[148:151], v[112:115], a[68:71]
 ds_read_b64_tr_b16 v[104:105], v34 offset:256
 ds_read_b64_tr_b16 v[106:107], v34 offset:4864
 s_waitcnt lgkmcnt(0)
 v_mfma_f32_16x16x32_bf16 a[0:3], v[72:75], v[64:67], a[0:3]
 ds_read_b64 v[108:109], v26 offset:0
 v_mfma_f32_16x16x32_bf16 a[4:7], v[72:75], v[68:71], a[4:7]
 ds_read_b64 v[110:111], v27 offset:0
 v_mfma_f32_16x16x32_bf16 a[8:11], v[76:79], v[64:67], a[8:11]
 ds_read_b64 v[112:113], v26 offset:2048
 v_mfma_f32_16x16x32_bf16 a[12:15], v[76:79], v[68:71], a[12:15]
 ds_read_b64 v[114:115], v27 offset:2048
 v_mfma_f32_16x16x32_bf16 a[16:19], v[80:83], v[64:67], a[16:19]
 ds_read_b64_tr_b16 v[116:117], v34 offset:9216
 ds_read_b64_tr_b16 v[118:119], v34 offset:13824
 v_mfma_f32_16x16x32_bf16 a[20:23], v[80:83], v[68:71], a[20:23]
 ds_read_b64_tr_b16 v[120:121], v34 offset:9248
 v_mfma_f32_16x16x32_bf16 a[24:27], v[84:87], v[64:67], a[24:27]
 ds_read_b64_tr_b16 v[122:123], v34 offset:13856
 v_mfma_f32_16x16x32_bf16 a[28:31], v[84:87], v[68:71], a[28:31]
 ds_read_b64_tr_b16 v[124:125], v34 offset:9280
 v_mfma_f32_16x16x32_bf16 a[32:35], v[88:91], v[64:67], a[32:35]
 ds_read_b64_tr_b16 v[126:127], v34 offset:13888
 ds_read_b64_tr_b16 v[128:129], v34 offset:9312
 v_mfma_f32_16x16x32_bf16 a[36:39], v[88:91], v[68:71], a[36:39]
 ds_read_b64_tr_b16 v[130:131], v34 offset:13920
 v_mfma_f32_16x16x32_bf16 a[40:43], v[92:95], v[64:67], a[40:43]
 ds_read_b64_tr_b16 v[132:133], v34 offset:9344
 v_mfma_f32_16x16x32_bf16 a[44:47], v[92:95], v[68:71], a[44:47]
 ds_read_b64_tr_b16 v[134:135], v34 offset:13952
 v_mfma_f32_16x16x32_bf16 a[48:51], v[96:99], v[64:67], a[48:51]
 ds_read_b64_tr_b16 v[136:137], v34 offset:9376
 v_mfma_f32_16x16x32_bf16 a[52:55], v[96:99], v[68:71], a[52:55]
 ds_read_b64_tr_b16 v[138:139], v34 offset:13984
 ds_read_b64_tr_b16 v[140:141], v34 offset:9408
 v_mfma_f32_16x16x32_bf16 a[56:59], v[100:103], v[64:67], a[56:59]
 ds_read_b64_tr_b16 v[142:143], v34 offset:14016
 v_mfma_f32_16x16x32_bf16 a[60:63], v[100:103], v[68:71], a[60:63]
 ds_read_b64_tr_b16 v[144:145], v34 offset:9440
 v_mfma_f32_16x16x32_bf16 a[64:67], v[104:107], v[64:67], a[64:67]
 ds_read_b64_tr_b16 v[146:147], v34 offset:14048
 v_mfma_f32_16x16x32_bf16 a[68:71], v[104:107], v[68:71], a[68:71]
 ds_read_b64_tr_b16 v[148:149], v34 offset:9472
 ds_read_b64_tr_b16 v[150:151], v34 offset:14080
 s_waitcnt lgkmcnt(0)
 s_waitcnt vmcnt(9)
 s_barrier
 v_mfma_f32_16x16x32_bf16 a[0:3], v[116:119], v[108:111], a[0:3]
 s_add_u32 s63, s53, 640
 s_add_u32 m0, s62, 69632
 s_nop 0
 buffer_load_dwordx4 v8, s[12:15], s63 offen lds
 v_mfma_f32_16x16x32_bf16 a[4:7], v[116:119], v[112:115], a[4:7]
 s_add_u32 s63, s53, 74368
 s_add_u32 m0, s62, 70656
 s_nop 0
 buffer_load_dwordx4 v9, s[12:15], s63 offen lds
 s_add_u32 s63, s53, 148096
 s_add_u32 m0, s62, 71680
 s_nop 0
 buffer_load_dwordx4 v8, s[12:15], s63 offen lds
 v_mfma_f32_16x16x32_bf16 a[8:11], v[120:123], v[108:111], a[8:11]
 s_add_u32 s63, s53, 221824
 s_add_u32 m0, s62, 72704
 s_nop 0
 buffer_load_dwordx4 v9, s[12:15], s63 offen lds
 s_add_u32 s63, s60, 368640
 s_lshl_b32 m0, s54, 10
 s_add_u32 m0, m0, 86016
 s_nop 0
 buffer_load_dwordx4 v10, s[28:31], s63 offen lds
 v_mfma_f32_16x16x32_bf16 a[12:15], v[120:123], v[112:115], a[12:15]
 s_add_u32 s63, s60, 368640
 s_lshl_b32 m0, s54, 10
 s_add_u32 m0, m0, 90112
 s_nop 0
 buffer_load_dwordx4 v11, s[28:31], s63 offen lds
 v_mfma_f32_16x16x32_bf16 a[16:19], v[124:127], v[108:111], a[16:19]
 s_add_u32 s63, s60, 368640
 s_lshl_b32 m0, s54, 10
 s_add_u32 m0, m0, 94208
 s_nop 0
 buffer_load_dwordx4 v12, s[28:31], s63 offen lds
 s_add_u32 s63, s60, 368640
 s_lshl_b32 m0, s54, 10
 s_add_u32 m0, m0, 98304
 s_nop 0
 buffer_load_dwordx4 v13, s[28:31], s63 offen lds
 v_mfma_f32_16x16x32_bf16 a[20:23], v[124:127], v[112:115], a[20:23]
 s_add_u32 s63, s60, 368640
 s_and_b32 m0, s54, 1
 s_lshl_b32 m0, m0, 10
 s_add_u32 m0, m0, 102400
 s_nop 0
 buffer_load_dwordx4 v14, s[28:31], s63 offen lds
 ds_read_b64 v[64:65], v16 offset:0
 v_mfma_f32_16x16x32_bf16 a[24:27], v[128:131], v[108:111], a[24:27]
 ds_read_b64 v[66:67], v17 offset:0
 ds_read_b64 v[68:69], v16 offset:2048
 v_mfma_f32_16x16x32_bf16 a[28:31], v[128:131], v[112:115], a[28:31]
 ds_read_b64 v[70:71], v17 offset:2048
 v_mfma_f32_16x16x32_bf16 a[32:35], v[132:135], v[108:111], a[32:35]
 ds_read_b64_tr_b16 v[72:73], v32 offset:0
 ds_read_b64_tr_b16 v[74:75], v32 offset:4608
 v_mfma_f32_16x16x32_bf16 a[36:39], v[132:135], v[112:115], a[36:39]
 ds_read_b64_tr_b16 v[76:77], v32 offset:32
 ds_read_b64_tr_b16 v[78:79], v32 offset:4640
 v_mfma_f32_16x16x32_bf16 a[40:43], v[136:139], v[108:111], a[40:43]
 ds_read_b64_tr_b16 v[80:81], v32 offset:64
 v_mfma_f32_16x16x32_bf16 a[44:47], v[136:139], v[112:115], a[44:47]
 ds_read_b64_tr_b16 v[82:83], v32 offset:4672
 ds_read_b64_tr_b16 v[84:85], v32 offset:96
 v_mfma_f32_16x16x32_bf16 a[48:51], v[140:143], v[108:111], a[48:51]
 ds_read_b64_tr_b16 v[86:87], v32 offset:4704
 ds_read_b64_tr_b16 v[88:89], v32 offset:128
 v_mfma_f32_16x16x32_bf16 a[52:55], v[140:143], v[112:115], a[52:55]
 ds_read_b64_tr_b16 v[90:91], v32 offset:4736
 ds_read_b64_tr_b16 v[92:93], v32 offset:160
 v_mfma_f32_16x16x32_bf16 a[56:59], v[144:147], v[108:111], a[56:59]
 ds_read_b64_tr_b16 v[94:95], v32 offset:4768
 v_mfma_f32_16x16x32_bf16 a[60:63], v[144:147], v[112:115], a[60:63]
 ds_read_b64_tr_b16 v[96:97], v32 offset:192
 ds_read_b64_tr_b16 v[98:99], v32 offset:4800
 v_mfma_f32_16x16x32_bf16 a[64:67], v[148:151], v[108:111], a[64:67]
 ds_read_b64_tr_b16 v[100:101], v32 offset:224
 ds_read_b64_tr_b16 v[102:103], v32 offset:4832
 v_mfma_f32_16x16x32_bf16 a[68:71], v[148:151], v[112:115], a[68:71]
 ds_read_b64_tr_b16 v[104:105], v32 offset:256
 ds_read_b64_tr_b16 v[106:107], v32 offset:4864
 s_waitcnt lgkmcnt(0)
 v_mfma_f32_16x16x32_bf16 a[0:3], v[72:75], v[64:67], a[0:3]
 ds_read_b64 v[108:109], v18 offset:0
 v_mfma_f32_16x16x32_bf16 a[4:7], v[72:75], v[68:71], a[4:7]
 ds_read_b64 v[110:111], v19 offset:0
 v_mfma_f32_16x16x32_bf16 a[8:11], v[76:79], v[64:67], a[8:11]
 ds_read_b64 v[112:113], v18 offset:2048
 v_mfma_f32_16x16x32_bf16 a[12:15], v[76:79], v[68:71], a[12:15]
 ds_read_b64 v[114:115], v19 offset:2048
 v_mfma_f32_16x16x32_bf16 a[16:19], v[80:83], v[64:67], a[16:19]
 ds_read_b64_tr_b16 v[116:117], v32 offset:9216
 ds_read_b64_tr_b16 v[118:119], v32 offset:13824
 v_mfma_f32_16x16x32_bf16 a[20:23], v[80:83], v[68:71], a[20:23]
 ds_read_b64_tr_b16 v[120:121], v32 offset:9248
 v_mfma_f32_16x16x32_bf16 a[24:27], v[84:87], v[64:67], a[24:27]
 ds_read_b64_tr_b16 v[122:123], v32 offset:13856
 v_mfma_f32_16x16x32_bf16 a[28:31], v[84:87], v[68:71], a[28:31]
 ds_read_b64_tr_b16 v[124:125], v32 offset:9280
 v_mfma_f32_16x16x32_bf16 a[32:35], v[88:91], v[64:67], a[32:35]
 ds_read_b64_tr_b16 v[126:127], v32 offset:13888
 ds_read_b64_tr_b16 v[128:129], v32 offset:9312
 v_mfma_f32_16x16x32_bf16 a[36:39], v[88:91], v[68:71], a[36:39]
 ds_read_b64_tr_b16 v[130:131], v32 offset:13920
 v_mfma_f32_16x16x32_bf16 a[40:43], v[92:95], v[64:67], a[40:43]
 ds_read_b64_tr_b16 v[132:133], v32 offset:9344
 v_mfma_f32_16x16x32_bf16 a[44:47], v[92:95], v[68:71], a[44:47]
 ds_read_b64_tr_b16 v[134:135], v32 offset:13952
 v_mfma_f32_16x16x32_bf16 a[48:51], v[96:99], v[64:67], a[48:51]
 ds_read_b64_tr_b16 v[136:137], v32 offset:9376
 v_mfma_f32_16x16x32_bf16 a[52:55], v[96:99], v[68:71], a[52:55]
 ds_read_b64_tr_b16 v[138:139], v32 offset:13984
 ds_read_b64_tr_b16 v[140:141], v32 offset:9408
 v_mfma_f32_16x16x32_bf16 a[56:59], v[100:103], v[64:67], a[56:59]
 ds_read_b64_tr_b16 v[142:143], v32 offset:14016
 v_mfma_f32_16x16x32_bf16 a[60:63], v[100:103], v[68:71], a[60:63]
 ds_read_b64_tr_b16 v[144:145], v32 offset:9440
 v_mfma_f32_16x16x32_bf16 a[64:67], v[104:107], v[64:67], a[64:67]
 ds_read_b64_tr_b16 v[146:147], v32 offset:14048
 v_mfma_f32_16x16x32_bf16 a[68:71], v[104:107], v[68:71], a[68:71]
 ds_read_b64_tr_b16 v[148:149], v32 offset:9472
 ds_read_b64_tr_b16 v[150:151], v32 offset:14080
 s_waitcnt lgkmcnt(0)
 s_waitcnt vmcnt(9)
 s_barrier
 v_mfma_f32_16x16x32_bf16 a[0:3], v[116:119], v[108:111], a[0:3]
 s_add_u32 s63, s53, 768
 s_add_u32 m0, s62, 0
 s_nop 0
 buffer_load_dwordx4 v8, s[12:15], s63 offen lds
 v_mfma_f32_16x16x32_bf16 a[4:7], v[116:119], v[112:115], a[4:7]
 s_add_u32 s63, s53, 74496
 s_add_u32 m0, s62, 1024
 s_nop 0
 buffer_load_dwordx4 v9, s[12:15], s63 offen lds
 s_add_u32 s63, s53, 148224
 s_add_u32 m0, s62, 2048
 s_nop 0
 buffer_load_dwordx4 v8, s[12:15], s63 offen lds
 v_mfma_f32_16x16x32_bf16 a[8:11], v[120:123], v[108:111], a[8:11]
 s_add_u32 s63, s53, 221952
 s_add_u32 m0, s62, 3072
 s_nop 0
 buffer_load_dwordx4 v9, s[12:15], s63 offen lds
 s_add_u32 s63, s60, 442368
 s_lshl_b32 m0, s54, 10
 s_add_u32 m0, m0, 16384
 s_nop 0
 buffer_load_dwordx4 v10, s[28:31], s63 offen lds
 v_mfma_f32_16x16x32_bf16 a[12:15], v[120:123], v[112:115], a[12:15]
 s_add_u32 s63, s60, 442368
 s_lshl_b32 m0, s54, 10
 s_add_u32 m0, m0, 20480
 s_nop 0
 buffer_load_dwordx4 v11, s[28:31], s63 offen lds
 v_mfma_f32_16x16x32_bf16 a[16:19], v[124:127], v[108:111], a[16:19]
 s_add_u32 s63, s60, 442368
 s_lshl_b32 m0, s54, 10
 s_add_u32 m0, m0, 24576
 s_nop 0
 buffer_load_dwordx4 v12, s[28:31], s63 offen lds
 s_add_u32 s63, s60, 442368
 s_lshl_b32 m0, s54, 10
 s_add_u32 m0, m0, 28672
 s_nop 0
 buffer_load_dwordx4 v13, s[28:31], s63 offen lds
 v_mfma_f32_16x16x32_bf16 a[20:23], v[124:127], v[112:115], a[20:23]
 s_add_u32 s63, s60, 442368
 s_and_b32 m0, s54, 1
 s_lshl_b32 m0, m0, 10
 s_add_u32 m0, m0, 32768
 s_nop 0
 buffer_load_dwordx4 v14, s[28:31], s63 offen lds
 ds_read_b64 v[64:65], v20 offset:0
 v_mfma_f32_16x16x32_bf16 a[24:27], v[128:131], v[108:111], a[24:27]
 ds_read_b64 v[66:67], v21 offset:0
 ds_read_b64 v[68:69], v20 offset:2048
 v_mfma_f32_16x16x32_bf16 a[28:31], v[128:131], v[112:115], a[28:31]
 ds_read_b64 v[70:71], v21 offset:2048
 v_mfma_f32_16x16x32_bf16 a[32:35], v[132:135], v[108:111], a[32:35]
 ds_read_b64_tr_b16 v[72:73], v33 offset:0
 ds_read_b64_tr_b16 v[74:75], v33 offset:4608
 v_mfma_f32_16x16x32_bf16 a[36:39], v[132:135], v[112:115], a[36:39]
 ds_read_b64_tr_b16 v[76:77], v33 offset:32
 ds_read_b64_tr_b16 v[78:79], v33 offset:4640
 v_mfma_f32_16x16x32_bf16 a[40:43], v[136:139], v[108:111], a[40:43]
 ds_read_b64_tr_b16 v[80:81], v33 offset:64
 v_mfma_f32_16x16x32_bf16 a[44:47], v[136:139], v[112:115], a[44:47]
 ds_read_b64_tr_b16 v[82:83], v33 offset:4672
 ds_read_b64_tr_b16 v[84:85], v33 offset:96
 v_mfma_f32_16x16x32_bf16 a[48:51], v[140:143], v[108:111], a[48:51]
 ds_read_b64_tr_b16 v[86:87], v33 offset:4704
 ds_read_b64_tr_b16 v[88:89], v33 offset:128
 v_mfma_f32_16x16x32_bf16 a[52:55], v[140:143], v[112:115], a[52:55]
 ds_read_b64_tr_b16 v[90:91], v33 offset:4736
 ds_read_b64_tr_b16 v[92:93], v33 offset:160
 v_mfma_f32_16x16x32_bf16 a[56:59], v[144:147], v[108:111], a[56:59]
 ds_read_b64_tr_b16 v[94:95], v33 offset:4768
 v_mfma_f32_16x16x32_bf16 a[60:63], v[144:147], v[112:115], a[60:63]
 ds_read_b64_tr_b16 v[96:97], v33 offset:192
 ds_read_b64_tr_b16 v[98:99], v33 offset:4800
 v_mfma_f32_16x16x32_bf16 a[64:67], v[148:151], v[108:111], a[64:67]
 ds_read_b64_tr_b16 v[100:101], v33 offset:224
 ds_read_b64_tr_b16 v[102:103], v33 offset:4832
 v_mfma_f32_16x16x32_bf16 a[68:71], v[148:151], v[112:115], a[68:71]
 ds_read_b64_tr_b16 v[104:105], v33 offset:256
 ds_read_b64_tr_b16 v[106:107], v33 offset:4864
 s_waitcnt lgkmcnt(0)
 v_mfma_f32_16x16x32_bf16 a[0:3], v[72:75], v[64:67], a[0:3]
 ds_read_b64 v[108:109], v22 offset:0
 v_mfma_f32_16x16x32_bf16 a[4:7], v[72:75], v[68:71], a[4:7]
 ds_read_b64 v[110:111], v23 offset:0
 v_mfma_f32_16x16x32_bf16 a[8:11], v[76:79], v[64:67], a[8:11]
 ds_read_b64 v[112:113], v22 offset:2048
 v_mfma_f32_16x16x32_bf16 a[12:15], v[76:79], v[68:71], a[12:15]
 ds_read_b64 v[114:115], v23 offset:2048
 v_mfma_f32_16x16x32_bf16 a[16:19], v[80:83], v[64:67], a[16:19]
 ds_read_b64_tr_b16 v[116:117], v33 offset:9216
 ds_read_b64_tr_b16 v[118:119], v33 offset:13824
 v_mfma_f32_16x16x32_bf16 a[20:23], v[80:83], v[68:71], a[20:23]
 ds_read_b64_tr_b16 v[120:121], v33 offset:9248
 v_mfma_f32_16x16x32_bf16 a[24:27], v[84:87], v[64:67], a[24:27]
 ds_read_b64_tr_b16 v[122:123], v33 offset:13856
 v_mfma_f32_16x16x32_bf16 a[28:31], v[84:87], v[68:71], a[28:31]
 ds_read_b64_tr_b16 v[124:125], v33 offset:9280
 v_mfma_f32_16x16x32_bf16 a[32:35], v[88:91], v[64:67], a[32:35]
 ds_read_b64_tr_b16 v[126:127], v33 offset:13888
 ds_read_b64_tr_b16 v[128:129], v33 offset:9312
 v_mfma_f32_16x16x32_bf16 a[36:39], v[88:91], v[68:71], a[36:39]
 ds_read_b64_tr_b16 v[130:131], v33 offset:13920
 v_mfma_f32_16x16x32_bf16 a[40:43], v[92:95], v[64:67], a[40:43]
 ds_read_b64_tr_b16 v[132:133], v33 offset:9344
 v_mfma_f32_16x16x32_bf16 a[44:47], v[92:95], v[68:71], a[44:47]
 ds_read_b64_tr_b16 v[134:135], v33 offset:13952
 v_mfma_f32_16x16x32_bf16 a[48:51], v[96:99], v[64:67], a[48:51]
 ds_read_b64_tr_b16 v[136:137], v33 offset:9376
 v_mfma_f32_16x16x32_bf16 a[52:55], v[96:99], v[68:71], a[52:55]
 ds_read_b64_tr_b16 v[138:139], v33 offset:13984
 ds_read_b64_tr_b16 v[140:141], v33 offset:9408
 v_mfma_f32_16x16x32_bf16 a[56:59], v[100:103], v[64:67], a[56:59]
 ds_read_b64_tr_b16 v[142:143], v33 offset:14016
 v_mfma_f32_16x16x32_bf16 a[60:63], v[100:103], v[68:71], a[60:63]
 ds_read_b64_tr_b16 v[144:145], v33 offset:9440
 v_mfma_f32_16x16x32_bf16 a[64:67], v[104:107], v[64:67], a[64:67]
 ds_read_b64_tr_b16 v[146:147], v33 offset:14048
 v_mfma_f32_16x16x32_bf16 a[68:71], v[104:107], v[68:71], a[68:71]
 ds_read_b64_tr_b16 v[148:149], v33 offset:9472
 ds_read_b64_tr_b16 v[150:151], v33 offset:14080
 s_waitcnt lgkmcnt(0)
 s_waitcnt vmcnt(9)
 s_barrier
 v_mfma_f32_16x16x32_bf16 a[0:3], v[116:119], v[108:111], a[0:3]
 s_add_u32 s63, s53, 896
 s_add_u32 m0, s62, 34816
 s_nop 0
 buffer_load_dwordx4 v8, s[12:15], s63 offen lds
 v_mfma_f32_16x16x32_bf16 a[4:7], v[116:119], v[112:115], a[4:7]
 s_add_u32 s63, s53, 74624
 s_add_u32 m0, s62, 35840
 s_nop 0
 buffer_load_dwordx4 v9, s[12:15], s63 offen lds
 s_add_u32 s63, s53, 148352
 s_add_u32 m0, s62, 36864
 s_nop 0
 buffer_load_dwordx4 v8, s[12:15], s63 offen lds
 v_mfma_f32_16x16x32_bf16 a[8:11], v[120:123], v[108:111], a[8:11]
 s_add_u32 s63, s53, 222080
 s_add_u32 m0, s62, 37888
 s_nop 0
 buffer_load_dwordx4 v9, s[12:15], s63 offen lds
 s_add_u32 s63, s60, 516096
 s_lshl_b32 m0, s54, 10
 s_add_u32 m0, m0, 51200
 s_nop 0
 buffer_load_dwordx4 v10, s[28:31], s63 offen lds
 v_mfma_f32_16x16x32_bf16 a[12:15], v[120:123], v[112:115], a[12:15]
 s_add_u32 s63, s60, 516096
 s_lshl_b32 m0, s54, 10
 s_add_u32 m0, m0, 55296
 s_nop 0
 buffer_load_dwordx4 v11, s[28:31], s63 offen lds
 v_mfma_f32_16x16x32_bf16 a[16:19], v[124:127], v[108:111], a[16:19]
 s_add_u32 s63, s60, 516096
 s_lshl_b32 m0, s54, 10
 s_add_u32 m0, m0, 59392
 s_nop 0
 buffer_load_dwordx4 v12, s[28:31], s63 offen lds
 s_add_u32 s63, s60, 516096
 s_lshl_b32 m0, s54, 10
 s_add_u32 m0, m0, 63488
 s_nop 0
 buffer_load_dwordx4 v13, s[28:31], s63 offen lds
 v_mfma_f32_16x16x32_bf16 a[20:23], v[124:127], v[112:115], a[20:23]
 s_add_u32 s63, s60, 516096
 s_and_b32 m0, s54, 1
 s_lshl_b32 m0, m0, 10
 s_add_u32 m0, m0, 67584
 s_nop 0
 buffer_load_dwordx4 v14, s[28:31], s63 offen lds
 ds_read_b64 v[64:65], v24 offset:0
 v_mfma_f32_16x16x32_bf16 a[24:27], v[128:131], v[108:111], a[24:27]
 ds_read_b64 v[66:67], v25 offset:0
 ds_read_b64 v[68:69], v24 offset:2048
 v_mfma_f32_16x16x32_bf16 a[28:31], v[128:131], v[112:115], a[28:31]
 ds_read_b64 v[70:71], v25 offset:2048
 v_mfma_f32_16x16x32_bf16 a[32:35], v[132:135], v[108:111], a[32:35]
 ds_read_b64_tr_b16 v[72:73], v34 offset:0
 ds_read_b64_tr_b16 v[74:75], v34 offset:4608
 v_mfma_f32_16x16x32_bf16 a[36:39], v[132:135], v[112:115], a[36:39]
 ds_read_b64_tr_b16 v[76:77], v34 offset:32
 ds_read_b64_tr_b16 v[78:79], v34 offset:4640
 v_mfma_f32_16x16x32_bf16 a[40:43], v[136:139], v[108:111], a[40:43]
 ds_read_b64_tr_b16 v[80:81], v34 offset:64
 v_mfma_f32_16x16x32_bf16 a[44:47], v[136:139], v[112:115], a[44:47]
 ds_read_b64_tr_b16 v[82:83], v34 offset:4672
 ds_read_b64_tr_b16 v[84:85], v34 offset:96
 v_mfma_f32_16x16x32_bf16 a[48:51], v[140:143], v[108:111], a[48:51]
 ds_read_b64_tr_b16 v[86:87], v34 offset:4704
 ds_read_b64_tr_b16 v[88:89], v34 offset:128
 v_mfma_f32_16x16x32_bf16 a[52:55], v[140:143], v[112:115], a[52:55]
 ds_read_b64_tr_b16 v[90:91], v34 offset:4736
 ds_read_b64_tr_b16 v[92:93], v34 offset:160
 v_mfma_f32_16x16x32_bf16 a[56:59], v[144:147], v[108:111], a[56:59]
 ds_read_b64_tr_b16 v[94:95], v34 offset:4768
 v_mfma_f32_16x16x32_bf16 a[60:63], v[144:147], v[112:115], a[60:63]
 ds_read_b64_tr_b16 v[96:97], v34 offset:192
 ds_read_b64_tr_b16 v[98:99], v34 offset:4800
 v_mfma_f32_16x16x32_bf16 a[64:67], v[148:151], v[108:111], a[64:67]
 ds_read_b64_tr_b16 v[100:101], v34 offset:224
 ds_read_b64_tr_b16 v[102:103], v34 offset:4832
 v_mfma_f32_16x16x32_bf16 a[68:71], v[148:151], v[112:115], a[68:71]
 ds_read_b64_tr_b16 v[104:105], v34 offset:256
 ds_read_b64_tr_b16 v[106:107], v34 offset:4864
 s_waitcnt lgkmcnt(0)
 v_mfma_f32_16x16x32_bf16 a[0:3], v[72:75], v[64:67], a[0:3]
 ds_read_b64 v[108:109], v26 offset:0
 v_mfma_f32_16x16x32_bf16 a[4:7], v[72:75], v[68:71], a[4:7]
 ds_read_b64 v[110:111], v27 offset:0
 v_mfma_f32_16x16x32_bf16 a[8:11], v[76:79], v[64:67], a[8:11]
 ds_read_b64 v[112:113], v26 offset:2048
 v_mfma_f32_16x16x32_bf16 a[12:15], v[76:79], v[68:71], a[12:15]
 ds_read_b64 v[114:115], v27 offset:2048
 v_mfma_f32_16x16x32_bf16 a[16:19], v[80:83], v[64:67], a[16:19]
 ds_read_b64_tr_b16 v[116:117], v34 offset:9216
 ds_read_b64_tr_b16 v[118:119], v34 offset:13824
 v_mfma_f32_16x16x32_bf16 a[20:23], v[80:83], v[68:71], a[20:23]
 ds_read_b64_tr_b16 v[120:121], v34 offset:9248
 v_mfma_f32_16x16x32_bf16 a[24:27], v[84:87], v[64:67], a[24:27]
 ds_read_b64_tr_b16 v[122:123], v34 offset:13856
 v_mfma_f32_16x16x32_bf16 a[28:31], v[84:87], v[68:71], a[28:31]
 ds_read_b64_tr_b16 v[124:125], v34 offset:9280
 v_mfma_f32_16x16x32_bf16 a[32:35], v[88:91], v[64:67], a[32:35]
 ds_read_b64_tr_b16 v[126:127], v34 offset:13888
 ds_read_b64_tr_b16 v[128:129], v34 offset:9312
 v_mfma_f32_16x16x32_bf16 a[36:39], v[88:91], v[68:71], a[36:39]
 ds_read_b64_tr_b16 v[130:131], v34 offset:13920
 v_mfma_f32_16x16x32_bf16 a[40:43], v[92:95], v[64:67], a[40:43]
 ds_read_b64_tr_b16 v[132:133], v34 offset:9344
 v_mfma_f32_16x16x32_bf16 a[44:47], v[92:95], v[68:71], a[44:47]
 ds_read_b64_tr_b16 v[134:135], v34 offset:13952
 v_mfma_f32_16x16x32_bf16 a[48:51], v[96:99], v[64:67], a[48:51]
 ds_read_b64_tr_b16 v[136:137], v34 offset:9376
 v_mfma_f32_16x16x32_bf16 a[52:55], v[96:99], v[68:71], a[52:55]
 ds_read_b64_tr_b16 v[138:139], v34 offset:13984
 ds_read_b64_tr_b16 v[140:141], v34 offset:9408
 v_mfma_f32_16x16x32_bf16 a[56:59], v[100:103], v[64:67], a[56:59]
 ds_read_b64_tr_b16 v[142:143], v34 offset:14016
 v_mfma_f32_16x16x32_bf16 a[60:63], v[100:103], v[68:71], a[60:63]
 ds_read_b64_tr_b16 v[144:145], v34 offset:9440
 v_mfma_f32_16x16x32_bf16 a[64:67], v[104:107], v[64:67], a[64:67]
 ds_read_b64_tr_b16 v[146:147], v34 offset:14048
 v_mfma_f32_16x16x32_bf16 a[68:71], v[104:107], v[68:71], a[68:71]
 ds_read_b64_tr_b16 v[148:149], v34 offset:9472
 ds_read_b64_tr_b16 v[150:151], v34 offset:14080
 s_waitcnt lgkmcnt(0)
 s_waitcnt vmcnt(9)
 s_barrier
 v_mfma_f32_16x16x32_bf16 a[0:3], v[116:119], v[108:111], a[0:3]
 s_add_u32 s63, s53, 1024
 s_add_u32 m0, s62, 69632
 s_nop 0
 buffer_load_dwordx4 v8, s[12:15], s63 offen lds
 v_mfma_f32_16x16x32_bf16 a[4:7], v[116:119], v[112:115], a[4:7]
 s_add_u32 s63, s53, 74752
 s_add_u32 m0, s62, 70656
 s_nop 0
 buffer_load_dwordx4 v9, s[12:15], s63 offen lds
 s_add_u32 s63, s53, 148480
 s_add_u32 m0, s62, 71680
 s_nop 0
 buffer_load_dwordx4 v8, s[12:15], s63 offen lds
 v_mfma_f32_16x16x32_bf16 a[8:11], v[120:123], v[108:111], a[8:11]
 s_add_u32 s63, s53, 222208
 s_add_u32 m0, s62, 72704
 s_nop 0
 buffer_load_dwordx4 v9, s[12:15], s63 offen lds
 s_add_u32 s63, s60, 589824
 s_lshl_b32 m0, s54, 10
 s_add_u32 m0, m0, 86016
 s_nop 0
 buffer_load_dwordx4 v10, s[28:31], s63 offen lds
 v_mfma_f32_16x16x32_bf16 a[12:15], v[120:123], v[112:115], a[12:15]
 s_add_u32 s63, s60, 589824
 s_lshl_b32 m0, s54, 10
 s_add_u32 m0, m0, 90112
 s_nop 0
 buffer_load_dwordx4 v11, s[28:31], s63 offen lds
 v_mfma_f32_16x16x32_bf16 a[16:19], v[124:127], v[108:111], a[16:19]
 s_add_u32 s63, s60, 589824
 s_lshl_b32 m0, s54, 10
 s_add_u32 m0, m0, 94208
 s_nop 0
 buffer_load_dwordx4 v12, s[28:31], s63 offen lds
 s_add_u32 s63, s60, 589824
 s_lshl_b32 m0, s54, 10
 s_add_u32 m0, m0, 98304
 s_nop 0
 buffer_load_dwordx4 v13, s[28:31], s63 offen lds
 v_mfma_f32_16x16x32_bf16 a[20:23], v[124:127], v[112:115], a[20:23]
 s_add_u32 s63, s60, 589824
 s_and_b32 m0, s54, 1
 s_lshl_b32 m0, m0, 10
 s_add_u32 m0, m0, 102400
 s_nop 0
 buffer_load_dwordx4 v14, s[28:31], s63 offen lds
 ds_read_b64 v[64:65], v16 offset:0
 v_mfma_f32_16x16x32_bf16 a[24:27], v[128:131], v[108:111], a[24:27]
 ds_read_b64 v[66:67], v17 offset:0
 ds_read_b64 v[68:69], v16 offset:2048
 v_mfma_f32_16x16x32_bf16 a[28:31], v[128:131], v[112:115], a[28:31]
 ds_read_b64 v[70:71], v17 offset:2048
 v_mfma_f32_16x16x32_bf16 a[32:35], v[132:135], v[108:111], a[32:35]
 ds_read_b64_tr_b16 v[72:73], v32 offset:0
 ds_read_b64_tr_b16 v[74:75], v32 offset:4608
 v_mfma_f32_16x16x32_bf16 a[36:39], v[132:135], v[112:115], a[36:39]
 ds_read_b64_tr_b16 v[76:77], v32 offset:32
 ds_read_b64_tr_b16 v[78:79], v32 offset:4640
 v_mfma_f32_16x16x32_bf16 a[40:43], v[136:139], v[108:111], a[40:43]
 ds_read_b64_tr_b16 v[80:81], v32 offset:64
 v_mfma_f32_16x16x32_bf16 a[44:47], v[136:139], v[112:115], a[44:47]
 ds_read_b64_tr_b16 v[82:83], v32 offset:4672
 ds_read_b64_tr_b16 v[84:85], v32 offset:96
 v_mfma_f32_16x16x32_bf16 a[48:51], v[140:143], v[108:111], a[48:51]
 ds_read_b64_tr_b16 v[86:87], v32 offset:4704
 ds_read_b64_tr_b16 v[88:89], v32 offset:128
 v_mfma_f32_16x16x32_bf16 a[52:55], v[140:143], v[112:115], a[52:55]
 ds_read_b64_tr_b16 v[90:91], v32 offset:4736
 ds_read_b64_tr_b16 v[92:93], v32 offset:160
 v_mfma_f32_16x16x32_bf16 a[56:59], v[144:147], v[108:111], a[56:59]
 ds_read_b64_tr_b16 v[94:95], v32 offset:4768
 v_mfma_f32_16x16x32_bf16 a[60:63], v[144:147], v[112:115], a[60:63]
 ds_read_b64_tr_b16 v[96:97], v32 offset:192
 ds_read_b64_tr_b16 v[98:99], v32 offset:4800
 v_mfma_f32_16x16x32_bf16 a[64:67], v[148:151], v[108:111], a[64:67]
 ds_read_b64_tr_b16 v[100:101], v32 offset:224
 ds_read_b64_tr_b16 v[102:103], v32 offset:4832
 v_mfma_f32_16x16x32_bf16 a[68:71], v[148:151], v[112:115], a[68:71]
 ds_read_b64_tr_b16 v[104:105], v32 offset:256
 ds_read_b64_tr_b16 v[106:107], v32 offset:4864
 s_waitcnt lgkmcnt(0)
 v_mfma_f32_16x16x32_bf16 a[0:3], v[72:75], v[64:67], a[0:3]
 ds_read_b64 v[108:109], v18 offset:0
 v_mfma_f32_16x16x32_bf16 a[4:7], v[72:75], v[68:71], a[4:7]
 ds_read_b64 v[110:111], v19 offset:0
 v_mfma_f32_16x16x32_bf16 a[8:11], v[76:79], v[64:67], a[8:11]
 ds_read_b64 v[112:113], v18 offset:2048
 v_mfma_f32_16x16x32_bf16 a[12:15], v[76:79], v[68:71], a[12:15]
 ds_read_b64 v[114:115], v19 offset:2048
 v_mfma_f32_16x16x32_bf16 a[16:19], v[80:83], v[64:67], a[16:19]
 ds_read_b64_tr_b16 v[116:117], v32 offset:9216
 ds_read_b64_tr_b16 v[118:119], v32 offset:13824
 v_mfma_f32_16x16x32_bf16 a[20:23], v[80:83], v[68:71], a[20:23]
 ds_read_b64_tr_b16 v[120:121], v32 offset:9248
 v_mfma_f32_16x16x32_bf16 a[24:27], v[84:87], v[64:67], a[24:27]
 ds_read_b64_tr_b16 v[122:123], v32 offset:13856
 v_mfma_f32_16x16x32_bf16 a[28:31], v[84:87], v[68:71], a[28:31]
 ds_read_b64_tr_b16 v[124:125], v32 offset:9280
 v_mfma_f32_16x16x32_bf16 a[32:35], v[88:91], v[64:67], a[32:35]
 ds_read_b64_tr_b16 v[126:127], v32 offset:13888
 ds_read_b64_tr_b16 v[128:129], v32 offset:9312
 v_mfma_f32_16x16x32_bf16 a[36:39], v[88:91], v[68:71], a[36:39]
 ds_read_b64_tr_b16 v[130:131], v32 offset:13920
 v_mfma_f32_16x16x32_bf16 a[40:43], v[92:95], v[64:67], a[40:43]
 ds_read_b64_tr_b16 v[132:133], v32 offset:9344
 v_mfma_f32_16x16x32_bf16 a[44:47], v[92:95], v[68:71], a[44:47]
 ds_read_b64_tr_b16 v[134:135], v32 offset:13952
 v_mfma_f32_16x16x32_bf16 a[48:51], v[96:99], v[64:67], a[48:51]
 ds_read_b64_tr_b16 v[136:137], v32 offset:9376
 v_mfma_f32_16x16x32_bf16 a[52:55], v[96:99], v[68:71], a[52:55]
 ds_read_b64_tr_b16 v[138:139], v32 offset:13984
 ds_read_b64_tr_b16 v[140:141], v32 offset:9408
 v_mfma_f32_16x16x32_bf16 a[56:59], v[100:103], v[64:67], a[56:59]
 ds_read_b64_tr_b16 v[142:143], v32 offset:14016
 v_mfma_f32_16x16x32_bf16 a[60:63], v[100:103], v[68:71], a[60:63]
 ds_read_b64_tr_b16 v[144:145], v32 offset:9440
 v_mfma_f32_16x16x32_bf16 a[64:67], v[104:107], v[64:67], a[64:67]
 ds_read_b64_tr_b16 v[146:147], v32 offset:14048
 v_mfma_f32_16x16x32_bf16 a[68:71], v[104:107], v[68:71], a[68:71]
 ds_read_b64_tr_b16 v[148:149], v32 offset:9472
 ds_read_b64_tr_b16 v[150:151], v32 offset:14080
 s_waitcnt lgkmcnt(0)
 s_waitcnt vmcnt(9)
 s_barrier
 v_mfma_f32_16x16x32_bf16 a[0:3], v[116:119], v[108:111], a[0:3]
 ds_read_b64 v[64:65], v20 offset:0
 v_mfma_f32_16x16x32_bf16 a[4:7], v[116:119], v[112:115], a[4:7]
 ds_read_b64 v[66:67], v21 offset:0
 v_mfma_f32_16x16x32_bf16 a[8:11], v[120:123], v[108:111], a[8:11]
 ds_read_b64 v[68:69], v20 offset:2048
 v_mfma_f32_16x16x32_bf16 a[12:15], v[120:123], v[112:115], a[12:15]
 ds_read_b64 v[70:71], v21 offset:2048
 v_mfma_f32_16x16x32_bf16 a[16:19], v[124:127], v[108:111], a[16:19]
 ds_read_b64_tr_b16 v[72:73], v33 offset:0
 ds_read_b64_tr_b16 v[74:75], v33 offset:4608
 v_mfma_f32_16x16x32_bf16 a[20:23], v[124:127], v[112:115], a[20:23]
 ds_read_b64_tr_b16 v[76:77], v33 offset:32
 v_mfma_f32_16x16x32_bf16 a[24:27], v[128:131], v[108:111], a[24:27]
 ds_read_b64_tr_b16 v[78:79], v33 offset:4640
 v_mfma_f32_16x16x32_bf16 a[28:31], v[128:131], v[112:115], a[28:31]
 ds_read_b64_tr_b16 v[80:81], v33 offset:64
 v_mfma_f32_16x16x32_bf16 a[32:35], v[132:135], v[108:111], a[32:35]
 ds_read_b64_tr_b16 v[82:83], v33 offset:4672
 ds_read_b64_tr_b16 v[84:85], v33 offset:96
 v_mfma_f32_16x16x32_bf16 a[36:39], v[132:135], v[112:115], a[36:39]
 ds_read_b64_tr_b16 v[86:87], v33 offset:4704
 v_mfma_f32_16x16x32_bf16 a[40:43], v[136:139], v[108:111], a[40:43]
 ds_read_b64_tr_b16 v[88:89], v33 offset:128
 v_mfma_f32_16x16x32_bf16 a[44:47], v[136:139], v[112:115], a[44:47]
 ds_read_b64_tr_b16 v[90:91], v33 offset:4736
 v_mfma_f32_16x16x32_bf16 a[48:51], v[140:143], v[108:111], a[48:51]
 ds_read_b64_tr_b16 v[92:93], v33 offset:160
 v_mfma_f32_16x16x32_bf16 a[52:55], v[140:143], v[112:115], a[52:55]
 ds_read_b64_tr_b16 v[94:95], v33 offset:4768
 ds_read_b64_tr_b16 v[96:97], v33 offset:192
 v_mfma_f32_16x16x32_bf16 a[56:59], v[144:147], v[108:111], a[56:59]
 ds_read_b64_tr_b16 v[98:99], v33 offset:4800
 v_mfma_f32_16x16x32_bf16 a[60:63], v[144:147], v[112:115], a[60:63]
 ds_read_b64_tr_b16 v[100:101], v33 offset:224
 v_mfma_f32_16x16x32_bf16 a[64:67], v[148:151], v[108:111], a[64:67]
 ds_read_b64_tr_b16 v[102:103], v33 offset:4832
 v_mfma_f32_16x16x32_bf16 a[68:71], v[148:151], v[112:115], a[68:71]
 ds_read_b64_tr_b16 v[104:105], v33 offset:256
 ds_read_b64_tr_b16 v[106:107], v33 offset:4864
 s_waitcnt lgkmcnt(0)
 v_mfma_f32_16x16x32_bf16 a[0:3], v[72:75], v[64:67], a[0:3]
 ds_read_b64 v[108:109], v22 offset:0
 v_mfma_f32_16x16x32_bf16 a[4:7], v[72:75], v[68:71], a[4:7]
 ds_read_b64 v[110:111], v23 offset:0
 v_mfma_f32_16x16x32_bf16 a[8:11], v[76:79], v[64:67], a[8:11]
 ds_read_b64 v[112:113], v22 offset:2048
 v_mfma_f32_16x16x32_bf16 a[12:15], v[76:79], v[68:71], a[12:15]
 ds_read_b64 v[114:115], v23 offset:2048
 v_mfma_f32_16x16x32_bf16 a[16:19], v[80:83], v[64:67], a[16:19]
 ds_read_b64_tr_b16 v[116:117], v33 offset:9216
 ds_read_b64_tr_b16 v[118:119], v33 offset:13824
 v_mfma_f32_16x16x32_bf16 a[20:23], v[80:83], v[68:71], a[20:23]
 ds_read_b64_tr_b16 v[120:121], v33 offset:9248
 v_mfma_f32_16x16x32_bf16 a[24:27], v[84:87], v[64:67], a[24:27]
 ds_read_b64_tr_b16 v[122:123], v33 offset:13856
 v_mfma_f32_16x16x32_bf16 a[28:31], v[84:87], v[68:71], a[28:31]
 ds_read_b64_tr_b16 v[124:125], v33 offset:9280
 v_mfma_f32_16x16x32_bf16 a[32:35], v[88:91], v[64:67], a[32:35]
 ds_read_b64_tr_b16 v[126:127], v33 offset:13888
 ds_read_b64_tr_b16 v[128:129], v33 offset:9312
 v_mfma_f32_16x16x32_bf16 a[36:39], v[88:91], v[68:71], a[36:39]
 ds_read_b64_tr_b16 v[130:131], v33 offset:13920
 v_mfma_f32_16x16x32_bf16 a[40:43], v[92:95], v[64:67], a[40:43]
 ds_read_b64_tr_b16 v[132:133], v33 offset:9344
 v_mfma_f32_16x16x32_bf16 a[44:47], v[92:95], v[68:71], a[44:47]
 ds_read_b64_tr_b16 v[134:135], v33 offset:13952
 v_mfma_f32_16x16x32_bf16 a[48:51], v[96:99], v[64:67], a[48:51]
 ds_read_b64_tr_b16 v[136:137], v33 offset:9376
 v_mfma_f32_16x16x32_bf16 a[52:55], v[96:99], v[68:71], a[52:55]
 ds_read_b64_tr_b16 v[138:139], v33 offset:13984
 ds_read_b64_tr_b16 v[140:141], v33 offset:9408
 v_mfma_f32_16x16x32_bf16 a[56:59], v[100:103], v[64:67], a[56:59]
 ds_read_b64_tr_b16 v[142:143], v33 offset:14016
 v_mfma_f32_16x16x32_bf16 a[60:63], v[100:103], v[68:71], a[60:63]
 ds_read_b64_tr_b16 v[144:145], v33 offset:9440
 v_mfma_f32_16x16x32_bf16 a[64:67], v[104:107], v[64:67], a[64:67]
 ds_read_b64_tr_b16 v[146:147], v33 offset:14048
 v_mfma_f32_16x16x32_bf16 a[68:71], v[104:107], v[68:71], a[68:71]
 ds_read_b64_tr_b16 v[148:149], v33 offset:9472
 ds_read_b64_tr_b16 v[150:151], v33 offset:14080
 s_waitcnt lgkmcnt(0)
 s_waitcnt vmcnt(0)
 s_barrier
 v_mfma_f32_16x16x32_bf16 a[0:3], v[116:119], v[108:111], a[0:3]
 ds_read_b64 v[64:65], v24 offset:0
 v_mfma_f32_16x16x32_bf16 a[4:7], v[116:119], v[112:115], a[4:7]
 ds_read_b64 v[66:67], v25 offset:0
 v_mfma_f32_16x16x32_bf16 a[8:11], v[120:123], v[108:111], a[8:11]
 ds_read_b64 v[68:69], v24 offset:2048
 v_mfma_f32_16x16x32_bf16 a[12:15], v[120:123], v[112:115], a[12:15]
 ds_read_b64 v[70:71], v25 offset:2048
 v_mfma_f32_16x16x32_bf16 a[16:19], v[124:127], v[108:111], a[16:19]
 ds_read_b64_tr_b16 v[72:73], v34 offset:0
 ds_read_b64_tr_b16 v[74:75], v34 offset:4608
 v_mfma_f32_16x16x32_bf16 a[20:23], v[124:127], v[112:115], a[20:23]
 ds_read_b64_tr_b16 v[76:77], v34 offset:32
 v_mfma_f32_16x16x32_bf16 a[24:27], v[128:131], v[108:111], a[24:27]
 ds_read_b64_tr_b16 v[78:79], v34 offset:4640
 v_mfma_f32_16x16x32_bf16 a[28:31], v[128:131], v[112:115], a[28:31]
 ds_read_b64_tr_b16 v[80:81], v34 offset:64
 v_mfma_f32_16x16x32_bf16 a[32:35], v[132:135], v[108:111], a[32:35]
 ds_read_b64_tr_b16 v[82:83], v34 offset:4672
 ds_read_b64_tr_b16 v[84:85], v34 offset:96
 v_mfma_f32_16x16x32_bf16 a[36:39], v[132:135], v[112:115], a[36:39]
 ds_read_b64_tr_b16 v[86:87], v34 offset:4704
 v_mfma_f32_16x16x32_bf16 a[40:43], v[136:139], v[108:111], a[40:43]
 ds_read_b64_tr_b16 v[88:89], v34 offset:128
 v_mfma_f32_16x16x32_bf16 a[44:47], v[136:139], v[112:115], a[44:47]
 ds_read_b64_tr_b16 v[90:91], v34 offset:4736
 v_mfma_f32_16x16x32_bf16 a[48:51], v[140:143], v[108:111], a[48:51]
 ds_read_b64_tr_b16 v[92:93], v34 offset:160
 v_mfma_f32_16x16x32_bf16 a[52:55], v[140:143], v[112:115], a[52:55]
 ds_read_b64_tr_b16 v[94:95], v34 offset:4768
 ds_read_b64_tr_b16 v[96:97], v34 offset:192
 v_mfma_f32_16x16x32_bf16 a[56:59], v[144:147], v[108:111], a[56:59]
 ds_read_b64_tr_b16 v[98:99], v34 offset:4800
 v_mfma_f32_16x16x32_bf16 a[60:63], v[144:147], v[112:115], a[60:63]
 ds_read_b64_tr_b16 v[100:101], v34 offset:224
 v_mfma_f32_16x16x32_bf16 a[64:67], v[148:151], v[108:111], a[64:67]
 ds_read_b64_tr_b16 v[102:103], v34 offset:4832
 v_mfma_f32_16x16x32_bf16 a[68:71], v[148:151], v[112:115], a[68:71]
 ds_read_b64_tr_b16 v[104:105], v34 offset:256
 ds_read_b64_tr_b16 v[106:107], v34 offset:4864
 s_waitcnt lgkmcnt(0)
 v_mfma_f32_16x16x32_bf16 a[0:3], v[72:75], v[64:67], a[0:3]
 ds_read_b64 v[108:109], v26 offset:0
 v_mfma_f32_16x16x32_bf16 a[4:7], v[72:75], v[68:71], a[4:7]
 ds_read_b64 v[110:111], v27 offset:0
 v_mfma_f32_16x16x32_bf16 a[8:11], v[76:79], v[64:67], a[8:11]
 ds_read_b64 v[112:113], v26 offset:2048
 v_mfma_f32_16x16x32_bf16 a[12:15], v[76:79], v[68:71], a[12:15]
 ds_read_b64 v[114:115], v27 offset:2048
 v_mfma_f32_16x16x32_bf16 a[16:19], v[80:83], v[64:67], a[16:19]
 ds_read_b64_tr_b16 v[116:117], v34 offset:9216
 ds_read_b64_tr_b16 v[118:119], v34 offset:13824
 v_mfma_f32_16x16x32_bf16 a[20:23], v[80:83], v[68:71], a[20:23]
 ds_read_b64_tr_b16 v[120:121], v34 offset:9248
 v_mfma_f32_16x16x32_bf16 a[24:27], v[84:87], v[64:67], a[24:27]
 ds_read_b64_tr_b16 v[122:123], v34 offset:13856
 v_mfma_f32_16x16x32_bf16 a[28:31], v[84:87], v[68:71], a[28:31]
 ds_read_b64_tr_b16 v[124:125], v34 offset:9280
 v_mfma_f32_16x16x32_bf16 a[32:35], v[88:91], v[64:67], a[32:35]
 ds_read_b64_tr_b16 v[126:127], v34 offset:13888
 ds_read_b64_tr_b16 v[128:129], v34 offset:9312
 v_mfma_f32_16x16x32_bf16 a[36:39], v[88:91], v[68:71], a[36:39]
 ds_read_b64_tr_b16 v[130:131], v34 offset:13920
 v_mfma_f32_16x16x32_bf16 a[40:43], v[92:95], v[64:67], a[40:43]
 ds_read_b64_tr_b16 v[132:133], v34 offset:9344
 v_mfma_f32_16x16x32_bf16 a[44:47], v[92:95], v[68:71], a[44:47]
 ds_read_b64_tr_b16 v[134:135], v34 offset:13952
 v_mfma_f32_16x16x32_bf16 a[48:51], v[96:99], v[64:67], a[48:51]
 ds_read_b64_tr_b16 v[136:137], v34 offset:9376
 v_mfma_f32_16x16x32_bf16 a[52:55], v[96:99], v[68:71], a[52:55]
 ds_read_b64_tr_b16 v[138:139], v34 offset:13984
 ds_read_b64_tr_b16 v[140:141], v34 offset:9408
 v_mfma_f32_16x16x32_bf16 a[56:59], v[100:103], v[64:67], a[56:59]
 ds_read_b64_tr_b16 v[142:143], v34 offset:14016
 v_mfma_f32_16x16x32_bf16 a[60:63], v[100:103], v[68:71], a[60:63]
 ds_read_b64_tr_b16 v[144:145], v34 offset:9440
 v_mfma_f32_16x16x32_bf16 a[64:67], v[104:107], v[64:67], a[64:67]
 ds_read_b64_tr_b16 v[146:147], v34 offset:14048
 v_mfma_f32_16x16x32_bf16 a[68:71], v[104:107], v[68:71], a[68:71]
 ds_read_b64_tr_b16 v[148:149], v34 offset:9472
 ds_read_b64_tr_b16 v[150:151], v34 offset:14080
 s_waitcnt lgkmcnt(0)
 v_mfma_f32_16x16x32_bf16 a[0:3], v[116:119], v[108:111], a[0:3]
 v_mfma_f32_16x16x32_bf16 a[4:7], v[116:119], v[112:115], a[4:7]
 v_mfma_f32_16x16x32_bf16 a[8:11], v[120:123], v[108:111], a[8:11]
 v_mfma_f32_16x16x32_bf16 a[12:15], v[120:123], v[112:115], a[12:15]
 v_mfma_f32_16x16x32_bf16 a[16:19], v[124:127], v[108:111], a[16:19]
 v_mfma_f32_16x16x32_bf16 a[20:23], v[124:127], v[112:115], a[20:23]
 v_mfma_f32_16x16x32_bf16 a[24:27], v[128:131], v[108:111], a[24:27]
 v_mfma_f32_16x16x32_bf16 a[28:31], v[128:131], v[112:115], a[28:31]
 v_mfma_f32_16x16x32_bf16 a[32:35], v[132:135], v[108:111], a[32:35]
 v_mfma_f32_16x16x32_bf16 a[36:39], v[132:135], v[112:115], a[36:39]
 v_mfma_f32_16x16x32_bf16 a[40:43], v[136:139], v[108:111], a[40:43]
 v_mfma_f32_16x16x32_bf16 a[44:47], v[136:139], v[112:115], a[44:47]
 v_mfma_f32_16x16x32_bf16 a[48:51], v[140:143], v[108:111], a[48:51]
 v_mfma_f32_16x16x32_bf16 a[52:55], v[140:143], v[112:115], a[52:55]
 v_mfma_f32_16x16x32_bf16 a[56:59], v[144:147], v[108:111], a[56:59]
 v_mfma_f32_16x16x32_bf16 a[60:63], v[144:147], v[112:115], a[60:63]
 v_mfma_f32_16x16x32_bf16 a[64:67], v[148:151], v[108:111], a[64:67]
 v_mfma_f32_16x16x32_bf16 a[68:71], v[148:151], v[112:115], a[68:71]
 s_nop 7
 s_nop 7
 s_lshl_b32 s58, s54, 5
 s_lshl_b32 s59, s45, 7
 s_add_u32 s58, s58, s59
 v_add_u32 v5, s58, v4
 s_movk_i32 s59, 2304
 v_mul_lo_u32 v5, v5, s59
 v_lshl_add_u32 v5, v3, 4, v5
 s_mul_i32 s58, s46, 4718592
 s_add_u32 s50, s50, s58
 s_add_u32 s58, s50, 0
 v_accvgpr_read_b32 v64, a0
 v_accvgpr_read_b32 v65, a1
 v_accvgpr_read_b32 v66, a2
 v_accvgpr_read_b32 v67, a3
 buffer_store_dwordx4 v[64:67], v5, s[24:27], s58 offen offset:0 sc1
 v_accvgpr_read_b32 v72, a8
 v_accvgpr_read_b32 v73, a9
 v_accvgpr_read_b32 v74, a10
 v_accvgpr_read_b32 v75, a11
 buffer_store_dwordx4 v[72:75], v5, s[24:27], s58 offen offset:64 sc1
 v_accvgpr_read_b32 v80, a16
 v_accvgpr_read_b32 v81, a17
 v_accvgpr_read_b32 v82, a18
 v_accvgpr_read_b32 v83, a19
 buffer_store_dwordx4 v[80:83], v5, s[24:27], s58 offen offset:128 sc1
 v_accvgpr_read_b32 v88, a24
 v_accvgpr_read_b32 v89, a25
 v_accvgpr_read_b32 v90, a26
 v_accvgpr_read_b32 v91, a27
 buffer_store_dwordx4 v[88:91], v5, s[24:27], s58 offen offset:192 sc1
 v_accvgpr_read_b32 v64, a32
 v_accvgpr_read_b32 v65, a33
 v_accvgpr_read_b32 v66, a34
 v_accvgpr_read_b32 v67, a35
 buffer_store_dwordx4 v[64:67], v5, s[24:27], s58 offen offset:256 sc1
 v_accvgpr_read_b32 v72, a40
 v_accvgpr_read_b32 v73, a41
 v_accvgpr_read_b32 v74, a42
 v_accvgpr_read_b32 v75, a43
 buffer_store_dwordx4 v[72:75], v5, s[24:27], s58 offen offset:320 sc1
 v_accvgpr_read_b32 v80, a48
 v_accvgpr_read_b32 v81, a49
 v_accvgpr_read_b32 v82, a50
 v_accvgpr_read_b32 v83, a51
 buffer_store_dwordx4 v[80:83], v5, s[24:27], s58 offen offset:384 sc1
 v_accvgpr_read_b32 v88, a56
 v_accvgpr_read_b32 v89, a57
 v_accvgpr_read_b32 v90, a58
 v_accvgpr_read_b32 v91, a59
 buffer_store_dwordx4 v[88:91], v5, s[24:27], s58 offen offset:448 sc1
 v_accvgpr_read_b32 v64, a64
 v_accvgpr_read_b32 v65, a65
 v_accvgpr_read_b32 v66, a66
 v_accvgpr_read_b32 v67, a67
 buffer_store_dwordx4 v[64:67], v5, s[24:27], s58 offen offset:512 sc1
 s_add_u32 s58, s50, 36864
 v_accvgpr_read_b32 v68, a4
 v_accvgpr_read_b32 v69, a5
 v_accvgpr_read_b32 v70, a6
 v_accvgpr_read_b32 v71, a7
 buffer_store_dwordx4 v[68:71], v5, s[24:27], s58 offen offset:0 sc1
 v_accvgpr_read_b32 v76, a12
 v_accvgpr_read_b32 v77, a13
 v_accvgpr_read_b32 v78, a14
 v_accvgpr_read_b32 v79, a15
 buffer_store_dwordx4 v[76:79], v5, s[24:27], s58 offen offset:64 sc1
 v_accvgpr_read_b32 v84, a20
 v_accvgpr_read_b32 v85, a21
 v_accvgpr_read_b32 v86, a22
 v_accvgpr_read_b32 v87, a23
 buffer_store_dwordx4 v[84:87], v5, s[24:27], s58 offen offset:128 sc1
 v_accvgpr_read_b32 v92, a28
 v_accvgpr_read_b32 v93, a29
 v_accvgpr_read_b32 v94, a30
 v_accvgpr_read_b32 v95, a31
 buffer_store_dwordx4 v[92:95], v5, s[24:27], s58 offen offset:192 sc1
 v_accvgpr_read_b32 v68, a36
 v_accvgpr_read_b32 v69, a37
 v_accvgpr_read_b32 v70, a38
 v_accvgpr_read_b32 v71, a39
 buffer_store_dwordx4 v[68:71], v5, s[24:27], s58 offen offset:256 sc1
 v_accvgpr_read_b32 v76, a44
 v_accvgpr_read_b32 v77, a45
 v_accvgpr_read_b32 v78, a46
 v_accvgpr_read_b32 v79, a47
 buffer_store_dwordx4 v[76:79], v5, s[24:27], s58 offen offset:320 sc1
 v_accvgpr_read_b32 v84, a52
 v_accvgpr_read_b32 v85, a53
 v_accvgpr_read_b32 v86, a54
 v_accvgpr_read_b32 v87, a55
 buffer_store_dwordx4 v[84:87], v5, s[24:27], s58 offen offset:384 sc1
 v_accvgpr_read_b32 v92, a60
 v_accvgpr_read_b32 v93, a61
 v_accvgpr_read_b32 v94, a62
 v_accvgpr_read_b32 v95, a63
 buffer_store_dwordx4 v[92:95], v5, s[24:27], s58 offen offset:448 sc1
 v_accvgpr_read_b32 v68, a68
 v_accvgpr_read_b32 v69, a69
 v_accvgpr_read_b32 v70, a70
 v_accvgpr_read_b32 v71, a71
 buffer_store_dwordx4 v[68:71], v5, s[24:27], s58 offen offset:512 sc1
 s_branch mega_kernel_sig91
mega_kernel_bfin116:
 s_load_dwordx2 s[4:5], s[0:1], 104
 s_load_dwordx2 s[8:9], s[0:1], 120
 s_waitcnt lgkmcnt(0)
 s_mov_b32 s20, s4
 s_and_b32 s21, s5, 0xffff
 s_mov_b32 s22, 2359296
 s_mov_b32 s23, 0x00020000
 s_add_u32 s16, s8, 0
 s_addc_u32 s17, s9, 0
 s_and_b32 s17, s17, 0xffff
 s_mov_b32 s18, 13824
 s_mov_b32 s19, 0x00020000
 s_add_u32 s12, s8, 88080384
 s_addc_u32 s13, s9, 0
 s_and_b32 s13, s13, 0xffff
 s_mov_b32 s14, 2359296
 s_mov_b32 s15, 0x00020000
 s_add_u32 s28, s8, 225443840
 s_addc_u32 s29, s9, 0
 s_and_b32 s29, s29, 0xffff
 s_mov_b32 s30, 37748736
 s_mov_b32 s31, 0x00020000
 v_lshrrev_b32 v1, 5, v0
 s_lshl_b32 s32, s2, 3
 v_add_u32 v1, s32, v1
 s_movk_i32 s33, 1152
 v_mul_lo_u32 v4, v1, s33
 v_and_b32 v2, 31, v0
 v_lshl_add_u32 v1, v2, 2, v4
 v_lshlrev_b32 v3, 3, v2
 v_lshl_add_u32 v4, v4, 1, v3
 buffer_load_dword v8, v1, s[12:15], 0 offen offset:0
 buffer_load_dword v9, v1, s[12:15], 0 offen offset:128
 buffer_load_dword v10, v1, s[12:15], 0 offen offset:256
 buffer_load_dword v11, v1, s[12:15], 0 offen offset:384
 buffer_load_dword v12, v1, s[12:15], 0 offen offset:512
 buffer_load_dword v13, v1, s[12:15], 0 offen offset:640
 buffer_load_dword v14, v1, s[12:15], 0 offen offset:768
 buffer_load_dword v15, v1, s[12:15], 0 offen offset:896
 buffer_load_dword v16, v1, s[12:15], 0 offen offset:1024
 s_mov_b32 s41, 11520
 buffer_load_dwordx2 v[72:73], v3, s[16:19], s41 offen offset:0
 buffer_load_dwordx2 v[74:75], v3, s[16:19], s41 offen offset:256
 buffer_load_dwordx2 v[76:77], v3, s[16:19], s41 offen offset:512
 buffer_load_dwordx2 v[78:79], v3, s[16:19], s41 offen offset:768
 buffer_load_dwordx2 v[80:81], v3, s[16:19], s41 offen offset:1024
 buffer_load_dwordx2 v[82:83], v3, s[16:19], s41 offen offset:1280
 buffer_load_dwordx2 v[84:85], v3, s[16:19], s41 offen offset:1536
 buffer_load_dwordx2 v[86:87], v3, s[16:19], s41 offen offset:1792
 buffer_load_dwordx2 v[88:89], v3, s[16:19], s41 offen offset:2048
 s_mov_b32 s42, 0
 buffer_load_dwordx2 v[92:93], v4, s[28:31], s42 offen offset:0
 buffer_load_dwordx2 v[94:95], v4, s[28:31], s42 offen offset:256
 buffer_load_dwordx2 v[96:97], v4, s[28:31], s42 offen offset:512
 buffer_load_dwordx2 v[98:99], v4, s[28:31], s42 offen offset:768
 buffer_load_dwordx2 v[100:101], v4, s[28:31], s42 offen offset:1024
 buffer_load_dwordx2 v[102:103], v4, s[28:31], s42 offen offset:1280
 buffer_load_dwordx2 v[104:105], v4, s[28:31], s42 offen offset:1536
 buffer_load_dwordx2 v[106:107], v4, s[28:31], s42 offen offset:1792
 buffer_load_dwordx2 v[108:109], v4, s[28:31], s42 offen offset:2048
 s_mov_b32 s42, 4718592
 buffer_load_dwordx2 v[110:111], v4, s[28:31], s42 offen offset:0
 buffer_load_dwordx2 v[112:113], v4, s[28:31], s42 offen offset:256
 buffer_load_dwordx2 v[114:115], v4, s[28:31], s42 offen offset:512
 buffer_load_dwordx2 v[116:117], v4, s[28:31], s42 offen offset:768
 buffer_load_dwordx2 v[118:119], v4, s[28:31], s42 offen offset:1024
 buffer_load_dwordx2 v[120:121], v4, s[28:31], s42 offen offset:1280
 buffer_load_dwordx2 v[122:123], v4, s[28:31], s42 offen offset:1536
 buffer_load_dwordx2 v[124:125], v4, s[28:31], s42 offen offset:1792
 buffer_load_dwordx2 v[126:127], v4, s[28:31], s42 offen offset:2048
 s_mov_b32 s42, 9437184
 buffer_load_dwordx2 v[128:129], v4, s[28:31], s42 offen offset:0
 buffer_load_dwordx2 v[130:131], v4, s[28:31], s42 offen offset:256
 buffer_load_dwordx2 v[132:133], v4, s[28:31], s42 offen offset:512
 buffer_load_dwordx2 v[134:135], v4, s[28:31], s42 offen offset:768
 buffer_load_dwordx2 v[136:137], v4, s[28:31], s42 offen offset:1024
 buffer_load_dwordx2 v[138:139], v4, s[28:31], s42 offen offset:1280
 buffer_load_dwordx2 v[140:141], v4, s[28:31], s42 offen offset:1536
 buffer_load_dwordx2 v[142:143], v4, s[28:31], s42 offen offset:1792
 buffer_load_dwordx2 v[144:145], v4, s[28:31], s42 offen offset:2048
 s_mov_b32 s42, 14155776
 buffer_load_dwordx2 v[146:147], v4, s[28:31], s42 offen offset:0
 buffer_load_dwordx2 v[148:149], v4, s[28:31], s42 offen offset:256
 buffer_load_dwordx2 v[150:151], v4, s[28:31], s42 offen offset:512
 buffer_load_dwordx2 v[152:153], v4, s[28:31], s42 offen offset:768
 buffer_load_dwordx2 v[154:155], v4, s[28:31], s42 offen offset:1024
 buffer_load_dwordx2 v[156:157], v4, s[28:31], s42 offen offset:1280
 buffer_load_dwordx2 v[158:159], v4, s[28:31], s42 offen offset:1536
 buffer_load_dwordx2 v[160:161], v4, s[28:31], s42 offen offset:1792
 buffer_load_dwordx2 v[162:163], v4, s[28:31], s42 offen offset:2048
 s_mov_b32 s42, 18874368
 buffer_load_dwordx2 v[164:165], v4, s[28:31], s42 offen offset:0
 buffer_load_dwordx2 v[166:167], v4, s[28:31], s42 offen offset:256
 buffer_load_dwordx2 v[168:169], v4, s[28:31], s42 offen offset:512
 buffer_load_dwordx2 v[170:171], v4, s[28:31], s42 offen offset:768
 buffer_load_dwordx2 v[172:173], v4, s[28:31], s42 offen offset:1024
 buffer_load_dwordx2 v[174:175], v4, s[28:31], s42 offen offset:1280
 buffer_load_dwordx2 v[176:177], v4, s[28:31], s42 offen offset:1536
 buffer_load_dwordx2 v[178:179], v4, s[28:31], s42 offen offset:1792
 buffer_load_dwordx2 v[180:181], v4, s[28:31], s42 offen offset:2048
 s_mov_b32 s42, 23592960
 buffer_load_dwordx2 v[182:183], v4, s[28:31], s42 offen offset:0
 buffer_load_dwordx2 v[184:185], v4, s[28:31], s42 offen offset:256
 buffer_load_dwordx2 v[186:187], v4, s[28:31], s42 offen offset:512
 buffer_load_dwordx2 v[188:189], v4, s[28:31], s42 offen offset:768
 buffer_load_dwordx2 v[190:191], v4, s[28:31], s42 offen offset:1024
 buffer_load_dwordx2 v[192:193], v4, s[28:31], s42 offen offset:1280
 buffer_load_dwordx2 v[194:195], v4, s[28:31], s42 offen offset:1536
 buffer_load_dwordx2 v[196:197], v4, s[28:31], s42 offen offset:1792
 buffer_load_dwordx2 v[198:199], v4, s[28:31], s42 offen offset:2048
 s_mov_b32 s42, 28311552
 buffer_load_dwordx2 v[200:201], v4, s[28:31], s42 offen offset:0
 buffer_load_dwordx2 v[202:203], v4, s[28:31], s42 offen offset:256
 buffer_load_dwordx2 v[204:205], v4, s[28:31], s42 offen offset:512
 buffer_load_dwordx2 v[206:207], v4, s[28:31], s42 offen offset:768
 buffer_load_dwordx2 v[208:209], v4, s[28:31], s42 offen offset:1024
 buffer_load_dwordx2 v[210:211], v4, s[28:31], s42 offen offset:1280
 buffer_load_dwordx2 v[212:213], v4, s[28:31], s42 offen offset:1536
 buffer_load_dwordx2 v[214:215], v4, s[28:31], s42 offen offset:1792
 buffer_load_dwordx2 v[216:217], v4, s[28:31], s42 offen offset:2048
 s_mov_b32 s42, 33030144
 buffer_load_dwordx2 v[218:219], v4, s[28:31], s42 offen offset:0
 buffer_load_dwordx2 v[220:221], v4, s[28:31], s42 offen offset:256
 buffer_load_dwordx2 v[222:223], v4, s[28:31], s42 offen offset:512
 buffer_load_dwordx2 v[224:225], v4, s[28:31], s42 offen offset:768
 buffer_load_dwordx2 v[226:227], v4, s[28:31], s42 offen offset:1024
 buffer_load_dwordx2 v[228:229], v4, s[28:31], s42 offen offset:1280
 buffer_load_dwordx2 v[230:231], v4, s[28:31], s42 offen offset:1536
 buffer_load_dwordx2 v[232:233], v4, s[28:31], s42 offen offset:1792
 buffer_load_dwordx2 v[234:235], v4, s[28:31], s42 offen offset:2048
 s_waitcnt vmcnt(0)
 v_add_f32 v92, v92, v110
 v_add_f32 v93, v93, v111
 v_add_f32 v94, v94, v112
 v_add_f32 v95, v95, v113
 v_add_f32 v96, v96, v114
 v_add_f32 v97, v97, v115
 v_add_f32 v98, v98, v116
 v_add_f32 v99, v99, v117
 v_add_f32 v100, v100, v118
 v_add_f32 v101, v101, v119
 v_add_f32 v102, v102, v120
 v_add_f32 v103, v103, v121
 v_add_f32 v104, v104, v122
 v_add_f32 v105, v105, v123
 v_add_f32 v106, v106, v124
 v_add_f32 v107, v107, v125
 v_add_f32 v108, v108, v126
 v_add_f32 v109, v109, v127
 v_add_f32 v128, v128, v146
 v_add_f32 v129, v129, v147
 v_add_f32 v130, v130, v148
 v_add_f32 v131, v131, v149
 v_add_f32 v132, v132, v150
 v_add_f32 v133, v133, v151
 v_add_f32 v134, v134, v152
 v_add_f32 v135, v135, v153
 v_add_f32 v136, v136, v154
 v_add_f32 v137, v137, v155
 v_add_f32 v138, v138, v156
 v_add_f32 v139, v139, v157
 v_add_f32 v140, v140, v158
 v_add_f32 v141, v141, v159
 v_add_f32 v142, v142, v160
 v_add_f32 v143, v143, v161
 v_add_f32 v144, v144, v162
 v_add_f32 v145, v145, v163
 v_add_f32 v164, v164, v182
 v_add_f32 v165, v165, v183
 v_add_f32 v166, v166, v184
 v_add_f32 v167, v167, v185
 v_add_f32 v168, v168, v186
 v_add_f32 v169, v169, v187
 v_add_f32 v170, v170, v188
 v_add_f32 v171, v171, v189
 v_add_f32 v172, v172, v190
 v_add_f32 v173, v173, v191
 v_add_f32 v174, v174, v192
 v_add_f32 v175, v175, v193
 v_add_f32 v176, v176, v194
 v_add_f32 v177, v177, v195
 v_add_f32 v178, v178, v196
 v_add_f32 v179, v179, v197
 v_add_f32 v180, v180, v198
 v_add_f32 v181, v181, v199
 v_add_f32 v200, v200, v218
 v_add_f32 v201, v201, v219
 v_add_f32 v202, v202, v220
 v_add_f32 v203, v203, v221
 v_add_f32 v204, v204, v222
 v_add_f32 v205, v205, v223
 v_add_f32 v206, v206, v224
 v_add_f32 v207, v207, v225
 v_add_f32 v208, v208, v226
 v_add_f32 v209, v209, v227
 v_add_f32 v210, v210, v228
 v_add_f32 v211, v211, v229
 v_add_f32 v212, v212, v230
 v_add_f32 v213, v213, v231
 v_add_f32 v214, v214, v232
 v_add_f32 v215, v215, v233
 v_add_f32 v216, v216, v234
 v_add_f32 v217, v217, v235
 v_add_f32 v92, v92, v128
 v_add_f32 v93, v93, v129
 v_add_f32 v94, v94, v130
 v_add_f32 v95, v95, v131
 v_add_f32 v96, v96, v132
 v_add_f32 v97, v97, v133
 v_add_f32 v98, v98, v134
 v_add_f32 v99, v99, v135
 v_add_f32 v100, v100, v136
 v_add_f32 v101, v101, v137
 v_add_f32 v102, v102, v138
 v_add_f32 v103, v103, v139
 v_add_f32 v104, v104, v140
 v_add_f32 v105, v105, v141
 v_add_f32 v106, v106, v142
 v_add_f32 v107, v107, v143
 v_add_f32 v108, v108, v144
 v_add_f32 v109, v109, v145
 v_add_f32 v164, v164, v200
 v_add_f32 v165, v165, v201
 v_add_f32 v166, v166, v202
 v_add_f32 v167, v167, v203
 v_add_f32 v168, v168, v204
 v_add_f32 v169, v169, v205
 v_add_f32 v170, v170, v206
 v_add_f32 v171, v171, v207
 v_add_f32 v172, v172, v208
 v_add_f32 v173, v173, v209
 v_add_f32 v174, v174, v210
 v_add_f32 v175, v175, v211
 v_add_f32 v176, v176, v212
 v_add_f32 v177, v177, v213
 v_add_f32 v178, v178, v214
 v_add_f32 v179, v179, v215
 v_add_f32 v180, v180, v216
 v_add_f32 v181, v181, v217
 v_add_f32 v92, v92, v164
 v_add_f32 v93, v93, v165
 v_add_f32 v94, v94, v166
 v_add_f32 v95, v95, v167
 v_add_f32 v96, v96, v168
 v_add_f32 v97, v97, v169
 v_add_f32 v98, v98, v170
 v_add_f32 v99, v99, v171
 v_add_f32 v100, v100, v172
 v_add_f32 v101, v101, v173
 v_add_f32 v102, v102, v174
 v_add_f32 v103, v103, v175
 v_add_f32 v104, v104, v176
 v_add_f32 v105, v105, v177
 v_add_f32 v106, v106, v178
 v_add_f32 v107, v107, v179
 v_add_f32 v108, v108, v180
 v_add_f32 v109, v109, v181
 v_cvt_pk_bf16_f32 v110, v92, v93
 v_lshlrev_b32 v92, 16, v110
 v_and_b32 v93, 0xffff0000, v110
 v_mul_f32 v92, v92, v72
 v_mul_f32 v93, v93, v73
 v_cvt_pk_bf16_f32 v110, v92, v93
 v_lshlrev_b32 v92, 16, v110
 v_and_b32 v93, 0xffff0000, v110
 v_lshlrev_b32 v110, 16, v8
 v_and_b32 v111, 0xffff0000, v8
 v_add_f32 v92, v92, v110
 v_add_f32 v93, v93, v111
 v_cvt_pk_bf16_f32 v8, v92, v93
 v_cvt_pk_bf16_f32 v110, v94, v95
 v_lshlrev_b32 v94, 16, v110
 v_and_b32 v95, 0xffff0000, v110
 v_mul_f32 v94, v94, v74
 v_mul_f32 v95, v95, v75
 v_cvt_pk_bf16_f32 v110, v94, v95
 v_lshlrev_b32 v94, 16, v110
 v_and_b32 v95, 0xffff0000, v110
 v_lshlrev_b32 v110, 16, v9
 v_and_b32 v111, 0xffff0000, v9
 v_add_f32 v94, v94, v110
 v_add_f32 v95, v95, v111
 v_cvt_pk_bf16_f32 v9, v94, v95
 v_cvt_pk_bf16_f32 v110, v96, v97
 v_lshlrev_b32 v96, 16, v110
 v_and_b32 v97, 0xffff0000, v110
 v_mul_f32 v96, v96, v76
 v_mul_f32 v97, v97, v77
 v_cvt_pk_bf16_f32 v110, v96, v97
 v_lshlrev_b32 v96, 16, v110
 v_and_b32 v97, 0xffff0000, v110
 v_lshlrev_b32 v110, 16, v10
 v_and_b32 v111, 0xffff0000, v10
 v_add_f32 v96, v96, v110
 v_add_f32 v97, v97, v111
 v_cvt_pk_bf16_f32 v10, v96, v97
 v_cvt_pk_bf16_f32 v110, v98, v99
 v_lshlrev_b32 v98, 16, v110
 v_and_b32 v99, 0xffff0000, v110
 v_mul_f32 v98, v98, v78
 v_mul_f32 v99, v99, v79
 v_cvt_pk_bf16_f32 v110, v98, v99
 v_lshlrev_b32 v98, 16, v110
 v_and_b32 v99, 0xffff0000, v110
 v_lshlrev_b32 v110, 16, v11
 v_and_b32 v111, 0xffff0000, v11
 v_add_f32 v98, v98, v110
 v_add_f32 v99, v99, v111
 v_cvt_pk_bf16_f32 v11, v98, v99
 v_cvt_pk_bf16_f32 v110, v100, v101
 v_lshlrev_b32 v100, 16, v110
 v_and_b32 v101, 0xffff0000, v110
 v_mul_f32 v100, v100, v80
 v_mul_f32 v101, v101, v81
 v_cvt_pk_bf16_f32 v110, v100, v101
 v_lshlrev_b32 v100, 16, v110
 v_and_b32 v101, 0xffff0000, v110
 v_lshlrev_b32 v110, 16, v12
 v_and_b32 v111, 0xffff0000, v12
 v_add_f32 v100, v100, v110
 v_add_f32 v101, v101, v111
 v_cvt_pk_bf16_f32 v12, v100, v101
 v_cvt_pk_bf16_f32 v110, v102, v103
 v_lshlrev_b32 v102, 16, v110
 v_and_b32 v103, 0xffff0000, v110
 v_mul_f32 v102, v102, v82
 v_mul_f32 v103, v103, v83
 v_cvt_pk_bf16_f32 v110, v102, v103
 v_lshlrev_b32 v102, 16, v110
 v_and_b32 v103, 0xffff0000, v110
 v_lshlrev_b32 v110, 16, v13
 v_and_b32 v111, 0xffff0000, v13
 v_add_f32 v102, v102, v110
 v_add_f32 v103, v103, v111
 v_cvt_pk_bf16_f32 v13, v102, v103
 v_cvt_pk_bf16_f32 v110, v104, v105
 v_lshlrev_b32 v104, 16, v110
 v_and_b32 v105, 0xffff0000, v110
 v_mul_f32 v104, v104, v84
 v_mul_f32 v105, v105, v85
 v_cvt_pk_bf16_f32 v110, v104, v105
 v_lshlrev_b32 v104, 16, v110
 v_and_b32 v105, 0xffff0000, v110
 v_lshlrev_b32 v110, 16, v14
 v_and_b32 v111, 0xffff0000, v14
 v_add_f32 v104, v104, v110
 v_add_f32 v105, v105, v111
 v_cvt_pk_bf16_f32 v14, v104, v105
 v_cvt_pk_bf16_f32 v110, v106, v107
 v_lshlrev_b32 v106, 16, v110
 v_and_b32 v107, 0xffff0000, v110
 v_mul_f32 v106, v106, v86
 v_mul_f32 v107, v107, v87
 v_cvt_pk_bf16_f32 v110, v106, v107
 v_lshlrev_b32 v106, 16, v110
 v_and_b32 v107, 0xffff0000, v110
 v_lshlrev_b32 v110, 16, v15
 v_and_b32 v111, 0xffff0000, v15
 v_add_f32 v106, v106, v110
 v_add_f32 v107, v107, v111
 v_cvt_pk_bf16_f32 v15, v106, v107
 v_cvt_pk_bf16_f32 v110, v108, v109
 v_lshlrev_b32 v108, 16, v110
 v_and_b32 v109, 0xffff0000, v110
 v_mul_f32 v108, v108, v88
 v_mul_f32 v109, v109, v89
 v_cvt_pk_bf16_f32 v110, v108, v109
 v_lshlrev_b32 v108, 16, v110
 v_and_b32 v109, 0xffff0000, v110
 v_lshlrev_b32 v110, 16, v16
 v_and_b32 v111, 0xffff0000, v16
 v_add_f32 v108, v108, v110
 v_add_f32 v109, v109, v111
 v_cvt_pk_bf16_f32 v16, v108, v109
 buffer_store_dword v8, v1, s[20:23], 0 offen offset:0
 buffer_store_dword v9, v1, s[20:23], 0 offen offset:128
 buffer_store_dword v10, v1, s[20:23], 0 offen offset:256
 buffer_store_dword v11, v1, s[20:23], 0 offen offset:384
 buffer_store_dword v12, v1, s[20:23], 0 offen offset:512
 buffer_store_dword v13, v1, s[20:23], 0 offen offset:640
 buffer_store_dword v14, v1, s[20:23], 0 offen offset:768
 buffer_store_dword v15, v1, s[20:23], 0 offen offset:896
 buffer_store_dword v16, v1, s[20:23], 0 offen offset:1024
 s_branch mega_kernel_sig91
mega_kernel_bmod100:
 s_load_dwordx2 s[4:5], s[0:1], 88
 s_load_dwordx2 s[6:7], s[0:1], 96
 s_load_dwordx2 s[8:9], s[0:1], 120
 s_waitcnt lgkmcnt(0)
 s_mov_b32 s12, s4
 s_and_b32 s13, s5, 0xffff
 s_mov_b32 s14, 1152
 s_mov_b32 s15, 0x00020000
 s_mov_b32 s16, s6
 s_and_b32 s17, s7, 0xffff
 s_mov_b32 s18, 3981312
 s_mov_b32 s19, 0x00020000
 s_add_u32 s20, s8, 0
 s_addc_u32 s21, s9, 0
 s_and_b32 s21, s21, 0xffff
 s_mov_b32 s22, 13824
 s_mov_b32 s23, 0x00020000
 v_lshrrev_b32 v1, 6, v0
 v_and_b32 v2, 63, v0
 s_nop 0
 v_readfirstlane_b32 s24, v1
 s_mul_i32 s25, s24, 144
 v_add_u32 v3, s25, v2
 v_lshlrev_b32 v3, 1, v3
 buffer_load_ushort v10, v3, s[12:15], 0 offen
 buffer_load_ushort v11, v3, s[12:15], 0 offen offset:128
 buffer_load_ushort v12, v3, s[12:15], 0 offen offset:256
 s_lshl_b32 s26, s2, 8
 v_lshl_add_u32 v4, v2, 2, s26
 s_mul_i32 s27, s25, 6912
 s_waitcnt vmcnt(0)
 s_mov_b32 s30, 0xbfb8aa3b
 v_lshlrev_b32 v10, 16, v10
 v_mul_f32 v5, s30, v10
 v_exp_f32 v5, v5
 s_nop 0
 v_add_f32 v5, 1.0, v5
 v_rcp_f32 v6, v5
 s_nop 0
 v_mul_f32 v7, v10, v6
 v_fma_f32 v8, -v7, v5, v10
 v_fma_f32 v7, v8, v6, v7
 v_cvt_pk_bf16_f32 v7, v7, v7
 v_lshlrev_b32 v10, 16, v7
 v_lshlrev_b32 v11, 16, v11
 v_mul_f32 v5, s30, v11
 v_exp_f32 v5, v5
 s_nop 0
 v_add_f32 v5, 1.0, v5
 v_rcp_f32 v6, v5
 s_nop 0
 v_mul_f32 v7, v11, v6
 v_fma_f32 v8, -v7, v5, v11
 v_fma_f32 v7, v8, v6, v7
 v_cvt_pk_bf16_f32 v7, v7, v7
 v_lshlrev_b32 v11, 16, v7
 v_lshlrev_b32 v12, 16, v12
 v_mul_f32 v5, s30, v12
 v_exp_f32 v5, v5
 s_nop 0
 v_add_f32 v5, 1.0, v5
 v_rcp_f32 v6, v5
 s_nop 0
 v_mul_f32 v7, v12, v6
 v_fma_f32 v8, -v7, v5, v12
 v_fma_f32 v7, v8, v6, v7
 v_cvt_pk_bf16_f32 v7, v7, v7
 v_lshlrev_b32 v12, 16, v7
 v_mov_b32 v20, 0
 v_mov_b32 v21, 0
 s_add_u32 s28, s27, 0
 buffer_load_dword v32, v4, s[16:19], s28 offen
 s_add_u32 s28, s27, 6912
 buffer_load_dword v33, v4, s[16:19], s28 offen
 s_add_u32 s28, s27, 13824
 buffer_load_dword v34, v4, s[16:19], s28 offen
 s_add_u32 s28, s27, 20736
 buffer_load_dword v35, v4, s[16:19], s28 offen
 s_add_u32 s28, s27, 27648
 buffer_load_dword v36, v4, s[16:19], s28 offen
 s_add_u32 s28, s27, 34560
 buffer_load_dword v37, v4, s[16:19], s28 offen
 s_add_u32 s28, s27, 41472
 buffer_load_dword v38, v4, s[16:19], s28 offen
 s_add_u32 s28, s27, 48384
 buffer_load_dword v39, v4, s[16:19], s28 offen
 s_add_u32 s28, s27, 55296
 buffer_load_dword v40, v4, s[16:19], s28 offen
 s_add_u32 s28, s27, 62208
 buffer_load_dword v41, v4, s[16:19], s28 offen
 s_add_u32 s28, s27, 69120
 buffer_load_dword v42, v4, s[16:19], s28 offen
 s_add_u32 s28, s27, 76032
 buffer_load_dword v43, v4, s[16:19], s28 offen
 s_add_u32 s28, s27, 82944
 buffer_load_dword v44, v4, s[16:19], s28 offen
 s_add_u32 s28, s27, 89856
 buffer_load_dword v45, v4, s[16:19], s28 offen
 s_add_u32 s28, s27, 96768
 buffer_load_dword v46, v4, s[16:19], s28 offen
 s_add_u32 s28, s27, 103680
 buffer_load_dword v47, v4, s[16:19], s28 offen
 s_add_u32 s28, s27, 110592
 buffer_load_dword v48, v4, s[16:19], s28 offen
 s_add_u32 s28, s27, 117504
 buffer_load_dword v49, v4, s[16:19], s28 offen
 s_add_u32 s28, s27, 124416
 buffer_load_dword v50, v4, s[16:19], s28 offen
 s_add_u32 s28, s27, 131328
 buffer_load_dword v51, v4, s[16:19], s28 offen
 s_add_u32 s28, s27, 138240
 buffer_load_dword v52, v4, s[16:19], s28 offen
 s_add_u32 s28, s27, 145152
 buffer_load_dword v53, v4, s[16:19], s28 offen
 s_add_u32 s28, s27, 152064
 buffer_load_dword v54, v4, s[16:19], s28 offen
 s_add_u32 s28, s27, 158976
 buffer_load_dword v55, v4, s[16:19], s28 offen
 s_add_u32 s28, s27, 165888
 buffer_load_dword v56, v4, s[16:19], s28 offen
 s_add_u32 s28, s27, 172800
 buffer_load_dword v57, v4, s[16:19], s28 offen
 s_add_u32 s28, s27, 179712
 buffer_load_dword v58, v4, s[16:19], s28 offen
 s_add_u32 s28, s27, 186624
 buffer_load_dword v59, v4, s[16:19], s28 offen
 s_add_u32 s28, s27, 193536
 buffer_load_dword v60, v4, s[16:19], s28 offen
 s_add_u32 s28, s27, 200448
 buffer_load_dword v61, v4, s[16:19], s28 offen
 s_add_u32 s28, s27, 207360
 buffer_load_dword v62, v4, s[16:19], s28 offen
 s_add_u32 s28, s27, 214272
 buffer_load_dword v63, v4, s[16:19], s28 offen
 s_add_u32 s28, s27, 221184
 buffer_load_dword v64, v4, s[16:19], s28 offen
 s_add_u32 s28, s27, 228096
 buffer_load_dword v65, v4, s[16:19], s28 offen
 s_add_u32 s28, s27, 235008
 buffer_load_dword v66, v4, s[16:19], s28 offen
 s_add_u32 s28, s27, 241920
 buffer_load_dword v67, v4, s[16:19], s28 offen
 s_add_u32 s28, s27, 248832
 buffer_load_dword v68, v4, s[16:19], s28 offen
 s_add_u32 s28, s27, 255744
 buffer_load_dword v69, v4, s[16:19], s28 offen
 s_add_u32 s28, s27, 262656
 buffer_load_dword v70, v4, s[16:19], s28 offen
 s_add_u32 s28, s27, 269568
 buffer_load_dword v71, v4, s[16:19], s28 offen
 s_add_u32 s28, s27, 276480
 buffer_load_dword v72, v4, s[16:19], s28 offen
 s_add_u32 s28, s27, 283392
 buffer_load_dword v73, v4, s[16:19], s28 offen
 s_add_u32 s28, s27, 290304
 buffer_load_dword v74, v4, s[16:19], s28 offen
 s_add_u32 s28, s27, 297216
 buffer_load_dword v75, v4, s[16:19], s28 offen
 s_add_u32 s28, s27, 304128
 buffer_load_dword v76, v4, s[16:19], s28 offen
 s_add_u32 s28, s27, 311040
 buffer_load_dword v77, v4, s[16:19], s28 offen
 s_add_u32 s28, s27, 317952
 buffer_load_dword v78, v4, s[16:19], s28 offen
 s_add_u32 s28, s27, 324864
 buffer_load_dword v79, v4, s[16:19], s28 offen
 s_add_u32 s28, s27, 331776
 buffer_load_dword v80, v4, s[16:19], s28 offen
 s_add_u32 s28, s27, 338688
 buffer_load_dword v81, v4, s[16:19], s28 offen
 s_add_u32 s28, s27, 345600
 buffer_load_dword v82, v4, s[16:19], s28 offen
 s_add_u32 s28, s27, 352512
 buffer_load_dword v83, v4, s[16:19], s28 offen
 s_add_u32 s28, s27, 359424
 buffer_load_dword v84, v4, s[16:19], s28 offen
 s_add_u32 s28, s27, 366336
 buffer_load_dword v85, v4, s[16:19], s28 offen
 s_add_u32 s28, s27, 373248
 buffer_load_dword v86, v4, s[16:19], s28 offen
 s_add_u32 s28, s27, 380160
 buffer_load_dword v87, v4, s[16:19], s28 offen
 s_add_u32 s28, s27, 387072
 buffer_load_dword v88, v4, s[16:19], s28 offen
 s_add_u32 s28, s27, 393984
 buffer_load_dword v89, v4, s[16:19], s28 offen
 s_add_u32 s28, s27, 400896
 buffer_load_dword v90, v4, s[16:19], s28 offen
 s_add_u32 s28, s27, 407808
 buffer_load_dword v91, v4, s[16:19], s28 offen
 s_add_u32 s28, s27, 414720
 buffer_load_dword v92, v4, s[16:19], s28 offen
 s_add_u32 s28, s27, 421632
 buffer_load_dword v93, v4, s[16:19], s28 offen
 s_add_u32 s28, s27, 428544
 buffer_load_dword v94, v4, s[16:19], s28 offen
 s_add_u32 s28, s27, 435456
 buffer_load_dword v95, v4, s[16:19], s28 offen
 s_add_u32 s28, s27, 442368
 buffer_load_dword v96, v4, s[16:19], s28 offen
 s_add_u32 s28, s27, 449280
 buffer_load_dword v97, v4, s[16:19], s28 offen
 s_add_u32 s28, s27, 456192
 buffer_load_dword v98, v4, s[16:19], s28 offen
 s_add_u32 s28, s27, 463104
 buffer_load_dword v99, v4, s[16:19], s28 offen
 s_add_u32 s28, s27, 470016
 buffer_load_dword v100, v4, s[16:19], s28 offen
 s_add_u32 s28, s27, 476928
 buffer_load_dword v101, v4, s[16:19], s28 offen
 s_add_u32 s28, s27, 483840
 buffer_load_dword v102, v4, s[16:19], s28 offen
 s_add_u32 s28, s27, 490752
 buffer_load_dword v103, v4, s[16:19], s28 offen
 s_add_u32 s28, s27, 497664
 buffer_load_dword v104, v4, s[16:19], s28 offen
 s_add_u32 s28, s27, 504576
 buffer_load_dword v105, v4, s[16:19], s28 offen
 s_add_u32 s28, s27, 511488
 buffer_load_dword v106, v4, s[16:19], s28 offen
 s_add_u32 s28, s27, 518400
 buffer_load_dword v107, v4, s[16:19], s28 offen
 s_add_u32 s28, s27, 525312
 buffer_load_dword v108, v4, s[16:19], s28 offen
 s_add_u32 s28, s27, 532224
 buffer_load_dword v109, v4, s[16:19], s28 offen
 s_add_u32 s28, s27, 539136
 buffer_load_dword v110, v4, s[16:19], s28 offen
 s_add_u32 s28, s27, 546048
 buffer_load_dword v111, v4, s[16:19], s28 offen
 s_add_u32 s28, s27, 552960
 buffer_load_dword v112, v4, s[16:19], s28 offen
 s_add_u32 s28, s27, 559872
 buffer_load_dword v113, v4, s[16:19], s28 offen
 s_add_u32 s28, s27, 566784
 buffer_load_dword v114, v4, s[16:19], s28 offen
 s_add_u32 s28, s27, 573696
 buffer_load_dword v115, v4, s[16:19], s28 offen
 s_add_u32 s28, s27, 580608
 buffer_load_dword v116, v4, s[16:19], s28 offen
 s_add_u32 s28, s27, 587520
 buffer_load_dword v117, v4, s[16:19], s28 offen
 s_add_u32 s28, s27, 594432
 buffer_load_dword v118, v4, s[16:19], s28 offen
 s_add_u32 s28, s27, 601344
 buffer_load_dword v119, v4, s[16:19], s28 offen
 s_add_u32 s28, s27, 608256
 buffer_load_dword v120, v4, s[16:19], s28 offen
 s_add_u32 s28, s27, 615168
 buffer_load_dword v121, v4, s[16:19], s28 offen
 s_add_u32 s28, s27, 622080
 buffer_load_dword v122, v4, s[16:19], s28 offen
 s_add_u32 s28, s27, 628992
 buffer_load_dword v123, v4, s[16:19], s28 offen
 s_add_u32 s28, s27, 635904
 buffer_load_dword v124, v4, s[16:19], s28 offen
 s_add_u32 s28, s27, 642816
 buffer_load_dword v125, v4, s[16:19], s28 offen
 s_add_u32 s28, s27, 649728
 buffer_load_dword v126, v4, s[16:19], s28 offen
 s_add_u32 s28, s27, 656640
 buffer_load_dword v127, v4, s[16:19], s28 offen
 s_add_u32 s28, s27, 663552
 buffer_load_dword v128, v4, s[16:19], s28 offen
 s_add_u32 s28, s27, 670464
 buffer_load_dword v129, v4, s[16:19], s28 offen
 s_add_u32 s28, s27, 677376
 buffer_load_dword v130, v4, s[16:19], s28 offen
 s_add_u32 s28, s27, 684288
 buffer_load_dword v131, v4, s[16:19], s28 offen
 s_add_u32 s28, s27, 691200
 buffer_load_dword v132, v4, s[16:19], s28 offen
 s_add_u32 s28, s27, 698112
 buffer_load_dword v133, v4, s[16:19], s28 offen
 s_add_u32 s28, s27, 705024
 buffer_load_dword v134, v4, s[16:19], s28 offen
 s_add_u32 s28, s27, 711936
 buffer_load_dword v135, v4, s[16:19], s28 offen
 s_add_u32 s28, s27, 718848
 buffer_load_dword v136, v4, s[16:19], s28 offen
 s_add_u32 s28, s27, 725760
 buffer_load_dword v137, v4, s[16:19], s28 offen
 s_add_u32 s28, s27, 732672
 buffer_load_dword v138, v4, s[16:19], s28 offen
 s_add_u32 s28, s27, 739584
 buffer_load_dword v139, v4, s[16:19], s28 offen
 s_add_u32 s28, s27, 746496
 buffer_load_dword v140, v4, s[16:19], s28 offen
 s_add_u32 s28, s27, 753408
 buffer_load_dword v141, v4, s[16:19], s28 offen
 s_add_u32 s28, s27, 760320
 buffer_load_dword v142, v4, s[16:19], s28 offen
 s_add_u32 s28, s27, 767232
 buffer_load_dword v143, v4, s[16:19], s28 offen
 s_add_u32 s28, s27, 774144
 buffer_load_dword v144, v4, s[16:19], s28 offen
 s_add_u32 s28, s27, 781056
 buffer_load_dword v145, v4, s[16:19], s28 offen
 s_add_u32 s28, s27, 787968
 buffer_load_dword v146, v4, s[16:19], s28 offen
 s_add_u32 s28, s27, 794880
 buffer_load_dword v147, v4, s[16:19], s28 offen
 s_add_u32 s28, s27, 801792
 buffer_load_dword v148, v4, s[16:19], s28 offen
 s_add_u32 s28, s27, 808704
 buffer_load_dword v149, v4, s[16:19], s28 offen
 s_add_u32 s28, s27, 815616
 buffer_load_dword v150, v4, s[16:19], s28 offen
 s_add_u32 s28, s27, 822528
 buffer_load_dword v151, v4, s[16:19], s28 offen
 s_add_u32 s28, s27, 829440
 buffer_load_dword v152, v4, s[16:19], s28 offen
 s_add_u32 s28, s27, 836352
 buffer_load_dword v153, v4, s[16:19], s28 offen
 s_add_u32 s28, s27, 843264
 buffer_load_dword v154, v4, s[16:19], s28 offen
 s_add_u32 s28, s27, 850176
 buffer_load_dword v155, v4, s[16:19], s28 offen
 s_add_u32 s28, s27, 857088
 buffer_load_dword v156, v4, s[16:19], s28 offen
 s_add_u32 s28, s27, 864000
 buffer_load_dword v157, v4, s[16:19], s28 offen
 s_add_u32 s28, s27, 870912
 buffer_load_dword v158, v4, s[16:19], s28 offen
 s_add_u32 s28, s27, 877824
 buffer_load_dword v159, v4, s[16:19], s28 offen
 s_add_u32 s28, s27, 884736
 buffer_load_dword v160, v4, s[16:19], s28 offen
 s_add_u32 s28, s27, 891648
 buffer_load_dword v161, v4, s[16:19], s28 offen
 s_add_u32 s28, s27, 898560
 buffer_load_dword v162, v4, s[16:19], s28 offen
 s_add_u32 s28, s27, 905472
 buffer_load_dword v163, v4, s[16:19], s28 offen
 s_add_u32 s28, s27, 912384
 buffer_load_dword v164, v4, s[16:19], s28 offen
 s_add_u32 s28, s27, 919296
 buffer_load_dword v165, v4, s[16:19], s28 offen
 s_add_u32 s28, s27, 926208
 buffer_load_dword v166, v4, s[16:19], s28 offen
 s_add_u32 s28, s27, 933120
 buffer_load_dword v167, v4, s[16:19], s28 offen
 s_add_u32 s28, s27, 940032
 buffer_load_dword v168, v4, s[16:19], s28 offen
 s_add_u32 s28, s27, 946944
 buffer_load_dword v169, v4, s[16:19], s28 offen
 s_add_u32 s28, s27, 953856
 buffer_load_dword v170, v4, s[16:19], s28 offen
 s_add_u32 s28, s27, 960768
 buffer_load_dword v171, v4, s[16:19], s28 offen
 s_add_u32 s28, s27, 967680
 buffer_load_dword v172, v4, s[16:19], s28 offen
 s_add_u32 s28, s27, 974592
 buffer_load_dword v173, v4, s[16:19], s28 offen
 s_add_u32 s28, s27, 981504
 buffer_load_dword v174, v4, s[16:19], s28 offen
 s_add_u32 s28, s27, 988416
 buffer_load_dword v175, v4, s[16:19], s28 offen
 v_readlane_b32 s29, v10, 0
 s_waitcnt vmcnt(0)
 v_lshlrev_b32 v22, 16, v32
 v_and_b32 v23, 0xffff0000, v32
 v_fmac_f32 v20, s29, v22
 v_fmac_f32 v21, s29, v23
 v_readlane_b32 s29, v10, 1
 v_lshlrev_b32 v22, 16, v33
 v_and_b32 v23, 0xffff0000, v33
 v_fmac_f32 v20, s29, v22
 v_fmac_f32 v21, s29, v23
 v_readlane_b32 s29, v10, 2
 v_lshlrev_b32 v22, 16, v34
 v_and_b32 v23, 0xffff0000, v34
 v_fmac_f32 v20, s29, v22
 v_fmac_f32 v21, s29, v23
 v_readlane_b32 s29, v10, 3
 v_lshlrev_b32 v22, 16, v35
 v_and_b32 v23, 0xffff0000, v35
 v_fmac_f32 v20, s29, v22
 v_fmac_f32 v21, s29, v23
 v_readlane_b32 s29, v10, 4
 v_lshlrev_b32 v22, 16, v36
 v_and_b32 v23, 0xffff0000, v36
 v_fmac_f32 v20, s29, v22
 v_fmac_f32 v21, s29, v23
 v_readlane_b32 s29, v10, 5
 v_lshlrev_b32 v22, 16, v37
 v_and_b32 v23, 0xffff0000, v37
 v_fmac_f32 v20, s29, v22
 v_fmac_f32 v21, s29, v23
 v_readlane_b32 s29, v10, 6
 v_lshlrev_b32 v22, 16, v38
 v_and_b32 v23, 0xffff0000, v38
 v_fmac_f32 v20, s29, v22
 v_fmac_f32 v21, s29, v23
 v_readlane_b32 s29, v10, 7
 v_lshlrev_b32 v22, 16, v39
 v_and_b32 v23, 0xffff0000, v39
 v_fmac_f32 v20, s29, v22
 v_fmac_f32 v21, s29, v23
 v_readlane_b32 s29, v10, 8
 v_lshlrev_b32 v22, 16, v40
 v_and_b32 v23, 0xffff0000, v40
 v_fmac_f32 v20, s29, v22
 v_fmac_f32 v21, s29, v23
 v_readlane_b32 s29, v10, 9
 v_lshlrev_b32 v22, 16, v41
 v_and_b32 v23, 0xffff0000, v41
 v_fmac_f32 v20, s29, v22
 v_fmac_f32 v21, s29, v23
 v_readlane_b32 s29, v10, 10
 v_lshlrev_b32 v22, 16, v42
 v_and_b32 v23, 0xffff0000, v42
 v_fmac_f32 v20, s29, v22
 v_fmac_f32 v21, s29, v23
 v_readlane_b32 s29, v10, 11
 v_lshlrev_b32 v22, 16, v43
 v_and_b32 v23, 0xffff0000, v43
 v_fmac_f32 v20, s29, v22
 v_fmac_f32 v21, s29, v23
 v_readlane_b32 s29, v10, 12
 v_lshlrev_b32 v22, 16, v44
 v_and_b32 v23, 0xffff0000, v44
 v_fmac_f32 v20, s29, v22
 v_fmac_f32 v21, s29, v23
 v_readlane_b32 s29, v10, 13
 v_lshlrev_b32 v22, 16, v45
 v_and_b32 v23, 0xffff0000, v45
 v_fmac_f32 v20, s29, v22
 v_fmac_f32 v21, s29, v23
 v_readlane_b32 s29, v10, 14
 v_lshlrev_b32 v22, 16, v46
 v_and_b32 v23, 0xffff0000, v46
 v_fmac_f32 v20, s29, v22
 v_fmac_f32 v21, s29, v23
 v_readlane_b32 s29, v10, 15
 v_lshlrev_b32 v22, 16, v47
 v_and_b32 v23, 0xffff0000, v47
 v_fmac_f32 v20, s29, v22
 v_fmac_f32 v21, s29, v23
 v_readlane_b32 s29, v10, 16
 v_lshlrev_b32 v22, 16, v48
 v_and_b32 v23, 0xffff0000, v48
 v_fmac_f32 v20, s29, v22
 v_fmac_f32 v21, s29, v23
 v_readlane_b32 s29, v10, 17
 v_lshlrev_b32 v22, 16, v49
 v_and_b32 v23, 0xffff0000, v49
 v_fmac_f32 v20, s29, v22
 v_fmac_f32 v21, s29, v23
 v_readlane_b32 s29, v10, 18
 v_lshlrev_b32 v22, 16, v50
 v_and_b32 v23, 0xffff0000, v50
 v_fmac_f32 v20, s29, v22
 v_fmac_f32 v21, s29, v23
 v_readlane_b32 s29, v10, 19
 v_lshlrev_b32 v22, 16, v51
 v_and_b32 v23, 0xffff0000, v51
 v_fmac_f32 v20, s29, v22
 v_fmac_f32 v21, s29, v23
 v_readlane_b32 s29, v10, 20
 v_lshlrev_b32 v22, 16, v52
 v_and_b32 v23, 0xffff0000, v52
 v_fmac_f32 v20, s29, v22
 v_fmac_f32 v21, s29, v23
 v_readlane_b32 s29, v10, 21
 v_lshlrev_b32 v22, 16, v53
 v_and_b32 v23, 0xffff0000, v53
 v_fmac_f32 v20, s29, v22
 v_fmac_f32 v21, s29, v23
 v_readlane_b32 s29, v10, 22
 v_lshlrev_b32 v22, 16, v54
 v_and_b32 v23, 0xffff0000, v54
 v_fmac_f32 v20, s29, v22
 v_fmac_f32 v21, s29, v23
 v_readlane_b32 s29, v10, 23
 v_lshlrev_b32 v22, 16, v55
 v_and_b32 v23, 0xffff0000, v55
 v_fmac_f32 v20, s29, v22
 v_fmac_f32 v21, s29, v23
 v_readlane_b32 s29, v10, 24
 v_lshlrev_b32 v22, 16, v56
 v_and_b32 v23, 0xffff0000, v56
 v_fmac_f32 v20, s29, v22
 v_fmac_f32 v21, s29, v23
 v_readlane_b32 s29, v10, 25
 v_lshlrev_b32 v22, 16, v57
 v_and_b32 v23, 0xffff0000, v57
 v_fmac_f32 v20, s29, v22
 v_fmac_f32 v21, s29, v23
 v_readlane_b32 s29, v10, 26
 v_lshlrev_b32 v22, 16, v58
 v_and_b32 v23, 0xffff0000, v58
 v_fmac_f32 v20, s29, v22
 v_fmac_f32 v21, s29, v23
 v_readlane_b32 s29, v10, 27
 v_lshlrev_b32 v22, 16, v59
 v_and_b32 v23, 0xffff0000, v59
 v_fmac_f32 v20, s29, v22
 v_fmac_f32 v21, s29, v23
 v_readlane_b32 s29, v10, 28
 v_lshlrev_b32 v22, 16, v60
 v_and_b32 v23, 0xffff0000, v60
 v_fmac_f32 v20, s29, v22
 v_fmac_f32 v21, s29, v23
 v_readlane_b32 s29, v10, 29
 v_lshlrev_b32 v22, 16, v61
 v_and_b32 v23, 0xffff0000, v61
 v_fmac_f32 v20, s29, v22
 v_fmac_f32 v21, s29, v23
 v_readlane_b32 s29, v10, 30
 v_lshlrev_b32 v22, 16, v62
 v_and_b32 v23, 0xffff0000, v62
 v_fmac_f32 v20, s29, v22
 v_fmac_f32 v21, s29, v23
 v_readlane_b32 s29, v10, 31
 v_lshlrev_b32 v22, 16, v63
 v_and_b32 v23, 0xffff0000, v63
 v_fmac_f32 v20, s29, v22
 v_fmac_f32 v21, s29, v23
 v_readlane_b32 s29, v10, 32
 v_lshlrev_b32 v22, 16, v64
 v_and_b32 v23, 0xffff0000, v64
 v_fmac_f32 v20, s29, v22
 v_fmac_f32 v21, s29, v23
 v_readlane_b32 s29, v10, 33
 v_lshlrev_b32 v22, 16, v65
 v_and_b32 v23, 0xffff0000, v65
 v_fmac_f32 v20, s29, v22
 v_fmac_f32 v21, s29, v23
 v_readlane_b32 s29, v10, 34
 v_lshlrev_b32 v22, 16, v66
 v_and_b32 v23, 0xffff0000, v66
 v_fmac_f32 v20, s29, v22
 v_fmac_f32 v21, s29, v23
 v_readlane_b32 s29, v10, 35
 v_lshlrev_b32 v22, 16, v67
 v_and_b32 v23, 0xffff0000, v67
 v_fmac_f32 v20, s29, v22
 v_fmac_f32 v21, s29, v23
 v_readlane_b32 s29, v10, 36
 v_lshlrev_b32 v22, 16, v68
 v_and_b32 v23, 0xffff0000, v68
 v_fmac_f32 v20, s29, v22
 v_fmac_f32 v21, s29, v23
 v_readlane_b32 s29, v10, 37
 v_lshlrev_b32 v22, 16, v69
 v_and_b32 v23, 0xffff0000, v69
 v_fmac_f32 v20, s29, v22
 v_fmac_f32 v21, s29, v23
 v_readlane_b32 s29, v10, 38
 v_lshlrev_b32 v22, 16, v70
 v_and_b32 v23, 0xffff0000, v70
 v_fmac_f32 v20, s29, v22
 v_fmac_f32 v21, s29, v23
 v_readlane_b32 s29, v10, 39
 v_lshlrev_b32 v22, 16, v71
 v_and_b32 v23, 0xffff0000, v71
 v_fmac_f32 v20, s29, v22
 v_fmac_f32 v21, s29, v23
 v_readlane_b32 s29, v10, 40
 v_lshlrev_b32 v22, 16, v72
 v_and_b32 v23, 0xffff0000, v72
 v_fmac_f32 v20, s29, v22
 v_fmac_f32 v21, s29, v23
 v_readlane_b32 s29, v10, 41
 v_lshlrev_b32 v22, 16, v73
 v_and_b32 v23, 0xffff0000, v73
 v_fmac_f32 v20, s29, v22
 v_fmac_f32 v21, s29, v23
 v_readlane_b32 s29, v10, 42
 v_lshlrev_b32 v22, 16, v74
 v_and_b32 v23, 0xffff0000, v74
 v_fmac_f32 v20, s29, v22
 v_fmac_f32 v21, s29, v23
 v_readlane_b32 s29, v10, 43
 v_lshlrev_b32 v22, 16, v75
 v_and_b32 v23, 0xffff0000, v75
 v_fmac_f32 v20, s29, v22
 v_fmac_f32 v21, s29, v23
 v_readlane_b32 s29, v10, 44
 v_lshlrev_b32 v22, 16, v76
 v_and_b32 v23, 0xffff0000, v76
 v_fmac_f32 v20, s29, v22
 v_fmac_f32 v21, s29, v23
 v_readlane_b32 s29, v10, 45
 v_lshlrev_b32 v22, 16, v77
 v_and_b32 v23, 0xffff0000, v77
 v_fmac_f32 v20, s29, v22
 v_fmac_f32 v21, s29, v23
 v_readlane_b32 s29, v10, 46
 v_lshlrev_b32 v22, 16, v78
 v_and_b32 v23, 0xffff0000, v78
 v_fmac_f32 v20, s29, v22
 v_fmac_f32 v21, s29, v23
 v_readlane_b32 s29, v10, 47
 v_lshlrev_b32 v22, 16, v79
 v_and_b32 v23, 0xffff0000, v79
 v_fmac_f32 v20, s29, v22
 v_fmac_f32 v21, s29, v23
 v_readlane_b32 s29, v10, 48
 v_lshlrev_b32 v22, 16, v80
 v_and_b32 v23, 0xffff0000, v80
 v_fmac_f32 v20, s29, v22
 v_fmac_f32 v21, s29, v23
 v_readlane_b32 s29, v10, 49
 v_lshlrev_b32 v22, 16, v81
 v_and_b32 v23, 0xffff0000, v81
 v_fmac_f32 v20, s29, v22
 v_fmac_f32 v21, s29, v23
 v_readlane_b32 s29, v10, 50
 v_lshlrev_b32 v22, 16, v82
 v_and_b32 v23, 0xffff0000, v82
 v_fmac_f32 v20, s29, v22
 v_fmac_f32 v21, s29, v23
 v_readlane_b32 s29, v10, 51
 v_lshlrev_b32 v22, 16, v83
 v_and_b32 v23, 0xffff0000, v83
 v_fmac_f32 v20, s29, v22
 v_fmac_f32 v21, s29, v23
 v_readlane_b32 s29, v10, 52
 v_lshlrev_b32 v22, 16, v84
 v_and_b32 v23, 0xffff0000, v84
 v_fmac_f32 v20, s29, v22
 v_fmac_f32 v21, s29, v23
 v_readlane_b32 s29, v10, 53
 v_lshlrev_b32 v22, 16, v85
 v_and_b32 v23, 0xffff0000, v85
 v_fmac_f32 v20, s29, v22
 v_fmac_f32 v21, s29, v23
 v_readlane_b32 s29, v10, 54
 v_lshlrev_b32 v22, 16, v86
 v_and_b32 v23, 0xffff0000, v86
 v_fmac_f32 v20, s29, v22
 v_fmac_f32 v21, s29, v23
 v_readlane_b32 s29, v10, 55
 v_lshlrev_b32 v22, 16, v87
 v_and_b32 v23, 0xffff0000, v87
 v_fmac_f32 v20, s29, v22
 v_fmac_f32 v21, s29, v23
 v_readlane_b32 s29, v10, 56
 v_lshlrev_b32 v22, 16, v88
 v_and_b32 v23, 0xffff0000, v88
 v_fmac_f32 v20, s29, v22
 v_fmac_f32 v21, s29, v23
 v_readlane_b32 s29, v10, 57
 v_lshlrev_b32 v22, 16, v89
 v_and_b32 v23, 0xffff0000, v89
 v_fmac_f32 v20, s29, v22
 v_fmac_f32 v21, s29, v23
 v_readlane_b32 s29, v10, 58
 v_lshlrev_b32 v22, 16, v90
 v_and_b32 v23, 0xffff0000, v90
 v_fmac_f32 v20, s29, v22
 v_fmac_f32 v21, s29, v23
 v_readlane_b32 s29, v10, 59
 v_lshlrev_b32 v22, 16, v91
 v_and_b32 v23, 0xffff0000, v91
 v_fmac_f32 v20, s29, v22
 v_fmac_f32 v21, s29, v23
 v_readlane_b32 s29, v10, 60
 v_lshlrev_b32 v22, 16, v92
 v_and_b32 v23, 0xffff0000, v92
 v_fmac_f32 v20, s29, v22
 v_fmac_f32 v21, s29, v23
 v_readlane_b32 s29, v10, 61
 v_lshlrev_b32 v22, 16, v93
 v_and_b32 v23, 0xffff0000, v93
 v_fmac_f32 v20, s29, v22
 v_fmac_f32 v21, s29, v23
 v_readlane_b32 s29, v10, 62
 v_lshlrev_b32 v22, 16, v94
 v_and_b32 v23, 0xffff0000, v94
 v_fmac_f32 v20, s29, v22
 v_fmac_f32 v21, s29, v23
 v_readlane_b32 s29, v10, 63
 v_lshlrev_b32 v22, 16, v95
 v_and_b32 v23, 0xffff0000, v95
 v_fmac_f32 v20, s29, v22
 v_fmac_f32 v21, s29, v23
 v_readlane_b32 s29, v11, 0
 v_lshlrev_b32 v22, 16, v96
 v_and_b32 v23, 0xffff0000, v96
 v_fmac_f32 v20, s29, v22
 v_fmac_f32 v21, s29, v23
 v_readlane_b32 s29, v11, 1
 v_lshlrev_b32 v22, 16, v97
 v_and_b32 v23, 0xffff0000, v97
 v_fmac_f32 v20, s29, v22
 v_fmac_f32 v21, s29, v23
 v_readlane_b32 s29, v11, 2
 v_lshlrev_b32 v22, 16, v98
 v_and_b32 v23, 0xffff0000, v98
 v_fmac_f32 v20, s29, v22
 v_fmac_f32 v21, s29, v23
 v_readlane_b32 s29, v11, 3
 v_lshlrev_b32 v22, 16, v99
 v_and_b32 v23, 0xffff0000, v99
 v_fmac_f32 v20, s29, v22
 v_fmac_f32 v21, s29, v23
 v_readlane_b32 s29, v11, 4
 v_lshlrev_b32 v22, 16, v100
 v_and_b32 v23, 0xffff0000, v100
 v_fmac_f32 v20, s29, v22
 v_fmac_f32 v21, s29, v23
 v_readlane_b32 s29, v11, 5
 v_lshlrev_b32 v22, 16, v101
 v_and_b32 v23, 0xffff0000, v101
 v_fmac_f32 v20, s29, v22
 v_fmac_f32 v21, s29, v23
 v_readlane_b32 s29, v11, 6
 v_lshlrev_b32 v22, 16, v102
 v_and_b32 v23, 0xffff0000, v102
 v_fmac_f32 v20, s29, v22
 v_fmac_f32 v21, s29, v23
 v_readlane_b32 s29, v11, 7
 v_lshlrev_b32 v22, 16, v103
 v_and_b32 v23, 0xffff0000, v103
 v_fmac_f32 v20, s29, v22
 v_fmac_f32 v21, s29, v23
 v_readlane_b32 s29, v11, 8
 v_lshlrev_b32 v22, 16, v104
 v_and_b32 v23, 0xffff0000, v104
 v_fmac_f32 v20, s29, v22
 v_fmac_f32 v21, s29, v23
 v_readlane_b32 s29, v11, 9
 v_lshlrev_b32 v22, 16, v105
 v_and_b32 v23, 0xffff0000, v105
 v_fmac_f32 v20, s29, v22
 v_fmac_f32 v21, s29, v23
 v_readlane_b32 s29, v11, 10
 v_lshlrev_b32 v22, 16, v106
 v_and_b32 v23, 0xffff0000, v106
 v_fmac_f32 v20, s29, v22
 v_fmac_f32 v21, s29, v23
 v_readlane_b32 s29, v11, 11
 v_lshlrev_b32 v22, 16, v107
 v_and_b32 v23, 0xffff0000, v107
 v_fmac_f32 v20, s29, v22
 v_fmac_f32 v21, s29, v23
 v_readlane_b32 s29, v11, 12
 v_lshlrev_b32 v22, 16, v108
 v_and_b32 v23, 0xffff0000, v108
 v_fmac_f32 v20, s29, v22
 v_fmac_f32 v21, s29, v23
 v_readlane_b32 s29, v11, 13
 v_lshlrev_b32 v22, 16, v109
 v_and_b32 v23, 0xffff0000, v109
 v_fmac_f32 v20, s29, v22
 v_fmac_f32 v21, s29, v23
 v_readlane_b32 s29, v11, 14
 v_lshlrev_b32 v22, 16, v110
 v_and_b32 v23, 0xffff0000, v110
 v_fmac_f32 v20, s29, v22
 v_fmac_f32 v21, s29, v23
 v_readlane_b32 s29, v11, 15
 v_lshlrev_b32 v22, 16, v111
 v_and_b32 v23, 0xffff0000, v111
 v_fmac_f32 v20, s29, v22
 v_fmac_f32 v21, s29, v23
 v_readlane_b32 s29, v11, 16
 v_lshlrev_b32 v22, 16, v112
 v_and_b32 v23, 0xffff0000, v112
 v_fmac_f32 v20, s29, v22
 v_fmac_f32 v21, s29, v23
 v_readlane_b32 s29, v11, 17
 v_lshlrev_b32 v22, 16, v113
 v_and_b32 v23, 0xffff0000, v113
 v_fmac_f32 v20, s29, v22
 v_fmac_f32 v21, s29, v23
 v_readlane_b32 s29, v11, 18
 v_lshlrev_b32 v22, 16, v114
 v_and_b32 v23, 0xffff0000, v114
 v_fmac_f32 v20, s29, v22
 v_fmac_f32 v21, s29, v23
 v_readlane_b32 s29, v11, 19
 v_lshlrev_b32 v22, 16, v115
 v_and_b32 v23, 0xffff0000, v115
 v_fmac_f32 v20, s29, v22
 v_fmac_f32 v21, s29, v23
 v_readlane_b32 s29, v11, 20
 v_lshlrev_b32 v22, 16, v116
 v_and_b32 v23, 0xffff0000, v116
 v_fmac_f32 v20, s29, v22
 v_fmac_f32 v21, s29, v23
 v_readlane_b32 s29, v11, 21
 v_lshlrev_b32 v22, 16, v117
 v_and_b32 v23, 0xffff0000, v117
 v_fmac_f32 v20, s29, v22
 v_fmac_f32 v21, s29, v23
 v_readlane_b32 s29, v11, 22
 v_lshlrev_b32 v22, 16, v118
 v_and_b32 v23, 0xffff0000, v118
 v_fmac_f32 v20, s29, v22
 v_fmac_f32 v21, s29, v23
 v_readlane_b32 s29, v11, 23
 v_lshlrev_b32 v22, 16, v119
 v_and_b32 v23, 0xffff0000, v119
 v_fmac_f32 v20, s29, v22
 v_fmac_f32 v21, s29, v23
 v_readlane_b32 s29, v11, 24
 v_lshlrev_b32 v22, 16, v120
 v_and_b32 v23, 0xffff0000, v120
 v_fmac_f32 v20, s29, v22
 v_fmac_f32 v21, s29, v23
 v_readlane_b32 s29, v11, 25
 v_lshlrev_b32 v22, 16, v121
 v_and_b32 v23, 0xffff0000, v121
 v_fmac_f32 v20, s29, v22
 v_fmac_f32 v21, s29, v23
 v_readlane_b32 s29, v11, 26
 v_lshlrev_b32 v22, 16, v122
 v_and_b32 v23, 0xffff0000, v122
 v_fmac_f32 v20, s29, v22
 v_fmac_f32 v21, s29, v23
 v_readlane_b32 s29, v11, 27
 v_lshlrev_b32 v22, 16, v123
 v_and_b32 v23, 0xffff0000, v123
 v_fmac_f32 v20, s29, v22
 v_fmac_f32 v21, s29, v23
 v_readlane_b32 s29, v11, 28
 v_lshlrev_b32 v22, 16, v124
 v_and_b32 v23, 0xffff0000, v124
 v_fmac_f32 v20, s29, v22
 v_fmac_f32 v21, s29, v23
 v_readlane_b32 s29, v11, 29
 v_lshlrev_b32 v22, 16, v125
 v_and_b32 v23, 0xffff0000, v125
 v_fmac_f32 v20, s29, v22
 v_fmac_f32 v21, s29, v23
 v_readlane_b32 s29, v11, 30
 v_lshlrev_b32 v22, 16, v126
 v_and_b32 v23, 0xffff0000, v126
 v_fmac_f32 v20, s29, v22
 v_fmac_f32 v21, s29, v23
 v_readlane_b32 s29, v11, 31
 v_lshlrev_b32 v22, 16, v127
 v_and_b32 v23, 0xffff0000, v127
 v_fmac_f32 v20, s29, v22
 v_fmac_f32 v21, s29, v23
 v_readlane_b32 s29, v11, 32
 v_lshlrev_b32 v22, 16, v128
 v_and_b32 v23, 0xffff0000, v128
 v_fmac_f32 v20, s29, v22
 v_fmac_f32 v21, s29, v23
 v_readlane_b32 s29, v11, 33
 v_lshlrev_b32 v22, 16, v129
 v_and_b32 v23, 0xffff0000, v129
 v_fmac_f32 v20, s29, v22
 v_fmac_f32 v21, s29, v23
 v_readlane_b32 s29, v11, 34
 v_lshlrev_b32 v22, 16, v130
 v_and_b32 v23, 0xffff0000, v130
 v_fmac_f32 v20, s29, v22
 v_fmac_f32 v21, s29, v23
 v_readlane_b32 s29, v11, 35
 v_lshlrev_b32 v22, 16, v131
 v_and_b32 v23, 0xffff0000, v131
 v_fmac_f32 v20, s29, v22
 v_fmac_f32 v21, s29, v23
 v_readlane_b32 s29, v11, 36
 v_lshlrev_b32 v22, 16, v132
 v_and_b32 v23, 0xffff0000, v132
 v_fmac_f32 v20, s29, v22
 v_fmac_f32 v21, s29, v23
 v_readlane_b32 s29, v11, 37
 v_lshlrev_b32 v22, 16, v133
 v_and_b32 v23, 0xffff0000, v133
 v_fmac_f32 v20, s29, v22
 v_fmac_f32 v21, s29, v23
 v_readlane_b32 s29, v11, 38
 v_lshlrev_b32 v22, 16, v134
 v_and_b32 v23, 0xffff0000, v134
 v_fmac_f32 v20, s29, v22
 v_fmac_f32 v21, s29, v23
 v_readlane_b32 s29, v11, 39
 v_lshlrev_b32 v22, 16, v135
 v_and_b32 v23, 0xffff0000, v135
 v_fmac_f32 v20, s29, v22
 v_fmac_f32 v21, s29, v23
 v_readlane_b32 s29, v11, 40
 v_lshlrev_b32 v22, 16, v136
 v_and_b32 v23, 0xffff0000, v136
 v_fmac_f32 v20, s29, v22
 v_fmac_f32 v21, s29, v23
 v_readlane_b32 s29, v11, 41
 v_lshlrev_b32 v22, 16, v137
 v_and_b32 v23, 0xffff0000, v137
 v_fmac_f32 v20, s29, v22
 v_fmac_f32 v21, s29, v23
 v_readlane_b32 s29, v11, 42
 v_lshlrev_b32 v22, 16, v138
 v_and_b32 v23, 0xffff0000, v138
 v_fmac_f32 v20, s29, v22
 v_fmac_f32 v21, s29, v23
 v_readlane_b32 s29, v11, 43
 v_lshlrev_b32 v22, 16, v139
 v_and_b32 v23, 0xffff0000, v139
 v_fmac_f32 v20, s29, v22
 v_fmac_f32 v21, s29, v23
 v_readlane_b32 s29, v11, 44
 v_lshlrev_b32 v22, 16, v140
 v_and_b32 v23, 0xffff0000, v140
 v_fmac_f32 v20, s29, v22
 v_fmac_f32 v21, s29, v23
 v_readlane_b32 s29, v11, 45
 v_lshlrev_b32 v22, 16, v141
 v_and_b32 v23, 0xffff0000, v141
 v_fmac_f32 v20, s29, v22
 v_fmac_f32 v21, s29, v23
 v_readlane_b32 s29, v11, 46
 v_lshlrev_b32 v22, 16, v142
 v_and_b32 v23, 0xffff0000, v142
 v_fmac_f32 v20, s29, v22
 v_fmac_f32 v21, s29, v23
 v_readlane_b32 s29, v11, 47
 v_lshlrev_b32 v22, 16, v143
 v_and_b32 v23, 0xffff0000, v143
 v_fmac_f32 v20, s29, v22
 v_fmac_f32 v21, s29, v23
 v_readlane_b32 s29, v11, 48
 v_lshlrev_b32 v22, 16, v144
 v_and_b32 v23, 0xffff0000, v144
 v_fmac_f32 v20, s29, v22
 v_fmac_f32 v21, s29, v23
 v_readlane_b32 s29, v11, 49
 v_lshlrev_b32 v22, 16, v145
 v_and_b32 v23, 0xffff0000, v145
 v_fmac_f32 v20, s29, v22
 v_fmac_f32 v21, s29, v23
 v_readlane_b32 s29, v11, 50
 v_lshlrev_b32 v22, 16, v146
 v_and_b32 v23, 0xffff0000, v146
 v_fmac_f32 v20, s29, v22
 v_fmac_f32 v21, s29, v23
 v_readlane_b32 s29, v11, 51
 v_lshlrev_b32 v22, 16, v147
 v_and_b32 v23, 0xffff0000, v147
 v_fmac_f32 v20, s29, v22
 v_fmac_f32 v21, s29, v23
 v_readlane_b32 s29, v11, 52
 v_lshlrev_b32 v22, 16, v148
 v_and_b32 v23, 0xffff0000, v148
 v_fmac_f32 v20, s29, v22
 v_fmac_f32 v21, s29, v23
 v_readlane_b32 s29, v11, 53
 v_lshlrev_b32 v22, 16, v149
 v_and_b32 v23, 0xffff0000, v149
 v_fmac_f32 v20, s29, v22
 v_fmac_f32 v21, s29, v23
 v_readlane_b32 s29, v11, 54
 v_lshlrev_b32 v22, 16, v150
 v_and_b32 v23, 0xffff0000, v150
 v_fmac_f32 v20, s29, v22
 v_fmac_f32 v21, s29, v23
 v_readlane_b32 s29, v11, 55
 v_lshlrev_b32 v22, 16, v151
 v_and_b32 v23, 0xffff0000, v151
 v_fmac_f32 v20, s29, v22
 v_fmac_f32 v21, s29, v23
 v_readlane_b32 s29, v11, 56
 v_lshlrev_b32 v22, 16, v152
 v_and_b32 v23, 0xffff0000, v152
 v_fmac_f32 v20, s29, v22
 v_fmac_f32 v21, s29, v23
 v_readlane_b32 s29, v11, 57
 v_lshlrev_b32 v22, 16, v153
 v_and_b32 v23, 0xffff0000, v153
 v_fmac_f32 v20, s29, v22
 v_fmac_f32 v21, s29, v23
 v_readlane_b32 s29, v11, 58
 v_lshlrev_b32 v22, 16, v154
 v_and_b32 v23, 0xffff0000, v154
 v_fmac_f32 v20, s29, v22
 v_fmac_f32 v21, s29, v23
 v_readlane_b32 s29, v11, 59
 v_lshlrev_b32 v22, 16, v155
 v_and_b32 v23, 0xffff0000, v155
 v_fmac_f32 v20, s29, v22
 v_fmac_f32 v21, s29, v23
 v_readlane_b32 s29, v11, 60
 v_lshlrev_b32 v22, 16, v156
 v_and_b32 v23, 0xffff0000, v156
 v_fmac_f32 v20, s29, v22
 v_fmac_f32 v21, s29, v23
 v_readlane_b32 s29, v11, 61
 v_lshlrev_b32 v22, 16, v157
 v_and_b32 v23, 0xffff0000, v157
 v_fmac_f32 v20, s29, v22
 v_fmac_f32 v21, s29, v23
 v_readlane_b32 s29, v11, 62
 v_lshlrev_b32 v22, 16, v158
 v_and_b32 v23, 0xffff0000, v158
 v_fmac_f32 v20, s29, v22
 v_fmac_f32 v21, s29, v23
 v_readlane_b32 s29, v11, 63
 v_lshlrev_b32 v22, 16, v159
 v_and_b32 v23, 0xffff0000, v159
 v_fmac_f32 v20, s29, v22
 v_fmac_f32 v21, s29, v23
 v_readlane_b32 s29, v12, 0
 v_lshlrev_b32 v22, 16, v160
 v_and_b32 v23, 0xffff0000, v160
 v_fmac_f32 v20, s29, v22
 v_fmac_f32 v21, s29, v23
 v_readlane_b32 s29, v12, 1
 v_lshlrev_b32 v22, 16, v161
 v_and_b32 v23, 0xffff0000, v161
 v_fmac_f32 v20, s29, v22
 v_fmac_f32 v21, s29, v23
 v_readlane_b32 s29, v12, 2
 v_lshlrev_b32 v22, 16, v162
 v_and_b32 v23, 0xffff0000, v162
 v_fmac_f32 v20, s29, v22
 v_fmac_f32 v21, s29, v23
 v_readlane_b32 s29, v12, 3
 v_lshlrev_b32 v22, 16, v163
 v_and_b32 v23, 0xffff0000, v163
 v_fmac_f32 v20, s29, v22
 v_fmac_f32 v21, s29, v23
 v_readlane_b32 s29, v12, 4
 v_lshlrev_b32 v22, 16, v164
 v_and_b32 v23, 0xffff0000, v164
 v_fmac_f32 v20, s29, v22
 v_fmac_f32 v21, s29, v23
 v_readlane_b32 s29, v12, 5
 v_lshlrev_b32 v22, 16, v165
 v_and_b32 v23, 0xffff0000, v165
 v_fmac_f32 v20, s29, v22
 v_fmac_f32 v21, s29, v23
 v_readlane_b32 s29, v12, 6
 v_lshlrev_b32 v22, 16, v166
 v_and_b32 v23, 0xffff0000, v166
 v_fmac_f32 v20, s29, v22
 v_fmac_f32 v21, s29, v23
 v_readlane_b32 s29, v12, 7
 v_lshlrev_b32 v22, 16, v167
 v_and_b32 v23, 0xffff0000, v167
 v_fmac_f32 v20, s29, v22
 v_fmac_f32 v21, s29, v23
 v_readlane_b32 s29, v12, 8
 v_lshlrev_b32 v22, 16, v168
 v_and_b32 v23, 0xffff0000, v168
 v_fmac_f32 v20, s29, v22
 v_fmac_f32 v21, s29, v23
 v_readlane_b32 s29, v12, 9
 v_lshlrev_b32 v22, 16, v169
 v_and_b32 v23, 0xffff0000, v169
 v_fmac_f32 v20, s29, v22
 v_fmac_f32 v21, s29, v23
 v_readlane_b32 s29, v12, 10
 v_lshlrev_b32 v22, 16, v170
 v_and_b32 v23, 0xffff0000, v170
 v_fmac_f32 v20, s29, v22
 v_fmac_f32 v21, s29, v23
 v_readlane_b32 s29, v12, 11
 v_lshlrev_b32 v22, 16, v171
 v_and_b32 v23, 0xffff0000, v171
 v_fmac_f32 v20, s29, v22
 v_fmac_f32 v21, s29, v23
 v_readlane_b32 s29, v12, 12
 v_lshlrev_b32 v22, 16, v172
 v_and_b32 v23, 0xffff0000, v172
 v_fmac_f32 v20, s29, v22
 v_fmac_f32 v21, s29, v23
 v_readlane_b32 s29, v12, 13
 v_lshlrev_b32 v22, 16, v173
 v_and_b32 v23, 0xffff0000, v173
 v_fmac_f32 v20, s29, v22
 v_fmac_f32 v21, s29, v23
 v_readlane_b32 s29, v12, 14
 v_lshlrev_b32 v22, 16, v174
 v_and_b32 v23, 0xffff0000, v174
 v_fmac_f32 v20, s29, v22
 v_fmac_f32 v21, s29, v23
 v_readlane_b32 s29, v12, 15
 v_lshlrev_b32 v22, 16, v175
 v_and_b32 v23, 0xffff0000, v175
 v_fmac_f32 v20, s29, v22
 v_fmac_f32 v21, s29, v23
 v_lshlrev_b32 v5, 3, v0
 ds_write_b64 v5, v[20:21]
 s_waitcnt lgkmcnt(0)
 s_barrier
 s_cmp_lg_u32 s24, 0
 s_cbranch_scc1 mega_kernel_end122
 ds_read_b64 v[24:25], v5 offset:512
 ds_read_b64 v[26:27], v5 offset:1024
 ds_read_b64 v[28:29], v5 offset:1536
 s_waitcnt lgkmcnt(0)
 v_add_f32 v20, v20, v24
 v_add_f32 v21, v21, v25
 v_add_f32 v26, v26, v28
 v_add_f32 v27, v27, v29
 v_add_f32 v20, v20, v26
 v_add_f32 v21, v21, v27
 v_cvt_pk_bf16_f32 v22, v20, v21
 v_lshlrev_b32 v20, 16, v22
 v_and_b32 v21, 0xffff0000, v22
 v_lshrrev_b32 v6, 1, v4
 v_add_f32 v24, 1.0, v20
 v_add_f32 v25, 1.0, v21
 v_cvt_pk_bf16_f32 v22, v24, v25
 v_lshlrev_b32 v24, 16, v22
 v_and_b32 v25, 0xffff0000, v22
 v_subrev_u32 v7, 576, v6
 s_movk_i32 s34, 576
 v_cmp_gt_u32 s[32:33], s34, v7
 v_subrev_u32 v7, 2304, v6
 v_cmp_gt_u32 s[36:37], s34, v7
 s_nop 1
 s_or_b64 s[32:33], s[32:33], s[36:37]
 v_cndmask_b32 v20, v20, v24, s[32:33]
 v_cndmask_b32 v21, v21, v25, s[32:33]
 v_lshlrev_b32 v6, 2, v6
 buffer_store_dwordx2 v[20:21], v6, s[20:23], 0 offen sc1
mega_kernel_end122:
 s_branch mega_kernel_sig91
mega_kernel_bfill101:
 s_load_dwordx2 s[8:9], s[0:1], 120
 s_waitcnt lgkmcnt(0)
 s_add_u32 s12, s8, 117440512
 s_addc_u32 s13, s9, 0
 s_and_b32 s13, s13, 0xffff
 s_mov_b32 s14, 2621440
 s_mov_b32 s15, 0x00020000
 s_lshl_b32 s24, s2, 19
 v_lshlrev_b32 v1, 4, v0
 v_mov_b32 v4, -1
 v_mov_b32 v5, -1
 v_mov_b32 v6, -1
 v_mov_b32 v7, -1
 s_mov_b32 s25, 0
mega_kernel_fl123:
 buffer_store_dwordx4 v[4:7], v1, s[12:15], s24 offen sc1
 s_add_u32 s24, s24, 4096
 buffer_store_dwordx4 v[4:7], v1, s[12:15], s24 offen sc1
 s_add_u32 s24, s24, 4096
 buffer_store_dwordx4 v[4:7], v1, s[12:15], s24 offen sc1
 s_add_u32 s24, s24, 4096
 buffer_store_dwordx4 v[4:7], v1, s[12:15], s24 offen sc1
 s_add_u32 s24, s24, 4096
 buffer_store_dwordx4 v[4:7], v1, s[12:15], s24 offen sc1
 s_add_u32 s24, s24, 4096
 buffer_store_dwordx4 v[4:7], v1, s[12:15], s24 offen sc1
 s_add_u32 s24, s24, 4096
 buffer_store_dwordx4 v[4:7], v1, s[12:15], s24 offen sc1
 s_add_u32 s24, s24, 4096
 buffer_store_dwordx4 v[4:7], v1, s[12:15], s24 offen sc1
 s_add_u32 s24, s24, 4096
 s_add_u32 s25, s25, 1
 s_cmp_lt_u32 s25, 16
 s_cbranch_scc1 mega_kernel_fl123
 s_branch mega_kernel_sig91
mega_kernel_bln1102:
 s_load_dwordx2 s[4:5], s[0:1], 0
 s_load_dwordx2 s[8:9], s[0:1], 120
 s_load_dwordx2 s[6:7], s[0:1], 8
 s_waitcnt lgkmcnt(0)
 s_mov_b32 s12, s4
 s_and_b32 s13, s5, 0xffff
 s_mov_b32 s14, 2359296
 s_mov_b32 s15, 0x00020000
 s_add_u32 s16, s8, 0
 s_addc_u32 s17, s9, 0
 s_and_b32 s17, s17, 0xffff
 s_mov_b32 s18, 13824
 s_mov_b32 s19, 0x00020000
 s_add_u32 s20, s8, 1048576
 s_addc_u32 s21, s9, 0
 s_and_b32 s21, s21, 0xffff
 s_mov_b32 s22, 2359296
 s_mov_b32 s23, 0x00020000
 s_cmp_lg_u32 s2, 0
 s_cbranch_scc1 mega_kernel_nc124
 s_mov_b32 s24, s6
 s_and_b32 s25, s7, 0xffff
 s_mov_b32 s26, 9216
 s_mov_b32 s27, 0x00020000
 s_add_u32 s28, s8, 120061952
 s_addc_u32 s29, s9, 0
 s_and_b32 s29, s29, 0xffff
 s_mov_b32 s30, 9216
 s_mov_b32 s31, 0x00020000
 s_mov_b32 s33, 58255
 v_add_u32 v1, 0, v0
 v_lshlrev_b32 v2, 4, v1
 buffer_load_dwordx4 v[8:11], v2, s[24:27], 0 offen
 v_mul_lo_u32 v3, v1, s33
 v_lshrrev_b32 v3, 22, v3
 v_mul_u32_u24 v4, 72, v3
 v_sub_u32 v4, v1, v4
 v_lshrrev_b32 v5, 1, v4
 v_lshlrev_b32 v5, 8, v5
 v_lshl_add_u32 v5, v3, 5, v5
 v_and_b32 v4, 1, v4
 v_lshl_add_u32 v20, v4, 4, v5
 v_add_u32 v1, 256, v0
 v_lshlrev_b32 v2, 4, v1
 buffer_load_dwordx4 v[12:15], v2, s[24:27], 0 offen
 v_mul_lo_u32 v3, v1, s33
 v_lshrrev_b32 v3, 22, v3
 v_mul_u32_u24 v4, 72, v3
 v_sub_u32 v4, v1, v4
 v_lshrrev_b32 v5, 1, v4
 v_lshlrev_b32 v5, 8, v5
 v_lshl_add_u32 v5, v3, 5, v5
 v_and_b32 v4, 1, v4
 v_lshl_add_u32 v21, v4, 4, v5
 v_add_u32 v1, 512, v0
 v_lshlrev_b32 v2, 4, v1
 buffer_load_dwordx4 v[16:19], v2, s[24:27], 0 offen
 v_mul_lo_u32 v3, v1, s33
 v_lshrrev_b32 v3, 22, v3
 v_mul_u32_u24 v4, 72, v3
 v_sub_u32 v4, v1, v4
 v_lshrrev_b32 v5, 1, v4
 v_lshlrev_b32 v5, 8, v5
 v_lshl_add_u32 v5, v3, 5, v5
 v_and_b32 v4, 1, v4
 v_lshl_add_u32 v22, v4, 4, v5
 v_cmp_gt_u32 vcc, 64, v0
 v_mov_b32 v6, 0x10000
 v_cndmask_b32 v22, v6, v22, vcc
 s_waitcnt vmcnt(0)
 buffer_store_dwordx4 v[8:11], v20, s[28:31], 0 offen sc1
 buffer_store_dwordx4 v[12:15], v21, s[28:31], 0 offen sc1
 buffer_store_dwordx4 v[16:19], v22, s[28:31], 0 offen sc1
 s_waitcnt vmcnt(0)
mega_kernel_nc124:
 v_lshrrev_b32 v1, 5, v0
 s_lshl_b32 s32, s2, 3
 v_add_u32 v1, s32, v1
 s_movk_i32 s33, 1152
 v_mul_lo_u32 v4, v1, s33
 v_and_b32 v2, 31, v0
 v_lshl_add_u32 v1, v2, 2, v4
 v_lshlrev_b32 v3, 3, v2
 v_lshl_add_u32 v4, v4, 1, v3
 buffer_load_dword v8, v1, s[12:15], 0 offen offset:0
 buffer_load_dword v9, v1, s[12:15], 0 offen offset:128
 buffer_load_dword v10, v1, s[12:15], 0 offen offset:256
 buffer_load_dword v11, v1, s[12:15], 0 offen offset:384
 buffer_load_dword v12, v1, s[12:15], 0 offen offset:512
 buffer_load_dword v13, v1, s[12:15], 0 offen offset:640
 buffer_load_dword v14, v1, s[12:15], 0 offen offset:768
 buffer_load_dword v15, v1, s[12:15], 0 offen offset:896
 buffer_load_dword v16, v1, s[12:15], 0 offen offset:1024
 s_mov_b32 s41, 2304
 buffer_load_dwordx2 v[20:21], v3, s[16:19], s41 offen offset:0
 buffer_load_dwordx2 v[22:23], v3, s[16:19], s41 offen offset:256
 buffer_load_dwordx2 v[24:25], v3, s[16:19], s41 offen offset:512
 buffer_load_dwordx2 v[26:27], v3, s[16:19], s41 offen offset:768
 buffer_load_dwordx2 v[28:29], v3, s[16:19], s41 offen offset:1024
 buffer_load_dwordx2 v[30:31], v3, s[16:19], s41 offen offset:1280
 buffer_load_dwordx2 v[32:33], v3, s[16:19], s41 offen offset:1536
 buffer_load_dwordx2 v[34:35], v3, s[16:19], s41 offen offset:1792
 buffer_load_dwordx2 v[36:37], v3, s[16:19], s41 offen offset:2048
 s_mov_b32 s41, 0
 buffer_load_dwordx2 v[40:41], v3, s[16:19], s41 offen offset:0
 buffer_load_dwordx2 v[42:43], v3, s[16:19], s41 offen offset:256
 buffer_load_dwordx2 v[44:45], v3, s[16:19], s41 offen offset:512
 buffer_load_dwordx2 v[46:47], v3, s[16:19], s41 offen offset:768
 buffer_load_dwordx2 v[48:49], v3, s[16:19], s41 offen offset:1024
 buffer_load_dwordx2 v[50:51], v3, s[16:19], s41 offen offset:1280
 buffer_load_dwordx2 v[52:53], v3, s[16:19], s41 offen offset:1536
 buffer_load_dwordx2 v[54:55], v3, s[16:19], s41 offen offset:1792
 buffer_load_dwordx2 v[56:57], v3, s[16:19], s41 offen offset:2048
 s_waitcnt vmcnt(18)
 v_mov_b32 v60, 0
 v_mov_b32 v61, 0
 v_lshlrev_b32 v62, 16, v8
 v_and_b32 v63, 0xffff0000, v8
 v_add_f32 v60, v60, v62
 v_add_f32 v61, v61, v63
 v_lshlrev_b32 v62, 16, v9
 v_and_b32 v63, 0xffff0000, v9
 v_add_f32 v60, v60, v62
 v_add_f32 v61, v61, v63
 v_lshlrev_b32 v62, 16, v10
 v_and_b32 v63, 0xffff0000, v10
 v_add_f32 v60, v60, v62
 v_add_f32 v61, v61, v63
 v_lshlrev_b32 v62, 16, v11
 v_and_b32 v63, 0xffff0000, v11
 v_add_f32 v60, v60, v62
 v_add_f32 v61, v61, v63
 v_lshlrev_b32 v62, 16, v12
 v_and_b32 v63, 0xffff0000, v12
 v_add_f32 v60, v60, v62
 v_add_f32 v61, v61, v63
 v_lshlrev_b32 v62, 16, v13
 v_and_b32 v63, 0xffff0000, v13
 v_add_f32 v60, v60, v62
 v_add_f32 v61, v61, v63
 v_lshlrev_b32 v62, 16, v14
 v_and_b32 v63, 0xffff0000, v14
 v_add_f32 v60, v60, v62
 v_add_f32 v61, v61, v63
 v_lshlrev_b32 v62, 16, v15
 v_and_b32 v63, 0xffff0000, v15
 v_add_f32 v60, v60, v62
 v_add_f32 v61, v61, v63
 v_lshlrev_b32 v62, 16, v16
 v_and_b32 v63, 0xffff0000, v16
 v_add_f32 v60, v60, v62
 v_add_f32 v61, v61, v63
 v_add_f32 v60, v60, v61
 ds_swizzle_b32 v62, v60 offset:1055
 s_waitcnt lgkmcnt(0)
 v_add_f32 v60, v60, v62
 ds_swizzle_b32 v62, v60 offset:2079
 s_waitcnt lgkmcnt(0)
 v_add_f32 v60, v60, v62
 ds_swizzle_b32 v62, v60 offset:4127
 s_waitcnt lgkmcnt(0)
 v_add_f32 v60, v60, v62
 ds_swizzle_b32 v62, v60 offset:8223
 s_waitcnt lgkmcnt(0)
 v_add_f32 v60, v60, v62
 ds_swizzle_b32 v62, v60 offset:16415
 s_waitcnt lgkmcnt(0)
 v_add_f32 v60, v60, v62
 s_mov_b32 s40, 0x3ae38e39
 v_mul_f32 v60, s40, v60
 v_mov_b32 v61, 0
 v_mov_b32 v64, 0
 v_lshlrev_b32 v62, 16, v8
 v_and_b32 v63, 0xffff0000, v8
 v_sub_f32 v62, v62, v60
 v_sub_f32 v63, v63, v60
 v_fmac_f32 v61, v62, v62
 v_fmac_f32 v64, v63, v63
 v_lshlrev_b32 v62, 16, v9
 v_and_b32 v63, 0xffff0000, v9
 v_sub_f32 v62, v62, v60
 v_sub_f32 v63, v63, v60
 v_fmac_f32 v61, v62, v62
 v_fmac_f32 v64, v63, v63
 v_lshlrev_b32 v62, 16, v10
 v_and_b32 v63, 0xffff0000, v10
 v_sub_f32 v62, v62, v60
 v_sub_f32 v63, v63, v60
 v_fmac_f32 v61, v62, v62
 v_fmac_f32 v64, v63, v63
 v_lshlrev_b32 v62, 16, v11
 v_and_b32 v63, 0xffff0000, v11
 v_sub_f32 v62, v62, v60
 v_sub_f32 v63, v63, v60
 v_fmac_f32 v61, v62, v62
 v_fmac_f32 v64, v63, v63
 v_lshlrev_b32 v62, 16, v12
 v_and_b32 v63, 0xffff0000, v12
 v_sub_f32 v62, v62, v60
 v_sub_f32 v63, v63, v60
 v_fmac_f32 v61, v62, v62
 v_fmac_f32 v64, v63, v63
 v_lshlrev_b32 v62, 16, v13
 v_and_b32 v63, 0xffff0000, v13
 v_sub_f32 v62, v62, v60
 v_sub_f32 v63, v63, v60
 v_fmac_f32 v61, v62, v62
 v_fmac_f32 v64, v63, v63
 v_lshlrev_b32 v62, 16, v14
 v_and_b32 v63, 0xffff0000, v14
 v_sub_f32 v62, v62, v60
 v_sub_f32 v63, v63, v60
 v_fmac_f32 v61, v62, v62
 v_fmac_f32 v64, v63, v63
 v_lshlrev_b32 v62, 16, v15
 v_and_b32 v63, 0xffff0000, v15
 v_sub_f32 v62, v62, v60
 v_sub_f32 v63, v63, v60
 v_fmac_f32 v61, v62, v62
 v_fmac_f32 v64, v63, v63
 v_lshlrev_b32 v62, 16, v16
 v_and_b32 v63, 0xffff0000, v16
 v_sub_f32 v62, v62, v60
 v_sub_f32 v63, v63, v60
 v_fmac_f32 v61, v62, v62
 v_fmac_f32 v64, v63, v63
 v_add_f32 v61, v61, v64
 ds_swizzle_b32 v62, v61 offset:1055
 s_waitcnt lgkmcnt(0)
 v_add_f32 v61, v61, v62
 ds_swizzle_b32 v62, v61 offset:2079
 s_waitcnt lgkmcnt(0)
 v_add_f32 v61, v61, v62
 ds_swizzle_b32 v62, v61 offset:4127
 s_waitcnt lgkmcnt(0)
 v_add_f32 v61, v61, v62
 ds_swizzle_b32 v62, v61 offset:8223
 s_waitcnt lgkmcnt(0)
 v_add_f32 v61, v61, v62
 ds_swizzle_b32 v62, v61 offset:16415
 s_waitcnt lgkmcnt(0)
 v_add_f32 v61, v61, v62
 v_mul_f32 v61, s40, v61
 v_cvt_pk_bf16_f32 v62, v60, v61
 v_lshlrev_b32 v60, 16, v62
 v_and_b32 v61, 0xffff0000, v62
 v_add_f32 v61, 0x3727c5ac, v61
 v_cvt_pk_bf16_f32 v62, v61, v61
 v_lshlrev_b32 v61, 16, v62
 v_sqrt_f32 v61, v61
 s_nop 0
 v_cvt_pk_bf16_f32 v62, v61, v61
 v_lshlrev_b32 v61, 16, v62
 v_rcp_f32 v64, v61
 s_waitcnt vmcnt(0)
 v_lshlrev_b32 v62, 16, v8
 v_and_b32 v63, 0xffff0000, v8
 v_sub_f32 v62, v62, v60
 v_sub_f32 v63, v63, v60
 v_cvt_pk_bf16_f32 v65, v62, v63
 v_lshlrev_b32 v62, 16, v65
 v_and_b32 v63, 0xffff0000, v65
 v_mul_f32 v66, v62, v64
 v_mul_f32 v67, v63, v64
 v_fma_f32 v68, -v66, v61, v62
 v_fma_f32 v69, -v67, v61, v63
 v_fma_f32 v66, v68, v64, v66
 v_fma_f32 v67, v69, v64, v67
 v_cvt_pk_bf16_f32 v65, v66, v67
 v_lshlrev_b32 v62, 16, v65
 v_and_b32 v63, 0xffff0000, v65
 v_mul_f32 v62, v62, v20
 v_mul_f32 v63, v63, v21
 v_cvt_pk_bf16_f32 v65, v62, v63
 v_lshlrev_b32 v62, 16, v65
 v_and_b32 v63, 0xffff0000, v65
 v_add_f32 v62, v62, v40
 v_add_f32 v63, v63, v41
 v_cvt_pk_bf16_f32 v8, v62, v63
 v_lshlrev_b32 v62, 16, v9
 v_and_b32 v63, 0xffff0000, v9
 v_sub_f32 v62, v62, v60
 v_sub_f32 v63, v63, v60
 v_cvt_pk_bf16_f32 v65, v62, v63
 v_lshlrev_b32 v62, 16, v65
 v_and_b32 v63, 0xffff0000, v65
 v_mul_f32 v66, v62, v64
 v_mul_f32 v67, v63, v64
 v_fma_f32 v68, -v66, v61, v62
 v_fma_f32 v69, -v67, v61, v63
 v_fma_f32 v66, v68, v64, v66
 v_fma_f32 v67, v69, v64, v67
 v_cvt_pk_bf16_f32 v65, v66, v67
 v_lshlrev_b32 v62, 16, v65
 v_and_b32 v63, 0xffff0000, v65
 v_mul_f32 v62, v62, v22
 v_mul_f32 v63, v63, v23
 v_cvt_pk_bf16_f32 v65, v62, v63
 v_lshlrev_b32 v62, 16, v65
 v_and_b32 v63, 0xffff0000, v65
 v_add_f32 v62, v62, v42
 v_add_f32 v63, v63, v43
 v_cvt_pk_bf16_f32 v9, v62, v63
 v_lshlrev_b32 v62, 16, v10
 v_and_b32 v63, 0xffff0000, v10
 v_sub_f32 v62, v62, v60
 v_sub_f32 v63, v63, v60
 v_cvt_pk_bf16_f32 v65, v62, v63
 v_lshlrev_b32 v62, 16, v65
 v_and_b32 v63, 0xffff0000, v65
 v_mul_f32 v66, v62, v64
 v_mul_f32 v67, v63, v64
 v_fma_f32 v68, -v66, v61, v62
 v_fma_f32 v69, -v67, v61, v63
 v_fma_f32 v66, v68, v64, v66
 v_fma_f32 v67, v69, v64, v67
 v_cvt_pk_bf16_f32 v65, v66, v67
 v_lshlrev_b32 v62, 16, v65
 v_and_b32 v63, 0xffff0000, v65
 v_mul_f32 v62, v62, v24
 v_mul_f32 v63, v63, v25
 v_cvt_pk_bf16_f32 v65, v62, v63
 v_lshlrev_b32 v62, 16, v65
 v_and_b32 v63, 0xffff0000, v65
 v_add_f32 v62, v62, v44
 v_add_f32 v63, v63, v45
 v_cvt_pk_bf16_f32 v10, v62, v63
 v_lshlrev_b32 v62, 16, v11
 v_and_b32 v63, 0xffff0000, v11
 v_sub_f32 v62, v62, v60
 v_sub_f32 v63, v63, v60
 v_cvt_pk_bf16_f32 v65, v62, v63
 v_lshlrev_b32 v62, 16, v65
 v_and_b32 v63, 0xffff0000, v65
 v_mul_f32 v66, v62, v64
 v_mul_f32 v67, v63, v64
 v_fma_f32 v68, -v66, v61, v62
 v_fma_f32 v69, -v67, v61, v63
 v_fma_f32 v66, v68, v64, v66
 v_fma_f32 v67, v69, v64, v67
 v_cvt_pk_bf16_f32 v65, v66, v67
 v_lshlrev_b32 v62, 16, v65
 v_and_b32 v63, 0xffff0000, v65
 v_mul_f32 v62, v62, v26
 v_mul_f32 v63, v63, v27
 v_cvt_pk_bf16_f32 v65, v62, v63
 v_lshlrev_b32 v62, 16, v65
 v_and_b32 v63, 0xffff0000, v65
 v_add_f32 v62, v62, v46
 v_add_f32 v63, v63, v47
 v_cvt_pk_bf16_f32 v11, v62, v63
 v_lshlrev_b32 v62, 16, v12
 v_and_b32 v63, 0xffff0000, v12
 v_sub_f32 v62, v62, v60
 v_sub_f32 v63, v63, v60
 v_cvt_pk_bf16_f32 v65, v62, v63
 v_lshlrev_b32 v62, 16, v65
 v_and_b32 v63, 0xffff0000, v65
 v_mul_f32 v66, v62, v64
 v_mul_f32 v67, v63, v64
 v_fma_f32 v68, -v66, v61, v62
 v_fma_f32 v69, -v67, v61, v63
 v_fma_f32 v66, v68, v64, v66
 v_fma_f32 v67, v69, v64, v67
 v_cvt_pk_bf16_f32 v65, v66, v67
 v_lshlrev_b32 v62, 16, v65
 v_and_b32 v63, 0xffff0000, v65
 v_mul_f32 v62, v62, v28
 v_mul_f32 v63, v63, v29
 v_cvt_pk_bf16_f32 v65, v62, v63
 v_lshlrev_b32 v62, 16, v65
 v_and_b32 v63, 0xffff0000, v65
 v_add_f32 v62, v62, v48
 v_add_f32 v63, v63, v49
 v_cvt_pk_bf16_f32 v12, v62, v63
 v_lshlrev_b32 v62, 16, v13
 v_and_b32 v63, 0xffff0000, v13
 v_sub_f32 v62, v62, v60
 v_sub_f32 v63, v63, v60
 v_cvt_pk_bf16_f32 v65, v62, v63
 v_lshlrev_b32 v62, 16, v65
 v_and_b32 v63, 0xffff0000, v65
 v_mul_f32 v66, v62, v64
 v_mul_f32 v67, v63, v64
 v_fma_f32 v68, -v66, v61, v62
 v_fma_f32 v69, -v67, v61, v63
 v_fma_f32 v66, v68, v64, v66
 v_fma_f32 v67, v69, v64, v67
 v_cvt_pk_bf16_f32 v65, v66, v67
 v_lshlrev_b32 v62, 16, v65
 v_and_b32 v63, 0xffff0000, v65
 v_mul_f32 v62, v62, v30
 v_mul_f32 v63, v63, v31
 v_cvt_pk_bf16_f32 v65, v62, v63
 v_lshlrev_b32 v62, 16, v65
 v_and_b32 v63, 0xffff0000, v65
 v_add_f32 v62, v62, v50
 v_add_f32 v63, v63, v51
 v_cvt_pk_bf16_f32 v13, v62, v63
 v_lshlrev_b32 v62, 16, v14
 v_and_b32 v63, 0xffff0000, v14
 v_sub_f32 v62, v62, v60
 v_sub_f32 v63, v63, v60
 v_cvt_pk_bf16_f32 v65, v62, v63
 v_lshlrev_b32 v62, 16, v65
 v_and_b32 v63, 0xffff0000, v65
 v_mul_f32 v66, v62, v64
 v_mul_f32 v67, v63, v64
 v_fma_f32 v68, -v66, v61, v62
 v_fma_f32 v69, -v67, v61, v63
 v_fma_f32 v66, v68, v64, v66
 v_fma_f32 v67, v69, v64, v67
 v_cvt_pk_bf16_f32 v65, v66, v67
 v_lshlrev_b32 v62, 16, v65
 v_and_b32 v63, 0xffff0000, v65
 v_mul_f32 v62, v62, v32
 v_mul_f32 v63, v63, v33
 v_cvt_pk_bf16_f32 v65, v62, v63
 v_lshlrev_b32 v62, 16, v65
 v_and_b32 v63, 0xffff0000, v65
 v_add_f32 v62, v62, v52
 v_add_f32 v63, v63, v53
 v_cvt_pk_bf16_f32 v14, v62, v63
 v_lshlrev_b32 v62, 16, v15
 v_and_b32 v63, 0xffff0000, v15
 v_sub_f32 v62, v62, v60
 v_sub_f32 v63, v63, v60
 v_cvt_pk_bf16_f32 v65, v62, v63
 v_lshlrev_b32 v62, 16, v65
 v_and_b32 v63, 0xffff0000, v65
 v_mul_f32 v66, v62, v64
 v_mul_f32 v67, v63, v64
 v_fma_f32 v68, -v66, v61, v62
 v_fma_f32 v69, -v67, v61, v63
 v_fma_f32 v66, v68, v64, v66
 v_fma_f32 v67, v69, v64, v67
 v_cvt_pk_bf16_f32 v65, v66, v67
 v_lshlrev_b32 v62, 16, v65
 v_and_b32 v63, 0xffff0000, v65
 v_mul_f32 v62, v62, v34
 v_mul_f32 v63, v63, v35
 v_cvt_pk_bf16_f32 v65, v62, v63
 v_lshlrev_b32 v62, 16, v65
 v_and_b32 v63, 0xffff0000, v65
 v_add_f32 v62, v62, v54
 v_add_f32 v63, v63, v55
 v_cvt_pk_bf16_f32 v15, v62, v63
 v_lshlrev_b32 v62, 16, v16
 v_and_b32 v63, 0xffff0000, v16
 v_sub_f32 v62, v62, v60
 v_sub_f32 v63, v63, v60
 v_cvt_pk_bf16_f32 v65, v62, v63
 v_lshlrev_b32 v62, 16, v65
 v_and_b32 v63, 0xffff0000, v65
 v_mul_f32 v66, v62, v64
 v_mul_f32 v67, v63, v64
 v_fma_f32 v68, -v66, v61, v62
 v_fma_f32 v69, -v67, v61, v63
 v_fma_f32 v66, v68, v64, v66
 v_fma_f32 v67, v69, v64, v67
 v_cvt_pk_bf16_f32 v65, v66, v67
 v_lshlrev_b32 v62, 16, v65
 v_and_b32 v63, 0xffff0000, v65
 v_mul_f32 v62, v62, v36
 v_mul_f32 v63, v63, v37
 v_cvt_pk_bf16_f32 v65, v62, v63
 v_lshlrev_b32 v62, 16, v65
 v_and_b32 v63, 0xffff0000, v65
 v_add_f32 v62, v62, v56
 v_add_f32 v63, v63, v57
 v_cvt_pk_bf16_f32 v16, v62, v63
 buffer_store_dword v8, v1, s[20:23], 0 offen offset:0 sc1
 buffer_store_dword v9, v1, s[20:23], 0 offen offset:128 sc1
 buffer_store_dword v10, v1, s[20:23], 0 offen offset:256 sc1
 buffer_store_dword v11, v1, s[20:23], 0 offen offset:384 sc1
 buffer_store_dword v12, v1, s[20:23], 0 offen offset:512 sc1
 buffer_store_dword v13, v1, s[20:23], 0 offen offset:640 sc1
 buffer_store_dword v14, v1, s[20:23], 0 offen offset:768 sc1
 buffer_store_dword v15, v1, s[20:23], 0 offen offset:896 sc1
 buffer_store_dword v16, v1, s[20:23], 0 offen offset:1024 sc1
 s_branch mega_kernel_sig91
mega_kernel_end1:
    s_endpgm
.section .rodata,"a"
.p2align 6
.amdhsa_kernel zero_kernel
  .amdhsa_next_free_vgpr 16
  .amdhsa_next_free_sgpr 24
  .amdhsa_accum_offset 16
  .amdhsa_group_segment_fixed_size 0
  .amdhsa_kernarg_size 128
  .amdhsa_user_sgpr_count 2
  .amdhsa_user_sgpr_kernarg_segment_ptr 1
  .amdhsa_system_sgpr_workgroup_id_x 1
  .amdhsa_float_denorm_mode_32 3
  .amdhsa_float_denorm_mode_16_64 3
.end_amdhsa_kernel
.p2align 6
.amdhsa_kernel mega_kernel
  .amdhsa_next_free_vgpr 512
  .amdhsa_next_free_sgpr 102
  .amdhsa_accum_offset 256
  .amdhsa_group_segment_fixed_size 0
  .amdhsa_kernarg_size 128
  .amdhsa_user_sgpr_count 2
  .amdhsa_user_sgpr_kernarg_segment_ptr 1
  .amdhsa_system_sgpr_workgroup_id_x 1
  .amdhsa_float_denorm_mode_32 3
  .amdhsa_float_denorm_mode_16_64 3
.end_amdhsa_kernel
```
